```python
import torch

def _softmax(x, axis=-1):
    return torch.softmax(x, dim=axis)
def _gelu(x):
    return torch.nn.functional.gelu(x, approximate="tanh")
def _silu(x):
    return torch.nn.functional.silu(x)
def _sigmoid(x):
    return torch.sigmoid(x)
def _layernorm(x, axis=-1, eps=1e-5):
    m = x.mean(dim=axis, keepdim=True)
    v = x.var(dim=axis, keepdim=True, unbiased=False)
    return (x - m) / torch.sqrt(v + eps)
def _scatter_add(tgt, idx, src, axis=0):
    return tgt.clone().index_add_(axis, idx, src)
def _segment_sum(src, seg, n):
    out = torch.zeros((n,) + src.shape[1:], dtype=src.dtype)
    return out.index_add_(0, seg, src)
def _pad(x, pw):
    flat = tuple(v for pair in reversed(pw) for v in pair)
    return torch.nn.functional.pad(x, flat)

kernel_name = 'sequential_preLN__ssm_conv_s4d__moe_arch_mod__prompt'

def setup_inputs():

    _w = (lambda a: (lambda t: t.to(torch.bfloat16) if t.is_floating_point() else t)(torch.as_tensor(a)))
    def _A_setup():
        Bsz, L, D, N = 1, 2048, 576, 128
        return {
            "u": _w((lambda *s: torch.randn(*s, dtype=torch.bfloat16) * 0.2)(Bsz, L, D)),
            "log_A_real": _w((lambda *s: torch.randn(*s, dtype=torch.bfloat16) * 6.4)(D, N) * 0.5),
            "A_imag": _w((lambda *s: torch.randn(*s, dtype=torch.bfloat16) * 0.2)(D, N) * 3.14),
            "C_real": _w((lambda *s: torch.randn(*s, dtype=torch.bfloat16) * 0.2)(D, N) / N ** 0.5),
            "C_imag": _w((lambda *s: torch.randn(*s, dtype=torch.bfloat16) * 0.2)(D, N) / N ** 0.5),
            "log_dt": _w((lambda *s: torch.randn(*s, dtype=torch.bfloat16) * 0.2)(D) * 0.5 - 4.0),
            "D_skip": _w((lambda *s: torch.randn(*s, dtype=torch.bfloat16) * 0.2)(D)),
        }
    _A_in = _A_setup()

    def _B_setup():
        B, S, D, F, C = 1, 2048, 576, 4608, 8
        return {
            "x": _w((lambda *s: torch.randn(*s, dtype=torch.bfloat16) * 0.2)(B, S, D)),
            "w_r": _w((lambda *s: torch.randn(*s, dtype=torch.bfloat16) * 0.2)(D)),
            "w_gate": _w((lambda *s: torch.randn(*s, dtype=torch.bfloat16) * 0.2)(D, F)),
            "w_up": _w((lambda *s: torch.randn(*s, dtype=torch.bfloat16) * 0.2)(D, F)),
            "w_down": _w((lambda *s: torch.randn(*s, dtype=torch.bfloat16) * 0.2)(F, D)),
        }
    _B_in = _B_setup()

    return {
        "A_u": _A_in["u"],
        "A_log_A_real": _A_in["log_A_real"],
        "A_A_imag": _A_in["A_imag"],
        "A_C_real": _A_in["C_real"],
        "A_C_imag": _A_in["C_imag"],
        "A_log_dt": _A_in["log_dt"],
        "A_D_skip": _A_in["D_skip"],
        "B_x": _B_in["x"],
        "B_w_r": _B_in["w_r"],
        "B_w_gate": _B_in["w_gate"],
        "B_w_up": _B_in["w_up"],
        "B_w_down": _B_in["w_down"],
    }

def reference(A_u, A_log_A_real, A_A_imag, A_C_real, A_C_imag, A_log_dt, A_D_skip, B_x, B_w_r, B_w_gate, B_w_up, B_w_down):
    def _A_ref(u, log_A_real, A_imag, C_real, C_imag, log_dt, D_skip):
        L = u.shape[1]
        dt = torch.exp(log_dt)
        A = -torch.exp(log_A_real) + 1j * A_imag
        C = (C_real + 1j * C_imag) * dt[:, None]
        pos = (lambda x, dt: x.to(dt))(torch.arange(L), log_dt.dtype)
        P = torch.exp((A * dt[:, None])[:, :, None] * pos[None, None, :])
        K = 2.0 * torch.einsum("dn,dnl->dl", C, P).real
        L2 = 2 * L
        u_t = (lambda x, *d: x.permute(*d))(u, 0, 2, 1)
        Kf = (lambda x, *a, **k: torch.fft.rfft(x.float(), *a, **k))(K, L2)
        Uf = (lambda x, *a, **k: torch.fft.rfft(x.float(), *a, **k))(u_t, L2)
        y = (lambda x, *a, **k: torch.fft.irfft(x, *a, **k).to(torch.bfloat16))(Uf * Kf[None, :, :], L2)[:, :, :L]
        y = (lambda x, *d: x.permute(*d))(y, 0, 2, 1)
        return y + u * D_skip[None, None, :]

    def _B_ref(x, w_r, w_gate, w_up, w_down):
        B, S, D = x.shape
        C = 8
        r = x @ w_r
        idx = torch.argsort(-r, axis=-1)[:, :C]
        idx_e = (lambda x, n, axis: torch.repeat_interleave(x, n, dim=axis))(idx.reshape(B, C, 1), D, axis=2)
        x_sel = (lambda x, i, axis: torch.take_along_dim(x, i, dim=axis))(x, idx_e, axis=1)
        g = _silu(x_sel @ w_gate)
        u = x_sel @ w_up
        y = (g * u) @ w_down
        r_sel = _sigmoid((lambda x, i, axis: torch.take_along_dim(x, i, dim=axis))(r, idx, axis=1))
        y = y * r_sel.reshape(B, C, 1)
        b_off = (torch.arange(B) * S).reshape(B, 1)
        flat_idx = (idx + b_off).reshape(B * C)
        zero = (x * 0.0).reshape(B * S, D)
        upd = _scatter_add(zero, flat_idx, y.reshape(B * C, D), axis=0)
        return x + upd.reshape(B, S, D)

    x = A_u
    h = x + _A_ref(_layernorm(x, axis=-1), A_log_A_real, A_A_imag, A_C_real, A_C_imag, A_log_dt, A_D_skip)
    h2 = h + _B_ref(_layernorm(h, axis=-1), B_w_r, B_w_gate, B_w_up, B_w_down)
    return h2
```

```asm
; @launch grid=(256,1,1) block=(1024,1,1) lds=113280
.amdgcn_target "amdgcn-amd-amdhsa--gfx950"
.text
.globl sequential_preLN__ssm_conv_s4d__moe_arch_mod__prompt_kernel
.p2align 8
.type sequential_preLN__ssm_conv_s4d__moe_arch_mod__prompt_kernel,@function
sequential_preLN__ssm_conv_s4d__moe_arch_mod__prompt_kernel:
    s_cmp_ge_u32 s2, 256
    s_cbranch_scc1 END
    s_load_dwordx16 s[4:19], s[0:1], 0
    s_load_dwordx2 s[30:31], s[0:1], 112
    s_load_dwordx8 s[20:27], s[0:1], 64
    s_load_dwordx2 s[28:29], s[0:1], 96
    v_lshrrev_b32 v2, 6, v0
    v_and_b32 v1, 63, v0
    v_readfirstlane_b32 s3, v2
    v_and_b32 v3, 15, v0
    v_lshrrev_b32 v5, 4, v1
    v_lshl_add_u32 v4, v2, 4, v3
    v_mul_u32_u24 v6, 6, v4
    v_and_b32 v6, -4, v6
    s_mul_i32 s32, s2, 9216
    v_mul_u32_u24 v7, 2304, v5
    v_add3_u32 v7, v7, v6, s32
    s_lshr_b32 s33, s3, 2
    s_mul_i32 s34, s2, 3
    s_add_u32 s34, s34, s33
    s_lshl_b32 s35, s34, 8
    v_lshl_add_u32 v8, v1, 2, s35
    s_lshl_b32 s35, s34, 1
    s_and_b32 s36, s35, -4
    s_cmp_ge_u32 s3, 12
    s_cbranch_scc1 HELP
    s_waitcnt lgkmcnt(0)
    global_load_dwordx2 v[10:11], v7, s[4:5]
    global_load_dwordx2 v[12:13], v7, s[4:5] offset:1152
    s_load_dword s48, s[30:31], 0
    s_cmp_ge_u32 s2, 192
    s_cbranch_scc1 NOPRM
    s_load_dword s37, s[14:15], s36
    global_load_dword v100, v8, s[6:7]
    global_load_dword v101, v8, s[8:9]
    global_load_dword v102, v8, s[10:11]
    global_load_dword v103, v8, s[12:13]
    global_load_dwordx2 v[14:15], v6, s[16:17]
    global_load_dwordx2 v[16:17], v6, s[20:21]
    s_branch PRM2
NOPRM:
    global_load_dwordx2 v[14:15], v6, s[16:17]
    global_load_dwordx2 v[16:17], v6, s[20:21]
    global_load_dword v100, v6, s[16:17]
    global_load_dword v101, v6, s[16:17]
    global_load_dword v102, v6, s[16:17]
    global_load_dword v103, v6, s[16:17]
PRM2:
    s_mov_b32 s40, s30
    s_and_b32 s41, s31, 0xffff
    s_mov_b32 s42, 0x10000000
    s_mov_b32 s43, 0x00020000
    v_and_b32 v18, 1, v0
    s_mov_b32 s38, 0x02020000
    v_mul_lo_u32 v18, v18, s38
    v_add_u32 v18, 0x01000c0c, v18
    v_add_u32 v19, s38, v18
    v_add_u32 v20, s38, v19
    v_lshl_add_u32 v21, v5, 4, v2
    v_lshlrev_b32 v21, 4, v21
    v_lshlrev_b32 v22, 4, v1
    v_lshlrev_b32 v23, 14, v4
    v_lshl_add_u32 v23, v5, 4, v23
    s_lshl_b32 s38, s2, 6
    s_add_u32 s38, s38, 4096
    s_mov_b32 s52, 0x3ae38e39
    s_mov_b32 s54, 0x00010001
    s_mov_b32 s55, 0x00010001
    s_waitcnt vmcnt(6)
    v_perm_b32 v24, v11, v10, v18
    v_perm_b32 v25, v13, v12, v18
    v_perm_b32 v26, v11, v10, v19
    v_perm_b32 v27, v13, v12, v19
    v_perm_b32 v28, v11, v10, v20
    v_perm_b32 v29, v13, v12, v20
    v_pk_add_f32 v[32:33], v[24:25], v[26:27]
    v_pk_mul_f32 v[34:35], v[24:25], v[24:25]
    v_pk_add_f32 v[32:33], v[32:33], v[28:29]
    v_pk_fma_f32 v[34:35], v[26:27], v[26:27], v[34:35]
    v_pk_fma_f32 v[34:35], v[28:29], v[28:29], v[34:35]
    v_add_f32_dpp v32, v32, v32 row_ror:8 row_mask:0xf bank_mask:0xf
    v_add_f32_dpp v33, v33, v33 row_ror:8 row_mask:0xf bank_mask:0xf
    v_add_f32_dpp v34, v34, v34 row_ror:8 row_mask:0xf bank_mask:0xf
    v_add_f32_dpp v35, v35, v35 row_ror:8 row_mask:0xf bank_mask:0xf
    v_add_f32_dpp v32, v32, v32 row_ror:4 row_mask:0xf bank_mask:0xf
    v_add_f32_dpp v33, v33, v33 row_ror:4 row_mask:0xf bank_mask:0xf
    v_add_f32_dpp v34, v34, v34 row_ror:4 row_mask:0xf bank_mask:0xf
    v_add_f32_dpp v35, v35, v35 row_ror:4 row_mask:0xf bank_mask:0xf
    v_add_f32_dpp v32, v32, v32 row_ror:2 row_mask:0xf bank_mask:0xf
    v_add_f32_dpp v33, v33, v33 row_ror:2 row_mask:0xf bank_mask:0xf
    v_add_f32_dpp v34, v34, v34 row_ror:2 row_mask:0xf bank_mask:0xf
    v_add_f32_dpp v35, v35, v35 row_ror:2 row_mask:0xf bank_mask:0xf
    v_add_f32_dpp v32, v32, v32 row_ror:1 row_mask:0xf bank_mask:0xf
    v_add_f32_dpp v33, v33, v33 row_ror:1 row_mask:0xf bank_mask:0xf
    v_add_f32_dpp v34, v34, v34 row_ror:1 row_mask:0xf bank_mask:0xf
    v_add_f32_dpp v35, v35, v35 row_ror:1 row_mask:0xf bank_mask:0xf
    s_mov_b64 exec, s[54:55]
    ds_write_b128 v21, v[32:35] offset:18304
    s_mov_b64 exec, -1
    s_waitcnt lgkmcnt(0)
    s_mul_i32 s48, s48, 1664525
    s_add_u32 s48, s48, 1013904223
    s_barrier
    ds_read_b128 v[32:35], v22 offset:18304
    v_mov_b32 v39, s48
    s_waitcnt lgkmcnt(0)
    v_add_f32_dpp v32, v32, v32 row_ror:8 row_mask:0xf bank_mask:0xf
    v_add_f32_dpp v33, v33, v33 row_ror:8 row_mask:0xf bank_mask:0xf
    v_add_f32_dpp v34, v34, v34 row_ror:8 row_mask:0xf bank_mask:0xf
    v_add_f32_dpp v35, v35, v35 row_ror:8 row_mask:0xf bank_mask:0xf
    v_add_f32_dpp v32, v32, v32 row_ror:4 row_mask:0xf bank_mask:0xf
    v_add_f32_dpp v33, v33, v33 row_ror:4 row_mask:0xf bank_mask:0xf
    v_add_f32_dpp v34, v34, v34 row_ror:4 row_mask:0xf bank_mask:0xf
    v_add_f32_dpp v35, v35, v35 row_ror:4 row_mask:0xf bank_mask:0xf
    v_add_f32_dpp v32, v32, v32 row_ror:2 row_mask:0xf bank_mask:0xf
    v_add_f32_dpp v33, v33, v33 row_ror:2 row_mask:0xf bank_mask:0xf
    v_add_f32_dpp v34, v34, v34 row_ror:2 row_mask:0xf bank_mask:0xf
    v_add_f32_dpp v35, v35, v35 row_ror:2 row_mask:0xf bank_mask:0xf
    v_add_f32_dpp v32, v32, v32 row_ror:1 row_mask:0xf bank_mask:0xf
    v_add_f32_dpp v33, v33, v33 row_ror:1 row_mask:0xf bank_mask:0xf
    v_add_f32_dpp v34, v34, v34 row_ror:1 row_mask:0xf bank_mask:0xf
    v_add_f32_dpp v35, v35, v35 row_ror:1 row_mask:0xf bank_mask:0xf
    v_pk_mul_f32 v[32:33], v[32:33], s[52:53] op_sel_hi:[1,0]
    v_pk_mul_f32 v[34:35], v[34:35], s[52:53] op_sel_hi:[1,0]
    v_pk_fma_f32 v[34:35], v[32:33], v[32:33], v[34:35] neg_lo:[1,0,0] neg_hi:[1,0,0]
    v_max_f32 v34, 0, v34
    v_max_f32 v35, 0, v35
    v_cvt_pk_bf16_f32 v30, v34, v35
    v_lshlrev_b32 v34, 16, v30
    v_and_b32 v35, 0xffff0000, v30
    v_add_f32 v34, 0x3727c5ac, v34
    v_add_f32 v35, 0x3727c5ac, v35
    v_cvt_pk_bf16_f32 v30, v34, v35
    v_lshlrev_b32 v34, 16, v30
    v_and_b32 v35, 0xffff0000, v30
    v_sqrt_f32 v34, v34
    v_sqrt_f32 v35, v35
    v_cvt_pk_bf16_f32 v31, v32, v33
    v_lshlrev_b32 v32, 16, v31
    v_and_b32 v33, 0xffff0000, v31
    v_cvt_pk_bf16_f32 v30, v34, v35
    v_lshlrev_b32 v34, 16, v30
    v_and_b32 v35, 0xffff0000, v30
    v_rcp_f32 v34, v34
    v_rcp_f32 v35, v35
    v_pk_add_f32 v[40:41], v[24:25], v[32:33] neg_lo:[0,1] neg_hi:[0,1]
    v_pk_add_f32 v[42:43], v[26:27], v[32:33] neg_lo:[0,1] neg_hi:[0,1]
    v_pk_add_f32 v[44:45], v[28:29], v[32:33] neg_lo:[0,1] neg_hi:[0,1]
    v_pk_mul_f32 v[46:47], v[40:41], v[34:35]
    v_pk_mul_f32 v[48:49], v[42:43], v[34:35]
    v_pk_mul_f32 v[50:51], v[44:45], v[34:35]
    v_cvt_pk_f16_f32 v36, v46, v47
    v_cvt_pk_f16_f32 v37, v48, v49
    v_cvt_pk_f16_f32 v38, v50, v51
    buffer_store_dwordx4 v[36:39], v23, s[40:43], s38 offen sc1
    s_waitcnt vmcnt(1)
    v_perm_b32 v52, v15, v14, v18
    v_perm_b32 v114, v17, v16, v18
    v_cvt_pk_bf16_f32 v108, v24, v25
    v_cvt_pk_bf16_f32 v30, v40, v41
    v_lshlrev_b32 v40, 16, v30
    v_and_b32 v41, 0xffff0000, v30
    v_pk_mul_f32 v[40:41], v[40:41], v[34:35]
    v_cvt_pk_bf16_f32 v30, v40, v41
    v_lshlrev_b32 v40, 16, v30
    v_and_b32 v41, 0xffff0000, v30
    v_mul_f32 v40, v40, v52
    v_mul_f32 v41, v41, v52
    v_cvt_pk_bf16_f32 v111, v40, v41
    v_perm_b32 v53, v15, v14, v19
    v_perm_b32 v115, v17, v16, v19
    v_cvt_pk_bf16_f32 v109, v26, v27
    v_cvt_pk_bf16_f32 v30, v42, v43
    v_lshlrev_b32 v42, 16, v30
    v_and_b32 v43, 0xffff0000, v30
    v_pk_mul_f32 v[42:43], v[42:43], v[34:35]
    v_cvt_pk_bf16_f32 v30, v42, v43
    v_lshlrev_b32 v42, 16, v30
    v_and_b32 v43, 0xffff0000, v30
    v_mul_f32 v42, v42, v53
    v_mul_f32 v43, v43, v53
    v_cvt_pk_bf16_f32 v112, v42, v43
    v_perm_b32 v54, v15, v14, v20
    v_perm_b32 v116, v17, v16, v20
    v_cvt_pk_bf16_f32 v110, v28, v29
    v_cvt_pk_bf16_f32 v30, v44, v45
    v_lshlrev_b32 v44, 16, v30
    v_and_b32 v45, 0xffff0000, v30
    v_pk_mul_f32 v[44:45], v[44:45], v[34:35]
    v_cvt_pk_bf16_f32 v30, v44, v45
    v_lshlrev_b32 v44, 16, v30
    v_and_b32 v45, 0xffff0000, v30
    v_mul_f32 v44, v44, v54
    v_mul_f32 v45, v45, v54
    v_cvt_pk_bf16_f32 v113, v44, v45
    v_add_f32 v30, v114, v115
    v_add_f32 v30, v30, v116
    s_nop 1
    v_add_f32_dpp v30, v30, v30 row_ror:8 row_mask:0xf bank_mask:0xf
    s_nop 1
    v_add_f32_dpp v30, v30, v30 row_ror:4 row_mask:0xf bank_mask:0xf
    s_nop 1
    v_add_f32_dpp v30, v30, v30 row_ror:2 row_mask:0xf bank_mask:0xf
    s_nop 1
    v_add_f32_dpp v30, v30, v30 row_ror:1 row_mask:0xf bank_mask:0xf
    v_lshlrev_b32 v31, 2, v2
    s_mov_b64 exec, 1
    ds_write_b32 v31, v30 offset:21376
    s_mov_b64 exec, -1
    s_cmp_ge_u32 s2, 192
    s_cbranch_scc1 SPARE
    s_waitcnt lgkmcnt(0)
    s_and_b32 s35, s35, 2
    s_lshl_b32 s35, s35, 3
    s_lshr_b32 s37, s37, s35
    s_lshl_b32 s37, s37, 16
    v_mov_b32 v28, 0x3fb8aa3b
    v_mul_f32 v29, s37, v28
    v_lshlrev_b32 v30, 16, v100
    v_and_b32 v31, 0xffff0000, v100
    v_exp_f32 v29, v29
    v_mul_f32 v30, v30, v28
    v_mul_f32 v31, v31, v28
    v_exp_f32 v30, v30
    v_exp_f32 v31, v31
    v_cvt_pk_bf16_f32 v29, v29, v29
    s_mul_i32 s39, s33, 28288
    v_lshl_add_u32 v9, v1, 3, s39
    v_lshlrev_b32 v29, 16, v29
    v_lshlrev_b32 v25, 16, v101
    v_and_b32 v27, 0xffff0000, v101
    v_cvt_pk_bf16_f32 v32, v30, v31
    v_lshlrev_b32 v30, 16, v32
    v_and_b32 v31, 0xffff0000, v32
    v_mul_f32 v33, 0xbfb8aa3b, v29
    v_mul_f32 v34, 0.15915494, v29
    v_mul_f32 v24, v30, v33
    v_mul_f32 v26, v31, v33
    v_mul_f32 v25, v25, v34
    v_mul_f32 v27, v27, v34
    v_rndne_f32 v30, v25
    v_rndne_f32 v31, v27
    v_sub_f32 v25, v25, v30
    v_sub_f32 v27, v27, v31
    s_add_u32 s39, s3, s33
    s_and_b32 s39, s39, 3
    s_cmp_ge_u32 s39, 2
    s_cbranch_scc1 KG_A
    s_mov_b32 s52, 0x41000000
    v_pk_mul_f32 v[48:49], v[24:25], s[52:53] op_sel_hi:[1,0]
    v_pk_mul_f32 v[50:51], v[26:27], s[52:53] op_sel_hi:[1,0]
    v_exp_f32 v48, v48
    v_cos_f32 v36, v49
    v_sin_f32 v37, v49
    v_exp_f32 v50, v50
    v_cos_f32 v38, v51
    v_sin_f32 v39, v51
    v_pk_mul_f32 v[36:37], v[36:37], v[48:49] op_sel_hi:[1,0]
    v_pk_mul_f32 v[38:39], v[38:39], v[50:51] op_sel_hi:[1,0]
    s_cmp_eq_u32 s39, 1
    s_cbranch_scc1 KG_B1
    v_mov_b32 v40, 1.0
    v_mov_b32 v41, 0
    v_mov_b32 v42, 1.0
    v_mov_b32 v43, 0
    s_branch KG_B2
KG_B1:
    s_mov_b32 s52, 0x43000000
    v_pk_mul_f32 v[48:49], v[24:25], s[52:53] op_sel_hi:[1,0]
    v_pk_mul_f32 v[50:51], v[26:27], s[52:53] op_sel_hi:[1,0]
    v_exp_f32 v48, v48
    v_cos_f32 v40, v49
    v_sin_f32 v41, v49
    v_exp_f32 v50, v50
    v_cos_f32 v42, v51
    v_sin_f32 v43, v51
    v_pk_mul_f32 v[40:41], v[40:41], v[48:49] op_sel_hi:[1,0]
    v_pk_mul_f32 v[42:43], v[42:43], v[50:51] op_sel_hi:[1,0]
    v_add_u32 v9, 8704, v9
KG_B2:
    v_pk_mul_f32 v[44:45], v[40:41], v[36:37] op_sel:[0,0] op_sel_hi:[1,0]
    v_pk_mul_f32 v[46:47], v[42:43], v[38:39] op_sel:[0,0] op_sel_hi:[1,0]
    v_pk_fma_f32 v[44:45], v[40:41], v[36:37], v[44:45] op_sel:[1,1,0] op_sel_hi:[0,1,1] neg_lo:[1,0,0]
    v_pk_fma_f32 v[46:47], v[42:43], v[38:39], v[46:47] op_sel:[1,1,0] op_sel_hi:[0,1,1] neg_lo:[1,0,0]
    v_cvt_pk_f16_f32 v92, v40, v41
    v_cvt_pk_f16_f32 v93, v42, v43
    ds_write_b64 v9, v[92:93] offset:39296
    v_pk_mul_f32 v[40:41], v[44:45], v[36:37] op_sel:[0,0] op_sel_hi:[1,0]
    v_pk_mul_f32 v[42:43], v[46:47], v[38:39] op_sel:[0,0] op_sel_hi:[1,0]
    v_pk_fma_f32 v[40:41], v[44:45], v[36:37], v[40:41] op_sel:[1,1,0] op_sel_hi:[0,1,1] neg_lo:[1,0,0]
    v_pk_fma_f32 v[42:43], v[46:47], v[38:39], v[42:43] op_sel:[1,1,0] op_sel_hi:[0,1,1] neg_lo:[1,0,0]
    v_cvt_pk_f16_f32 v94, v44, v45
    v_cvt_pk_f16_f32 v95, v46, v47
    ds_write_b64 v9, v[94:95] offset:39840
    v_pk_mul_f32 v[44:45], v[40:41], v[36:37] op_sel:[0,0] op_sel_hi:[1,0]
    v_pk_mul_f32 v[46:47], v[42:43], v[38:39] op_sel:[0,0] op_sel_hi:[1,0]
    v_pk_fma_f32 v[44:45], v[40:41], v[36:37], v[44:45] op_sel:[1,1,0] op_sel_hi:[0,1,1] neg_lo:[1,0,0]
    v_pk_fma_f32 v[46:47], v[42:43], v[38:39], v[46:47] op_sel:[1,1,0] op_sel_hi:[0,1,1] neg_lo:[1,0,0]
    v_cvt_pk_f16_f32 v96, v40, v41
    v_cvt_pk_f16_f32 v97, v42, v43
    ds_write_b64 v9, v[96:97] offset:40384
    v_pk_mul_f32 v[40:41], v[44:45], v[36:37] op_sel:[0,0] op_sel_hi:[1,0]
    v_pk_mul_f32 v[42:43], v[46:47], v[38:39] op_sel:[0,0] op_sel_hi:[1,0]
    v_pk_fma_f32 v[40:41], v[44:45], v[36:37], v[40:41] op_sel:[1,1,0] op_sel_hi:[0,1,1] neg_lo:[1,0,0]
    v_pk_fma_f32 v[42:43], v[46:47], v[38:39], v[42:43] op_sel:[1,1,0] op_sel_hi:[0,1,1] neg_lo:[1,0,0]
    v_cvt_pk_f16_f32 v98, v44, v45
    v_cvt_pk_f16_f32 v99, v46, v47
    ds_write_b64 v9, v[98:99] offset:40928
    v_pk_mul_f32 v[44:45], v[40:41], v[36:37] op_sel:[0,0] op_sel_hi:[1,0]
    v_pk_mul_f32 v[46:47], v[42:43], v[38:39] op_sel:[0,0] op_sel_hi:[1,0]
    v_pk_fma_f32 v[44:45], v[40:41], v[36:37], v[44:45] op_sel:[1,1,0] op_sel_hi:[0,1,1] neg_lo:[1,0,0]
    v_pk_fma_f32 v[46:47], v[42:43], v[38:39], v[46:47] op_sel:[1,1,0] op_sel_hi:[0,1,1] neg_lo:[1,0,0]
    v_cvt_pk_f16_f32 v92, v40, v41
    v_cvt_pk_f16_f32 v93, v42, v43
    ds_write_b64 v9, v[92:93] offset:41472
    v_pk_mul_f32 v[40:41], v[44:45], v[36:37] op_sel:[0,0] op_sel_hi:[1,0]
    v_pk_mul_f32 v[42:43], v[46:47], v[38:39] op_sel:[0,0] op_sel_hi:[1,0]
    v_pk_fma_f32 v[40:41], v[44:45], v[36:37], v[40:41] op_sel:[1,1,0] op_sel_hi:[0,1,1] neg_lo:[1,0,0]
    v_pk_fma_f32 v[42:43], v[46:47], v[38:39], v[42:43] op_sel:[1,1,0] op_sel_hi:[0,1,1] neg_lo:[1,0,0]
    v_cvt_pk_f16_f32 v94, v44, v45
    v_cvt_pk_f16_f32 v95, v46, v47
    ds_write_b64 v9, v[94:95] offset:42016
    v_pk_mul_f32 v[44:45], v[40:41], v[36:37] op_sel:[0,0] op_sel_hi:[1,0]
    v_pk_mul_f32 v[46:47], v[42:43], v[38:39] op_sel:[0,0] op_sel_hi:[1,0]
    v_pk_fma_f32 v[44:45], v[40:41], v[36:37], v[44:45] op_sel:[1,1,0] op_sel_hi:[0,1,1] neg_lo:[1,0,0]
    v_pk_fma_f32 v[46:47], v[42:43], v[38:39], v[46:47] op_sel:[1,1,0] op_sel_hi:[0,1,1] neg_lo:[1,0,0]
    v_cvt_pk_f16_f32 v96, v40, v41
    v_cvt_pk_f16_f32 v97, v42, v43
    ds_write_b64 v9, v[96:97] offset:42560
    v_pk_mul_f32 v[40:41], v[44:45], v[36:37] op_sel:[0,0] op_sel_hi:[1,0]
    v_pk_mul_f32 v[42:43], v[46:47], v[38:39] op_sel:[0,0] op_sel_hi:[1,0]
    v_pk_fma_f32 v[40:41], v[44:45], v[36:37], v[40:41] op_sel:[1,1,0] op_sel_hi:[0,1,1] neg_lo:[1,0,0]
    v_pk_fma_f32 v[42:43], v[46:47], v[38:39], v[42:43] op_sel:[1,1,0] op_sel_hi:[0,1,1] neg_lo:[1,0,0]
    v_cvt_pk_f16_f32 v98, v44, v45
    v_cvt_pk_f16_f32 v99, v46, v47
    ds_write_b64 v9, v[98:99] offset:43104
    v_pk_mul_f32 v[44:45], v[40:41], v[36:37] op_sel:[0,0] op_sel_hi:[1,0]
    v_pk_mul_f32 v[46:47], v[42:43], v[38:39] op_sel:[0,0] op_sel_hi:[1,0]
    v_pk_fma_f32 v[44:45], v[40:41], v[36:37], v[44:45] op_sel:[1,1,0] op_sel_hi:[0,1,1] neg_lo:[1,0,0]
    v_pk_fma_f32 v[46:47], v[42:43], v[38:39], v[46:47] op_sel:[1,1,0] op_sel_hi:[0,1,1] neg_lo:[1,0,0]
    v_cvt_pk_f16_f32 v92, v40, v41
    v_cvt_pk_f16_f32 v93, v42, v43
    ds_write_b64 v9, v[92:93] offset:43648
    v_pk_mul_f32 v[40:41], v[44:45], v[36:37] op_sel:[0,0] op_sel_hi:[1,0]
    v_pk_mul_f32 v[42:43], v[46:47], v[38:39] op_sel:[0,0] op_sel_hi:[1,0]
    v_pk_fma_f32 v[40:41], v[44:45], v[36:37], v[40:41] op_sel:[1,1,0] op_sel_hi:[0,1,1] neg_lo:[1,0,0]
    v_pk_fma_f32 v[42:43], v[46:47], v[38:39], v[42:43] op_sel:[1,1,0] op_sel_hi:[0,1,1] neg_lo:[1,0,0]
    v_cvt_pk_f16_f32 v94, v44, v45
    v_cvt_pk_f16_f32 v95, v46, v47
    ds_write_b64 v9, v[94:95] offset:44192
    v_pk_mul_f32 v[44:45], v[40:41], v[36:37] op_sel:[0,0] op_sel_hi:[1,0]
    v_pk_mul_f32 v[46:47], v[42:43], v[38:39] op_sel:[0,0] op_sel_hi:[1,0]
    v_pk_fma_f32 v[44:45], v[40:41], v[36:37], v[44:45] op_sel:[1,1,0] op_sel_hi:[0,1,1] neg_lo:[1,0,0]
    v_pk_fma_f32 v[46:47], v[42:43], v[38:39], v[46:47] op_sel:[1,1,0] op_sel_hi:[0,1,1] neg_lo:[1,0,0]
    v_cvt_pk_f16_f32 v96, v40, v41
    v_cvt_pk_f16_f32 v97, v42, v43
    ds_write_b64 v9, v[96:97] offset:44736
    v_pk_mul_f32 v[40:41], v[44:45], v[36:37] op_sel:[0,0] op_sel_hi:[1,0]
    v_pk_mul_f32 v[42:43], v[46:47], v[38:39] op_sel:[0,0] op_sel_hi:[1,0]
    v_pk_fma_f32 v[40:41], v[44:45], v[36:37], v[40:41] op_sel:[1,1,0] op_sel_hi:[0,1,1] neg_lo:[1,0,0]
    v_pk_fma_f32 v[42:43], v[46:47], v[38:39], v[42:43] op_sel:[1,1,0] op_sel_hi:[0,1,1] neg_lo:[1,0,0]
    v_cvt_pk_f16_f32 v98, v44, v45
    v_cvt_pk_f16_f32 v99, v46, v47
    ds_write_b64 v9, v[98:99] offset:45280
    v_pk_mul_f32 v[44:45], v[40:41], v[36:37] op_sel:[0,0] op_sel_hi:[1,0]
    v_pk_mul_f32 v[46:47], v[42:43], v[38:39] op_sel:[0,0] op_sel_hi:[1,0]
    v_pk_fma_f32 v[44:45], v[40:41], v[36:37], v[44:45] op_sel:[1,1,0] op_sel_hi:[0,1,1] neg_lo:[1,0,0]
    v_pk_fma_f32 v[46:47], v[42:43], v[38:39], v[46:47] op_sel:[1,1,0] op_sel_hi:[0,1,1] neg_lo:[1,0,0]
    v_cvt_pk_f16_f32 v92, v40, v41
    v_cvt_pk_f16_f32 v93, v42, v43
    ds_write_b64 v9, v[92:93] offset:45824
    v_pk_mul_f32 v[40:41], v[44:45], v[36:37] op_sel:[0,0] op_sel_hi:[1,0]
    v_pk_mul_f32 v[42:43], v[46:47], v[38:39] op_sel:[0,0] op_sel_hi:[1,0]
    v_pk_fma_f32 v[40:41], v[44:45], v[36:37], v[40:41] op_sel:[1,1,0] op_sel_hi:[0,1,1] neg_lo:[1,0,0]
    v_pk_fma_f32 v[42:43], v[46:47], v[38:39], v[42:43] op_sel:[1,1,0] op_sel_hi:[0,1,1] neg_lo:[1,0,0]
    v_cvt_pk_f16_f32 v94, v44, v45
    v_cvt_pk_f16_f32 v95, v46, v47
    ds_write_b64 v9, v[94:95] offset:46368
    v_pk_mul_f32 v[44:45], v[40:41], v[36:37] op_sel:[0,0] op_sel_hi:[1,0]
    v_pk_mul_f32 v[46:47], v[42:43], v[38:39] op_sel:[0,0] op_sel_hi:[1,0]
    v_pk_fma_f32 v[44:45], v[40:41], v[36:37], v[44:45] op_sel:[1,1,0] op_sel_hi:[0,1,1] neg_lo:[1,0,0]
    v_pk_fma_f32 v[46:47], v[42:43], v[38:39], v[46:47] op_sel:[1,1,0] op_sel_hi:[0,1,1] neg_lo:[1,0,0]
    v_cvt_pk_f16_f32 v96, v40, v41
    v_cvt_pk_f16_f32 v97, v42, v43
    ds_write_b64 v9, v[96:97] offset:46912
    v_cvt_pk_f16_f32 v98, v44, v45
    v_cvt_pk_f16_f32 v99, v46, v47
    ds_write_b64 v9, v[98:99] offset:47456
    s_branch KG_END
KG_A:
    v_lshlrev_b32 v36, 16, v102
    v_and_b32 v38, 0xffff0000, v102
    v_lshlrev_b32 v37, 16, v103
    v_and_b32 v39, 0xffff0000, v103
    v_add_f32 v30, |v36|, |v37|
    v_add_f32 v31, |v38|, |v39|
    v_add_f32 v30, v30, v31
    v_add_f32 v31, v36, v38
    s_nop 0
    v_add_f32_dpp v30, v30, v30 row_ror:8 row_mask:0xf bank_mask:0xf
    v_add_f32_dpp v31, v31, v31 row_ror:8 row_mask:0xf bank_mask:0xf
    s_nop 0
    v_add_f32_dpp v30, v30, v30 row_ror:4 row_mask:0xf bank_mask:0xf
    v_add_f32_dpp v31, v31, v31 row_ror:4 row_mask:0xf bank_mask:0xf
    s_nop 0
    v_add_f32_dpp v30, v30, v30 row_ror:2 row_mask:0xf bank_mask:0xf
    v_add_f32_dpp v31, v31, v31 row_ror:2 row_mask:0xf bank_mask:0xf
    s_nop 0
    v_add_f32_dpp v30, v30, v30 row_ror:1 row_mask:0xf bank_mask:0xf
    v_add_f32_dpp v31, v31, v31 row_ror:1 row_mask:0xf bank_mask:0xf
    s_nop 0
    v_add_f32_dpp v30, v30, v30 row_bcast:15 row_mask:0xa bank_mask:0xf
    v_add_f32_dpp v31, v31, v31 row_bcast:15 row_mask:0xa bank_mask:0xf
    s_nop 0
    v_add_f32_dpp v30, v30, v30 row_bcast:31 row_mask:0xc bank_mask:0xf
    v_add_f32_dpp v31, v31, v31 row_bcast:31 row_mask:0xc bank_mask:0xf
    s_mov_b32 s52, 0x43800000
    v_pk_mul_f32 v[48:49], v[24:25], s[52:53] op_sel_hi:[1,0]
    v_pk_mul_f32 v[50:51], v[26:27], s[52:53] op_sel_hi:[1,0]
    v_exp_f32 v48, v48
    v_cos_f32 v40, v49
    v_sin_f32 v41, v49
    v_exp_f32 v50, v50
    v_cos_f32 v42, v51
    v_sin_f32 v43, v51
    v_pk_mul_f32 v[40:41], v[40:41], v[48:49] op_sel_hi:[1,0]
    v_pk_mul_f32 v[42:43], v[42:43], v[50:51] op_sel_hi:[1,0]
    v_readlane_b32 s56, v30, 63
    v_readlane_b32 s57, v31, 63
    v_mov_b32 v33, -100
    v_frexp_exp_i32_f32 v32, s56
    v_med3_i32 v32, v32, v33, 64
    v_sub_u32 v33, 14, v32
    v_ldexp_f32 v34, 1.0, v33
    v_pk_mul_f32 v[36:37], v[36:37], v[34:35] op_sel_hi:[1,0]
    v_pk_mul_f32 v[38:39], v[38:39], v[34:35] op_sel_hi:[1,0]
    s_cmp_eq_u32 s39, 3
    s_cbranch_scc1 KG_A3
    s_mov_b32 s52, 0x3f800000
    v_pk_mul_f32 v[48:49], v[24:25], s[52:53] op_sel_hi:[1,0]
    v_pk_mul_f32 v[50:51], v[26:27], s[52:53] op_sel_hi:[1,0]
    v_exp_f32 v48, v48
    v_cos_f32 v44, v49
    v_sin_f32 v45, v49
    v_exp_f32 v50, v50
    v_cos_f32 v46, v51
    v_sin_f32 v47, v51
    v_pk_mul_f32 v[44:45], v[44:45], v[48:49] op_sel_hi:[1,0]
    v_pk_mul_f32 v[46:47], v[46:47], v[50:51] op_sel_hi:[1,0]
    v_add_u32 v33, -13, v32
    v_ldexp_f32 v33, v29, v33
    v_mul_f32 v34, s57, v34
    v_cvt_f16_f32 v34, v34
    s_mul_i32 s56, s33, 1408
    v_mov_b32 v30, s56
    s_lshl_b32 s56, s33, 2
    v_mov_b32 v31, s56
    s_mov_b64 exec, 1
    ds_write_b16 v30, v34 offset:14110
    ds_write_b32 v31, v33 offset:21472
    s_mov_b64 exec, -1
    v_pk_mul_f32 v[52:53], v[36:37], v[44:45] op_sel:[0,0] op_sel_hi:[1,0]
    v_pk_mul_f32 v[54:55], v[38:39], v[46:47] op_sel:[0,0] op_sel_hi:[1,0]
    v_pk_fma_f32 v[52:53], v[36:37], v[44:45], v[52:53] op_sel:[1,1,0] op_sel_hi:[0,1,1] neg_lo:[1,0,0]
    v_pk_fma_f32 v[54:55], v[38:39], v[46:47], v[54:55] op_sel:[1,1,0] op_sel_hi:[0,1,1] neg_lo:[1,0,0]
    v_cvt_pk_f16_f32 v92, v52, -v53
    v_cvt_pk_f16_f32 v93, v54, -v55
    ds_write_b64 v9, v[92:93] offset:28416
    v_pk_mul_f32 v[56:57], v[52:53], v[44:45] op_sel:[0,0] op_sel_hi:[1,0]
    v_pk_mul_f32 v[58:59], v[54:55], v[46:47] op_sel:[0,0] op_sel_hi:[1,0]
    v_pk_fma_f32 v[56:57], v[52:53], v[44:45], v[56:57] op_sel:[1,1,0] op_sel_hi:[0,1,1] neg_lo:[1,0,0]
    v_pk_fma_f32 v[58:59], v[54:55], v[46:47], v[58:59] op_sel:[1,1,0] op_sel_hi:[0,1,1] neg_lo:[1,0,0]
    v_cvt_pk_f16_f32 v94, v56, -v57
    v_cvt_pk_f16_f32 v95, v58, -v59
    ds_write_b64 v9, v[94:95] offset:28960
    v_pk_mul_f32 v[60:61], v[56:57], v[40:41] op_sel:[0,0] op_sel_hi:[1,0]
    v_pk_mul_f32 v[62:63], v[58:59], v[42:43] op_sel:[0,0] op_sel_hi:[1,0]
    v_pk_fma_f32 v[60:61], v[56:57], v[40:41], v[60:61] op_sel:[1,1,0] op_sel_hi:[0,1,1] neg_lo:[1,0,0]
    v_pk_fma_f32 v[62:63], v[58:59], v[42:43], v[62:63] op_sel:[1,1,0] op_sel_hi:[0,1,1] neg_lo:[1,0,0]
    v_cvt_pk_f16_f32 v96, v60, -v61
    v_cvt_pk_f16_f32 v97, v62, -v63
    ds_write_b64 v9, v[96:97] offset:32768
    v_pk_mul_f32 v[52:53], v[56:57], v[44:45] op_sel:[0,0] op_sel_hi:[1,0]
    v_pk_mul_f32 v[54:55], v[58:59], v[46:47] op_sel:[0,0] op_sel_hi:[1,0]
    v_pk_fma_f32 v[52:53], v[56:57], v[44:45], v[52:53] op_sel:[1,1,0] op_sel_hi:[0,1,1] neg_lo:[1,0,0]
    v_pk_fma_f32 v[54:55], v[58:59], v[46:47], v[54:55] op_sel:[1,1,0] op_sel_hi:[0,1,1] neg_lo:[1,0,0]
    v_cvt_pk_f16_f32 v98, v52, -v53
    v_cvt_pk_f16_f32 v99, v54, -v55
    ds_write_b64 v9, v[98:99] offset:29504
    v_pk_mul_f32 v[56:57], v[52:53], v[44:45] op_sel:[0,0] op_sel_hi:[1,0]
    v_pk_mul_f32 v[58:59], v[54:55], v[46:47] op_sel:[0,0] op_sel_hi:[1,0]
    v_pk_fma_f32 v[56:57], v[52:53], v[44:45], v[56:57] op_sel:[1,1,0] op_sel_hi:[0,1,1] neg_lo:[1,0,0]
    v_pk_fma_f32 v[58:59], v[54:55], v[46:47], v[58:59] op_sel:[1,1,0] op_sel_hi:[0,1,1] neg_lo:[1,0,0]
    v_cvt_pk_f16_f32 v92, v56, -v57
    v_cvt_pk_f16_f32 v93, v58, -v59
    ds_write_b64 v9, v[92:93] offset:30048
    v_pk_mul_f32 v[60:61], v[56:57], v[40:41] op_sel:[0,0] op_sel_hi:[1,0]
    v_pk_mul_f32 v[62:63], v[58:59], v[42:43] op_sel:[0,0] op_sel_hi:[1,0]
    v_pk_fma_f32 v[60:61], v[56:57], v[40:41], v[60:61] op_sel:[1,1,0] op_sel_hi:[0,1,1] neg_lo:[1,0,0]
    v_pk_fma_f32 v[62:63], v[58:59], v[42:43], v[62:63] op_sel:[1,1,0] op_sel_hi:[0,1,1] neg_lo:[1,0,0]
    v_cvt_pk_f16_f32 v94, v60, -v61
    v_cvt_pk_f16_f32 v95, v62, -v63
    ds_write_b64 v9, v[94:95] offset:33312
    v_pk_mul_f32 v[52:53], v[56:57], v[44:45] op_sel:[0,0] op_sel_hi:[1,0]
    v_pk_mul_f32 v[54:55], v[58:59], v[46:47] op_sel:[0,0] op_sel_hi:[1,0]
    v_pk_fma_f32 v[52:53], v[56:57], v[44:45], v[52:53] op_sel:[1,1,0] op_sel_hi:[0,1,1] neg_lo:[1,0,0]
    v_pk_fma_f32 v[54:55], v[58:59], v[46:47], v[54:55] op_sel:[1,1,0] op_sel_hi:[0,1,1] neg_lo:[1,0,0]
    v_cvt_pk_f16_f32 v96, v52, -v53
    v_cvt_pk_f16_f32 v97, v54, -v55
    ds_write_b64 v9, v[96:97] offset:30592
    v_pk_mul_f32 v[56:57], v[52:53], v[44:45] op_sel:[0,0] op_sel_hi:[1,0]
    v_pk_mul_f32 v[58:59], v[54:55], v[46:47] op_sel:[0,0] op_sel_hi:[1,0]
    v_pk_fma_f32 v[56:57], v[52:53], v[44:45], v[56:57] op_sel:[1,1,0] op_sel_hi:[0,1,1] neg_lo:[1,0,0]
    v_pk_fma_f32 v[58:59], v[54:55], v[46:47], v[58:59] op_sel:[1,1,0] op_sel_hi:[0,1,1] neg_lo:[1,0,0]
    v_cvt_pk_f16_f32 v98, v56, -v57
    v_cvt_pk_f16_f32 v99, v58, -v59
    ds_write_b64 v9, v[98:99] offset:31136
    v_pk_mul_f32 v[60:61], v[56:57], v[40:41] op_sel:[0,0] op_sel_hi:[1,0]
    v_pk_mul_f32 v[62:63], v[58:59], v[42:43] op_sel:[0,0] op_sel_hi:[1,0]
    v_pk_fma_f32 v[60:61], v[56:57], v[40:41], v[60:61] op_sel:[1,1,0] op_sel_hi:[0,1,1] neg_lo:[1,0,0]
    v_pk_fma_f32 v[62:63], v[58:59], v[42:43], v[62:63] op_sel:[1,1,0] op_sel_hi:[0,1,1] neg_lo:[1,0,0]
    v_cvt_pk_f16_f32 v92, v60, -v61
    v_cvt_pk_f16_f32 v93, v62, -v63
    ds_write_b64 v9, v[92:93] offset:33856
    v_pk_mul_f32 v[52:53], v[56:57], v[44:45] op_sel:[0,0] op_sel_hi:[1,0]
    v_pk_mul_f32 v[54:55], v[58:59], v[46:47] op_sel:[0,0] op_sel_hi:[1,0]
    v_pk_fma_f32 v[52:53], v[56:57], v[44:45], v[52:53] op_sel:[1,1,0] op_sel_hi:[0,1,1] neg_lo:[1,0,0]
    v_pk_fma_f32 v[54:55], v[58:59], v[46:47], v[54:55] op_sel:[1,1,0] op_sel_hi:[0,1,1] neg_lo:[1,0,0]
    v_cvt_pk_f16_f32 v94, v52, -v53
    v_cvt_pk_f16_f32 v95, v54, -v55
    ds_write_b64 v9, v[94:95] offset:31680
    v_pk_mul_f32 v[56:57], v[52:53], v[44:45] op_sel:[0,0] op_sel_hi:[1,0]
    v_pk_mul_f32 v[58:59], v[54:55], v[46:47] op_sel:[0,0] op_sel_hi:[1,0]
    v_pk_fma_f32 v[56:57], v[52:53], v[44:45], v[56:57] op_sel:[1,1,0] op_sel_hi:[0,1,1] neg_lo:[1,0,0]
    v_pk_fma_f32 v[58:59], v[54:55], v[46:47], v[58:59] op_sel:[1,1,0] op_sel_hi:[0,1,1] neg_lo:[1,0,0]
    v_cvt_pk_f16_f32 v96, v56, -v57
    v_cvt_pk_f16_f32 v97, v58, -v59
    ds_write_b64 v9, v[96:97] offset:32224
    v_pk_mul_f32 v[60:61], v[56:57], v[40:41] op_sel:[0,0] op_sel_hi:[1,0]
    v_pk_mul_f32 v[62:63], v[58:59], v[42:43] op_sel:[0,0] op_sel_hi:[1,0]
    v_pk_fma_f32 v[60:61], v[56:57], v[40:41], v[60:61] op_sel:[1,1,0] op_sel_hi:[0,1,1] neg_lo:[1,0,0]
    v_pk_fma_f32 v[62:63], v[58:59], v[42:43], v[62:63] op_sel:[1,1,0] op_sel_hi:[0,1,1] neg_lo:[1,0,0]
    v_cvt_pk_f16_f32 v98, v60, -v61
    v_cvt_pk_f16_f32 v99, v62, -v63
    ds_write_b64 v9, v[98:99] offset:34400
    s_branch KG_END
KG_A3:
    s_mov_b32 s52, 0x44010000
    v_pk_mul_f32 v[48:49], v[24:25], s[52:53] op_sel_hi:[1,0]
    v_pk_mul_f32 v[50:51], v[26:27], s[52:53] op_sel_hi:[1,0]
    v_fract_f32 v49, v49
    v_fract_f32 v51, v51
    v_exp_f32 v48, v48
    v_cos_f32 v44, v49
    v_sin_f32 v45, v49
    v_exp_f32 v50, v50
    v_cos_f32 v46, v51
    v_sin_f32 v47, v51
    v_pk_mul_f32 v[44:45], v[44:45], v[48:49] op_sel_hi:[1,0]
    v_pk_mul_f32 v[46:47], v[46:47], v[50:51] op_sel_hi:[1,0]
    s_mov_b32 s52, 0x44020000
    v_pk_mul_f32 v[48:49], v[24:25], s[52:53] op_sel_hi:[1,0]
    v_pk_mul_f32 v[50:51], v[26:27], s[52:53] op_sel_hi:[1,0]
    v_fract_f32 v49, v49
    v_fract_f32 v51, v51
    v_exp_f32 v48, v48
    v_cos_f32 v52, v49
    v_sin_f32 v53, v49
    v_exp_f32 v50, v50
    v_cos_f32 v54, v51
    v_sin_f32 v55, v51
    v_pk_mul_f32 v[52:53], v[52:53], v[48:49] op_sel_hi:[1,0]
    v_pk_mul_f32 v[54:55], v[54:55], v[50:51] op_sel_hi:[1,0]
    v_pk_mul_f32 v[56:57], v[44:45], v[36:37] op_sel:[0,0] op_sel_hi:[1,0]
    v_pk_mul_f32 v[58:59], v[46:47], v[38:39] op_sel:[0,0] op_sel_hi:[1,0]
    v_pk_fma_f32 v[56:57], v[44:45], v[36:37], v[56:57] op_sel:[1,1,0] op_sel_hi:[0,1,1] neg_lo:[1,0,0]
    v_pk_fma_f32 v[58:59], v[46:47], v[38:39], v[58:59] op_sel:[1,1,0] op_sel_hi:[0,1,1] neg_lo:[1,0,0]
    v_pk_mul_f32 v[60:61], v[52:53], v[36:37] op_sel:[0,0] op_sel_hi:[1,0]
    v_pk_mul_f32 v[62:63], v[54:55], v[38:39] op_sel:[0,0] op_sel_hi:[1,0]
    v_pk_fma_f32 v[60:61], v[52:53], v[36:37], v[60:61] op_sel:[1,1,0] op_sel_hi:[0,1,1] neg_lo:[1,0,0]
    v_pk_fma_f32 v[62:63], v[54:55], v[38:39], v[62:63] op_sel:[1,1,0] op_sel_hi:[0,1,1] neg_lo:[1,0,0]
    v_cvt_pk_f16_f32 v92, v56, -v57
    v_cvt_pk_f16_f32 v93, v58, -v59
    ds_write_b64 v9, v[92:93] offset:34944
    v_cvt_pk_f16_f32 v94, v60, -v61
    v_cvt_pk_f16_f32 v95, v62, -v63
    ds_write_b64 v9, v[94:95] offset:35488
    v_pk_mul_f32 v[44:45], v[56:57], v[40:41] op_sel:[0,0] op_sel_hi:[1,0]
    v_pk_mul_f32 v[46:47], v[58:59], v[42:43] op_sel:[0,0] op_sel_hi:[1,0]
    v_pk_fma_f32 v[44:45], v[56:57], v[40:41], v[44:45] op_sel:[1,1,0] op_sel_hi:[0,1,1] neg_lo:[1,0,0]
    v_pk_fma_f32 v[46:47], v[58:59], v[42:43], v[46:47] op_sel:[1,1,0] op_sel_hi:[0,1,1] neg_lo:[1,0,0]
    v_pk_mul_f32 v[52:53], v[60:61], v[40:41] op_sel:[0,0] op_sel_hi:[1,0]
    v_pk_mul_f32 v[54:55], v[62:63], v[42:43] op_sel:[0,0] op_sel_hi:[1,0]
    v_pk_fma_f32 v[52:53], v[60:61], v[40:41], v[52:53] op_sel:[1,1,0] op_sel_hi:[0,1,1] neg_lo:[1,0,0]
    v_pk_fma_f32 v[54:55], v[62:63], v[42:43], v[54:55] op_sel:[1,1,0] op_sel_hi:[0,1,1] neg_lo:[1,0,0]
    v_cvt_pk_f16_f32 v96, v44, -v45
    v_cvt_pk_f16_f32 v97, v46, -v47
    ds_write_b64 v9, v[96:97] offset:36032
    v_cvt_pk_f16_f32 v98, v52, -v53
    v_cvt_pk_f16_f32 v99, v54, -v55
    ds_write_b64 v9, v[98:99] offset:36576
    v_pk_mul_f32 v[56:57], v[52:53], v[40:41] op_sel:[0,0] op_sel_hi:[1,0]
    v_pk_mul_f32 v[58:59], v[54:55], v[42:43] op_sel:[0,0] op_sel_hi:[1,0]
    v_pk_fma_f32 v[56:57], v[52:53], v[40:41], v[56:57] op_sel:[1,1,0] op_sel_hi:[0,1,1] neg_lo:[1,0,0]
    v_pk_fma_f32 v[58:59], v[54:55], v[42:43], v[58:59] op_sel:[1,1,0] op_sel_hi:[0,1,1] neg_lo:[1,0,0]
    v_cvt_pk_f16_f32 v92, v56, -v57
    v_cvt_pk_f16_f32 v93, v58, -v59
    ds_write_b64 v9, v[92:93] offset:37120
    v_pk_mul_f32 v[60:61], v[56:57], v[40:41] op_sel:[0,0] op_sel_hi:[1,0]
    v_pk_mul_f32 v[62:63], v[58:59], v[42:43] op_sel:[0,0] op_sel_hi:[1,0]
    v_pk_fma_f32 v[60:61], v[56:57], v[40:41], v[60:61] op_sel:[1,1,0] op_sel_hi:[0,1,1] neg_lo:[1,0,0]
    v_pk_fma_f32 v[62:63], v[58:59], v[42:43], v[62:63] op_sel:[1,1,0] op_sel_hi:[0,1,1] neg_lo:[1,0,0]
    v_cvt_pk_f16_f32 v94, v60, -v61
    v_cvt_pk_f16_f32 v95, v62, -v63
    ds_write_b64 v9, v[94:95] offset:37664
    v_pk_mul_f32 v[56:57], v[60:61], v[40:41] op_sel:[0,0] op_sel_hi:[1,0]
    v_pk_mul_f32 v[58:59], v[62:63], v[42:43] op_sel:[0,0] op_sel_hi:[1,0]
    v_pk_fma_f32 v[56:57], v[60:61], v[40:41], v[56:57] op_sel:[1,1,0] op_sel_hi:[0,1,1] neg_lo:[1,0,0]
    v_pk_fma_f32 v[58:59], v[62:63], v[42:43], v[58:59] op_sel:[1,1,0] op_sel_hi:[0,1,1] neg_lo:[1,0,0]
    v_cvt_pk_f16_f32 v96, v56, -v57
    v_cvt_pk_f16_f32 v97, v58, -v59
    ds_write_b64 v9, v[96:97] offset:38208
    v_pk_mul_f32 v[60:61], v[56:57], v[40:41] op_sel:[0,0] op_sel_hi:[1,0]
    v_pk_mul_f32 v[62:63], v[58:59], v[42:43] op_sel:[0,0] op_sel_hi:[1,0]
    v_pk_fma_f32 v[60:61], v[56:57], v[40:41], v[60:61] op_sel:[1,1,0] op_sel_hi:[0,1,1] neg_lo:[1,0,0]
    v_pk_fma_f32 v[62:63], v[58:59], v[42:43], v[62:63] op_sel:[1,1,0] op_sel_hi:[0,1,1] neg_lo:[1,0,0]
    v_cvt_pk_f16_f32 v98, v60, -v61
    v_cvt_pk_f16_f32 v99, v62, -v63
    ds_write_b64 v9, v[98:99] offset:38752
KG_END:
    s_and_b32 s39, s3, 3
    s_mul_i32 s56, s33, 28288
    v_and_b32 v30, 3, v3
    v_add_u32 v30, 16, v30
    s_cmp_ge_u32 s39, 2
    s_cselect_b64 vcc, -1, 0
    v_cndmask_b32 v30, v3, v30, vcc
    v_mul_u32_u24 v30, 544, v30
    v_lshl_add_u32 v30, v5, 4, v30
    v_add_u32 v30, s56, v30
    s_and_b32 s57, s39, 1
    s_mul_i32 s58, s57, 8704
    s_add_u32 s56, s56, s58
    v_mul_u32_u24 v31, 544, v3
    v_lshl_add_u32 v31, v5, 4, v31
    v_add_u32 v31, s56, v31
    s_lshl_b32 s57, s57, 4
    v_add_u32 v24, s57, v3
    s_mul_i32 s56, s33, 1408
    v_lshlrev_b32 v25, 4, v24
    v_lshl_add_u32 v25, v5, 3, v25
    v_add_u32 v25, 32, v25
    v_lshlrev_b32 v26, 3, v24
    v_add_u32 v26, 544, v26
    v_lshlrev_b32 v27, 2, v24
    v_add_u32 v27, 800, v27
    v_cmp_eq_u32 vcc, 2, v5
    s_nop 1
    v_cndmask_b32 v25, v25, v26, vcc
    v_cmp_eq_u32 vcc, 3, v5
    s_nop 1
    v_cndmask_b32 v25, v25, v27, vcc
    v_mov_b32 v26, 128
    v_cndmask_b32 v26, 4, v26, vcc
    v_add_u32 v25, s56, v25
    v_add_u32 v26, v25, v26
    v_lshl_add_u32 v27, v24, 1, s56
    s_waitcnt lgkmcnt(0)
    s_barrier
    ds_read_b128 v[36:39], v30 offset:28416
    ds_read_b128 v[40:43], v31 offset:39296
    ds_read_b128 v[44:47], v30 offset:28480
    ds_read_b128 v[48:51], v31 offset:39360
    ds_read_b128 v[52:55], v30 offset:28544
    ds_read_b128 v[56:59], v31 offset:39424
    ds_read_b128 v[60:63], v30 offset:28608
    ds_read_b128 v[64:67], v31 offset:39488
    ds_read_b128 v[68:71], v30 offset:28672
    ds_read_b128 v[72:75], v31 offset:39552
    ds_read_b128 v[76:79], v30 offset:28736
    ds_read_b128 v[80:83], v31 offset:39616
    ds_read_b128 v[84:87], v30 offset:28800
    ds_read_b128 v[88:91], v31 offset:39680
    s_waitcnt lgkmcnt(12)
    ds_read_b128 v[92:95], v30 offset:28864
    ds_read_b128 v[96:99], v31 offset:39744
    s_waitcnt lgkmcnt(14)
    v_mfma_f32_16x16x32_f16 v[32:35], v[36:39], v[40:43], 0
    s_waitcnt lgkmcnt(12)
    v_mfma_f32_16x16x32_f16 v[32:35], v[44:47], v[48:51], v[32:35]
    s_waitcnt lgkmcnt(10)
    v_mfma_f32_16x16x32_f16 v[32:35], v[52:55], v[56:59], v[32:35]
    s_waitcnt lgkmcnt(8)
    v_mfma_f32_16x16x32_f16 v[32:35], v[60:63], v[64:67], v[32:35]
    s_waitcnt lgkmcnt(6)
    v_mfma_f32_16x16x32_f16 v[32:35], v[68:71], v[72:75], v[32:35]
    s_waitcnt lgkmcnt(4)
    v_mfma_f32_16x16x32_f16 v[32:35], v[76:79], v[80:83], v[32:35]
    s_waitcnt lgkmcnt(2)
    v_mfma_f32_16x16x32_f16 v[32:35], v[84:87], v[88:91], v[32:35]
    s_waitcnt lgkmcnt(0)
    v_mfma_f32_16x16x32_f16 v[32:35], v[92:95], v[96:99], v[32:35]
    v_lshlrev_b32 v28, 2, v3
    ds_read_b32 v117, v28 offset:21376
    s_nop 5
    v_cvt_pk_f16_f32 v28, v32, v33
    v_cvt_pk_f16_f32 v29, v34, v35
    s_cmp_ge_u32 s39, 2
    s_cbranch_scc1 KG_W1
    ds_write_b32 v25, v28 offset:14080
    ds_write_b32 v26, v29 offset:14080
    s_branch KG_W2
KG_W1:
    s_mov_b64 exec, 0xffff
    ds_write_b16 v27, v28 offset:15136
    ds_write_b16_d16_hi v27, v28 offset:15200
    ds_write_b16 v27, v29 offset:15264
    ds_write_b16_d16_hi v27, v29 offset:15328
    s_mov_b64 exec, -1
KG_W2:
    s_waitcnt lgkmcnt(0)
    v_add_f32_dpp v117, v117, v117 row_ror:8 row_mask:0xf bank_mask:0xf
    s_nop 1
    v_add_f32_dpp v117, v117, v117 row_ror:4 row_mask:0xf bank_mask:0xf
    s_nop 1
    v_add_f32_dpp v117, v117, v117 row_ror:2 row_mask:0xf bank_mask:0xf
    s_nop 1
    v_add_f32_dpp v117, v117, v117 row_ror:1 row_mask:0xf bank_mask:0xf
    s_branch KG_DONE
HELP:
    v_mov_b32 v10, 0
    v_mov_b32 v11, 0
    v_mov_b32 v12, 0
    v_mov_b32 v13, 0
    v_lshl_add_u32 v21, v5, 4, v2
    v_lshlrev_b32 v22, 4, v21
    v_lshlrev_b32 v21, 5, v21
    v_lshlrev_b32 v31, 2, v2
    ds_write_b128 v22, v[10:13] offset:18304
    ds_write_b128 v21, v[10:13] offset:19328
    ds_write_b128 v21, v[10:13] offset:19344
    ds_write_b32 v31, v10 offset:21376
    s_cmp_eq_u32 s3, 15
    s_cbranch_scc1 HELP15
    s_sub_u32 s38, s3, 12
    s_lshl_b32 s39, 256, s38
    v_lshlrev_b32 v14, 3, v5
    v_sub_u32 v14, v3, v14
    v_add3_u32 v14, v14, s39, 16
    v_cvt_f32_u32 v14, v14
    s_mov_b32 s52, 0x42714271
    s_mov_b32 s53, 0x02020202
    v_mov_b32 v9, 0x01000100
    s_lshl_b32 s39, s38, 11
    v_lshl_add_u32 v8, v1, 4, s39
    s_lshl_b32 s39, s38, 8
    v_lshl_add_u32 v7, v1, 2, s39
    v_add_f32 v16, 0x00000000, v14
    v_add_f32 v17, 0xbf800000, v14
    v_add_f32 v18, 0xc0000000, v14
    v_add_f32 v19, 0xc0400000, v14
    v_add_f32 v20, 0xc0800000, v14
    v_add_f32 v21, 0xc0a00000, v14
    v_add_f32 v22, 0xc0c00000, v14
    v_add_f32 v23, 0xc0e00000, v14
    v_cvt_pk_bf16_f32 v24, v16, v17
    v_cvt_pk_bf16_f32 v25, v18, v19
    v_cvt_pk_bf16_f32 v26, v20, v21
    v_cvt_pk_bf16_f32 v27, v22, v23
    v_pk_sub_u16 v24, v24, s52
    v_pk_sub_u16 v25, v25, s52
    v_pk_sub_u16 v26, v26, s52
    v_pk_sub_u16 v27, v27, s52
    v_pk_lshlrev_b16 v24, 1, v24 op_sel_hi:[0,1]
    v_pk_lshlrev_b16 v25, 1, v25 op_sel_hi:[0,1]
    v_pk_lshlrev_b16 v26, 1, v26 op_sel_hi:[0,1]
    v_pk_lshlrev_b16 v27, 1, v27 op_sel_hi:[0,1]
    ds_write_b128 v8, v[24:27] offset:22528
    v_add_f32 v16, 0x42000000, v14
    v_add_f32 v17, 0x41f80000, v14
    v_add_f32 v18, 0x41f00000, v14
    v_add_f32 v19, 0x41e80000, v14
    v_add_f32 v20, 0x41e00000, v14
    v_add_f32 v21, 0x41d80000, v14
    v_add_f32 v22, 0x41d00000, v14
    v_add_f32 v23, 0x41c80000, v14
    v_cvt_pk_bf16_f32 v24, v16, v17
    v_cvt_pk_bf16_f32 v25, v18, v19
    v_cvt_pk_bf16_f32 v26, v20, v21
    v_cvt_pk_bf16_f32 v27, v22, v23
    v_pk_sub_u16 v24, v24, s52
    v_pk_sub_u16 v25, v25, s52
    v_pk_sub_u16 v26, v26, s52
    v_pk_sub_u16 v27, v27, s52
    v_lshrrev_b32 v15, 16, v27
    v_and_b32 v15, -2, v15
    v_lshl_or_b32 v28, v15, 16, v15
    v_pk_sub_u16 v24, v24, v28
    v_pk_sub_u16 v25, v25, v28
    v_pk_sub_u16 v26, v26, v28
    v_pk_sub_u16 v27, v27, v28
    v_pk_mad_u16 v24, v24, s53, v9
    v_pk_mad_u16 v25, v25, s53, v9
    v_pk_mad_u16 v26, v26, s53, v9
    v_pk_mad_u16 v27, v27, s53, v9
    v_lshlrev_b32 v15, 1, v15
    ds_write_b128 v8, v[24:27] offset:21504
    ds_write_b32 v7, v15 offset:27648
    s_branch HELP2
HELP15:
    v_lshlrev_b32 v7, 4, v1
    s_mov_b64 exec, 0x3fffffff
    ds_write_b128 v7, v[10:13] offset:256
    ds_write_b128 v7, v[10:13] offset:4864
    ds_write_b128 v7, v[10:13] offset:9472
    s_mov_b64 exec, 3
    ds_write_b128 v7, v[10:13] offset:14080
    ds_write_b128 v7, v[10:13] offset:15488
    ds_write_b128 v7, v[10:13] offset:16896
    ds_write_b128 v7, v[10:13] offset:21440
    s_mov_b64 exec, -1
HELP2:
    s_waitcnt lgkmcnt(0)
    s_load_dword s48, s[30:31], 0
    s_mov_b32 s40, s30
    s_and_b32 s41, s31, 0xffff
    s_mov_b32 s42, 0x10000000
    s_mov_b32 s43, 0x00020000
    s_waitcnt lgkmcnt(0)
    s_mul_i32 s48, s48, 1664525
    s_add_u32 s48, s48, 1013904223
    s_barrier
    s_cmp_ge_u32 s2, 192
    s_cbranch_scc1 SPARE
    s_barrier
KG_DONE:
    s_barrier
    v_lshlrev_b32 v68, 4, v0
    s_lshl_b32 s38, s2, 14
    s_add_u32 s38, s38, 4096
    buffer_load_dwordx4 v[6:9], v68, s[40:43], s38 offen sc1
    s_mov_b32 s39, 0
    s_and_b32 s56, s3, 3
    s_cmp_eq_u32 s56, 3
    s_cselect_b32 s39, 2, 0
    s_cmp_eq_u32 s3, 15
    s_cselect_b32 s39, 0, s39
    s_cmp_lt_u32 s3, 3
    s_cselect_b32 s39, 1, s39
    s_cselect_b32 s33, s3, s33
    s_cmp_eq_u32 s39, 0
    s_cbranch_scc1 CV_POLL
    s_setprio 3
    v_lshlrev_b32 v64, 4, v1
    v_lshlrev_b32 v65, 2, v1
    s_mul_i32 s56, s33, 1408
    s_add_u32 s56, s56, 14080
    ds_read_b128 v[72:75], v64 offset:22528
    ds_read_b128 v[76:79], v64 offset:24576
    ds_read_b128 v[80:83], v64 offset:26624
    ds_read_b32 v106, v65 offset:27648
    ds_read_b32 v107, v65 offset:27904
    ds_read_b32 v10, v65 offset:28160
    ds_read_b64 v[126:127], v64 offset:21512
    ds_read_b128 v[118:121], v64 offset:23552
    ds_read_b128 v[122:125], v64 offset:25600
    s_lshl_b32 s57, s33, 2
    v_mov_b32 v66, s57
    ds_read_b32 v66, v66 offset:21472
    v_lshlrev_b32 v69, 3, v5
    v_sub_u32 v69, v3, v69
    v_add_u32 v69, 24, v69
    v_and_b32 v70, 1, v69
    v_and_b32 v69, -2, v69
    v_lshl_add_u32 v93, v69, 1, s56
    s_mov_b32 s57, 0x02020202
    v_mul_lo_u32 v70, v70, s57
    v_add_u32 v89, 0x01000302, v70
    s_mul_i32 s57, s33, 4608
    s_add_u32 s57, s57, 704
    v_lshlrev_b32 v69, 5, v3
    v_lshl_add_u32 v69, v5, 4, v69
    v_add_u32 v11, s57, v69
    ds_read2_b32 v[84:85], v93 offset0:0 offset1:1
    ds_read2_b32 v[86:87], v93 offset0:2 offset1:3
    ds_read_b32 v88, v93 offset:16
    s_waitcnt lgkmcnt(3)
    v_readfirstlane_b32 s58, v66
    v_add_u32 v106, s56, v106
    v_add_u32 v107, s56, v107
    v_add_u32 v10, s56, v10
    s_and_b32 s57, s56, 0xffff
    s_mul_i32 s57, s57, 0x10001
    v_pk_add_u16 v72, v72, s57
    v_pk_add_u16 v73, v73, s57
    v_pk_add_u16 v74, v74, s57
    v_pk_add_u16 v75, v75, s57
    v_pk_add_u16 v76, v76, s57
    v_pk_add_u16 v77, v77, s57
    v_pk_add_u16 v78, v78, s57
    v_pk_add_u16 v79, v79, s57
    v_pk_add_u16 v80, v80, s57
    v_pk_add_u16 v81, v81, s57
    v_pk_add_u16 v82, v82, s57
    v_pk_add_u16 v83, v83, s57
    ds_read2_b32 v[96:97], v107 offset0:28 offset1:29
    v_and_b32 v12, 0xffff, v72
    v_lshrrev_b32 v13, 16, v72
    v_and_b32 v14, 0xffff, v73
    v_lshrrev_b32 v15, 16, v73
    v_and_b32 v16, 0xffff, v74
    v_lshrrev_b32 v17, 16, v74
    v_and_b32 v18, 0xffff, v75
    v_lshrrev_b32 v19, 16, v75
    ds_read_u16 v20, v12
    ds_read_u16 v21, v13
    ds_read_u16 v22, v14
    ds_read_u16 v23, v15
    ds_read_u16 v24, v16
    ds_read_u16 v25, v17
    ds_read_u16 v26, v18
    ds_read_u16 v27, v19
    s_waitcnt lgkmcnt(0)
    v_lshl_or_b32 v36, v21, 16, v20
    v_lshl_or_b32 v37, v23, 16, v22
    v_lshl_or_b32 v38, v25, 16, v24
    v_lshl_or_b32 v39, v27, 16, v26
    v_perm_b32 v32, v88, v87, v89
    v_perm_b32 v33, v87, v86, v89
    v_perm_b32 v34, v86, v85, v89
    v_perm_b32 v35, v85, v84, v89
    v_perm_b32 v44, v97, v96, v118
    v_perm_b32 v45, v97, v96, v119
    v_perm_b32 v46, v97, v96, v120
    v_perm_b32 v47, v97, v96, v121
    v_and_b32 v12, 0xffff, v76
    v_lshrrev_b32 v13, 16, v76
    v_and_b32 v14, 0xffff, v77
    v_lshrrev_b32 v15, 16, v77
    v_and_b32 v16, 0xffff, v78
    v_lshrrev_b32 v17, 16, v78
    v_and_b32 v18, 0xffff, v79
    v_lshrrev_b32 v19, 16, v79
    ds_read_u16 v20, v12
    ds_read_u16 v21, v13
    ds_read_u16 v22, v14
    ds_read_u16 v23, v15
    ds_read_u16 v24, v16
    ds_read_u16 v25, v17
    ds_read_u16 v26, v18
    ds_read_u16 v27, v19
    s_waitcnt lgkmcnt(0)
    v_lshl_or_b32 v40, v21, 16, v20
    v_lshl_or_b32 v41, v23, 16, v22
    v_lshl_or_b32 v42, v25, 16, v24
    v_lshl_or_b32 v43, v27, 16, v26
    v_add_u32 v93, 64, v93
    s_cmp_eq_u32 s39, 2
    s_cbranch_scc1 CV_POLL
    ds_read2_b32 v[100:101], v10 offset0:14 offset1:15
    ds_read2_b32 v[102:103], v10 offset0:30 offset1:31
    ds_read2_b32 v[104:105], v10 offset0:46 offset1:47
    v_and_b32 v12, 0xffff, v80
    v_lshrrev_b32 v13, 16, v80
    v_and_b32 v14, 0xffff, v81
    v_lshrrev_b32 v15, 16, v81
    v_and_b32 v16, 0xffff, v82
    v_lshrrev_b32 v17, 16, v82
    v_and_b32 v18, 0xffff, v83
    v_lshrrev_b32 v19, 16, v83
    ds_read_u16 v20, v12
    ds_read_u16 v21, v13
    ds_read_u16 v22, v14
    ds_read_u16 v23, v15
    ds_read_u16 v24, v16
    ds_read_u16 v25, v17
    ds_read_u16 v26, v18
    ds_read_u16 v27, v19
    s_waitcnt lgkmcnt(0)
    v_lshl_or_b32 v48, v21, 16, v20
    v_lshl_or_b32 v49, v23, 16, v22
    v_lshl_or_b32 v50, v25, 16, v24
    v_lshl_or_b32 v51, v27, 16, v26
    v_perm_b32 v52, v101, v100, v122
    v_perm_b32 v53, v101, v100, v123
    v_perm_b32 v54, v101, v100, v124
    v_perm_b32 v55, v101, v100, v125
    v_perm_b32 v56, v103, v102, v122
    v_perm_b32 v57, v103, v102, v123
    v_perm_b32 v58, v103, v102, v124
    v_perm_b32 v59, v103, v102, v125
    v_perm_b32 v60, v105, v104, v122
    v_perm_b32 v61, v105, v104, v123
    v_perm_b32 v62, v105, v104, v124
    v_perm_b32 v63, v105, v104, v125
CV_POLL:
    s_mov_b32 s49, 0
    s_branch PC_3
P_1:
    buffer_load_dwordx4 v[6:9], v68, s[40:43], s38 offen sc1
PC_3:
    s_add_u32 s49, s49, 1
    s_waitcnt vmcnt(0)
    v_cmp_ne_u32 vcc, s48, v9
    s_nop 0
    s_cbranch_vccz PD_2
    s_cmp_lt_u32 s49, 60000
    s_cbranch_scc1 P_1
PD_2:
    v_lshlrev_b32 v68, 2, v0
    ds_write_b32 v68, v6 offset:736
    ds_write_b32 v68, v7 offset:5344
    ds_write_b32 v68, v8 offset:9952
    s_waitcnt lgkmcnt(0)
    s_barrier
    s_cmp_eq_u32 s39, 0
    s_cbranch_scc1 CV_IDLE
    s_cmp_eq_u32 s39, 2
    s_cbranch_scc1 CV_LIGHT
    ds_read_b128 v[64:67], v11 offset:0
    ds_read_b128 v[68:71], v11 offset:512
    ds_read_b128 v[72:75], v11 offset:1024
    s_waitcnt lgkmcnt(2)
    v_mfma_f32_16x16x32_f16 v[16:19], v[48:51], v[64:67], 0
    v_mfma_f32_16x16x32_f16 v[20:23], v[52:55], v[64:67], 0
    ds_read_b128 v[76:79], v11 offset:1536
    v_mfma_f32_16x16x32_f16 v[24:27], v[56:59], v[64:67], 0
    v_mfma_f32_16x16x32_f16 v[28:31], v[60:63], v[64:67], 0
    s_waitcnt lgkmcnt(2)
    v_mfma_f32_16x16x32_f16 v[16:19], v[44:47], v[68:71], v[16:19]
    ds_read2_b32 v[104:105], v10 offset0:48 offset1:49
    v_mfma_f32_16x16x32_f16 v[20:23], v[48:51], v[68:71], v[20:23]
    ds_read_b128 v[80:83], v11 offset:2048
    v_mfma_f32_16x16x32_f16 v[24:27], v[52:55], v[68:71], v[24:27]
    v_mfma_f32_16x16x32_f16 v[28:31], v[56:59], v[68:71], v[28:31]
    ds_read2_b32 v[102:103], v10 offset0:32 offset1:33
    s_waitcnt lgkmcnt(4)
    v_mfma_f32_16x16x32_f16 v[16:19], v[40:43], v[72:75], v[16:19]
    v_mfma_f32_16x16x32_f16 v[20:23], v[44:47], v[72:75], v[20:23]
    ds_read_b128 v[6:9], v11 offset:2560
    v_mfma_f32_16x16x32_f16 v[24:27], v[48:51], v[72:75], v[24:27]
    ds_read2_b32 v[100:101], v10 offset0:16 offset1:17
    v_mfma_f32_16x16x32_f16 v[28:31], v[52:55], v[72:75], v[28:31]
    s_waitcnt lgkmcnt(5)
    v_mfma_f32_16x16x32_f16 v[16:19], v[36:39], v[76:79], v[16:19]
    s_waitcnt lgkmcnt(4)
    v_perm_b32 v60, v105, v104, v122
    v_perm_b32 v61, v105, v104, v123
    ds_read_b128 v[72:75], v11 offset:3072
    v_mfma_f32_16x16x32_f16 v[20:23], v[40:43], v[76:79], v[20:23]
    v_perm_b32 v62, v105, v104, v124
    ds_read2_b32 v[98:99], v10 offset0:0 offset1:1
    v_add_u32 v10, 8, v10
    v_mfma_f32_16x16x32_f16 v[24:27], v[44:47], v[76:79], v[24:27]
    v_perm_b32 v63, v105, v104, v125
    v_mfma_f32_16x16x32_f16 v[28:31], v[48:51], v[76:79], v[28:31]
    s_waitcnt lgkmcnt(4)
    v_perm_b32 v56, v103, v102, v122
    v_perm_b32 v57, v103, v102, v123
    ds_read_b128 v[76:79], v11 offset:3584
    v_add_u32 v11, -64, v11
    v_mfma_f32_16x16x32_f16 v[12:15], v[32:35], v[64:67], 0
    v_perm_b32 v58, v103, v102, v124
    ds_read2_b32 v[96:97], v107 offset0:32 offset1:33
    v_mfma_f32_16x16x32_f16 v[16:19], v[32:35], v[80:83], v[16:19]
    v_perm_b32 v59, v103, v102, v125
    ds_read_b128 v[64:67], v11 offset:0
    v_mfma_f32_16x16x32_f16 v[20:23], v[36:39], v[80:83], v[20:23]
    s_waitcnt lgkmcnt(5)
    v_perm_b32 v52, v101, v100, v122
    v_perm_b32 v53, v101, v100, v123
    v_mfma_f32_16x16x32_f16 v[24:27], v[40:43], v[80:83], v[24:27]
    v_perm_b32 v54, v101, v100, v124
    ds_read2_b32 v[94:95], v107 offset0:0 offset1:1
    v_add_u32 v107, 16, v107
    v_mfma_f32_16x16x32_f16 v[28:31], v[44:47], v[80:83], v[28:31]
    v_perm_b32 v55, v101, v100, v125
    ds_read_b128 v[68:71], v11 offset:512
    v_mfma_f32_16x16x32_f16 v[20:23], v[32:35], v[6:9], v[20:23]
    s_waitcnt lgkmcnt(5)
    v_perm_b32 v48, v99, v98, v122
    v_perm_b32 v49, v99, v98, v123
    v_mfma_f32_16x16x32_f16 v[24:27], v[36:39], v[6:9], v[24:27]
    v_perm_b32 v50, v99, v98, v124
    ds_read2_b32 v[90:91], v106 offset0:0 offset1:1
    ds_read_b32 v92, v106 offset:8
    v_add_u32 v106, 32, v106
    v_mfma_f32_16x16x32_f16 v[28:31], v[40:43], v[6:9], v[28:31]
    v_perm_b32 v51, v99, v98, v125
    v_mfma_f32_16x16x32_f16 v[24:27], v[32:35], v[72:75], v[24:27]
    s_waitcnt lgkmcnt(5)
    v_perm_b32 v44, v97, v96, v118
    v_perm_b32 v45, v97, v96, v119
    v_mfma_f32_16x16x32_f16 v[28:31], v[36:39], v[72:75], v[28:31]
    v_perm_b32 v46, v97, v96, v120
    ds_read2_b32 v[84:85], v93 offset0:0 offset1:1
    ds_read2_b32 v[86:87], v93 offset0:2 offset1:3
    ds_read_b32 v88, v93 offset:16
    v_add_u32 v93, 64, v93
    ds_read_b128 v[72:75], v11 offset:1024
    v_mfma_f32_16x16x32_f16 v[28:31], v[32:35], v[76:79], v[28:31]
    v_perm_b32 v47, v97, v96, v121
    s_mov_b32 s56, 1
CV_CHL:
    s_waitcnt lgkmcnt(8)
    v_mfma_f32_16x16x32_f16 v[16:19], v[48:51], v[64:67], v[16:19]
    s_waitcnt lgkmcnt(7)
    v_perm_b32 v40, v95, v94, v118
    v_mfma_f32_16x16x32_f16 v[20:23], v[52:55], v[64:67], v[20:23]
    v_perm_b32 v41, v95, v94, v119
    ds_read_b128 v[76:79], v11 offset:1536
    v_mfma_f32_16x16x32_f16 v[24:27], v[56:59], v[64:67], v[24:27]
    v_perm_b32 v42, v95, v94, v120
    v_mfma_f32_16x16x32_f16 v[28:31], v[60:63], v[64:67], v[28:31]
    v_perm_b32 v43, v95, v94, v121
    s_waitcnt lgkmcnt(7)
    v_mfma_f32_16x16x32_f16 v[16:19], v[44:47], v[68:71], v[16:19]
    s_waitcnt lgkmcnt(5)
    v_perm_b32 v36, v92, v91, v126
    ds_read2_b32 v[104:105], v10 offset0:48 offset1:49
    v_mfma_f32_16x16x32_f16 v[20:23], v[48:51], v[68:71], v[20:23]
    v_perm_b32 v37, v92, v91, v127
    ds_read_b128 v[80:83], v11 offset:2048
    v_mfma_f32_16x16x32_f16 v[24:27], v[52:55], v[68:71], v[24:27]
    v_perm_b32 v38, v91, v90, v126
    v_mfma_f32_16x16x32_f16 v[28:31], v[56:59], v[68:71], v[28:31]
    v_perm_b32 v39, v91, v90, v127
    ds_read2_b32 v[102:103], v10 offset0:32 offset1:33
    s_waitcnt lgkmcnt(4)
    v_mfma_f32_16x16x32_f16 v[16:19], v[40:43], v[72:75], v[16:19]
    v_perm_b32 v32, v88, v87, v89
    v_mfma_f32_16x16x32_f16 v[20:23], v[44:47], v[72:75], v[20:23]
    v_perm_b32 v33, v87, v86, v89
    ds_read_b128 v[6:9], v11 offset:2560
    v_mfma_f32_16x16x32_f16 v[24:27], v[48:51], v[72:75], v[24:27]
    v_perm_b32 v34, v86, v85, v89
    ds_read2_b32 v[100:101], v10 offset0:16 offset1:17
    v_mfma_f32_16x16x32_f16 v[28:31], v[52:55], v[72:75], v[28:31]
    v_perm_b32 v35, v85, v84, v89
    s_waitcnt lgkmcnt(5)
    v_mfma_f32_16x16x32_f16 v[16:19], v[36:39], v[76:79], v[16:19]
    s_waitcnt lgkmcnt(4)
    v_perm_b32 v60, v105, v104, v122
    v_perm_b32 v61, v105, v104, v123
    ds_read_b128 v[72:75], v11 offset:3072
    v_mfma_f32_16x16x32_f16 v[20:23], v[40:43], v[76:79], v[20:23]
    v_perm_b32 v62, v105, v104, v124
    ds_read2_b32 v[98:99], v10 offset0:0 offset1:1
    v_add_u32 v10, 8, v10
    v_mfma_f32_16x16x32_f16 v[24:27], v[44:47], v[76:79], v[24:27]
    v_perm_b32 v63, v105, v104, v125
    v_mfma_f32_16x16x32_f16 v[28:31], v[48:51], v[76:79], v[28:31]
    s_waitcnt lgkmcnt(4)
    v_perm_b32 v56, v103, v102, v122
    v_perm_b32 v57, v103, v102, v123
    ds_read_b128 v[76:79], v11 offset:3584
    v_add_u32 v11, -64, v11
    v_mfma_f32_16x16x32_f16 v[12:15], v[32:35], v[64:67], v[12:15]
    v_perm_b32 v58, v103, v102, v124
    ds_read2_b32 v[96:97], v107 offset0:32 offset1:33
    v_mfma_f32_16x16x32_f16 v[16:19], v[32:35], v[80:83], v[16:19]
    v_perm_b32 v59, v103, v102, v125
    ds_read_b128 v[64:67], v11 offset:0
    v_mfma_f32_16x16x32_f16 v[20:23], v[36:39], v[80:83], v[20:23]
    s_waitcnt lgkmcnt(5)
    v_perm_b32 v52, v101, v100, v122
    v_perm_b32 v53, v101, v100, v123
    v_mfma_f32_16x16x32_f16 v[24:27], v[40:43], v[80:83], v[24:27]
    v_perm_b32 v54, v101, v100, v124
    ds_read2_b32 v[94:95], v107 offset0:0 offset1:1
    v_add_u32 v107, 16, v107
    v_mfma_f32_16x16x32_f16 v[28:31], v[44:47], v[80:83], v[28:31]
    v_perm_b32 v55, v101, v100, v125
    ds_read_b128 v[68:71], v11 offset:512
    v_mfma_f32_16x16x32_f16 v[20:23], v[32:35], v[6:9], v[20:23]
    s_waitcnt lgkmcnt(5)
    v_perm_b32 v48, v99, v98, v122
    v_perm_b32 v49, v99, v98, v123
    v_mfma_f32_16x16x32_f16 v[24:27], v[36:39], v[6:9], v[24:27]
    v_perm_b32 v50, v99, v98, v124
    ds_read2_b32 v[90:91], v106 offset0:0 offset1:1
    ds_read_b32 v92, v106 offset:8
    v_add_u32 v106, 32, v106
    v_mfma_f32_16x16x32_f16 v[28:31], v[40:43], v[6:9], v[28:31]
    v_perm_b32 v51, v99, v98, v125
    v_mfma_f32_16x16x32_f16 v[24:27], v[32:35], v[72:75], v[24:27]
    s_waitcnt lgkmcnt(5)
    v_perm_b32 v44, v97, v96, v118
    v_perm_b32 v45, v97, v96, v119
    v_mfma_f32_16x16x32_f16 v[28:31], v[36:39], v[72:75], v[28:31]
    v_perm_b32 v46, v97, v96, v120
    ds_read2_b32 v[84:85], v93 offset0:0 offset1:1
    ds_read2_b32 v[86:87], v93 offset0:2 offset1:3
    ds_read_b32 v88, v93 offset:16
    v_add_u32 v93, 64, v93
    ds_read_b128 v[72:75], v11 offset:1024
    v_mfma_f32_16x16x32_f16 v[28:31], v[32:35], v[76:79], v[28:31]
    v_perm_b32 v47, v97, v96, v121
    s_add_u32 s56, s56, 1
    s_cmp_lt_u32 s56, 8
    s_cbranch_scc1 CV_CHL
    s_waitcnt lgkmcnt(0)
    s_lshl_b32 s56, s33, 12
    v_lshl_add_u32 v64, v1, 3, s56
    s_mov_b32 s59, s58
    v_pk_mul_f32 v[12:13], v[12:13], s[58:59]
    v_pk_mul_f32 v[14:15], v[14:15], s[58:59]
    v_cvt_pk_bf16_f32 v12, v12, v13
    v_cvt_pk_bf16_f32 v13, v14, v15
    ds_write_b64 v64, v[12:13] offset:28416
    v_pk_mul_f32 v[16:17], v[16:17], s[58:59]
    v_pk_mul_f32 v[18:19], v[18:19], s[58:59]
    v_cvt_pk_bf16_f32 v16, v16, v17
    v_cvt_pk_bf16_f32 v17, v18, v19
    ds_write_b64 v64, v[16:17] offset:30464
    v_pk_mul_f32 v[20:21], v[20:21], s[58:59]
    v_pk_mul_f32 v[22:23], v[22:23], s[58:59]
    v_cvt_pk_bf16_f32 v20, v20, v21
    v_cvt_pk_bf16_f32 v21, v22, v23
    ds_write_b64 v64, v[20:21] offset:30976
    v_pk_mul_f32 v[24:25], v[24:25], s[58:59]
    v_pk_mul_f32 v[26:27], v[26:27], s[58:59]
    v_cvt_pk_bf16_f32 v24, v24, v25
    v_cvt_pk_bf16_f32 v25, v26, v27
    ds_write_b64 v64, v[24:25] offset:31488
    v_pk_mul_f32 v[28:29], v[28:29], s[58:59]
    v_pk_mul_f32 v[30:31], v[30:31], s[58:59]
    v_cvt_pk_bf16_f32 v28, v28, v29
    v_cvt_pk_bf16_f32 v29, v30, v31
    ds_write_b64 v64, v[28:29] offset:32000
    s_branch CV_DONE
CV_LIGHT:
    ds_read_b128 v[64:67], v11 offset:0
    ds_read_b128 v[68:71], v11 offset:512
    ds_read_b128 v[72:75], v11 offset:1024
    ds_read_b128 v[76:79], v11 offset:1536
    v_add_u32 v11, -64, v11
    s_waitcnt lgkmcnt(0)
    ds_read2_b32 v[90:91], v106 offset0:0 offset1:1
    ds_read_b32 v92, v106 offset:8
    ds_read2_b32 v[94:95], v107 offset0:0 offset1:1
    ds_read2_b32 v[96:97], v107 offset0:32 offset1:33
    ds_read2_b32 v[84:85], v93 offset0:0 offset1:1
    ds_read2_b32 v[86:87], v93 offset0:2 offset1:3
    ds_read_b32 v88, v93 offset:16
    v_mfma_f32_16x16x32_f16 v[12:15], v[36:39], v[64:67], 0
    v_mfma_f32_16x16x32_f16 v[16:19], v[40:43], v[64:67], 0
    v_mfma_f32_16x16x32_f16 v[20:23], v[44:47], v[64:67], 0
    ds_read_b128 v[64:67], v11 offset:0
    v_mfma_f32_16x16x32_f16 v[12:15], v[32:35], v[68:71], v[12:15]
    v_mfma_f32_16x16x32_f16 v[16:19], v[36:39], v[68:71], v[16:19]
    v_mfma_f32_16x16x32_f16 v[20:23], v[40:43], v[68:71], v[20:23]
    ds_read_b128 v[68:71], v11 offset:512
    v_mfma_f32_16x16x32_f16 v[16:19], v[32:35], v[72:75], v[16:19]
    v_mfma_f32_16x16x32_f16 v[20:23], v[36:39], v[72:75], v[20:23]
    ds_read_b128 v[72:75], v11 offset:1024
    v_mfma_f32_16x16x32_f16 v[20:23], v[32:35], v[76:79], v[20:23]
    ds_read_b128 v[76:79], v11 offset:1536
    v_add_u32 v107, 16, v107
    v_add_u32 v106, 32, v106
    v_add_u32 v93, 64, v93
    s_mov_b32 s56, 1
CV_LL:
    s_waitcnt lgkmcnt(4)
    v_perm_b32 v36, v92, v91, v126
    v_perm_b32 v37, v92, v91, v127
    v_perm_b32 v38, v91, v90, v126
    v_perm_b32 v39, v91, v90, v127
    v_perm_b32 v40, v95, v94, v118
    v_perm_b32 v41, v95, v94, v119
    v_perm_b32 v42, v95, v94, v120
    v_perm_b32 v43, v95, v94, v121
    v_perm_b32 v44, v97, v96, v118
    v_perm_b32 v45, v97, v96, v119
    v_perm_b32 v46, v97, v96, v120
    v_perm_b32 v47, v97, v96, v121
    v_perm_b32 v32, v88, v87, v89
    v_perm_b32 v33, v87, v86, v89
    v_perm_b32 v34, v86, v85, v89
    v_perm_b32 v35, v85, v84, v89
    v_add_u32 v11, -64, v11
    s_waitcnt lgkmcnt(0)
    ds_read2_b32 v[90:91], v106 offset0:0 offset1:1
    ds_read_b32 v92, v106 offset:8
    ds_read2_b32 v[94:95], v107 offset0:0 offset1:1
    ds_read2_b32 v[96:97], v107 offset0:32 offset1:33
    ds_read2_b32 v[84:85], v93 offset0:0 offset1:1
    ds_read2_b32 v[86:87], v93 offset0:2 offset1:3
    ds_read_b32 v88, v93 offset:16
    v_mfma_f32_16x16x32_f16 v[12:15], v[36:39], v[64:67], v[12:15]
    v_mfma_f32_16x16x32_f16 v[16:19], v[40:43], v[64:67], v[16:19]
    v_mfma_f32_16x16x32_f16 v[20:23], v[44:47], v[64:67], v[20:23]
    ds_read_b128 v[64:67], v11 offset:0
    v_mfma_f32_16x16x32_f16 v[12:15], v[32:35], v[68:71], v[12:15]
    v_mfma_f32_16x16x32_f16 v[16:19], v[36:39], v[68:71], v[16:19]
    v_mfma_f32_16x16x32_f16 v[20:23], v[40:43], v[68:71], v[20:23]
    ds_read_b128 v[68:71], v11 offset:512
    v_mfma_f32_16x16x32_f16 v[16:19], v[32:35], v[72:75], v[16:19]
    v_mfma_f32_16x16x32_f16 v[20:23], v[36:39], v[72:75], v[20:23]
    ds_read_b128 v[72:75], v11 offset:1024
    v_mfma_f32_16x16x32_f16 v[20:23], v[32:35], v[76:79], v[20:23]
    ds_read_b128 v[76:79], v11 offset:1536
    v_add_u32 v107, 16, v107
    v_add_u32 v106, 32, v106
    v_add_u32 v93, 64, v93
    s_add_u32 s56, s56, 1
    s_cmp_lt_u32 s56, 8
    s_cbranch_scc1 CV_LL
    s_waitcnt lgkmcnt(0)
    s_lshl_b32 s56, s33, 12
    v_lshl_add_u32 v64, v1, 3, s56
    s_mov_b32 s59, s58
    v_pk_mul_f32 v[12:13], v[12:13], s[58:59]
    v_pk_mul_f32 v[14:15], v[14:15], s[58:59]
    v_cvt_pk_bf16_f32 v12, v12, v13
    v_cvt_pk_bf16_f32 v13, v14, v15
    ds_write_b64 v64, v[12:13] offset:28928
    v_pk_mul_f32 v[16:17], v[16:17], s[58:59]
    v_pk_mul_f32 v[18:19], v[18:19], s[58:59]
    v_cvt_pk_bf16_f32 v16, v16, v17
    v_cvt_pk_bf16_f32 v17, v18, v19
    ds_write_b64 v64, v[16:17] offset:29440
    v_pk_mul_f32 v[20:21], v[20:21], s[58:59]
    v_pk_mul_f32 v[22:23], v[22:23], s[58:59]
    v_cvt_pk_bf16_f32 v20, v20, v21
    v_cvt_pk_bf16_f32 v21, v22, v23
    ds_write_b64 v64, v[20:21] offset:29952
    s_branch CV_DONE
CV_IDLE:
    s_cmp_lt_u32 s2, 112
    s_cbranch_scc1 CV_DONE
    s_sub_u32 s44, s2, 112
    s_and_b32 s56, s44, 0xf0
    s_and_b32 s57, s44, 7
    s_lshl_b32 s57, s57, 1
    s_or_b32 s56, s56, s57
    s_bfe_u32 s57, s44, 0x10003
    s_or_b32 s44, s56, s57
    s_cmp_ge_u32 s3, 12
    s_cbranch_scc1 WL_GUA
    s_and_b32 s56, s3, 3
    s_cmp_eq_u32 s56, 3
    s_cbranch_scc1 WL_ENDA
    s_cmp_lt_u32 s3, 4
    s_cbranch_scc1 WL_ENDA
    s_lshr_b32 s57, s3, 3
    s_sub_u32 s56, s3, 4
    s_sub_u32 s56, s56, s57
    s_lshl_b32 s56, s56, 7
    s_mul_i32 s57, s44, 36864
    s_add_u32 s56, s56, s57
    v_mul_u32_u24 v12, 9216, v5
    v_lshl_add_u32 v12, v3, 3, v12
    v_add_u32 v12, s56, v12
    v_add_u32 v13, 4608, v12
    global_load_dwordx2 v[44:45], v12, s[26:27] offset:0
    global_load_dwordx2 v[46:47], v12, s[26:27] offset:1152
    global_load_dwordx2 v[48:49], v12, s[26:27] offset:2304
    global_load_dwordx2 v[50:51], v12, s[26:27] offset:3456
    global_load_dwordx2 v[52:53], v13, s[26:27] offset:0
    global_load_dwordx2 v[54:55], v13, s[26:27] offset:1152
    global_load_dwordx2 v[56:57], v13, s[26:27] offset:2304
    global_load_dwordx2 v[58:59], v13, s[26:27] offset:3456
    s_mov_b32 s56, 0x05040100
    s_mov_b32 s57, 0x07060302
    s_cmp_ge_u32 s3, 8
    s_cbranch_scc1 WL_D1A
    v_add_u32 v12, 768, v12
    v_add_u32 v13, 768, v13
    global_load_dwordx2 v[60:61], v12, s[26:27] offset:0
    global_load_dwordx2 v[62:63], v12, s[26:27] offset:1152
    global_load_dwordx2 v[64:65], v12, s[26:27] offset:2304
    global_load_dwordx2 v[66:67], v12, s[26:27] offset:3456
    global_load_dwordx2 v[68:69], v13, s[26:27] offset:0
    global_load_dwordx2 v[70:71], v13, s[26:27] offset:1152
    global_load_dwordx2 v[72:73], v13, s[26:27] offset:2304
    global_load_dwordx2 v[74:75], v13, s[26:27] offset:3456
    s_waitcnt vmcnt(0)
    v_perm_b32 v92, v62, v60, s56
    v_perm_b32 v93, v66, v64, s56
    v_perm_b32 v94, v70, v68, s56
    v_perm_b32 v95, v74, v72, s56
    v_perm_b32 v96, v62, v60, s57
    v_perm_b32 v97, v66, v64, s57
    v_perm_b32 v98, v70, v68, s57
    v_perm_b32 v99, v74, v72, s57
    v_perm_b32 v100, v63, v61, s56
    v_perm_b32 v101, v67, v65, s56
    v_perm_b32 v102, v71, v69, s56
    v_perm_b32 v103, v75, v73, s56
    v_perm_b32 v104, v63, v61, s57
    v_perm_b32 v105, v67, v65, s57
    v_perm_b32 v106, v71, v69, s57
    v_perm_b32 v107, v75, v73, s57
WL_D1A:
    s_waitcnt vmcnt(0)
    v_perm_b32 v76, v46, v44, s56
    v_perm_b32 v77, v50, v48, s56
    v_perm_b32 v78, v54, v52, s56
    v_perm_b32 v79, v58, v56, s56
    v_perm_b32 v80, v46, v44, s57
    v_perm_b32 v81, v50, v48, s57
    v_perm_b32 v82, v54, v52, s57
    v_perm_b32 v83, v58, v56, s57
    v_perm_b32 v84, v47, v45, s56
    v_perm_b32 v85, v51, v49, s56
    v_perm_b32 v86, v55, v53, s56
    v_perm_b32 v87, v59, v57, s56
    v_perm_b32 v88, v47, v45, s57
    v_perm_b32 v89, v51, v49, s57
    v_perm_b32 v90, v55, v53, s57
    v_perm_b32 v91, v59, v57, s57
    s_branch WL_ENDA
WL_GUA:
    s_sub_u32 s56, s3, 12
    s_mul_i32 s57, s56, 5
    s_cmp_eq_u32 s56, 3
    s_cselect_b32 s57, 14, s57
    s_mul_i32 s57, s57, 294912
    s_lshl_b32 s58, s44, 6
    s_add_u32 s57, s57, s58
    v_mul_u32_u24 v12, 73728, v5
    v_and_b32 v13, 7, v3
    v_lshl_add_u32 v12, v13, 3, v12
    v_add_u32 v12, s57, v12
    v_mov_b32 v13, 0
    v_mov_b32 v14, s22
    v_mov_b32 v15, s23
    v_mov_b32 v16, s24
    v_mov_b32 v17, s25
    v_cmp_lt_u32 vcc, 7, v3
    s_nop 1
    v_cndmask_b32 v14, v14, v16, vcc
    v_cndmask_b32 v15, v15, v17, vcc
    v_lshl_add_u64 v[14:15], v[12:13], 0, v[14:15]
    s_mov_b32 s56, 9216
    s_mov_b32 s57, 0
    s_mov_b32 s58, 230400
    s_mov_b32 s59, 0
    global_load_dwordx2 v[48:49], v[14:15], off
    v_lshl_add_u64 v[14:15], v[14:15], 0, s[56:57]
    global_load_dwordx2 v[50:51], v[14:15], off
    v_lshl_add_u64 v[14:15], v[14:15], 0, s[56:57]
    global_load_dwordx2 v[52:53], v[14:15], off
    v_lshl_add_u64 v[14:15], v[14:15], 0, s[56:57]
    global_load_dwordx2 v[54:55], v[14:15], off
    v_lshl_add_u64 v[14:15], v[14:15], 0, s[56:57]
    global_load_dwordx2 v[56:57], v[14:15], off
    v_lshl_add_u64 v[14:15], v[14:15], 0, s[56:57]
    global_load_dwordx2 v[58:59], v[14:15], off
    v_lshl_add_u64 v[14:15], v[14:15], 0, s[56:57]
    global_load_dwordx2 v[60:61], v[14:15], off
    v_lshl_add_u64 v[14:15], v[14:15], 0, s[56:57]
    global_load_dwordx2 v[62:63], v[14:15], off
    v_lshl_add_u64 v[14:15], v[14:15], 0, s[58:59]
    global_load_dwordx2 v[64:65], v[14:15], off
    v_lshl_add_u64 v[14:15], v[14:15], 0, s[56:57]
    global_load_dwordx2 v[66:67], v[14:15], off
    v_lshl_add_u64 v[14:15], v[14:15], 0, s[56:57]
    global_load_dwordx2 v[68:69], v[14:15], off
    v_lshl_add_u64 v[14:15], v[14:15], 0, s[56:57]
    global_load_dwordx2 v[70:71], v[14:15], off
    v_lshl_add_u64 v[14:15], v[14:15], 0, s[56:57]
    global_load_dwordx2 v[72:73], v[14:15], off
    v_lshl_add_u64 v[14:15], v[14:15], 0, s[56:57]
    global_load_dwordx2 v[74:75], v[14:15], off
    v_lshl_add_u64 v[14:15], v[14:15], 0, s[56:57]
    global_load_dwordx2 v[76:77], v[14:15], off
    v_lshl_add_u64 v[14:15], v[14:15], 0, s[56:57]
    global_load_dwordx2 v[78:79], v[14:15], off
    v_lshl_add_u64 v[14:15], v[14:15], 0, s[58:59]
    global_load_dwordx2 v[80:81], v[14:15], off
    v_lshl_add_u64 v[14:15], v[14:15], 0, s[56:57]
    global_load_dwordx2 v[82:83], v[14:15], off
    v_lshl_add_u64 v[14:15], v[14:15], 0, s[56:57]
    global_load_dwordx2 v[84:85], v[14:15], off
    v_lshl_add_u64 v[14:15], v[14:15], 0, s[56:57]
    global_load_dwordx2 v[86:87], v[14:15], off
    v_lshl_add_u64 v[14:15], v[14:15], 0, s[56:57]
    global_load_dwordx2 v[88:89], v[14:15], off
    v_lshl_add_u64 v[14:15], v[14:15], 0, s[56:57]
    global_load_dwordx2 v[90:91], v[14:15], off
    v_lshl_add_u64 v[14:15], v[14:15], 0, s[56:57]
    global_load_dwordx2 v[92:93], v[14:15], off
    v_lshl_add_u64 v[14:15], v[14:15], 0, s[56:57]
    global_load_dwordx2 v[94:95], v[14:15], off
    v_lshl_add_u64 v[14:15], v[14:15], 0, s[58:59]
    global_load_dwordx2 v[96:97], v[14:15], off
    v_lshl_add_u64 v[14:15], v[14:15], 0, s[56:57]
    global_load_dwordx2 v[98:99], v[14:15], off
    v_lshl_add_u64 v[14:15], v[14:15], 0, s[56:57]
    global_load_dwordx2 v[100:101], v[14:15], off
    v_lshl_add_u64 v[14:15], v[14:15], 0, s[56:57]
    global_load_dwordx2 v[102:103], v[14:15], off
    v_lshl_add_u64 v[14:15], v[14:15], 0, s[56:57]
    global_load_dwordx2 v[104:105], v[14:15], off
    v_lshl_add_u64 v[14:15], v[14:15], 0, s[56:57]
    global_load_dwordx2 v[106:107], v[14:15], off
    v_lshl_add_u64 v[14:15], v[14:15], 0, s[56:57]
    global_load_dwordx2 v[108:109], v[14:15], off
    v_lshl_add_u64 v[14:15], v[14:15], 0, s[56:57]
    global_load_dwordx2 v[110:111], v[14:15], off
    v_lshl_add_u64 v[14:15], v[14:15], 0, s[58:59]
    s_cmp_ge_u32 s3, 14
    s_cbranch_scc1 WL_ENDA
    global_load_dwordx2 v[112:113], v[14:15], off
    v_lshl_add_u64 v[14:15], v[14:15], 0, s[56:57]
    global_load_dwordx2 v[114:115], v[14:15], off
    v_lshl_add_u64 v[14:15], v[14:15], 0, s[56:57]
    global_load_dwordx2 v[116:117], v[14:15], off
    v_lshl_add_u64 v[14:15], v[14:15], 0, s[56:57]
    global_load_dwordx2 v[118:119], v[14:15], off
    v_lshl_add_u64 v[14:15], v[14:15], 0, s[56:57]
    global_load_dwordx2 v[120:121], v[14:15], off
    v_lshl_add_u64 v[14:15], v[14:15], 0, s[56:57]
    global_load_dwordx2 v[122:123], v[14:15], off
    v_lshl_add_u64 v[14:15], v[14:15], 0, s[56:57]
    global_load_dwordx2 v[124:125], v[14:15], off
    v_lshl_add_u64 v[14:15], v[14:15], 0, s[56:57]
    global_load_dwordx2 v[126:127], v[14:15], off
WL_ENDA:
CV_DONE:
    s_setprio 0
    v_lshrrev_b32 v12, 7, v0
    v_lshlrev_b32 v12, 5, v12
    v_and_b32 v13, 30, v0
    v_bfe_u32 v14, v0, 6, 1
    v_add3_u32 v12, v12, v13, v14
    v_mul_u32_u24 v12, 12288, v12
    v_and_b32 v13, 32, v0
    v_and_b32 v14, 1, v0
    v_lshlrev_b32 v14, 4, v14
    v_add3_u32 v12, v12, v13, v14
    v_lshlrev_b32 v13, 2, v0
    v_mov_b32 v9, s48
    s_lshl_b32 s38, s2, 6
    s_add_u32 s38, s38, 3149824
    s_waitcnt lgkmcnt(0)
    s_barrier
    ds_read_b32 v6, v13 offset:28416
    ds_read_b32 v7, v13 offset:32512
    ds_read_b32 v8, v13 offset:36608
    s_waitcnt lgkmcnt(0)
    buffer_store_dwordx4 v[6:9], v12, s[40:43], s38 offen sc1
    s_branch LN2
SPARE:
    s_waitcnt vmcnt(0) lgkmcnt(0)
    s_sleep 16
    s_sub_u32 s44, s2, 112
    s_and_b32 s56, s44, 0xf0
    s_and_b32 s57, s44, 7
    s_lshl_b32 s57, s57, 1
    s_or_b32 s56, s56, s57
    s_bfe_u32 s57, s44, 0x10003
    s_or_b32 s44, s56, s57
    s_cmp_ge_u32 s3, 12
    s_cbranch_scc1 WL_GUB
    s_and_b32 s56, s3, 3
    s_cmp_eq_u32 s56, 3
    s_cbranch_scc1 WL_ENDB
    s_cmp_lt_u32 s3, 4
    s_cbranch_scc1 WL_ENDB
    s_lshr_b32 s57, s3, 3
    s_sub_u32 s56, s3, 4
    s_sub_u32 s56, s56, s57
    s_lshl_b32 s56, s56, 7
    s_mul_i32 s57, s44, 36864
    s_add_u32 s56, s56, s57
    v_mul_u32_u24 v12, 9216, v5
    v_lshl_add_u32 v12, v3, 3, v12
    v_add_u32 v12, s56, v12
    v_add_u32 v13, 4608, v12
    global_load_dwordx2 v[44:45], v12, s[26:27] offset:0
    global_load_dwordx2 v[46:47], v12, s[26:27] offset:1152
    global_load_dwordx2 v[48:49], v12, s[26:27] offset:2304
    global_load_dwordx2 v[50:51], v12, s[26:27] offset:3456
    global_load_dwordx2 v[52:53], v13, s[26:27] offset:0
    global_load_dwordx2 v[54:55], v13, s[26:27] offset:1152
    global_load_dwordx2 v[56:57], v13, s[26:27] offset:2304
    global_load_dwordx2 v[58:59], v13, s[26:27] offset:3456
    s_mov_b32 s56, 0x05040100
    s_mov_b32 s57, 0x07060302
    s_cmp_ge_u32 s3, 8
    s_cbranch_scc1 WL_D1B
    v_add_u32 v12, 768, v12
    v_add_u32 v13, 768, v13
    global_load_dwordx2 v[60:61], v12, s[26:27] offset:0
    global_load_dwordx2 v[62:63], v12, s[26:27] offset:1152
    global_load_dwordx2 v[64:65], v12, s[26:27] offset:2304
    global_load_dwordx2 v[66:67], v12, s[26:27] offset:3456
    global_load_dwordx2 v[68:69], v13, s[26:27] offset:0
    global_load_dwordx2 v[70:71], v13, s[26:27] offset:1152
    global_load_dwordx2 v[72:73], v13, s[26:27] offset:2304
    global_load_dwordx2 v[74:75], v13, s[26:27] offset:3456
    s_waitcnt vmcnt(0)
    v_perm_b32 v92, v62, v60, s56
    v_perm_b32 v93, v66, v64, s56
    v_perm_b32 v94, v70, v68, s56
    v_perm_b32 v95, v74, v72, s56
    v_perm_b32 v96, v62, v60, s57
    v_perm_b32 v97, v66, v64, s57
    v_perm_b32 v98, v70, v68, s57
    v_perm_b32 v99, v74, v72, s57
    v_perm_b32 v100, v63, v61, s56
    v_perm_b32 v101, v67, v65, s56
    v_perm_b32 v102, v71, v69, s56
    v_perm_b32 v103, v75, v73, s56
    v_perm_b32 v104, v63, v61, s57
    v_perm_b32 v105, v67, v65, s57
    v_perm_b32 v106, v71, v69, s57
    v_perm_b32 v107, v75, v73, s57
WL_D1B:
    s_waitcnt vmcnt(0)
    v_perm_b32 v76, v46, v44, s56
    v_perm_b32 v77, v50, v48, s56
    v_perm_b32 v78, v54, v52, s56
    v_perm_b32 v79, v58, v56, s56
    v_perm_b32 v80, v46, v44, s57
    v_perm_b32 v81, v50, v48, s57
    v_perm_b32 v82, v54, v52, s57
    v_perm_b32 v83, v58, v56, s57
    v_perm_b32 v84, v47, v45, s56
    v_perm_b32 v85, v51, v49, s56
    v_perm_b32 v86, v55, v53, s56
    v_perm_b32 v87, v59, v57, s56
    v_perm_b32 v88, v47, v45, s57
    v_perm_b32 v89, v51, v49, s57
    v_perm_b32 v90, v55, v53, s57
    v_perm_b32 v91, v59, v57, s57
    s_branch WL_ENDB
WL_GUB:
    s_sub_u32 s56, s3, 12
    s_mul_i32 s57, s56, 5
    s_cmp_eq_u32 s56, 3
    s_cselect_b32 s57, 14, s57
    s_mul_i32 s57, s57, 294912
    s_lshl_b32 s58, s44, 6
    s_add_u32 s57, s57, s58
    v_mul_u32_u24 v12, 73728, v5
    v_and_b32 v13, 7, v3
    v_lshl_add_u32 v12, v13, 3, v12
    v_add_u32 v12, s57, v12
    v_mov_b32 v13, 0
    v_mov_b32 v14, s22
    v_mov_b32 v15, s23
    v_mov_b32 v16, s24
    v_mov_b32 v17, s25
    v_cmp_lt_u32 vcc, 7, v3
    s_nop 1
    v_cndmask_b32 v14, v14, v16, vcc
    v_cndmask_b32 v15, v15, v17, vcc
    v_lshl_add_u64 v[14:15], v[12:13], 0, v[14:15]
    s_mov_b32 s56, 9216
    s_mov_b32 s57, 0
    s_mov_b32 s58, 230400
    s_mov_b32 s59, 0
    global_load_dwordx2 v[48:49], v[14:15], off
    v_lshl_add_u64 v[14:15], v[14:15], 0, s[56:57]
    global_load_dwordx2 v[50:51], v[14:15], off
    v_lshl_add_u64 v[14:15], v[14:15], 0, s[56:57]
    global_load_dwordx2 v[52:53], v[14:15], off
    v_lshl_add_u64 v[14:15], v[14:15], 0, s[56:57]
    global_load_dwordx2 v[54:55], v[14:15], off
    v_lshl_add_u64 v[14:15], v[14:15], 0, s[56:57]
    global_load_dwordx2 v[56:57], v[14:15], off
    v_lshl_add_u64 v[14:15], v[14:15], 0, s[56:57]
    global_load_dwordx2 v[58:59], v[14:15], off
    v_lshl_add_u64 v[14:15], v[14:15], 0, s[56:57]
    global_load_dwordx2 v[60:61], v[14:15], off
    v_lshl_add_u64 v[14:15], v[14:15], 0, s[56:57]
    global_load_dwordx2 v[62:63], v[14:15], off
    v_lshl_add_u64 v[14:15], v[14:15], 0, s[58:59]
    global_load_dwordx2 v[64:65], v[14:15], off
    v_lshl_add_u64 v[14:15], v[14:15], 0, s[56:57]
    global_load_dwordx2 v[66:67], v[14:15], off
    v_lshl_add_u64 v[14:15], v[14:15], 0, s[56:57]
    global_load_dwordx2 v[68:69], v[14:15], off
    v_lshl_add_u64 v[14:15], v[14:15], 0, s[56:57]
    global_load_dwordx2 v[70:71], v[14:15], off
    v_lshl_add_u64 v[14:15], v[14:15], 0, s[56:57]
    global_load_dwordx2 v[72:73], v[14:15], off
    v_lshl_add_u64 v[14:15], v[14:15], 0, s[56:57]
    global_load_dwordx2 v[74:75], v[14:15], off
    v_lshl_add_u64 v[14:15], v[14:15], 0, s[56:57]
    global_load_dwordx2 v[76:77], v[14:15], off
    v_lshl_add_u64 v[14:15], v[14:15], 0, s[56:57]
    global_load_dwordx2 v[78:79], v[14:15], off
    v_lshl_add_u64 v[14:15], v[14:15], 0, s[58:59]
    global_load_dwordx2 v[80:81], v[14:15], off
    v_lshl_add_u64 v[14:15], v[14:15], 0, s[56:57]
    global_load_dwordx2 v[82:83], v[14:15], off
    v_lshl_add_u64 v[14:15], v[14:15], 0, s[56:57]
    global_load_dwordx2 v[84:85], v[14:15], off
    v_lshl_add_u64 v[14:15], v[14:15], 0, s[56:57]
    global_load_dwordx2 v[86:87], v[14:15], off
    v_lshl_add_u64 v[14:15], v[14:15], 0, s[56:57]
    global_load_dwordx2 v[88:89], v[14:15], off
    v_lshl_add_u64 v[14:15], v[14:15], 0, s[56:57]
    global_load_dwordx2 v[90:91], v[14:15], off
    v_lshl_add_u64 v[14:15], v[14:15], 0, s[56:57]
    global_load_dwordx2 v[92:93], v[14:15], off
    v_lshl_add_u64 v[14:15], v[14:15], 0, s[56:57]
    global_load_dwordx2 v[94:95], v[14:15], off
    v_lshl_add_u64 v[14:15], v[14:15], 0, s[58:59]
    global_load_dwordx2 v[96:97], v[14:15], off
    v_lshl_add_u64 v[14:15], v[14:15], 0, s[56:57]
    global_load_dwordx2 v[98:99], v[14:15], off
    v_lshl_add_u64 v[14:15], v[14:15], 0, s[56:57]
    global_load_dwordx2 v[100:101], v[14:15], off
    v_lshl_add_u64 v[14:15], v[14:15], 0, s[56:57]
    global_load_dwordx2 v[102:103], v[14:15], off
    v_lshl_add_u64 v[14:15], v[14:15], 0, s[56:57]
    global_load_dwordx2 v[104:105], v[14:15], off
    v_lshl_add_u64 v[14:15], v[14:15], 0, s[56:57]
    global_load_dwordx2 v[106:107], v[14:15], off
    v_lshl_add_u64 v[14:15], v[14:15], 0, s[56:57]
    global_load_dwordx2 v[108:109], v[14:15], off
    v_lshl_add_u64 v[14:15], v[14:15], 0, s[56:57]
    global_load_dwordx2 v[110:111], v[14:15], off
    v_lshl_add_u64 v[14:15], v[14:15], 0, s[58:59]
    s_cmp_ge_u32 s3, 14
    s_cbranch_scc1 WL_ENDB
    global_load_dwordx2 v[112:113], v[14:15], off
    v_lshl_add_u64 v[14:15], v[14:15], 0, s[56:57]
    global_load_dwordx2 v[114:115], v[14:15], off
    v_lshl_add_u64 v[14:15], v[14:15], 0, s[56:57]
    global_load_dwordx2 v[116:117], v[14:15], off
    v_lshl_add_u64 v[14:15], v[14:15], 0, s[56:57]
    global_load_dwordx2 v[118:119], v[14:15], off
    v_lshl_add_u64 v[14:15], v[14:15], 0, s[56:57]
    global_load_dwordx2 v[120:121], v[14:15], off
    v_lshl_add_u64 v[14:15], v[14:15], 0, s[56:57]
    global_load_dwordx2 v[122:123], v[14:15], off
    v_lshl_add_u64 v[14:15], v[14:15], 0, s[56:57]
    global_load_dwordx2 v[124:125], v[14:15], off
    v_lshl_add_u64 v[14:15], v[14:15], 0, s[56:57]
    global_load_dwordx2 v[126:127], v[14:15], off
WL_ENDB:
    s_cmp_lg_u32 s3, 0
    s_cbranch_scc1 SP_BAR
    v_lshlrev_b32 v10, 4, v1
    s_mul_i32 s38, s2, 12288
    s_add_u32 s38, s38, 3149824
    s_mov_b64 exec, 15
    s_mov_b32 s49, 0
P_4:
    buffer_load_dwordx4 v[6:9], v10, s[40:43], s38 offen sc1
PC_6:
    s_add_u32 s49, s49, 1
    s_waitcnt vmcnt(0)
    v_cmp_ne_u32 vcc, s48, v9
    s_nop 0
    s_cbranch_vccz PD_5
    s_sleep 2
    s_cmp_lt_u32 s49, 60000
    s_cbranch_scc1 P_4
PD_5:
    s_mov_b64 exec, -1
SP_BAR:
    s_barrier
    s_cmp_ge_u32 s3, 12
    s_cbranch_scc1 LN2
    v_lshlrev_b32 v28, 2, v3
    ds_read_b32 v117, v28 offset:21376
    s_waitcnt lgkmcnt(0)
    v_add_f32_dpp v117, v117, v117 row_ror:8 row_mask:0xf bank_mask:0xf
    s_nop 1
    v_add_f32_dpp v117, v117, v117 row_ror:4 row_mask:0xf bank_mask:0xf
    s_nop 1
    v_add_f32_dpp v117, v117, v117 row_ror:2 row_mask:0xf bank_mask:0xf
    s_nop 1
    v_add_f32_dpp v117, v117, v117 row_ror:1 row_mask:0xf bank_mask:0xf
LN2:
    s_cmp_ge_u32 s3, 12
    s_cbranch_scc1 LN2_H
    v_lshlrev_b32 v10, 6, v4
    v_lshl_add_u32 v10, v5, 4, v10
    s_mul_i32 s38, s2, 12288
    s_add_u32 s38, s38, 3149824
    v_lshlrev_b32 v12, 16, v108
    v_and_b32 v13, 0xffff0000, v108
    v_lshlrev_b32 v18, 16, v111
    v_and_b32 v19, 0xffff0000, v111
    v_pk_add_f32 v[24:25], v[12:13], v[18:19]
    v_lshlrev_b32 v14, 16, v109
    v_and_b32 v15, 0xffff0000, v109
    v_lshlrev_b32 v20, 16, v112
    v_and_b32 v21, 0xffff0000, v112
    v_pk_add_f32 v[26:27], v[14:15], v[20:21]
    v_lshlrev_b32 v16, 16, v110
    v_and_b32 v17, 0xffff0000, v110
    v_lshlrev_b32 v22, 16, v113
    v_and_b32 v23, 0xffff0000, v113
    v_pk_add_f32 v[28:29], v[16:17], v[22:23]
    v_lshl_add_u32 v11, v5, 4, v2
    v_lshlrev_b32 v11, 5, v11
    v_lshlrev_b32 v44, 5, v1
    s_mov_b32 s52, 0x3ae38e39
    s_lshl_b32 s39, s2, 5
    s_add_u32 s39, s39, 6295552
    v_lshlrev_b32 v45, 3, v5
    s_waitcnt vmcnt(0)
    s_mov_b32 s49, 0
P_7:
    buffer_load_dwordx4 v[6:9], v10, s[40:43], s38 offen sc1
PC_9:
    s_add_u32 s49, s49, 1
    s_waitcnt vmcnt(0)
    v_cmp_ne_u32 vcc, s48, v9
    s_nop 0
    s_cbranch_vccz PD_8
    s_cmp_lt_u32 s49, 60000
    s_cbranch_scc1 P_7
PD_8:
    v_lshlrev_b32 v30, 16, v6
    v_and_b32 v31, 0xffff0000, v6
    v_lshlrev_b32 v32, 16, v7
    v_and_b32 v33, 0xffff0000, v7
    v_lshlrev_b32 v34, 16, v8
    v_and_b32 v35, 0xffff0000, v8
    v_pk_add_f32 v[24:25], v[24:25], v[30:31]
    v_pk_add_f32 v[26:27], v[26:27], v[32:33]
    v_pk_add_f32 v[28:29], v[28:29], v[34:35]
    v_pk_add_f32 v[36:37], v[24:25], v[26:27]
    v_pk_mul_f32 v[38:39], v[24:25], v[24:25]
    v_pk_mul_f32 v[40:41], v[24:25], v[114:115] op_sel_hi:[1,0]
    v_pk_add_f32 v[36:37], v[36:37], v[28:29]
    v_pk_fma_f32 v[38:39], v[26:27], v[26:27], v[38:39]
    v_pk_fma_f32 v[40:41], v[26:27], v[114:115], v[40:41] op_sel:[0,1,0] op_sel_hi:[1,1,1]
    v_pk_fma_f32 v[38:39], v[28:29], v[28:29], v[38:39]
    v_pk_fma_f32 v[40:41], v[28:29], v[116:117], v[40:41] op_sel_hi:[1,0,1]
    v_add_f32_dpp v36, v36, v36 row_ror:8 row_mask:0xf bank_mask:0xf
    v_add_f32_dpp v37, v37, v37 row_ror:8 row_mask:0xf bank_mask:0xf
    v_add_f32_dpp v38, v38, v38 row_ror:8 row_mask:0xf bank_mask:0xf
    v_add_f32_dpp v39, v39, v39 row_ror:8 row_mask:0xf bank_mask:0xf
    v_add_f32_dpp v40, v40, v40 row_ror:8 row_mask:0xf bank_mask:0xf
    v_add_f32_dpp v41, v41, v41 row_ror:8 row_mask:0xf bank_mask:0xf
    v_add_f32_dpp v36, v36, v36 row_ror:4 row_mask:0xf bank_mask:0xf
    v_add_f32_dpp v37, v37, v37 row_ror:4 row_mask:0xf bank_mask:0xf
    v_add_f32_dpp v38, v38, v38 row_ror:4 row_mask:0xf bank_mask:0xf
    v_add_f32_dpp v39, v39, v39 row_ror:4 row_mask:0xf bank_mask:0xf
    v_add_f32_dpp v40, v40, v40 row_ror:4 row_mask:0xf bank_mask:0xf
    v_add_f32_dpp v41, v41, v41 row_ror:4 row_mask:0xf bank_mask:0xf
    v_add_f32_dpp v36, v36, v36 row_ror:2 row_mask:0xf bank_mask:0xf
    v_add_f32_dpp v37, v37, v37 row_ror:2 row_mask:0xf bank_mask:0xf
    v_add_f32_dpp v38, v38, v38 row_ror:2 row_mask:0xf bank_mask:0xf
    v_add_f32_dpp v39, v39, v39 row_ror:2 row_mask:0xf bank_mask:0xf
    v_add_f32_dpp v40, v40, v40 row_ror:2 row_mask:0xf bank_mask:0xf
    v_add_f32_dpp v41, v41, v41 row_ror:2 row_mask:0xf bank_mask:0xf
    v_add_f32_dpp v36, v36, v36 row_ror:1 row_mask:0xf bank_mask:0xf
    v_add_f32_dpp v37, v37, v37 row_ror:1 row_mask:0xf bank_mask:0xf
    v_add_f32_dpp v38, v38, v38 row_ror:1 row_mask:0xf bank_mask:0xf
    v_add_f32_dpp v39, v39, v39 row_ror:1 row_mask:0xf bank_mask:0xf
    v_add_f32_dpp v40, v40, v40 row_ror:1 row_mask:0xf bank_mask:0xf
    v_add_f32_dpp v41, v41, v41 row_ror:1 row_mask:0xf bank_mask:0xf
    s_mov_b64 exec, s[54:55]
    ds_write_b128 v11, v[36:39] offset:19328
    ds_write_b64 v11, v[40:41] offset:19344
    s_mov_b64 exec, -1
    s_waitcnt lgkmcnt(0)
    s_barrier
    ds_read_b128 v[36:39], v44 offset:19328
    ds_read_b64 v[40:41], v44 offset:19344
    s_waitcnt lgkmcnt(0)
    v_add_f32_dpp v36, v36, v36 row_ror:8 row_mask:0xf bank_mask:0xf
    v_add_f32_dpp v37, v37, v37 row_ror:8 row_mask:0xf bank_mask:0xf
    v_add_f32_dpp v38, v38, v38 row_ror:8 row_mask:0xf bank_mask:0xf
    v_add_f32_dpp v39, v39, v39 row_ror:8 row_mask:0xf bank_mask:0xf
    v_add_f32_dpp v40, v40, v40 row_ror:8 row_mask:0xf bank_mask:0xf
    v_add_f32_dpp v41, v41, v41 row_ror:8 row_mask:0xf bank_mask:0xf
    v_add_f32_dpp v36, v36, v36 row_ror:4 row_mask:0xf bank_mask:0xf
    v_add_f32_dpp v37, v37, v37 row_ror:4 row_mask:0xf bank_mask:0xf
    v_add_f32_dpp v38, v38, v38 row_ror:4 row_mask:0xf bank_mask:0xf
    v_add_f32_dpp v39, v39, v39 row_ror:4 row_mask:0xf bank_mask:0xf
    v_add_f32_dpp v40, v40, v40 row_ror:4 row_mask:0xf bank_mask:0xf
    v_add_f32_dpp v41, v41, v41 row_ror:4 row_mask:0xf bank_mask:0xf
    v_add_f32_dpp v36, v36, v36 row_ror:2 row_mask:0xf bank_mask:0xf
    v_add_f32_dpp v37, v37, v37 row_ror:2 row_mask:0xf bank_mask:0xf
    v_add_f32_dpp v38, v38, v38 row_ror:2 row_mask:0xf bank_mask:0xf
    v_add_f32_dpp v39, v39, v39 row_ror:2 row_mask:0xf bank_mask:0xf
    v_add_f32_dpp v40, v40, v40 row_ror:2 row_mask:0xf bank_mask:0xf
    v_add_f32_dpp v41, v41, v41 row_ror:2 row_mask:0xf bank_mask:0xf
    v_add_f32_dpp v36, v36, v36 row_ror:1 row_mask:0xf bank_mask:0xf
    v_add_f32_dpp v37, v37, v37 row_ror:1 row_mask:0xf bank_mask:0xf
    v_add_f32_dpp v38, v38, v38 row_ror:1 row_mask:0xf bank_mask:0xf
    v_add_f32_dpp v39, v39, v39 row_ror:1 row_mask:0xf bank_mask:0xf
    v_add_f32_dpp v40, v40, v40 row_ror:1 row_mask:0xf bank_mask:0xf
    v_add_f32_dpp v41, v41, v41 row_ror:1 row_mask:0xf bank_mask:0xf
    v_pk_mul_f32 v[36:37], v[36:37], s[52:53] op_sel_hi:[1,0]
    v_pk_mul_f32 v[38:39], v[38:39], s[52:53] op_sel_hi:[1,0]
    v_pk_fma_f32 v[38:39], v[36:37], v[36:37], v[38:39] neg_lo:[1,0,0] neg_hi:[1,0,0]
    v_max_f32 v38, 0, v38
    v_max_f32 v39, 0, v39
    v_cvt_pk_bf16_f32 v42, v38, v39
    v_lshlrev_b32 v38, 16, v42
    v_and_b32 v39, 0xffff0000, v42
    v_add_f32 v38, 0x3727c5ac, v38
    v_add_f32 v39, 0x3727c5ac, v39
    v_cvt_pk_bf16_f32 v42, v38, v39
    v_lshlrev_b32 v38, 16, v42
    v_and_b32 v39, 0xffff0000, v42
    v_sqrt_f32 v38, v38
    v_sqrt_f32 v39, v39
    v_cvt_pk_bf16_f32 v43, v36, v37
    v_lshlrev_b32 v36, 16, v43
    v_and_b32 v37, 0xffff0000, v43
    v_cvt_pk_bf16_f32 v42, v38, v39
    v_lshlrev_b32 v38, 16, v42
    v_and_b32 v39, 0xffff0000, v42
    v_rcp_f32 v38, v38
    v_rcp_f32 v39, v39
    v_pk_fma_f32 v[40:41], v[36:37], v[116:117], v[40:41] op_sel:[0,1,0] op_sel_hi:[1,1,1] neg_lo:[1,0,0] neg_hi:[1,0,0]
    v_pk_mul_f32 v[40:41], v[40:41], v[38:39]
    v_cvt_pk_bf16_f32 v42, v40, v41
    v_pk_ashrrev_i16 v43, 15, v42 op_sel_hi:[0,1]
    v_or_b32 v43, 0x80008000, v43
    v_xor_b32 v8, v42, v43
    s_cmp_lg_u32 s3, 0
    s_cbranch_scc1 NOKEY
    s_mov_b64 exec, s[54:55]
    buffer_store_dwordx2 v[8:9], v45, s[40:43], s39 offen sc1
    ds_write_b32 v45, v8 offset:21376
    s_mov_b64 exec, -1
NOKEY:
    v_pk_add_f32 v[30:31], v[30:31], v[18:19]
    v_cvt_pk_bf16_f32 v42, v30, v31
    v_lshlrev_b32 v30, 16, v42
    v_and_b32 v31, 0xffff0000, v42
    v_pk_add_f32 v[30:31], v[30:31], v[12:13]
    v_cvt_pk_bf16_f32 v48, v30, v31
    v_lshlrev_b32 v30, 16, v48
    v_and_b32 v31, 0xffff0000, v48
    v_pk_add_f32 v[24:25], v[30:31], v[36:37] neg_lo:[0,1] neg_hi:[0,1]
    v_cvt_pk_bf16_f32 v42, v24, v25
    v_lshlrev_b32 v24, 16, v42
    v_and_b32 v25, 0xffff0000, v42
    v_pk_mul_f32 v[24:25], v[24:25], v[38:39]
    v_cvt_pk_bf16_f32 v52, v24, v25
    v_lshlrev_b32 v24, 16, v52
    v_and_b32 v25, 0xffff0000, v52
    v_pk_add_f32 v[24:25], v[24:25], v[30:31]
    v_cvt_pk_bf16_f32 v56, v24, v25
    v_pk_add_f32 v[32:33], v[32:33], v[20:21]
    v_cvt_pk_bf16_f32 v42, v32, v33
    v_lshlrev_b32 v32, 16, v42
    v_and_b32 v33, 0xffff0000, v42
    v_pk_add_f32 v[32:33], v[32:33], v[14:15]
    v_cvt_pk_bf16_f32 v49, v32, v33
    v_lshlrev_b32 v32, 16, v49
    v_and_b32 v33, 0xffff0000, v49
    v_pk_add_f32 v[26:27], v[32:33], v[36:37] neg_lo:[0,1] neg_hi:[0,1]
    v_cvt_pk_bf16_f32 v42, v26, v27
    v_lshlrev_b32 v26, 16, v42
    v_and_b32 v27, 0xffff0000, v42
    v_pk_mul_f32 v[26:27], v[26:27], v[38:39]
    v_cvt_pk_bf16_f32 v53, v26, v27
    v_lshlrev_b32 v26, 16, v53
    v_and_b32 v27, 0xffff0000, v53
    v_pk_add_f32 v[26:27], v[26:27], v[32:33]
    v_cvt_pk_bf16_f32 v57, v26, v27
    v_pk_add_f32 v[34:35], v[34:35], v[22:23]
    v_cvt_pk_bf16_f32 v42, v34, v35
    v_lshlrev_b32 v34, 16, v42
    v_and_b32 v35, 0xffff0000, v42
    v_pk_add_f32 v[34:35], v[34:35], v[16:17]
    v_cvt_pk_bf16_f32 v50, v34, v35
    v_lshlrev_b32 v34, 16, v50
    v_and_b32 v35, 0xffff0000, v50
    v_pk_add_f32 v[28:29], v[34:35], v[36:37] neg_lo:[0,1] neg_hi:[0,1]
    v_cvt_pk_bf16_f32 v42, v28, v29
    v_lshlrev_b32 v28, 16, v42
    v_and_b32 v29, 0xffff0000, v42
    v_pk_mul_f32 v[28:29], v[28:29], v[38:39]
    v_cvt_pk_bf16_f32 v54, v28, v29
    v_lshlrev_b32 v28, 16, v54
    v_and_b32 v29, 0xffff0000, v54
    v_pk_add_f32 v[28:29], v[28:29], v[34:35]
    v_cvt_pk_bf16_f32 v58, v28, v29
    v_mul_u32_u24 v10, 12, v4
    v_mul_u32_u24 v11, 2304, v5
    v_add_u32 v10, v10, v11
    ds_write_b32 v10, v48 offset:49920
    ds_write_b32 v10, v49 offset:49924
    ds_write_b32 v10, v50 offset:49928
    ds_write_b32 v10, v52 offset:40704
    ds_write_b32 v10, v53 offset:40708
    ds_write_b32 v10, v54 offset:40712
    ds_write_b32 v10, v56 offset:59136
    ds_write_b32 v10, v57 offset:59140
    ds_write_b32 v10, v58 offset:59144
    s_branch LN2_J
LN2_H:
    s_barrier
LN2_J:
    v_lshlrev_b32 v10, 4, v0
    s_mov_b32 s39, 6295552
    s_cmp_ge_u32 s3, 8
    s_cbranch_scc1 NOKL
    buffer_load_dwordx4 v[12:15], v10, s[40:43], s39 offen sc1
NOKL:
    s_waitcnt lgkmcnt(0)
    s_barrier
    v_mov_b32 v11, 0
    v_mov_b32 v11, 21376
    ds_read2_b32 v[16:17], v11 offset0:0 offset1:2
    ds_read2_b32 v[18:19], v11 offset0:4 offset1:6
    s_lshl_b32 s12, s2, 3
    s_sub_u32 s12, 0xffff, s12
    s_waitcnt lgkmcnt(0)
    v_readfirstlane_b32 s5, v16
    v_readfirstlane_b32 s7, v17
    v_readfirstlane_b32 s9, v18
    v_readfirstlane_b32 s11, v19
    s_lshl_b32 s4, s5, 16
    s_and_b32 s5, s5, 0xffff0000
    s_lshl_b32 s6, s7, 16
    s_and_b32 s7, s7, 0xffff0000
    s_lshl_b32 s8, s9, 16
    s_and_b32 s9, s9, 0xffff0000
    s_lshl_b32 s10, s11, 16
    s_and_b32 s11, s11, 0xffff0000
    s_sub_u32 s13, s12, 0
    s_or_b32 s4, s4, s13
    s_sub_u32 s13, s12, 1
    s_or_b32 s5, s5, s13
    s_sub_u32 s13, s12, 2
    s_or_b32 s6, s6, s13
    s_sub_u32 s13, s12, 3
    s_or_b32 s7, s7, s13
    s_sub_u32 s13, s12, 4
    s_or_b32 s8, s8, s13
    s_sub_u32 s13, s12, 5
    s_or_b32 s9, s9, s13
    s_sub_u32 s13, s12, 6
    s_or_b32 s10, s10, s13
    s_sub_u32 s13, s12, 7
    s_or_b32 s11, s11, s13
    s_mov_b32 s14, -1
    s_mov_b32 s17, 0
    s_mov_b32 s18, 0
RANK:
    s_mov_b32 s15, 0
    s_cmp_lt_u32 s4, s14
    s_cselect_b32 s13, s4, 0
    s_max_u32 s15, s15, s13
    s_cmp_lt_u32 s5, s14
    s_cselect_b32 s13, s5, 0
    s_max_u32 s15, s15, s13
    s_cmp_lt_u32 s6, s14
    s_cselect_b32 s13, s6, 0
    s_max_u32 s15, s15, s13
    s_cmp_lt_u32 s7, s14
    s_cselect_b32 s13, s7, 0
    s_max_u32 s15, s15, s13
    s_cmp_lt_u32 s8, s14
    s_cselect_b32 s13, s8, 0
    s_max_u32 s15, s15, s13
    s_cmp_lt_u32 s9, s14
    s_cselect_b32 s13, s9, 0
    s_max_u32 s15, s15, s13
    s_cmp_lt_u32 s10, s14
    s_cselect_b32 s13, s10, 0
    s_max_u32 s15, s15, s13
    s_cmp_lt_u32 s11, s14
    s_cselect_b32 s13, s11, 0
    s_max_u32 s15, s15, s13
    s_mov_b32 s16, 0
    s_cmp_lt_u32 s4, s15
    s_cselect_b32 s13, s4, 0
    s_max_u32 s16, s16, s13
    s_cmp_lt_u32 s5, s15
    s_cselect_b32 s13, s5, 0
    s_max_u32 s16, s16, s13
    s_cmp_lt_u32 s6, s15
    s_cselect_b32 s13, s6, 0
    s_max_u32 s16, s16, s13
    s_cmp_lt_u32 s7, s15
    s_cselect_b32 s13, s7, 0
    s_max_u32 s16, s16, s13
    s_cmp_lt_u32 s8, s15
    s_cselect_b32 s13, s8, 0
    s_max_u32 s16, s16, s13
    s_cmp_lt_u32 s9, s15
    s_cselect_b32 s13, s9, 0
    s_max_u32 s16, s16, s13
    s_cmp_lt_u32 s10, s15
    s_cselect_b32 s13, s10, 0
    s_max_u32 s16, s16, s13
    s_cmp_lt_u32 s11, s15
    s_cselect_b32 s13, s11, 0
    s_max_u32 s16, s16, s13
    s_cmp_lt_u32 s3, 8
    s_cbranch_scc1 RK_CNT
    s_bitcmp1_b32 s3, 2
    s_cselect_b32 s19, s16, s15
    s_sub_u32 s13, s12, s19
    s_and_b32 s13, s13, 7
    s_lshr_b32 s36, s13, 1
    s_mul_i32 s36, s36, 2304
    s_bitcmp1_b32 s3, 1
    s_cselect_b32 s37, 9216, 0
    s_add_u32 s36, s36, s37
    v_and_b32 v16, 127, v0
    v_mul_u32_u24 v17, 24, v16
    v_add_u32 v17, s36, v17
    ds_read_b64 v[18:19], v17 offset:40704
    ds_read_b64 v[20:21], v17 offset:40712
    ds_read_b64 v[22:23], v17 offset:40720
    s_bitcmp1_b32 s13, 0
    s_mov_b32 s36, 0x05040100
    s_cselect_b32 s36, 0x07060302, s36
    v_mov_b32 v27, s48
    v_mov_b32 v28, s19
    v_cmp_eq_u32 vcc, 96, v16
    s_waitcnt lgkmcnt(0)
    v_perm_b32 v24, v19, v18, s36
    v_perm_b32 v25, v21, v20, s36
    v_perm_b32 v26, v23, v22, s36
    v_cndmask_b32 v24, v24, v28, vcc
    s_bitcmp1_b32 s3, 1
    s_cselect_b32 s36, 1, 0
    s_add_u32 s36, s36, 96
    v_cmp_gt_u32 s[34:35], s36, v16
    v_lshlrev_b32 v16, 4, v16
    s_branch RK_BAR
RK_CNT:
    s_cmp_lg_u32 s18, 0
    s_cbranch_scc1 RK_C2
    v_lshlrev_b32 v16, 2, v0
    v_sub_u32 v16, 0xffff, v16
    v_add_u32 v17, -1, v16
    v_add_u32 v18, -2, v16
    v_add_u32 v19, -3, v16
    s_mov_b32 s13, 0xffff0000
    s_mov_b32 s49, 0
    s_branch PC_12
P_10:
    buffer_load_dwordx4 v[12:15], v10, s[40:43], s39 offen sc1
PC_12:
    s_add_u32 s49, s49, 1
    s_waitcnt vmcnt(0)
    v_cmp_ne_u32 vcc, s48, v13
    v_cmp_ne_u32 s[50:51], s48, v15
    s_nop 0
    s_or_b64 vcc, vcc, s[50:51]
    s_cbranch_vccz PD_11
    s_cmp_lt_u32 s49, 60000
    s_cbranch_scc1 P_10
PD_11:
    v_lshl_or_b32 v16, v12, 16, v16
    v_and_or_b32 v17, v12, s13, v17
    v_lshl_or_b32 v18, v14, 16, v18
    v_and_or_b32 v19, v14, s13, v19
RK_C2:
    v_cmp_lt_u32 s[20:21], s15, v16
    v_cmp_lt_u32 s[22:23], s15, v17
    v_cmp_lt_u32 s[24:25], s15, v18
    v_cmp_lt_u32 s[26:27], s15, v19
    s_bcnt1_i32_b64 s56, s[20:21]
    s_bcnt1_i32_b64 s57, s[22:23]
    s_bcnt1_i32_b64 s58, s[24:25]
    s_bcnt1_i32_b64 s59, s[26:27]
    v_cmp_lt_u32 s[20:21], s16, v16
    v_cmp_lt_u32 s[22:23], s16, v17
    v_cmp_lt_u32 s[24:25], s16, v18
    v_cmp_lt_u32 s[26:27], s16, v19
    s_add_u32 s56, s56, s57
    s_add_u32 s58, s58, s59
    s_add_u32 s13, s56, s58
    s_bcnt1_i32_b64 s56, s[20:21]
    s_bcnt1_i32_b64 s57, s[22:23]
    s_bcnt1_i32_b64 s58, s[24:25]
    s_bcnt1_i32_b64 s59, s[26:27]
    s_add_u32 s56, s56, s57
    s_add_u32 s58, s58, s59
    s_add_u32 s56, s56, s58
    s_lshl_b32 s56, s56, 16
    s_or_b32 s13, s13, s56
    v_mov_b32 v20, s13
    v_mov_b32 v21, s18
    s_mov_b64 exec, 1
    ds_add_u32 v21, v20 offset:21440
    s_mov_b64 exec, -1
RK_BAR:
    v_mov_b32 v29, s18
    s_waitcnt lgkmcnt(0)
    s_barrier
    ds_read_b32 v29, v29 offset:21440
    s_waitcnt lgkmcnt(0)
    v_readfirstlane_b32 s56, v29
    s_nop 0
    s_lshr_b32 s57, s56, 16
    s_and_b32 s56, s56, 0xffff
    s_cmp_lt_u32 s3, 8
    s_cbranch_scc1 RK_NP
    s_bitcmp1_b32 s3, 2
    s_cselect_b32 s58, s57, s56
    s_cmp_ge_u32 s58, 8
    s_cbranch_scc1 RK_NP
    s_mul_i32 s59, s58, 1536
    s_add_u32 s59, s59, 6303744
    s_lshl_b32 s58, s58, 11
    s_add_u32 s58, s58, 6316032
    s_bitcmp1_b32 s3, 1
    s_cselect_b32 s58, s58, s59
    s_mov_b64 exec, s[34:35]
    buffer_store_dwordx4 v[24:27], v16, s[40:43], s58 offen sc1
    s_mov_b64 exec, -1
RK_NP:
    s_cmp_ge_u32 s56, 8
    s_cbranch_scc1 RK_DONE
    s_sub_u32 s13, s12, s15
    s_and_b32 s13, s13, 7
    s_bitset1_b32 s17, s13
    s_cmp_ge_u32 s57, 8
    s_cbranch_scc1 RK_DONE
    s_sub_u32 s13, s12, s16
    s_and_b32 s13, s13, 7
    s_bitset1_b32 s17, s13
    s_mov_b32 s14, s16
    s_add_u32 s18, s18, 4
    s_cmp_lt_u32 s18, 16
    s_cbranch_scc1 RANK
RK_DONE:
    s_mov_b32 s32, s28
    s_and_b32 s33, s29, 0xffff
    s_mov_b32 s34, 0x00240000
    s_mov_b32 s35, 0x00020000
    s_cmp_ge_u32 s3, 5
    s_cbranch_scc1 OS_DONE
    v_mul_u32_u24 v12, 911, v0
    v_lshrrev_b32 v12, 16, v12
    v_lshlrev_b32 v13, 5, v0
    ds_read_b128 v[16:19], v13 offset:59136
    ds_read_b128 v[20:23], v13 offset:59152
    v_mul_u32_u24 v14, 1152, v12
    v_lshl_add_u32 v14, v0, 4, v14
    v_lshlrev_b32 v12, 1, v12
    s_or_b32 s13, s17, 0x300
    v_lshrrev_b32 v12, v12, s13
    v_and_b32 v15, 1, v12
    v_and_b32 v12, 2, v12
    v_cmp_eq_u32 s[56:57], 0, v15
    v_cmp_eq_u32 s[58:59], 0, v12
    s_mov_b32 s36, 0x05040100
    s_mov_b32 s37, 0x07060302
    s_mul_i32 s13, s2, 9216
    s_waitcnt lgkmcnt(0)
    v_perm_b32 v24, v17, v16, s36
    v_perm_b32 v25, v19, v18, s36
    v_perm_b32 v26, v21, v20, s36
    v_perm_b32 v27, v23, v22, s36
    v_perm_b32 v28, v17, v16, s37
    v_perm_b32 v29, v19, v18, s37
    v_perm_b32 v30, v21, v20, s37
    v_perm_b32 v31, v23, v22, s37
    s_mov_b64 exec, s[56:57]
    s_cbranch_execz OS_13
    buffer_store_dwordx4 v[24:27], v14, s[32:35], s13 offen sc1
OS_13:
    s_mov_b64 exec, s[58:59]
    s_cbranch_execz OS_14
    buffer_store_dwordx4 v[28:31], v14, s[32:35], s13 offen offset:1152 sc1
OS_14:
    s_mov_b64 exec, -1
OS_DONE:
    s_cmp_lt_u32 s2, 112
    s_cbranch_scc1 FIN
    s_sub_u32 s44, s2, 112
    s_and_b32 s56, s44, 0xf0
    s_and_b32 s57, s44, 7
    s_lshl_b32 s57, s57, 1
    s_or_b32 s56, s56, s57
    s_bfe_u32 s57, s44, 0x10003
    s_or_b32 s44, s56, s57
    s_cmp_ge_u32 s3, 12
    s_cbranch_scc1 F_GUP
    v_lshlrev_b32 v10, 4, v0
    v_mul_u32_u24 v11, 683, v0
    v_lshrrev_b32 v11, 16, v11
    v_mul_u32_u24 v12, 12, v0
    v_lshl_add_u32 v11, v11, 4, v12
    s_mov_b32 s38, 6303744
    s_sleep 4
    s_mov_b32 s49, 0
P_15:
    buffer_load_dwordx4 v[6:9], v10, s[40:43], s38 offen sc1
PC_17:
    s_add_u32 s49, s49, 1
    s_waitcnt vmcnt(0)
    v_cmp_ne_u32 vcc, s48, v9
    s_nop 0
    s_cbranch_vccz PD_16
    s_cmp_lt_u32 s49, 60000
    s_cbranch_scc1 P_15
PD_16:
    ds_write_b32 v11, v6 offset:256
    ds_write_b32 v11, v7 offset:260
    ds_write_b32 v11, v8 offset:264
    s_waitcnt lgkmcnt(0)
    s_barrier
    s_cmp_lg_u32 s3, 11
    s_cbranch_scc1 F_A0
    s_mul_i32 s56, s44, 3641
    s_lshr_b32 s56, s56, 16
    s_mul_i32 s57, s56, 18
    s_sub_u32 s57, s44, s57
    s_lshr_b32 s58, s57, 1
    s_lshl_b32 s58, s58, 6
    s_and_b32 s57, s57, 1
    s_lshl_b32 s57, s57, 1
    s_add_u32 s58, s58, s57
    v_and_b32 v12, 3, v1
    v_lshlrev_b32 v12, 4, v12
    v_bfe_u32 v13, v1, 2, 1
    v_add3_u32 v12, v12, v13, s58
    v_bfe_u32 v13, v1, 4, 1
    v_lshl_add_u32 v12, v13, 3, v12
    v_bfe_u32 v13, v1, 5, 1
    v_lshl_add_u32 v12, v13, 2, v12
    v_mul_u32_u24 v13, 10923, v12
    v_lshrrev_b32 v13, 16, v13
    v_mul_u32_u24 v14, 6, v13
    v_sub_u32 v14, v12, v14
    v_lshlrev_b32 v13, 4, v13
    v_mov_b32 v15, 1536
    s_lshl_b32 s38, s56, 11
    s_add_u32 s38, s38, 6316032
    s_mul_i32 s57, s56, 1168
    v_lshlrev_b32 v12, 1, v12
    v_add_u32 v24, s57, v12
    ds_read_u16 v24, v24 offset:256
    s_mov_b32 s49, 0
P_18:
    buffer_load_dwordx4 v[16:19], v13, s[40:43], s38 offen sc1
    buffer_load_dwordx4 v[20:23], v15, s[40:43], s38 offen sc1
PC_20:
    s_add_u32 s49, s49, 1
    s_waitcnt vmcnt(0)
    v_cmp_ne_u32 vcc, s48, v19
    v_cmp_ne_u32 s[50:51], s48, v23
    s_nop 0
    s_or_b64 vcc, vcc, s[50:51]
    s_cbranch_vccz PD_19
    s_cmp_lt_u32 s49, 60000
    s_cbranch_scc1 P_18
PD_19:
    v_cmp_lt_u32 vcc, 1, v14
    s_nop 1
    v_cndmask_b32 v16, v16, v17, vcc
    v_cmp_lt_u32 vcc, 3, v14
    s_nop 1
    v_cndmask_b32 v16, v16, v18, vcc
    v_and_b32 v14, 1, v14
    v_lshlrev_b32 v14, 4, v14
    v_lshrrev_b32 v16, v14, v16
    v_lshlrev_b32 v16, 16, v16
    v_readfirstlane_b32 s45, v20
    s_nop 0
    s_lshr_b32 s56, s45, 16
    s_xor_b32 s57, s56, 0x8000
    s_xor_b32 s58, s56, 0xffff
    s_bitcmp1_b32 s56, 15
    s_cselect_b32 s56, s57, s58
    s_lshl_b32 s56, s56, 16
    v_mov_b32 v17, 0xbfb8aa3b
    v_mul_f32 v17, s56, v17
    v_exp_f32 v17, v17
    s_and_b32 s45, s45, 0x7ff
    s_sub_u32 s45, 0x7ff, s45
    s_mul_i32 s45, s45, 1152
    v_add_f32 v17, 1.0, v17
    v_rcp_f32 v17, v17
    s_waitcnt lgkmcnt(0)
    v_lshlrev_b32 v24, 16, v24
    v_cvt_pk_bf16_f32 v17, v17, v17
    v_lshlrev_b32 v17, 16, v17
F_A0:
    v_bfe_u32 v26, v0, 3, 2
    v_lshlrev_b32 v26, 9, v26
    v_bfe_u32 v27, v0, 7, 1
    v_lshl_add_u32 v26, v27, 7, v26
    v_and_b32 v27, 7, v0
    v_lshl_add_u32 v26, v27, 4, v26
    v_bfe_u32 v28, v0, 5, 2
    v_lshl_add_u32 v26, v28, 2, v26
    v_add_u32 v26, 28416, v26
    v_mul_u32_u24 v27, 80, v27
    v_lshl_add_u32 v29, v5, 4, v27
    v_lshrrev_b32 v28, 3, v0
    v_lshl_add_u32 v27, v28, 1, v27
    v_and_b32 v30, 7, v1
    s_mov_b32 s56, 331776
    v_mul_lo_u32 v30, v30, s56
    v_lshl_add_u32 v30, v5, 4, v30
    s_lshr_b32 s57, s3, 3
    s_sub_u32 s56, s3, 4
    s_sub_u32 s56, s56, s57
    s_mul_i32 s56, s56, 36864
    s_lshl_b32 s57, s44, 7
    s_add_u32 s56, s56, s57
    s_add_u32 s36, s56, 6332416
    s_add_u32 s37, s36, 18432
    s_lshr_b32 s20, s48, 0
    s_lshr_b32 s21, s48, 8
    s_lshr_b32 s22, s48, 16
    s_lshr_b32 s23, s48, 24
    v_mov_b32 v31, 0xff
    s_barrier
    s_cmp_ge_u32 s3, 4
    s_cbranch_scc1 F_A1
    ds_read2st64_b32 v[32:33], v26 offset0:0 offset1:1
    ds_read2st64_b32 v[34:35], v26 offset0:8 offset1:9
    ds_read2st64_b32 v[36:37], v26 offset0:16 offset1:17
    ds_read2st64_b32 v[38:39], v26 offset0:24 offset1:25
    s_waitcnt lgkmcnt(2)
    v_pk_add_f32 v[32:33], v[32:33], v[34:35]
    s_waitcnt lgkmcnt(0)
    v_pk_add_f32 v[36:37], v[36:37], v[38:39]
    v_pk_add_f32 v[32:33], v[32:33], v[36:37]
    v_cvt_pk_bf16_f32 v34, v32, v33
    v_lshlrev_b32 v32, 16, v34
    v_and_b32 v33, 0xffff0000, v34
    v_mul_f32 v34, 0xbfb8aa3b, v32
    v_exp_f32 v34, v34
    s_nop 0
    v_add_f32 v34, 1.0, v34
    v_rcp_f32 v34, v34
    s_nop 0
    v_mul_f32 v32, v32, v34
    v_cvt_pk_bf16_f32 v32, v32, v32
    v_lshlrev_b32 v32, 16, v32
    v_mul_f32 v32, v32, v33
    v_cvt_pk_bf16_f32 v32, v32, v32
    ds_write_b16 v27, v32 offset:9600
    s_waitcnt lgkmcnt(0)
F_A1:
    s_barrier
    s_cmp_lt_u32 s3, 4
    s_cbranch_scc1 F_D2
    s_and_b32 s56, s3, 3
    s_cmp_eq_u32 s56, 3
    s_cbranch_scc1 F_D2
    ds_read_b128 v[32:35], v29 offset:9600
    s_mov_b32 s56, 0x00ff00ff
    s_mov_b32 s57, 0x00ff00ff
    s_waitcnt lgkmcnt(0)
    v_mfma_f32_16x16x32_bf16 v[36:39], v[76:79], v[32:35], 0
    v_mfma_f32_16x16x32_bf16 v[40:43], v[80:83], v[32:35], 0
    v_mfma_f32_16x16x32_bf16 v[44:47], v[84:87], v[32:35], 0
    v_mfma_f32_16x16x32_bf16 v[48:51], v[88:91], v[32:35], 0
    s_cmp_ge_u32 s3, 8
    s_nop 1
    s_cbranch_scc1 F_D1
    v_mfma_f32_16x16x32_bf16 v[52:55], v[92:95], v[32:35], 0
    v_mfma_f32_16x16x32_bf16 v[56:59], v[96:99], v[32:35], 0
    v_mfma_f32_16x16x32_bf16 v[60:63], v[100:103], v[32:35], 0
    v_mfma_f32_16x16x32_bf16 v[64:67], v[104:107], v[32:35], 0
    s_mov_b64 exec, s[56:57]
    v_bfi_b32 v36, v31, s20, v36
    v_bfi_b32 v37, v31, s21, v37
    v_bfi_b32 v38, v31, s22, v38
    v_bfi_b32 v39, v31, s23, v39
    buffer_store_dwordx4 v[36:39], v30, s[40:43], s36 offen offset:0 sc1
    v_bfi_b32 v40, v31, s20, v40
    v_bfi_b32 v41, v31, s21, v41
    v_bfi_b32 v42, v31, s22, v42
    v_bfi_b32 v43, v31, s23, v43
    buffer_store_dwordx4 v[40:43], v30, s[40:43], s36 offen offset:64 sc1
    v_bfi_b32 v44, v31, s20, v44
    v_bfi_b32 v45, v31, s21, v45
    v_bfi_b32 v46, v31, s22, v46
    v_bfi_b32 v47, v31, s23, v47
    buffer_store_dwordx4 v[44:47], v30, s[40:43], s37 offen offset:0 sc1
    v_bfi_b32 v48, v31, s20, v48
    v_bfi_b32 v49, v31, s21, v49
    v_bfi_b32 v50, v31, s22, v50
    v_bfi_b32 v51, v31, s23, v51
    buffer_store_dwordx4 v[48:51], v30, s[40:43], s37 offen offset:64 sc1
    s_mov_b64 exec, -1
    s_add_u32 s36, s36, 221184
    s_add_u32 s37, s37, 221184
    s_mov_b64 exec, s[56:57]
    v_bfi_b32 v52, v31, s20, v52
    v_bfi_b32 v53, v31, s21, v53
    v_bfi_b32 v54, v31, s22, v54
    v_bfi_b32 v55, v31, s23, v55
    buffer_store_dwordx4 v[52:55], v30, s[40:43], s36 offen offset:0 sc1
    v_bfi_b32 v56, v31, s20, v56
    v_bfi_b32 v57, v31, s21, v57
    v_bfi_b32 v58, v31, s22, v58
    v_bfi_b32 v59, v31, s23, v59
    buffer_store_dwordx4 v[56:59], v30, s[40:43], s36 offen offset:64 sc1
    v_bfi_b32 v60, v31, s20, v60
    v_bfi_b32 v61, v31, s21, v61
    v_bfi_b32 v62, v31, s22, v62
    v_bfi_b32 v63, v31, s23, v63
    buffer_store_dwordx4 v[60:63], v30, s[40:43], s37 offen offset:0 sc1
    v_bfi_b32 v64, v31, s20, v64
    v_bfi_b32 v65, v31, s21, v65
    v_bfi_b32 v66, v31, s22, v66
    v_bfi_b32 v67, v31, s23, v67
    buffer_store_dwordx4 v[64:67], v30, s[40:43], s37 offen offset:64 sc1
    s_mov_b64 exec, -1
    s_branch F_D2
F_D1:
    s_mov_b64 exec, s[56:57]
    v_bfi_b32 v36, v31, s20, v36
    v_bfi_b32 v37, v31, s21, v37
    v_bfi_b32 v38, v31, s22, v38
    v_bfi_b32 v39, v31, s23, v39
    buffer_store_dwordx4 v[36:39], v30, s[40:43], s36 offen offset:0 sc1
    v_bfi_b32 v40, v31, s20, v40
    v_bfi_b32 v41, v31, s21, v41
    v_bfi_b32 v42, v31, s22, v42
    v_bfi_b32 v43, v31, s23, v43
    buffer_store_dwordx4 v[40:43], v30, s[40:43], s36 offen offset:64 sc1
    v_bfi_b32 v44, v31, s20, v44
    v_bfi_b32 v45, v31, s21, v45
    v_bfi_b32 v46, v31, s22, v46
    v_bfi_b32 v47, v31, s23, v47
    buffer_store_dwordx4 v[44:47], v30, s[40:43], s37 offen offset:0 sc1
    v_bfi_b32 v48, v31, s20, v48
    v_bfi_b32 v49, v31, s21, v49
    v_bfi_b32 v50, v31, s22, v50
    v_bfi_b32 v51, v31, s23, v51
    buffer_store_dwordx4 v[48:51], v30, s[40:43], s37 offen offset:64 sc1
    s_mov_b64 exec, -1
F_D2:
    v_lshlrev_b32 v10, 11, v2
    v_lshl_add_u32 v10, v1, 4, v10
    s_mul_i32 s38, s44, 18432
    s_add_u32 s38, s38, 6332416
    s_mov_b32 s56, 0x0c0c0400
    s_mov_b32 s57, 0x05040100
    v_lshlrev_b32 v11, 2, v0
    s_waitcnt vmcnt(0)
    s_barrier
    s_cmp_ge_u32 s3, 9
    s_cbranch_scc1 F_R1
    s_mov_b32 s49, 0
P_21:
    buffer_load_dwordx4 v[32:35], v10, s[40:43], s38 offen sc1
    buffer_load_dwordx4 v[36:39], v10, s[40:43], s38 offen offset:1024 sc1
    s_add_u32 s49, s49, 1
    s_waitcnt vmcnt(1)
    v_perm_b32 v40, v33, v32, s56
    v_perm_b32 v41, v35, v34, s56
    v_perm_b32 v40, v41, v40, s57
    v_cmp_ne_u32 vcc, s48, v40
    s_waitcnt vmcnt(0)
    v_perm_b32 v42, v37, v36, s56
    v_perm_b32 v43, v39, v38, s56
    v_perm_b32 v42, v43, v42, s57
    v_cmp_ne_u32 s[50:51], s48, v42
    s_nop 0
    s_or_b64 vcc, vcc, s[50:51]
    s_cbranch_vccz PD_22
    s_cmp_lt_u32 s49, 60000
    s_cbranch_scc1 P_21
PD_22:
    v_and_b32 v32, 0xffffff00, v32
    v_and_b32 v33, 0xffffff00, v33
    v_and_b32 v34, 0xffffff00, v34
    v_and_b32 v35, 0xffffff00, v35
    v_and_b32 v36, 0xffffff00, v36
    v_and_b32 v37, 0xffffff00, v37
    v_and_b32 v38, 0xffffff00, v38
    v_and_b32 v39, 0xffffff00, v39
    v_pk_add_f32 v[32:33], v[32:33], v[36:37]
    v_pk_add_f32 v[34:35], v[34:35], v[38:39]
    s_nop 0
    v_permlane32_swap_b32 v32, v33
    v_permlane32_swap_b32 v34, v35
    v_add_f32 v32, v32, v33
    v_add_f32 v34, v34, v35
    s_nop 1
    v_permlane16_swap_b32 v32, v34
    v_add_f32 v32, v32, v34
    s_nop 1
    v_add_f32_dpp v32, v32, v32 row_ror:8 row_mask:0xf bank_mask:0xf
    ds_write_b32 v11, v32 offset:10240
    s_waitcnt lgkmcnt(0)
F_R1:
    s_barrier
    s_cmp_lg_u32 s3, 11
    s_cbranch_scc1 FIN
    v_lshlrev_b32 v11, 2, v1
    v_add_u32 v11, 10240, v11
    ds_read2st64_b32 v[32:33], v11 offset0:0 offset1:1
    ds_read2st64_b32 v[34:35], v11 offset0:2 offset1:3
    ds_read2st64_b32 v[36:37], v11 offset0:4 offset1:5
    ds_read2st64_b32 v[38:39], v11 offset0:6 offset1:7
    ds_read_b32 v40, v11 offset:2048
    s_waitcnt lgkmcnt(3)
    v_pk_add_f32 v[32:33], v[32:33], v[34:35]
    s_waitcnt lgkmcnt(1)
    v_pk_add_f32 v[36:37], v[36:37], v[38:39]
    v_pk_add_f32 v[32:33], v[32:33], v[36:37]
    v_add_f32 v32, v32, v33
    s_waitcnt lgkmcnt(0)
    v_add_f32 v32, v32, v40
    v_cvt_pk_bf16_f32 v32, v32, v32
    v_lshlrev_b32 v32, 16, v32
    v_mul_f32 v32, v32, v17
    v_cvt_pk_bf16_f32 v32, v32, v32
    v_lshlrev_b32 v32, 16, v32
    v_add_f32 v32, v32, v24
    v_cvt_pk_bf16_f32 v32, v32, v32
    v_lshlrev_b32 v32, 16, v32
    v_add_f32 v32, v32, v16
    v_cvt_pk_bf16_f32 v32, v32, v32
    s_mov_b32 exec_lo, 0x00ff00ff
    s_mov_b32 exec_hi, 0x00ff00ff
    buffer_store_short v32, v12, s[32:35], s45 offen sc1
    s_mov_b64 exec, -1
    s_branch FIN
F_GUP:
    s_mov_b32 s56, 0x05040100
    s_mov_b32 s57, 0x07060302
    s_sub_u32 s58, s3, 12
    s_mul_i32 s59, s58, 5
    s_cmp_eq_u32 s58, 3
    s_cselect_b32 s59, 14, s59
    s_lshl_b32 s59, s59, 6
    v_and_b32 v6, 7, v1
    v_mul_u32_u24 v7, 1168, v6
    v_lshl_add_u32 v7, v5, 4, v7
    v_add_u32 v7, s59, v7
    v_lshl_add_u32 v6, v5, 3, v6
    v_lshlrev_b32 v6, 4, v6
    s_lshl_b32 s58, s58, 11
    v_add_u32 v6, s58, v6
    s_waitcnt vmcnt(0)
    v_perm_b32 v32, v50, v48, s56
    v_perm_b32 v33, v54, v52, s56
    v_perm_b32 v34, v58, v56, s56
    v_perm_b32 v35, v62, v60, s56
    v_perm_b32 v36, v50, v48, s57
    v_perm_b32 v37, v54, v52, s57
    v_perm_b32 v38, v58, v56, s57
    v_perm_b32 v39, v62, v60, s57
    v_perm_b32 v40, v51, v49, s56
    v_perm_b32 v41, v55, v53, s56
    v_perm_b32 v42, v59, v57, s56
    v_perm_b32 v43, v63, v61, s56
    v_perm_b32 v44, v51, v49, s57
    v_perm_b32 v45, v55, v53, s57
    v_perm_b32 v46, v59, v57, s57
    v_perm_b32 v47, v63, v61, s57
    v_perm_b32 v48, v66, v64, s56
    v_perm_b32 v49, v70, v68, s56
    v_perm_b32 v50, v74, v72, s56
    v_perm_b32 v51, v78, v76, s56
    v_perm_b32 v52, v66, v64, s57
    v_perm_b32 v53, v70, v68, s57
    v_perm_b32 v54, v74, v72, s57
    v_perm_b32 v55, v78, v76, s57
    v_perm_b32 v56, v67, v65, s56
    v_perm_b32 v57, v71, v69, s56
    v_perm_b32 v58, v75, v73, s56
    v_perm_b32 v59, v79, v77, s56
    v_perm_b32 v60, v67, v65, s57
    v_perm_b32 v61, v71, v69, s57
    v_perm_b32 v62, v75, v73, s57
    v_perm_b32 v63, v79, v77, s57
    v_perm_b32 v64, v82, v80, s56
    v_perm_b32 v65, v86, v84, s56
    v_perm_b32 v66, v90, v88, s56
    v_perm_b32 v67, v94, v92, s56
    v_perm_b32 v68, v82, v80, s57
    v_perm_b32 v69, v86, v84, s57
    v_perm_b32 v70, v90, v88, s57
    v_perm_b32 v71, v94, v92, s57
    v_perm_b32 v72, v83, v81, s56
    v_perm_b32 v73, v87, v85, s56
    v_perm_b32 v74, v91, v89, s56
    v_perm_b32 v75, v95, v93, s56
    v_perm_b32 v76, v83, v81, s57
    v_perm_b32 v77, v87, v85, s57
    v_perm_b32 v78, v91, v89, s57
    v_perm_b32 v79, v95, v93, s57
    v_perm_b32 v80, v98, v96, s56
    v_perm_b32 v81, v102, v100, s56
    v_perm_b32 v82, v106, v104, s56
    v_perm_b32 v83, v110, v108, s56
    v_perm_b32 v84, v98, v96, s57
    v_perm_b32 v85, v102, v100, s57
    v_perm_b32 v86, v106, v104, s57
    v_perm_b32 v87, v110, v108, s57
    v_perm_b32 v88, v99, v97, s56
    v_perm_b32 v89, v103, v101, s56
    v_perm_b32 v90, v107, v105, s56
    v_perm_b32 v91, v111, v109, s56
    v_perm_b32 v92, v99, v97, s57
    v_perm_b32 v93, v103, v101, s57
    v_perm_b32 v94, v107, v105, s57
    v_perm_b32 v95, v111, v109, s57
    v_perm_b32 v96, v114, v112, s56
    v_perm_b32 v97, v118, v116, s56
    v_perm_b32 v98, v122, v120, s56
    v_perm_b32 v99, v126, v124, s56
    v_perm_b32 v100, v114, v112, s57
    v_perm_b32 v101, v118, v116, s57
    v_perm_b32 v102, v122, v120, s57
    v_perm_b32 v103, v126, v124, s57
    v_perm_b32 v104, v115, v113, s56
    v_perm_b32 v105, v119, v117, s56
    v_perm_b32 v106, v123, v121, s56
    v_perm_b32 v107, v127, v125, s56
    v_perm_b32 v108, v115, v113, s57
    v_perm_b32 v109, v119, v117, s57
    v_perm_b32 v110, v123, v121, s57
    v_perm_b32 v111, v127, v125, s57
    s_barrier
    ds_read_b128 v[8:11], v7 offset:256
    ds_read_b128 v[12:15], v7 offset:320
    ds_read_b128 v[16:19], v7 offset:384
    ds_read_b128 v[20:23], v7 offset:448
    ds_read_b128 v[24:27], v7 offset:512
    s_waitcnt lgkmcnt(4)
    v_mfma_f32_16x16x32_bf16 v[112:115], v[32:35], v[8:11], 0
    v_mfma_f32_16x16x32_bf16 v[116:119], v[36:39], v[8:11], 0
    v_mfma_f32_16x16x32_bf16 v[120:123], v[40:43], v[8:11], 0
    v_mfma_f32_16x16x32_bf16 v[124:127], v[44:47], v[8:11], 0
    s_waitcnt lgkmcnt(3)
    v_mfma_f32_16x16x32_bf16 v[112:115], v[48:51], v[12:15], v[112:115]
    v_mfma_f32_16x16x32_bf16 v[116:119], v[52:55], v[12:15], v[116:119]
    v_mfma_f32_16x16x32_bf16 v[120:123], v[56:59], v[12:15], v[120:123]
    v_mfma_f32_16x16x32_bf16 v[124:127], v[60:63], v[12:15], v[124:127]
    s_waitcnt lgkmcnt(2)
    v_mfma_f32_16x16x32_bf16 v[112:115], v[64:67], v[16:19], v[112:115]
    v_mfma_f32_16x16x32_bf16 v[116:119], v[68:71], v[16:19], v[116:119]
    v_mfma_f32_16x16x32_bf16 v[120:123], v[72:75], v[16:19], v[120:123]
    v_mfma_f32_16x16x32_bf16 v[124:127], v[76:79], v[16:19], v[124:127]
    s_waitcnt lgkmcnt(1)
    v_mfma_f32_16x16x32_bf16 v[112:115], v[80:83], v[20:23], v[112:115]
    v_mfma_f32_16x16x32_bf16 v[116:119], v[84:87], v[20:23], v[116:119]
    v_mfma_f32_16x16x32_bf16 v[120:123], v[88:91], v[20:23], v[120:123]
    v_mfma_f32_16x16x32_bf16 v[124:127], v[92:95], v[20:23], v[124:127]
    s_cmp_ge_u32 s3, 14
    s_cbranch_scc1 F_G1
    s_waitcnt lgkmcnt(0)
    v_mfma_f32_16x16x32_bf16 v[112:115], v[96:99], v[24:27], v[112:115]
    v_mfma_f32_16x16x32_bf16 v[116:119], v[100:103], v[24:27], v[116:119]
    v_mfma_f32_16x16x32_bf16 v[120:123], v[104:107], v[24:27], v[120:123]
    v_mfma_f32_16x16x32_bf16 v[124:127], v[108:111], v[24:27], v[124:127]
F_G1:
    s_mov_b32 exec_lo, 0x00ff00ff
    s_mov_b32 exec_hi, 0x00ff00ff
    s_nop 2
    ds_write_b128 v6, v[112:115] offset:28416
    ds_write_b128 v6, v[116:119] offset:28928
    ds_write_b128 v6, v[120:123] offset:29440
    ds_write_b128 v6, v[124:127] offset:29952
    s_mov_b64 exec, -1
    s_waitcnt lgkmcnt(0)
    s_barrier
    s_barrier
    s_barrier
    s_barrier
FIN:
    s_cmp_lg_u32 s2, 0
    s_cbranch_scc1 NOEP
    s_cmp_lg_u32 s3, 15
    s_cbranch_scc1 NOEP
    v_mov_b32 v6, 0
    v_mov_b32 v7, s48
    s_mov_b64 exec, 1
    buffer_store_dword v7, v6, s[40:43], 0 offen sc1
NOEP:
END:
    s_endpgm
.section .rodata,"a"
.p2align 6
.amdhsa_kernel sequential_preLN__ssm_conv_s4d__moe_arch_mod__prompt_kernel
  .amdhsa_next_free_vgpr 128
  .amdhsa_next_free_sgpr 102
  .amdhsa_accum_offset 128
  .amdhsa_group_segment_fixed_size 0
  .amdhsa_kernarg_size 120
  .amdhsa_user_sgpr_count 2
  .amdhsa_user_sgpr_kernarg_segment_ptr 1
  .amdhsa_system_sgpr_workgroup_id_x 1
.end_amdhsa_kernel
.text
```

```asm
; @launch grid=(256,1,1) block=(1024,1,1) lds=149504
.amdgcn_target "amdgcn-amd-amdhsa--gfx950"
.text
.globl sequential_preLN__ssm_conv_s4d__moe_arch_mod__prompt_kernel
.p2align 8
.type sequential_preLN__ssm_conv_s4d__moe_arch_mod__prompt_kernel,@function
sequential_preLN__ssm_conv_s4d__moe_arch_mod__prompt_kernel:
    s_cmp_ge_u32 s2, 256
    s_cbranch_scc1 END
    s_load_dwordx16 s[4:19], s[0:1], 0
    s_load_dwordx2 s[30:31], s[0:1], 112
    s_load_dwordx8 s[20:27], s[0:1], 64
    s_load_dwordx2 s[28:29], s[0:1], 96
    v_lshrrev_b32 v2, 6, v0
    v_and_b32 v1, 63, v0
    v_readfirstlane_b32 s3, v2
    v_and_b32 v3, 15, v0
    v_lshrrev_b32 v5, 4, v1
    s_cmp_ge_u32 s3, 4
    s_cbranch_scc1 KLOAD
    s_setprio 3
    v_mov_b32 v32, -1
    v_mov_b32 v33, -1
    v_mov_b32 v34, -1
    v_mov_b32 v35, -1
    v_lshlrev_b32 v22, 6, v5
    v_lshl_add_u32 v21, v2, 4, v22
    ds_write_b128 v21, v[32:35] offset:0
    ds_write_b128 v21, v[32:35] offset:256
    s_and_b32 s34, s3, 3
    s_mul_i32 s34, s34, 48
    v_add_u32 v4, s34, v3
    v_mul_u32_u24 v6, 6, v4
    v_and_b32 v6, -4, v6
    s_mul_i32 s32, s2, 9216
    v_mul_u32_u24 v7, 2304, v5
    v_add3_u32 v7, v7, v6, s32
    v_mov_b32 v62, 0
    s_or_b32 s33, s2, 4
    s_mul_i32 s34, s33, 9216
    s_mul_i32 s35, s3, 2304
    s_add_u32 s34, s34, s35
    v_min_u32 v20, 35, v1
    v_lshl_add_u32 v20, v20, 6, s34
    s_min_u32 s33, s33, 191
    s_mul_i32 s33, s33, 768
    v_min_u32 v27, 11, v1
    v_lshl_add_u32 v27, v27, 6, s33
    s_waitcnt lgkmcnt(0)
    global_load_dwordx2 v[8:9], v7, s[4:5] offset:0
    global_load_dwordx2 v[10:11], v7, s[4:5] offset:1152
    global_load_dwordx2 v[12:13], v7, s[4:5] offset:96
    global_load_dwordx2 v[14:15], v7, s[4:5] offset:1248
    global_load_dwordx2 v[16:17], v7, s[4:5] offset:192
    global_load_dwordx2 v[18:19], v7, s[4:5] offset:1344
    global_load_dword v51, v62, s[30:31]
    s_bitcmp1_b32 s3, 0
    s_cselect_b64 s[34:35], s[8:9], s[6:7]
    s_cselect_b64 s[36:37], s[12:13], s[10:11]
    s_bitcmp1_b32 s3, 1
    s_cselect_b64 s[34:35], s[36:37], s[34:35]
    global_load_dword v28, v20, s[4:5]
    global_load_dword v29, v27, s[34:35]
    s_branch B0
KLOAD:
    s_setprio 1
    s_sub_u32 s32, s3, 4
    s_lshr_b32 s33, s32, 2
    s_add_u32 s39, s32, s33
    s_and_b32 s39, s39, 3
    s_mul_i32 s34, s2, 3
    s_add_u32 s34, s34, s33
    s_lshl_b32 s35, s34, 8
    v_lshl_add_u32 v13, v1, 2, s35
    s_and_b32 s36, s39, 1
    s_lshl_b32 s36, s36, 7
    s_add_u32 s35, s35, s36
    v_lshl_add_u32 v12, v1, 1, s35
    s_lshl_b32 s35, s34, 1
    v_mov_b32 v15, s35
    v_mov_b32 v16, 0
    v_mov_b32 v17, 0
    v_mov_b32 v18, 0
    v_mov_b32 v19, 0
    v_lshlrev_b32 v14, 4, v1
    v_mov_b32 v6, 0
    s_mov_b64 exec, 7
    ds_write_b128 v14, v[16:19] offset:1600
    s_mov_b64 exec, -1
    s_cmp_ge_u32 s2, 192
    s_waitcnt lgkmcnt(0)
    s_cbranch_scc1 B0
    global_load_ushort v41, v15, s[14:15]
    global_load_ushort v44, v12, s[6:7]
    global_load_ushort v45, v12, s[8:9]
    s_bitcmp1_b32 s39, 1
    s_cbranch_scc1 B0
    global_load_dword v42, v13, s[10:11]
    global_load_dword v43, v13, s[12:13]
    global_load_ushort v46, v12, s[10:11]
    global_load_ushort v47, v12, s[12:13]
B0:
    s_barrier
    s_mov_b32 s40, s30
    s_and_b32 s41, s31, 0xffff
    s_mov_b32 s42, 0x10000000
    s_mov_b32 s43, 0x00020000
    s_cmp_ge_u32 s3, 4
    s_cbranch_scc1 KWAVE
    s_mov_b32 s47, 0
    v_and_b32 v24, 1, v0
    s_mov_b32 s39, 0x02020000
    v_mul_lo_u32 v24, v24, s39
    v_add_u32 v24, 0x01000c0c, v24
    v_add_u32 v25, s39, v24
    v_add_u32 v26, s39, v25
    s_mov_b32 s52, 0x3ae38e39
    s_mov_b32 s54, 0x00010001
    s_mov_b32 s55, 0x00010001
    v_lshlrev_b32 v23, 14, v4
    v_lshl_add_u32 v23, v5, 4, v23
    s_lshl_b32 s36, s2, 6
    s_add_u32 s36, s36, 4096
    s_add_u32 s37, s36, 262144
    s_add_u32 s38, s36, 524288
    s_waitcnt vmcnt(7)
    v_perm_b32 v64, v9, v8, v24
    v_perm_b32 v65, v11, v10, v24
    v_perm_b32 v66, v9, v8, v25
    v_perm_b32 v67, v11, v10, v25
    v_perm_b32 v68, v9, v8, v26
    v_perm_b32 v69, v11, v10, v26
    v_pk_mul_f32 v[42:43], v[64:65], v[64:65]
    v_pk_add_f32 v[40:41], v[66:67], v[64:65]
    v_pk_fma_f32 v[42:43], v[66:67], v[66:67], v[42:43]
    v_pk_add_f32 v[40:41], v[68:69], v[40:41]
    v_pk_fma_f32 v[42:43], v[68:69], v[68:69], v[42:43]
    s_waitcnt vmcnt(5)
    v_perm_b32 v70, v13, v12, v24
    v_perm_b32 v71, v15, v14, v24
    v_perm_b32 v72, v13, v12, v25
    v_perm_b32 v73, v15, v14, v25
    v_perm_b32 v74, v13, v12, v26
    v_perm_b32 v75, v15, v14, v26
    v_pk_add_f32 v[40:41], v[70:71], v[40:41]
    v_pk_fma_f32 v[42:43], v[70:71], v[70:71], v[42:43]
    v_pk_add_f32 v[40:41], v[72:73], v[40:41]
    v_pk_fma_f32 v[42:43], v[72:73], v[72:73], v[42:43]
    v_pk_add_f32 v[40:41], v[74:75], v[40:41]
    v_pk_fma_f32 v[42:43], v[74:75], v[74:75], v[42:43]
    s_waitcnt vmcnt(3)
    v_perm_b32 v76, v17, v16, v24
    v_perm_b32 v77, v19, v18, v24
    v_perm_b32 v78, v17, v16, v25
    v_perm_b32 v79, v19, v18, v25
    v_perm_b32 v80, v17, v16, v26
    v_perm_b32 v81, v19, v18, v26
    v_pk_add_f32 v[40:41], v[76:77], v[40:41]
    v_pk_fma_f32 v[42:43], v[76:77], v[76:77], v[42:43]
    v_pk_add_f32 v[40:41], v[78:79], v[40:41]
    v_pk_fma_f32 v[42:43], v[78:79], v[78:79], v[42:43]
    v_pk_add_f32 v[40:41], v[80:81], v[40:41]
    v_pk_fma_f32 v[42:43], v[80:81], v[80:81], v[42:43]
    s_nop 0
    v_add_f32_dpp v40, v40, v40 row_ror:8 row_mask:0xf bank_mask:0xf
    v_add_f32_dpp v41, v41, v41 row_ror:8 row_mask:0xf bank_mask:0xf
    v_add_f32_dpp v42, v42, v42 row_ror:8 row_mask:0xf bank_mask:0xf
    v_add_f32_dpp v43, v43, v43 row_ror:8 row_mask:0xf bank_mask:0xf
    v_add_f32_dpp v40, v40, v40 row_ror:4 row_mask:0xf bank_mask:0xf
    v_add_f32_dpp v41, v41, v41 row_ror:4 row_mask:0xf bank_mask:0xf
    v_add_f32_dpp v42, v42, v42 row_ror:4 row_mask:0xf bank_mask:0xf
    v_add_f32_dpp v43, v43, v43 row_ror:4 row_mask:0xf bank_mask:0xf
    v_add_f32_dpp v40, v40, v40 row_ror:2 row_mask:0xf bank_mask:0xf
    v_add_f32_dpp v41, v41, v41 row_ror:2 row_mask:0xf bank_mask:0xf
    v_add_f32_dpp v42, v42, v42 row_ror:2 row_mask:0xf bank_mask:0xf
    v_add_f32_dpp v43, v43, v43 row_ror:2 row_mask:0xf bank_mask:0xf
    v_add_f32_dpp v40, v40, v40 row_ror:1 row_mask:0xf bank_mask:0xf
    v_add_f32_dpp v41, v41, v41 row_ror:1 row_mask:0xf bank_mask:0xf
    v_add_f32_dpp v42, v42, v42 row_ror:1 row_mask:0xf bank_mask:0xf
    v_add_f32_dpp v43, v43, v43 row_ror:1 row_mask:0xf bank_mask:0xf
    v_max_f32 v43, 0, v43
    s_mov_b64 exec, s[54:55]
    ds_write_b128 v21, v[40:43] offset:0
    s_mov_b64 exec, -1
    s_waitcnt vmcnt(2)
    v_readfirstlane_b32 s48, v51
    s_nop 0
    s_mul_i32 s48, s48, 1664525
    s_add_u32 s48, s48, 1013904223
    v_mov_b32 v11, s48
    v_mov_b32 v15, s48
    v_mov_b32 v19, s48
    s_mov_b32 s49, 0
LA_SPIN:
    ds_read_b128 v[32:35], v22 offset:0
    ds_read_b128 v[36:39], v22 offset:16
    ds_read_b128 v[40:43], v22 offset:32
    ds_read_b128 v[44:47], v22 offset:48
    s_add_u32 s49, s49, 1
    s_waitcnt lgkmcnt(0)
    v_max3_u32 v30, v35, v39, v43
    v_max_u32 v30, v30, v47
    v_cmp_eq_u32 vcc, -1, v30
    s_nop 0
    s_cbranch_vccz LA_GO
    s_cmp_lt_u32 s49, 60000
    s_cbranch_scc1 LA_SPIN
LA_GO:
    v_pk_add_f32 v[32:33], v[32:33], v[36:37]
    v_pk_add_f32 v[34:35], v[34:35], v[38:39]
    v_pk_add_f32 v[40:41], v[40:41], v[44:45]
    v_pk_add_f32 v[42:43], v[42:43], v[46:47]
    v_pk_add_f32 v[32:33], v[32:33], v[40:41]
    v_pk_add_f32 v[60:61], v[34:35], v[42:43]
    v_pk_mul_f32 v[32:33], v[32:33], s[52:53] op_sel_hi:[1,0]
    v_pk_mul_f32 v[60:61], v[60:61], s[52:53] op_sel_hi:[1,0]
    v_pk_fma_f32 v[60:61], v[32:33], v[32:33], v[60:61] neg_lo:[1,0,0] neg_hi:[1,0,0]
    v_max_f32 v60, 0, v60
    v_max_f32 v61, 0, v61
    v_cvt_pk_bf16_f32 v30, v60, v61
    v_lshlrev_b32 v60, 16, v30
    v_and_b32 v61, 0xffff0000, v30
    v_add_f32 v60, 0x3727c5ac, v60
    v_add_f32 v61, 0x3727c5ac, v61
    v_cvt_pk_bf16_f32 v30, v60, v61
    v_lshlrev_b32 v60, 16, v30
    v_and_b32 v61, 0xffff0000, v30
    v_sqrt_f32 v60, v60
    v_sqrt_f32 v61, v61
    v_cvt_pk_bf16_f32 v31, v32, v33
    v_lshlrev_b32 v32, 16, v31
    v_and_b32 v33, 0xffff0000, v31
    v_cvt_pk_bf16_f32 v30, v60, v61
    v_lshlrev_b32 v60, 16, v30
    v_and_b32 v61, 0xffff0000, v30
    v_rcp_f32 v60, v60
    v_rcp_f32 v61, v61
    v_pk_add_f32 v[82:83], v[64:65], v[32:33] neg_lo:[0,1] neg_hi:[0,1]
    v_pk_add_f32 v[84:85], v[66:67], v[32:33] neg_lo:[0,1] neg_hi:[0,1]
    v_pk_add_f32 v[86:87], v[68:69], v[32:33] neg_lo:[0,1] neg_hi:[0,1]
    v_pk_mul_f32 v[36:37], v[82:83], v[60:61]
    v_pk_mul_f32 v[38:39], v[84:85], v[60:61]
    v_pk_mul_f32 v[40:41], v[86:87], v[60:61]
    v_cvt_pk_f16_f32 v8, v36, v37
    v_cvt_pk_f16_f32 v9, v38, v39
    v_cvt_pk_f16_f32 v10, v40, v41
    buffer_store_dwordx4 v[8:11], v23, s[40:43], s36 offen sc1
    v_pk_add_f32 v[88:89], v[70:71], v[32:33] neg_lo:[0,1] neg_hi:[0,1]
    v_pk_add_f32 v[90:91], v[72:73], v[32:33] neg_lo:[0,1] neg_hi:[0,1]
    v_pk_add_f32 v[92:93], v[74:75], v[32:33] neg_lo:[0,1] neg_hi:[0,1]
    v_pk_mul_f32 v[36:37], v[88:89], v[60:61]
    v_pk_mul_f32 v[38:39], v[90:91], v[60:61]
    v_pk_mul_f32 v[40:41], v[92:93], v[60:61]
    v_cvt_pk_f16_f32 v12, v36, v37
    v_cvt_pk_f16_f32 v13, v38, v39
    v_cvt_pk_f16_f32 v14, v40, v41
    buffer_store_dwordx4 v[12:15], v23, s[40:43], s37 offen sc1
    v_pk_add_f32 v[94:95], v[76:77], v[32:33] neg_lo:[0,1] neg_hi:[0,1]
    v_pk_add_f32 v[96:97], v[78:79], v[32:33] neg_lo:[0,1] neg_hi:[0,1]
    v_pk_add_f32 v[98:99], v[80:81], v[32:33] neg_lo:[0,1] neg_hi:[0,1]
    v_pk_mul_f32 v[36:37], v[94:95], v[60:61]
    v_pk_mul_f32 v[38:39], v[96:97], v[60:61]
    v_pk_mul_f32 v[40:41], v[98:99], v[60:61]
    v_cvt_pk_f16_f32 v16, v36, v37
    v_cvt_pk_f16_f32 v17, v38, v39
    v_cvt_pk_f16_f32 v18, v40, v41
    buffer_store_dwordx4 v[16:19], v23, s[40:43], s38 offen sc1
    s_cmp_ge_u32 s2, 192
    s_cbranch_scc1 FFN_C
    global_load_dwordx2 v[48:49], v6, s[16:17] offset:0
    global_load_dwordx2 v[50:51], v6, s[20:21] offset:0
    global_load_dwordx2 v[52:53], v6, s[16:17] offset:96
    global_load_dwordx2 v[54:55], v6, s[20:21] offset:96
    global_load_dwordx2 v[56:57], v6, s[16:17] offset:192
    global_load_dwordx2 v[58:59], v6, s[20:21] offset:192
    v_lshlrev_b32 v31, 2, v0
    v_add_u32 v31, 107744, v31
    v_lshlrev_b32 v30, 4, v0
    s_lshl_b32 s36, s2, 14
    s_add_u32 s36, s36, 4096
    s_add_u32 s37, s36, 4096
    s_add_u32 s38, s36, 8192
    s_add_u32 s39, s36, 12288
    s_waitcnt vmcnt(0)
    s_mov_b32 s49, 0
    buffer_load_dwordx4 v[32:35], v30, s[40:43], s36 offen sc1
    buffer_load_dwordx4 v[36:39], v30, s[40:43], s37 offen sc1
    buffer_load_dwordx4 v[40:43], v30, s[40:43], s38 offen sc1
    buffer_load_dwordx4 v[44:47], v30, s[40:43], s39 offen sc1
P_1:
    s_add_u32 s49, s49, 1
    s_waitcnt vmcnt(0)
    v_cmp_ne_u32 s[6:7], s48, v35
    v_cmp_ne_u32 s[8:9], s48, v39
    v_cmp_ne_u32 s[10:11], s48, v43
    v_cmp_ne_u32 s[12:13], s48, v47
    s_or_b64 s[50:51], s[6:7], s[8:9]
    s_or_b64 s[50:51], s[50:51], s[10:11]
    s_or_b64 s[50:51], s[50:51], s[12:13]
    s_cbranch_scc0 PD_2
    s_sleep 1
    s_wqm_b64 exec, s[6:7]
    s_cbranch_execz PS_3
    buffer_load_dwordx4 v[32:35], v30, s[40:43], s36 offen sc1
PS_3:
    s_wqm_b64 exec, s[8:9]
    s_cbranch_execz PS_4
    buffer_load_dwordx4 v[36:39], v30, s[40:43], s37 offen sc1
PS_4:
    s_wqm_b64 exec, s[10:11]
    s_cbranch_execz PS_5
    buffer_load_dwordx4 v[40:43], v30, s[40:43], s38 offen sc1
PS_5:
    s_wqm_b64 exec, s[12:13]
    s_cbranch_execz PS_6
    buffer_load_dwordx4 v[44:47], v30, s[40:43], s39 offen sc1
PS_6:
    s_mov_b64 exec, -1
    s_cmp_lt_u32 s49, 60000
    s_cbranch_scc1 P_1
    s_waitcnt vmcnt(0)
PD_2:
    ds_write_b32 v31, v32 offset:0
    ds_write_b32 v31, v33 offset:4608
    ds_write_b32 v31, v34 offset:9216
    ds_write_b32 v31, v36 offset:1024
    ds_write_b32 v31, v37 offset:5632
    ds_write_b32 v31, v38 offset:10240
    ds_write_b32 v31, v40 offset:2048
    ds_write_b32 v31, v41 offset:6656
    ds_write_b32 v31, v42 offset:11264
    ds_write_b32 v31, v44 offset:3072
    ds_write_b32 v31, v45 offset:7680
    ds_write_b32 v31, v46 offset:12288
    s_mov_b32 s46, s3
    s_branch CV_B4
KWAVE:
    s_load_dword s48, s[30:31], 0
    s_cmp_ge_u32 s2, 192
    s_cbranch_scc1 FFN_CK
    s_and_b32 s56, s3, 3
    s_lshr_b32 s57, s32, 3
    s_sub_u32 s46, s32, s57
    s_cmp_eq_u32 s56, 3
    s_cselect_b32 s47, 2, 0
    s_cselect_b32 s46, s33, s46
    s_cmp_lt_u32 s32, 3
    s_cselect_b32 s47, 1, s47
    s_and_b32 s38, s32, 3
    s_mul_i32 s56, s33, 29376
    s_add_u32 s56, s56, 2048
    s_mul_i32 s57, s33, 5696
    s_add_u32 s57, s57, 90176
    v_and_b32 v14, 255, v0
    v_cmp_gt_u32 vcc, 100, v14
    v_lshl_add_u32 v14, v14, 4, s57
    ds_write_b128 v14, v[16:19]
    s_mul_i32 s58, s33, 4608
    s_add_u32 s58, s58, 107264
    v_lshl_add_u32 v15, v1, 4, s58
    s_mov_b64 exec, vcc
    ds_write_b128 v14, v[16:19] offset:4096
    s_mov_b64 exec, 0x3fffffff
    ds_write_b128 v15, v[16:19]
    s_mov_b64 exec, -1
    s_and_b32 s58, s38, 1
    s_lshl_b32 s59, s58, 4
    s_add_u32 s59, s59, 22
    v_add_u32 v14, s59, v3
    v_mul_u32_u24 v14, 544, v14
    v_lshl_add_u32 v15, v5, 4, s56
    v_and_b32 v16, 3, v1
    v_mul_u32_u24 v16, 1218, v16
    v_add_u32 v16, s57, v16
    s_cmp_ge_u32 s38, 2
    s_cbranch_scc1 CC_T
    s_mov_b32 s52, 0x45670123
    s_mov_b32 s53, 0xabcc89aa
    v_lshlrev_b32 v17, 2, v3
    v_lshrrev_b64 v[18:19], v17, s[52:53]
    v_and_b32 v18, 15, v18
    v_mul_u32_u24 v18, 544, v18
    v_add_u32 v8, v18, v15
    v_add_u32 v9, v14, v15
    s_lshl_b32 s58, s58, 8
    s_sub_u32 s58, s57, s58
    s_add_u32 s58, s58, 1080
    v_and_b32 v17, 1, v5
    v_lshlrev_b32 v17, 3, v17
    v_lshl_add_u32 v17, v3, 4, v17
    v_lshrrev_b32 v18, 1, v5
    v_lshl_add_u32 v17, v18, 9, v17
    v_sub_u32 v10, s58, v17
    v_bfe_u32 v17, v1, 2, 1
    v_lshlrev_b32 v17, 1, v17
    v_sub_u32 v11, v16, v17
    v_add_u32 v11, 62, v11
    s_branch CC_2
CC_T:
    v_min_u32 v18, 8, v3
    v_add_u32 v18, 13, v18
    v_mul_u32_u24 v18, 544, v18
    v_add_u32 v9, v18, v15
    v_add_u32 v8, v14, v15
    v_and_b32 v17, 1, v3
    v_lshlrev_b32 v17, 8, v17
    v_lshrrev_b32 v18, 1, v3
    v_lshl_add_u32 v17, v18, 6, v17
    v_lshlrev_b32 v18, 6, v3
    v_add_u32 v18, 256, v18
    v_cmp_lt_u32 vcc, 3, v3
    s_nop 1
    v_cndmask_b32 v17, v17, v18, vcc
    s_lshl_b32 s58, s58, 5
    s_add_u32 s58, s58, s57
    s_add_u32 s58, s58, 4928
    v_lshl_add_u32 v17, v5, 3, v17
    v_add_u32 v10, s58, v17
    v_add_u32 v11, 1088, v16
CC_2:
    s_and_b32 s58, s39, 1
    s_lshl_b32 s58, s58, 8
    s_add_u32 s58, s58, s56
    s_mov_b32 m0, s58
    s_cmp_eq_u32 s47, 0
    s_cbranch_scc1 CC_END
    s_mul_i32 s57, s46, 5696
    s_add_u32 s57, s57, 90176
    s_mul_i32 s58, s46, 10608
    s_add_u32 s58, s58, 14376
    v_and_b32 v16, 3, v3
    v_mul_u32_u24 v17, 1218, v16
    v_lshlrev_b32 v18, 3, v5
    v_sub_u32 v18, v18, v3
    v_lshl_add_u32 v17, v18, 1, v17
    v_add3_u32 v127, v17, s57, 32
    s_mul_i32 s59, s46, 4608
    s_add_u32 s59, s59, 107264
    v_lshlrev_b32 v17, 5, v3
    v_lshl_add_u32 v17, v5, 4, v17
    v_add_u32 v126, s59, v17
    v_lshlrev_b32 v17, 1, v5
    v_sub_u32 v17, v3, v17
    s_add_u32 s59, s57, 4892
    v_lshl_add_u32 v125, v17, 2, s59
    v_bfe_u32 v19, v1, 2, 1
    v_bfe_u32 v20, v1, 3, 1
    v_lshl_add_u32 v21, v16, 3, s58
    v_mul_u32_u24 v17, 3192, v20
    v_lshlrev_b32 v22, 4, v19
    v_sub_u32 v17, v17, v22
    v_lshl_add_u32 v17, v5, 6, v17
    v_add3_u32 v124, v17, v21, -8
    s_lshl_b32 s59, s46, 12
    v_lshl_add_u32 v123, v1, 3, s59
    s_cmp_eq_u32 s47, 2
    s_cbranch_scc1 CC_END
    v_lshlrev_b32 v17, 2, v5
    v_sub_u32 v17, v3, v17
    s_add_u32 s59, s57, 5428
    v_lshl_add_u32 v122, v17, 2, s59
    v_mul_u32_u24 v17, 2112, v19
    v_lshl_add_u32 v17, v20, 5, v17
    v_lshl_add_u32 v17, v5, 7, v17
    v_add_u32 v17, 6384, v17
    v_add_u32 v121, v17, v21
    s_add_u32 s59, s57, 5308
    v_mov_b32 v120, s59
    s_mov_b32 s52, -1
    s_mov_b32 s53, 0
    v_sub_u32 v17, 14, v18
    v_med3_i32 v17, v17, 0, 4
    v_lshlrev_b32 v17, 4, v17
    v_lshlrev_b64 v[22:23], v17, s[52:53]
    v_mov_b32 v116, v23
    v_sub_u32 v17, 12, v18
    v_med3_i32 v17, v17, 0, 4
    v_lshlrev_b32 v17, 4, v17
    v_lshlrev_b64 v[22:23], v17, s[52:53]
    v_mov_b32 v117, v23
    v_sub_u32 v17, 10, v18
    v_med3_i32 v17, v17, 0, 4
    v_lshlrev_b32 v17, 4, v17
    v_lshlrev_b64 v[22:23], v17, s[52:53]
    v_mov_b32 v118, v23
    v_sub_u32 v17, 8, v18
    v_med3_i32 v17, v17, 0, 4
    v_lshlrev_b32 v17, 4, v17
    v_lshlrev_b64 v[22:23], v17, s[52:53]
    v_mov_b32 v119, v23
CC_END:
    s_waitcnt vmcnt(0)
    v_lshlrev_b32 v41, 16, v41
    v_lshlrev_b32 v44, 16, v44
    v_mul_f32 v41, 0x3fb8aa3b, v41
    v_mul_f32 v44, 0x3fb8aa3b, v44
    v_exp_f32 v41, v41
    v_exp_f32 v44, v44
    v_lshlrev_b32 v45, 16, v45
    v_mul_f32 v45, 0.15915494, v45
    v_cvt_pk_bf16_f32 v14, v41, v44
    v_lshlrev_b32 v41, 16, v14
    v_and_b32 v44, 0xffff0000, v14
    v_mul_f32 v13, v45, v41
    v_mul_f32 v44, v44, v41
    v_rndne_f32 v14, v13
    v_mul_f32 v12, 0xbfb8aa3b, v44
    v_sub_f32 v13, v13, v14
    s_bitcmp0_b32 s39, 1
    s_cbranch_scc1 KG_A
    v_mul_f32 v14, 0x41000000, v12
    v_mul_f32 v15, 0x41000000, v13
    v_exp_f32 v14, v14
    v_cos_f32 v32, v15
    v_sin_f32 v33, v15
    v_mul_f32 v32, v32, v14
    v_mul_f32 v33, v33, v14
    v_mov_b32 v16, 0x3c00
    ds_write_addtid_b32 v16 offset:11968
    v_pk_mul_f32 v[36:37], v[32:33], v[32:33] op_sel:[0,0] op_sel_hi:[1,0]
    v_pk_fma_f32 v[36:37], v[32:33], v[32:33], v[36:37] op_sel:[1,1,0] op_sel_hi:[0,1,1] neg_lo:[1,0,0]
    v_cvt_pk_f16_f32 v17, v32, v33
    ds_write_addtid_b32 v17 offset:12512
    v_pk_mul_f32 v[34:35], v[36:37], v[32:33] op_sel:[0,0] op_sel_hi:[1,0]
    v_pk_fma_f32 v[34:35], v[36:37], v[32:33], v[34:35] op_sel:[1,1,0] op_sel_hi:[0,1,1] neg_lo:[1,0,0]
    v_cvt_pk_f16_f32 v18, v36, v37
    ds_write_addtid_b32 v18 offset:13056
    v_pk_mul_f32 v[36:37], v[34:35], v[32:33] op_sel:[0,0] op_sel_hi:[1,0]
    v_pk_fma_f32 v[36:37], v[34:35], v[32:33], v[36:37] op_sel:[1,1,0] op_sel_hi:[0,1,1] neg_lo:[1,0,0]
    v_cvt_pk_f16_f32 v19, v34, v35
    ds_write_addtid_b32 v19 offset:13600
    v_pk_mul_f32 v[34:35], v[36:37], v[32:33] op_sel:[0,0] op_sel_hi:[1,0]
    v_pk_fma_f32 v[34:35], v[36:37], v[32:33], v[34:35] op_sel:[1,1,0] op_sel_hi:[0,1,1] neg_lo:[1,0,0]
    v_cvt_pk_f16_f32 v20, v36, v37
    ds_write_addtid_b32 v20 offset:14144
    v_pk_mul_f32 v[36:37], v[34:35], v[32:33] op_sel:[0,0] op_sel_hi:[1,0]
    v_pk_fma_f32 v[36:37], v[34:35], v[32:33], v[36:37] op_sel:[1,1,0] op_sel_hi:[0,1,1] neg_lo:[1,0,0]
    v_cvt_pk_f16_f32 v21, v34, v35
    ds_write_addtid_b32 v21 offset:14688
    v_pk_mul_f32 v[34:35], v[36:37], v[32:33] op_sel:[0,0] op_sel_hi:[1,0]
    v_pk_fma_f32 v[34:35], v[36:37], v[32:33], v[34:35] op_sel:[1,1,0] op_sel_hi:[0,1,1] neg_lo:[1,0,0]
    v_cvt_pk_f16_f32 v22, v36, v37
    ds_write_addtid_b32 v22 offset:15232
    v_pk_mul_f32 v[36:37], v[34:35], v[32:33] op_sel:[0,0] op_sel_hi:[1,0]
    v_pk_fma_f32 v[36:37], v[34:35], v[32:33], v[36:37] op_sel:[1,1,0] op_sel_hi:[0,1,1] neg_lo:[1,0,0]
    v_cvt_pk_f16_f32 v23, v34, v35
    ds_write_addtid_b32 v23 offset:15776
    v_pk_mul_f32 v[34:35], v[36:37], v[32:33] op_sel:[0,0] op_sel_hi:[1,0]
    v_pk_fma_f32 v[34:35], v[36:37], v[32:33], v[34:35] op_sel:[1,1,0] op_sel_hi:[0,1,1] neg_lo:[1,0,0]
    v_cvt_pk_f16_f32 v24, v36, v37
    ds_write_addtid_b32 v24 offset:16320
    v_pk_mul_f32 v[36:37], v[34:35], v[32:33] op_sel:[0,0] op_sel_hi:[1,0]
    v_pk_fma_f32 v[36:37], v[34:35], v[32:33], v[36:37] op_sel:[1,1,0] op_sel_hi:[0,1,1] neg_lo:[1,0,0]
    v_cvt_pk_f16_f32 v25, v34, v35
    ds_write_addtid_b32 v25 offset:16864
    v_pk_mul_f32 v[34:35], v[36:37], v[32:33] op_sel:[0,0] op_sel_hi:[1,0]
    v_pk_fma_f32 v[34:35], v[36:37], v[32:33], v[34:35] op_sel:[1,1,0] op_sel_hi:[0,1,1] neg_lo:[1,0,0]
    v_cvt_pk_f16_f32 v26, v36, v37
    ds_write_addtid_b32 v26 offset:17408
    v_pk_mul_f32 v[36:37], v[34:35], v[32:33] op_sel:[0,0] op_sel_hi:[1,0]
    v_pk_fma_f32 v[36:37], v[34:35], v[32:33], v[36:37] op_sel:[1,1,0] op_sel_hi:[0,1,1] neg_lo:[1,0,0]
    v_cvt_pk_f16_f32 v27, v34, v35
    ds_write_addtid_b32 v27 offset:17952
    v_pk_mul_f32 v[34:35], v[36:37], v[32:33] op_sel:[0,0] op_sel_hi:[1,0]
    v_pk_fma_f32 v[34:35], v[36:37], v[32:33], v[34:35] op_sel:[1,1,0] op_sel_hi:[0,1,1] neg_lo:[1,0,0]
    v_cvt_pk_f16_f32 v28, v36, v37
    ds_write_addtid_b32 v28 offset:18496
    v_pk_mul_f32 v[36:37], v[34:35], v[32:33] op_sel:[0,0] op_sel_hi:[1,0]
    v_pk_fma_f32 v[36:37], v[34:35], v[32:33], v[36:37] op_sel:[1,1,0] op_sel_hi:[0,1,1] neg_lo:[1,0,0]
    v_cvt_pk_f16_f32 v29, v34, v35
    ds_write_addtid_b32 v29 offset:19040
    v_pk_mul_f32 v[34:35], v[36:37], v[32:33] op_sel:[0,0] op_sel_hi:[1,0]
    v_pk_fma_f32 v[34:35], v[36:37], v[32:33], v[34:35] op_sel:[1,1,0] op_sel_hi:[0,1,1] neg_lo:[1,0,0]
    v_cvt_pk_f16_f32 v30, v36, v37
    ds_write_addtid_b32 v30 offset:19584
    v_pk_mul_f32 v[36:37], v[34:35], v[32:33] op_sel:[0,0] op_sel_hi:[1,0]
    v_pk_fma_f32 v[36:37], v[34:35], v[32:33], v[36:37] op_sel:[1,1,0] op_sel_hi:[0,1,1] neg_lo:[1,0,0]
    v_cvt_pk_f16_f32 v31, v34, v35
    ds_write_addtid_b32 v31 offset:20128
    v_cvt_pk_f16_f32 v38, v36, v37
    ds_write_addtid_b32 v38 offset:20672
    v_pk_mul_f16 v33, v17, v38 op_sel:[0,0] op_sel_hi:[1,0]
    v_pk_fma_f16 v33, v17, v38, v33 op_sel:[1,1,0] op_sel_hi:[0,1,1] neg_lo:[1,0,0]
    ds_write_addtid_b32 v33 offset:21216
    v_pk_mul_f16 v34, v18, v38 op_sel:[0,0] op_sel_hi:[1,0]
    v_pk_fma_f16 v34, v18, v38, v34 op_sel:[1,1,0] op_sel_hi:[0,1,1] neg_lo:[1,0,0]
    ds_write_addtid_b32 v34 offset:21760
    v_pk_mul_f16 v35, v19, v38 op_sel:[0,0] op_sel_hi:[1,0]
    v_pk_fma_f16 v35, v19, v38, v35 op_sel:[1,1,0] op_sel_hi:[0,1,1] neg_lo:[1,0,0]
    ds_write_addtid_b32 v35 offset:22304
    v_pk_mul_f16 v32, v20, v38 op_sel:[0,0] op_sel_hi:[1,0]
    v_pk_fma_f16 v32, v20, v38, v32 op_sel:[1,1,0] op_sel_hi:[0,1,1] neg_lo:[1,0,0]
    ds_write_addtid_b32 v32 offset:22848
    v_pk_mul_f16 v33, v21, v38 op_sel:[0,0] op_sel_hi:[1,0]
    v_pk_fma_f16 v33, v21, v38, v33 op_sel:[1,1,0] op_sel_hi:[0,1,1] neg_lo:[1,0,0]
    ds_write_addtid_b32 v33 offset:23392
    v_pk_mul_f16 v34, v22, v38 op_sel:[0,0] op_sel_hi:[1,0]
    v_pk_fma_f16 v34, v22, v38, v34 op_sel:[1,1,0] op_sel_hi:[0,1,1] neg_lo:[1,0,0]
    ds_write_addtid_b32 v34 offset:23936
    v_pk_mul_f16 v35, v23, v38 op_sel:[0,0] op_sel_hi:[1,0]
    v_pk_fma_f16 v35, v23, v38, v35 op_sel:[1,1,0] op_sel_hi:[0,1,1] neg_lo:[1,0,0]
    ds_write_addtid_b32 v35 offset:24480
    v_pk_mul_f16 v32, v24, v38 op_sel:[0,0] op_sel_hi:[1,0]
    v_pk_fma_f16 v32, v24, v38, v32 op_sel:[1,1,0] op_sel_hi:[0,1,1] neg_lo:[1,0,0]
    ds_write_addtid_b32 v32 offset:25024
    v_pk_mul_f16 v33, v25, v38 op_sel:[0,0] op_sel_hi:[1,0]
    v_pk_fma_f16 v33, v25, v38, v33 op_sel:[1,1,0] op_sel_hi:[0,1,1] neg_lo:[1,0,0]
    ds_write_addtid_b32 v33 offset:25568
    v_pk_mul_f16 v34, v26, v38 op_sel:[0,0] op_sel_hi:[1,0]
    v_pk_fma_f16 v34, v26, v38, v34 op_sel:[1,1,0] op_sel_hi:[0,1,1] neg_lo:[1,0,0]
    ds_write_addtid_b32 v34 offset:26112
    v_pk_mul_f16 v35, v27, v38 op_sel:[0,0] op_sel_hi:[1,0]
    v_pk_fma_f16 v35, v27, v38, v35 op_sel:[1,1,0] op_sel_hi:[0,1,1] neg_lo:[1,0,0]
    ds_write_addtid_b32 v35 offset:26656
    v_pk_mul_f16 v32, v28, v38 op_sel:[0,0] op_sel_hi:[1,0]
    v_pk_fma_f16 v32, v28, v38, v32 op_sel:[1,1,0] op_sel_hi:[0,1,1] neg_lo:[1,0,0]
    ds_write_addtid_b32 v32 offset:27200
    v_pk_mul_f16 v33, v29, v38 op_sel:[0,0] op_sel_hi:[1,0]
    v_pk_fma_f16 v33, v29, v38, v33 op_sel:[1,1,0] op_sel_hi:[0,1,1] neg_lo:[1,0,0]
    ds_write_addtid_b32 v33 offset:27744
    v_pk_mul_f16 v34, v30, v38 op_sel:[0,0] op_sel_hi:[1,0]
    v_pk_fma_f16 v34, v30, v38, v34 op_sel:[1,1,0] op_sel_hi:[0,1,1] neg_lo:[1,0,0]
    ds_write_addtid_b32 v34 offset:28288
    v_pk_mul_f16 v35, v31, v38 op_sel:[0,0] op_sel_hi:[1,0]
    v_pk_fma_f16 v35, v31, v38, v35 op_sel:[1,1,0] op_sel_hi:[0,1,1] neg_lo:[1,0,0]
    ds_write_addtid_b32 v35 offset:28832
    s_branch KG_END
KG_A:
    v_and_b32 v42, 0x7fff7fff, v42
    v_and_b32 v43, 0x7fff7fff, v43
    v_pk_max_u16 v42, v42, v43
    v_lshlrev_b32 v43, 16, v42
    v_max_u32 v42, v42, v43
    v_exp_f32 v14, v12
    v_cos_f32 v16, v13
    v_max_u32_dpp v42, v42, v42 row_ror:8 row_mask:0xf bank_mask:0xf
    v_sin_f32 v17, v13
    v_mul_f32 v16, v16, v14
    v_max_u32_dpp v42, v42, v42 row_ror:4 row_mask:0xf bank_mask:0xf
    v_mul_f32 v17, v17, v14
    v_mul_f32 v14, 0x43800000, v12
    v_max_u32_dpp v42, v42, v42 row_ror:2 row_mask:0xf bank_mask:0xf
    v_mul_f32 v15, 0x43800000, v13
    v_exp_f32 v14, v14
    v_max_u32_dpp v42, v42, v42 row_ror:1 row_mask:0xf bank_mask:0xf
    v_cos_f32 v18, v15
    v_sin_f32 v19, v15
    v_max_u32_dpp v42, v42, v42 row_bcast:15 row_mask:0xa bank_mask:0xf
    v_mul_f32 v18, v18, v14
    v_mul_f32 v19, v19, v14
    v_max_u32_dpp v42, v42, v42 row_bcast:31 row_mask:0xc bank_mask:0xf
    v_lshlrev_b32 v46, 16, v46
    v_lshlrev_b32 v47, 16, v47
    v_readlane_b32 s56, v42, 63
    s_nop 0
    s_lshr_b32 s56, s56, 23
    s_max_u32 s56, s56, 6
    s_sub_u32 s57, 260, s56
    s_lshl_b32 s57, s57, 23
    s_sub_u32 s56, s56, 5
    s_lshl_b32 s56, s56, 23
    v_mul_f32 v46, s57, v46
    v_mul_f32 v47, s57, v47
    v_mul_f32 v41, s56, v41
    s_lshl_b32 s56, s33, 2
    v_mov_b32 v14, s56
    s_mov_b64 exec, 1
    ds_write_b32 v14, v41 offset:1648
    s_mov_b64 exec, -1
    v_cvt_pk_f16_f32 v32, v46, -v47
    ds_write_addtid_b32 v32 offset:11424
    v_pk_mul_f32 v[24:25], v[46:47], v[18:19] op_sel:[0,0] op_sel_hi:[1,0]
    v_pk_fma_f32 v[24:25], v[46:47], v[18:19], v[24:25] op_sel:[1,1,0] op_sel_hi:[0,1,1] neg_lo:[1,0,0]
    v_cvt_pk_f16_f32 v33, v24, -v25
    ds_write_addtid_b32 v33 offset:4352
    v_pk_mul_f32 v[22:23], v[46:47], v[16:17] op_sel:[0,0] op_sel_hi:[1,0]
    v_pk_fma_f32 v[22:23], v[46:47], v[16:17], v[22:23] op_sel:[1,1,0] op_sel_hi:[0,1,1] neg_lo:[1,0,0]
    v_cvt_pk_f16_f32 v34, v22, -v23
    ds_write_addtid_b32 v34 offset:0
    v_pk_mul_f32 v[20:21], v[22:23], v[16:17] op_sel:[0,0] op_sel_hi:[1,0]
    v_pk_fma_f32 v[20:21], v[22:23], v[16:17], v[20:21] op_sel:[1,1,0] op_sel_hi:[0,1,1] neg_lo:[1,0,0]
    v_cvt_pk_f16_f32 v35, v20, -v21
    ds_write_addtid_b32 v35 offset:544
    v_pk_mul_f32 v[24:25], v[20:21], v[18:19] op_sel:[0,0] op_sel_hi:[1,0]
    v_pk_fma_f32 v[24:25], v[20:21], v[18:19], v[24:25] op_sel:[1,1,0] op_sel_hi:[0,1,1] neg_lo:[1,0,0]
    v_cvt_pk_f16_f32 v36, v24, -v25
    ds_write_addtid_b32 v36 offset:4896
    v_pk_mul_f32 v[22:23], v[20:21], v[16:17] op_sel:[0,0] op_sel_hi:[1,0]
    v_pk_fma_f32 v[22:23], v[20:21], v[16:17], v[22:23] op_sel:[1,1,0] op_sel_hi:[0,1,1] neg_lo:[1,0,0]
    v_cvt_pk_f16_f32 v37, v22, -v23
    ds_write_addtid_b32 v37 offset:1088
    v_pk_mul_f32 v[20:21], v[22:23], v[16:17] op_sel:[0,0] op_sel_hi:[1,0]
    v_pk_fma_f32 v[20:21], v[22:23], v[16:17], v[20:21] op_sel:[1,1,0] op_sel_hi:[0,1,1] neg_lo:[1,0,0]
    v_cvt_pk_f16_f32 v32, v20, -v21
    ds_write_addtid_b32 v32 offset:1632
    v_pk_mul_f32 v[24:25], v[20:21], v[18:19] op_sel:[0,0] op_sel_hi:[1,0]
    v_pk_fma_f32 v[24:25], v[20:21], v[18:19], v[24:25] op_sel:[1,1,0] op_sel_hi:[0,1,1] neg_lo:[1,0,0]
    v_cvt_pk_f16_f32 v33, v24, -v25
    ds_write_addtid_b32 v33 offset:5440
    v_pk_mul_f32 v[26:27], v[24:25], v[18:19] op_sel:[0,0] op_sel_hi:[1,0]
    v_pk_fma_f32 v[26:27], v[24:25], v[18:19], v[26:27] op_sel:[1,1,0] op_sel_hi:[0,1,1] neg_lo:[1,0,0]
    v_cvt_pk_f16_f32 v34, v26, -v27
    ds_write_addtid_b32 v34 offset:7072
    v_pk_mul_f32 v[24:25], v[26:27], v[18:19] op_sel:[0,0] op_sel_hi:[1,0]
    v_pk_fma_f32 v[24:25], v[26:27], v[18:19], v[24:25] op_sel:[1,1,0] op_sel_hi:[0,1,1] neg_lo:[1,0,0]
    v_cvt_pk_f16_f32 v35, v24, -v25
    ds_write_addtid_b32 v35 offset:8160
    v_pk_mul_f32 v[22:23], v[20:21], v[16:17] op_sel:[0,0] op_sel_hi:[1,0]
    v_pk_fma_f32 v[22:23], v[20:21], v[16:17], v[22:23] op_sel:[1,1,0] op_sel_hi:[0,1,1] neg_lo:[1,0,0]
    v_cvt_pk_f16_f32 v36, v22, -v23
    ds_write_addtid_b32 v36 offset:2176
    v_pk_mul_f32 v[20:21], v[22:23], v[16:17] op_sel:[0,0] op_sel_hi:[1,0]
    v_pk_fma_f32 v[20:21], v[22:23], v[16:17], v[20:21] op_sel:[1,1,0] op_sel_hi:[0,1,1] neg_lo:[1,0,0]
    v_cvt_pk_f16_f32 v37, v20, -v21
    ds_write_addtid_b32 v37 offset:2720
    v_pk_mul_f32 v[24:25], v[20:21], v[18:19] op_sel:[0,0] op_sel_hi:[1,0]
    v_pk_fma_f32 v[24:25], v[20:21], v[18:19], v[24:25] op_sel:[1,1,0] op_sel_hi:[0,1,1] neg_lo:[1,0,0]
    v_cvt_pk_f16_f32 v32, v24, -v25
    ds_write_addtid_b32 v32 offset:5984
    v_pk_mul_f32 v[22:23], v[20:21], v[16:17] op_sel:[0,0] op_sel_hi:[1,0]
    v_pk_fma_f32 v[22:23], v[20:21], v[16:17], v[22:23] op_sel:[1,1,0] op_sel_hi:[0,1,1] neg_lo:[1,0,0]
    v_cvt_pk_f16_f32 v33, v22, -v23
    ds_write_addtid_b32 v33 offset:3264
    v_pk_mul_f32 v[20:21], v[22:23], v[16:17] op_sel:[0,0] op_sel_hi:[1,0]
    v_pk_fma_f32 v[20:21], v[22:23], v[16:17], v[20:21] op_sel:[1,1,0] op_sel_hi:[0,1,1] neg_lo:[1,0,0]
    v_cvt_pk_f16_f32 v34, v20, -v21
    ds_write_addtid_b32 v34 offset:3808
    v_pk_mul_f32 v[24:25], v[20:21], v[18:19] op_sel:[0,0] op_sel_hi:[1,0]
    v_pk_fma_f32 v[24:25], v[20:21], v[18:19], v[24:25] op_sel:[1,1,0] op_sel_hi:[0,1,1] neg_lo:[1,0,0]
    v_cvt_pk_f16_f32 v35, v24, -v25
    ds_write_addtid_b32 v35 offset:6528
    v_pk_mul_f32 v[26:27], v[24:25], v[18:19] op_sel:[0,0] op_sel_hi:[1,0]
    v_pk_fma_f32 v[26:27], v[24:25], v[18:19], v[26:27] op_sel:[1,1,0] op_sel_hi:[0,1,1] neg_lo:[1,0,0]
    v_cvt_pk_f16_f32 v36, v26, -v27
    ds_write_addtid_b32 v36 offset:7616
    v_pk_mul_f32 v[24:25], v[26:27], v[18:19] op_sel:[0,0] op_sel_hi:[1,0]
    v_pk_fma_f32 v[24:25], v[26:27], v[18:19], v[24:25] op_sel:[1,1,0] op_sel_hi:[0,1,1] neg_lo:[1,0,0]
    v_cvt_pk_f16_f32 v37, v24, -v25
    ds_write_addtid_b32 v37 offset:8704
    v_pk_mul_f32 v[26:27], v[24:25], v[18:19] op_sel:[0,0] op_sel_hi:[1,0]
    v_pk_fma_f32 v[26:27], v[24:25], v[18:19], v[26:27] op_sel:[1,1,0] op_sel_hi:[0,1,1] neg_lo:[1,0,0]
    v_cvt_pk_f16_f32 v32, v26, -v27
    ds_write_addtid_b32 v32 offset:9248
    v_pk_mul_f32 v[24:25], v[26:27], v[18:19] op_sel:[0,0] op_sel_hi:[1,0]
    v_pk_fma_f32 v[24:25], v[26:27], v[18:19], v[24:25] op_sel:[1,1,0] op_sel_hi:[0,1,1] neg_lo:[1,0,0]
    v_cvt_pk_f16_f32 v33, v24, -v25
    ds_write_addtid_b32 v33 offset:9792
    v_pk_mul_f32 v[26:27], v[24:25], v[18:19] op_sel:[0,0] op_sel_hi:[1,0]
    v_pk_fma_f32 v[26:27], v[24:25], v[18:19], v[26:27] op_sel:[1,1,0] op_sel_hi:[0,1,1] neg_lo:[1,0,0]
    v_cvt_pk_f16_f32 v34, v26, -v27
    ds_write_addtid_b32 v34 offset:10336
    v_pk_mul_f32 v[24:25], v[26:27], v[18:19] op_sel:[0,0] op_sel_hi:[1,0]
    v_pk_fma_f32 v[24:25], v[26:27], v[18:19], v[24:25] op_sel:[1,1,0] op_sel_hi:[0,1,1] neg_lo:[1,0,0]
    v_cvt_pk_f16_f32 v35, v24, -v25
    ds_write_addtid_b32 v35 offset:10880
KG_END:
    s_lshl_b32 s56, s33, 2
    v_mov_b32 v14, s56
    v_mov_b32 v15, 1
    s_waitcnt lgkmcnt(0)
    s_mov_b64 exec, 1
    ds_add_u32 v14, v15 offset:1632
    s_mov_b64 exec, -1
    s_mul_i32 s48, s48, 1664525
    s_add_u32 s48, s48, 1013904223
    s_mov_b32 s49, 0
KG_SPIN:
    ds_read_b32 v15, v14 offset:1632
    s_add_u32 s49, s49, 1
    s_waitcnt lgkmcnt(0)
    v_readfirstlane_b32 s56, v15
    s_nop 0
    s_cmp_ge_u32 s56, 4
    s_cbranch_scc1 KG_GO
    s_sleep 1
    s_cmp_lt_u32 s49, 60000
    s_cbranch_scc1 KG_SPIN
KG_GO:
    s_setprio 2
    ds_read_b128 v[12:15], v8 offset:0
    ds_read_b128 v[16:19], v9 offset:0
    ds_read_b128 v[20:23], v8 offset:64
    ds_read_b128 v[24:27], v9 offset:64
    ds_read_b128 v[28:31], v8 offset:128
    ds_read_b128 v[32:35], v9 offset:128
    ds_read_b128 v[36:39], v8 offset:192
    ds_read_b128 v[40:43], v9 offset:192
    s_waitcnt lgkmcnt(6)
    v_mfma_f32_16x16x32_f16 v[44:47], v[12:15], v[16:19], 0
    ds_read_b128 v[12:15], v8 offset:256
    ds_read_b128 v[16:19], v9 offset:256
    s_waitcnt lgkmcnt(6)
    v_mfma_f32_16x16x32_f16 v[44:47], v[20:23], v[24:27], v[44:47]
    ds_read_b128 v[20:23], v8 offset:320
    ds_read_b128 v[24:27], v9 offset:320
    s_waitcnt lgkmcnt(6)
    v_mfma_f32_16x16x32_f16 v[44:47], v[28:31], v[32:35], v[44:47]
    ds_read_b128 v[28:31], v8 offset:384
    ds_read_b128 v[32:35], v9 offset:384
    s_waitcnt lgkmcnt(6)
    v_mfma_f32_16x16x32_f16 v[44:47], v[36:39], v[40:43], v[44:47]
    ds_read_b128 v[36:39], v8 offset:448
    ds_read_b128 v[40:43], v9 offset:448
    s_waitcnt lgkmcnt(6)
    v_mfma_f32_16x16x32_f16 v[44:47], v[12:15], v[16:19], v[44:47]
    s_waitcnt lgkmcnt(4)
    v_mfma_f32_16x16x32_f16 v[44:47], v[20:23], v[24:27], v[44:47]
    s_waitcnt lgkmcnt(2)
    v_mfma_f32_16x16x32_f16 v[44:47], v[28:31], v[32:35], v[44:47]
    s_waitcnt lgkmcnt(0)
    v_mfma_f32_16x16x32_f16 v[44:47], v[36:39], v[40:43], v[44:47]
    s_nop 7
    v_cvt_pk_f16_f32 v12, v44, v45
    v_cvt_pk_f16_f32 v13, v46, v47
    s_cmp_ge_u32 s38, 2
    s_cbranch_scc1 KG_WT
    v_cvt_pk_f16_f32 v14, v45, v46
    ds_write_b64 v10, v[12:13]
    ds_write_b16 v10, v12 offset:1218
    ds_write_b32 v10, v14 offset:1220
    ds_write_b16_d16_hi v10, v13 offset:1224
    ds_write_b32 v10, v12 offset:2436
    ds_write_b32 v10, v13 offset:2440
    ds_write_b16 v10, v12 offset:3654
    ds_write_b32 v10, v14 offset:3656
    ds_write_b16_d16_hi v10, v13 offset:3660
    s_cmp_eq_u32 s38, 0
    s_cbranch_scc1 KG_WD
    v_readlane_b32 s56, v12, 63
    s_mov_b64 exec, 0xff
    s_nop 0
    v_mov_b32 v15, s56
    ds_write_b16 v11, v15
    s_branch KG_WD
KG_WT:
    v_readlane_b32 s56, v12, 8
    s_mov_b32 exec_lo, 0x00ff00ff
    s_mov_b32 exec_hi, 0x00ff00ff
    ds_write_b64 v10, v[12:13]
    s_cmp_eq_u32 s38, 3
    s_cbranch_scc1 KG_WD
    s_mov_b64 exec, 15
    v_mov_b32 v15, s56
    ds_write_b16 v11, v15
KG_WD:
    s_mov_b64 exec, -1
    s_cmp_ge_u32 s3, 8
    s_cbranch_scc1 CV_B4
    s_cmp_ge_u32 s2, 128
    s_cbranch_scc1 CV_B4
    s_and_b32 s34, s3, 3
    s_mul_i32 s34, s34, 48
    v_add_u32 v4, s34, v3
    v_mul_u32_u24 v6, 6, v4
    v_and_b32 v6, -4, v6
    s_mul_i32 s34, s2, 9216
    s_add_u32 s34, s34, 1179648
    v_mul_u32_u24 v7, 2304, v5
    v_add3_u32 v7, v7, v6, s34
    global_load_dwordx2 v[28:29], v7, s[4:5] offset:0
    global_load_dwordx2 v[30:31], v7, s[4:5] offset:1152
    global_load_dwordx2 v[32:33], v7, s[4:5] offset:96
    global_load_dwordx2 v[34:35], v7, s[4:5] offset:1248
    global_load_dwordx2 v[36:37], v7, s[4:5] offset:192
    global_load_dwordx2 v[38:39], v7, s[4:5] offset:1344
CV_B4:
    s_waitcnt lgkmcnt(0)
    s_barrier
    s_cmp_eq_u32 s47, 0
    s_cbranch_scc1 CV_WIN
    s_setprio 2
    s_cmp_eq_u32 s47, 2
    s_cbranch_scc1 CV_LIGHT
    s_lshl_b32 s57, s46, 2
    v_mov_b32 v4, s57
    ds_read_b128 v[40:43], v126 offset:1408
    ds_read_b64 v[44:45], v127 offset:448
    ds_read_b64 v[46:47], v127 offset:456
    ds_read_b128 v[48:51], v126 offset:1920
    ds_read_b64 v[52:53], v127 offset:960
    ds_read_b32 v4, v4 offset:1648
    ds_read_b32 v120, v120
    v_mov_b32 v6, 0
    ds_read_b64 v[54:55], v127 offset:968
    ds_read_b128 v[56:59], v126 offset:2432
    ds_read_b128 v[60:63], v126 offset:2944
    ds_read_b128 v[64:67], v126 offset:3456
    s_waitcnt lgkmcnt(8)
    v_mfma_f32_16x16x32_f16 v[8:11], v[44:47], v[40:43], 0
    ds_read_b128 v[68:71], v126 offset:3968
    s_waitcnt lgkmcnt(4)
    v_mfma_f32_16x16x32_f16 v[8:11], v[52:55], v[48:51], v[8:11]
    ds_read_b128 v[72:75], v126 offset:1344
    ds_read_b64 v[76:77], v127 offset:384
    v_mfma_f32_16x16x32_f16 v[12:15], v[44:47], v[48:51], 0
    ds_read_b64 v[78:79], v127 offset:392
    ds_read_b128 v[80:83], v126 offset:1856
    s_waitcnt lgkmcnt(7)
    v_mfma_f32_16x16x32_f16 v[12:15], v[52:55], v[56:59], v[12:15]
    ds_read_b64 v[84:85], v127 offset:896
    ds_read_b64 v[86:87], v127 offset:904
    v_mfma_f32_16x16x32_f16 v[16:19], v[44:47], v[56:59], 0
    ds_read_b128 v[88:91], v126 offset:2368
    s_waitcnt lgkmcnt(9)
    v_mfma_f32_16x16x32_f16 v[16:19], v[52:55], v[60:63], v[16:19]
    v_mfma_f32_16x16x32_f16 v[20:23], v[44:47], v[60:63], 0
    ds_read_b128 v[92:95], v126 offset:2880
    s_waitcnt lgkmcnt(9)
    v_mfma_f32_16x16x32_f16 v[20:23], v[52:55], v[64:67], v[20:23]
    v_mfma_f32_16x16x32_f16 v[24:27], v[44:47], v[64:67], 0
    ds_read_b128 v[96:99], v126 offset:3392
    s_waitcnt lgkmcnt(9)
    v_mfma_f32_16x16x32_f16 v[24:27], v[52:55], v[68:71], v[24:27]
    s_waitcnt lgkmcnt(6)
    v_mfma_f32_16x16x32_f16 v[8:11], v[76:79], v[72:75], v[8:11]
    ds_read_b128 v[100:103], v126 offset:3904
    s_waitcnt lgkmcnt(4)
    v_mfma_f32_16x16x32_f16 v[8:11], v[84:87], v[80:83], v[8:11]
    ds_read_b128 v[104:107], v126 offset:1280
    ds_read_b64 v[108:109], v127 offset:320
    v_mfma_f32_16x16x32_f16 v[12:15], v[76:79], v[80:83], v[12:15]
    v_readfirstlane_b32 s58, v4
    s_waitcnt lgkmcnt(5)
    v_mfma_f32_16x16x32_f16 v[12:15], v[84:87], v[88:91], v[12:15]
    ds_read_b64 v[110:111], v127 offset:328
    ds_read_b128 v[112:115], v126 offset:1792
    v_mfma_f32_16x16x32_f16 v[16:19], v[76:79], v[88:91], v[16:19]
    s_mov_b32 s56, 0x03020302
    v_perm_b32 v120, v120, v120, s56
    s_waitcnt lgkmcnt(6)
    v_mfma_f32_16x16x32_f16 v[16:19], v[84:87], v[92:95], v[16:19]
    ds_read_b64 v[40:41], v127 offset:832
    ds_read_b64 v[42:43], v127 offset:840
    v_mfma_f32_16x16x32_f16 v[20:23], v[76:79], v[92:95], v[20:23]
    v_and_b32 v116, v116, v120
    v_and_b32 v117, v117, v120
    s_waitcnt lgkmcnt(7)
    v_mfma_f32_16x16x32_f16 v[20:23], v[84:87], v[96:99], v[20:23]
    ds_read_b128 v[48:51], v126 offset:2304
    ds_read_b128 v[56:59], v126 offset:2816
    v_mfma_f32_16x16x32_f16 v[24:27], v[76:79], v[96:99], v[24:27]
    v_and_b32 v118, v118, v120
    v_and_b32 v119, v119, v120
    s_waitcnt lgkmcnt(8)
    v_mfma_f32_16x16x32_f16 v[24:27], v[84:87], v[100:103], v[24:27]
    ds_read_b128 v[60:63], v126 offset:3328
    s_waitcnt lgkmcnt(6)
    v_mfma_f32_16x16x32_f16 v[8:11], v[108:111], v[104:107], v[8:11]
    ds_read_b128 v[44:47], v126 offset:3840
    s_waitcnt lgkmcnt(4)
    v_mfma_f32_16x16x32_f16 v[8:11], v[40:43], v[112:115], v[8:11]
    ds_read_b128 v[64:67], v126 offset:1216
    ds_read_b64 v[52:53], v127 offset:256
    v_mfma_f32_16x16x32_f16 v[12:15], v[108:111], v[112:115], v[12:15]
    ds_read_b64 v[54:55], v127 offset:264
    ds_read_b128 v[68:71], v126 offset:1728
    s_waitcnt lgkmcnt(7)
    v_mfma_f32_16x16x32_f16 v[12:15], v[40:43], v[48:51], v[12:15]
    ds_read_b64 v[72:73], v127 offset:768
    ds_read_b64 v[74:75], v127 offset:776
    v_mfma_f32_16x16x32_f16 v[16:19], v[108:111], v[48:51], v[16:19]
    ds_read_b128 v[80:83], v126 offset:2240
    s_waitcnt lgkmcnt(9)
    v_mfma_f32_16x16x32_f16 v[16:19], v[40:43], v[56:59], v[16:19]
    v_mfma_f32_16x16x32_f16 v[20:23], v[108:111], v[56:59], v[20:23]
    ds_read_b128 v[88:91], v126 offset:2752
    s_waitcnt lgkmcnt(9)
    v_mfma_f32_16x16x32_f16 v[20:23], v[40:43], v[60:63], v[20:23]
    v_mfma_f32_16x16x32_f16 v[24:27], v[108:111], v[60:63], v[24:27]
    ds_read_b128 v[92:95], v126 offset:3264
    s_waitcnt lgkmcnt(9)
    v_mfma_f32_16x16x32_f16 v[24:27], v[40:43], v[44:47], v[24:27]
    s_waitcnt lgkmcnt(6)
    v_mfma_f32_16x16x32_f16 v[8:11], v[52:55], v[64:67], v[8:11]
    ds_read_b128 v[76:79], v126 offset:3776
    s_waitcnt lgkmcnt(4)
    v_mfma_f32_16x16x32_f16 v[8:11], v[72:75], v[68:71], v[8:11]
    ds_read_b128 v[96:99], v126 offset:1152
    ds_read_b64 v[84:85], v127 offset:192
    v_mfma_f32_16x16x32_f16 v[12:15], v[52:55], v[68:71], v[12:15]
    ds_read_b64 v[86:87], v127 offset:200
    ds_read_b128 v[100:103], v126 offset:1664
    s_waitcnt lgkmcnt(7)
    v_mfma_f32_16x16x32_f16 v[12:15], v[72:75], v[80:83], v[12:15]
    ds_read_b64 v[104:105], v127 offset:704
    ds_read_b64 v[106:107], v127 offset:712
    v_mfma_f32_16x16x32_f16 v[16:19], v[52:55], v[80:83], v[16:19]
    ds_read_b128 v[112:115], v126 offset:2176
    s_waitcnt lgkmcnt(9)
    v_mfma_f32_16x16x32_f16 v[16:19], v[72:75], v[88:91], v[16:19]
    v_mfma_f32_16x16x32_f16 v[20:23], v[52:55], v[88:91], v[20:23]
    ds_read_b128 v[48:51], v126 offset:2688
    s_waitcnt lgkmcnt(9)
    v_mfma_f32_16x16x32_f16 v[20:23], v[72:75], v[92:95], v[20:23]
    v_mfma_f32_16x16x32_f16 v[24:27], v[52:55], v[92:95], v[24:27]
    ds_read_b128 v[56:59], v126 offset:3200
    s_waitcnt lgkmcnt(9)
    v_mfma_f32_16x16x32_f16 v[24:27], v[72:75], v[76:79], v[24:27]
    s_waitcnt lgkmcnt(6)
    v_mfma_f32_16x16x32_f16 v[8:11], v[84:87], v[96:99], v[8:11]
    ds_read_b128 v[108:111], v126 offset:3712
    s_waitcnt lgkmcnt(4)
    v_mfma_f32_16x16x32_f16 v[8:11], v[104:107], v[100:103], v[8:11]
    ds_read_b128 v[60:63], v126 offset:1088
    ds_read_b64 v[40:41], v127 offset:128
    v_mfma_f32_16x16x32_f16 v[12:15], v[84:87], v[100:103], v[12:15]
    ds_read_b64 v[42:43], v127 offset:136
    ds_read_b128 v[44:47], v126 offset:1600
    s_waitcnt lgkmcnt(7)
    v_mfma_f32_16x16x32_f16 v[12:15], v[104:107], v[112:115], v[12:15]
    ds_read_b64 v[64:65], v127 offset:640
    ds_read_b64 v[66:67], v127 offset:648
    v_mfma_f32_16x16x32_f16 v[16:19], v[84:87], v[112:115], v[16:19]
    ds_read_b128 v[68:71], v126 offset:2112
    s_waitcnt lgkmcnt(9)
    v_mfma_f32_16x16x32_f16 v[16:19], v[104:107], v[48:51], v[16:19]
    v_mfma_f32_16x16x32_f16 v[20:23], v[84:87], v[48:51], v[20:23]
    ds_read_b128 v[80:83], v126 offset:2624
    s_waitcnt lgkmcnt(9)
    v_mfma_f32_16x16x32_f16 v[20:23], v[104:107], v[56:59], v[20:23]
    v_mfma_f32_16x16x32_f16 v[24:27], v[84:87], v[56:59], v[24:27]
    ds_read_b128 v[88:91], v126 offset:3136
    s_waitcnt lgkmcnt(9)
    v_mfma_f32_16x16x32_f16 v[24:27], v[104:107], v[108:111], v[24:27]
    s_waitcnt lgkmcnt(6)
    v_mfma_f32_16x16x32_f16 v[8:11], v[40:43], v[60:63], v[8:11]
    ds_read_b128 v[52:55], v126 offset:3648
    s_waitcnt lgkmcnt(4)
    v_mfma_f32_16x16x32_f16 v[8:11], v[64:67], v[44:47], v[8:11]
    ds_read_b128 v[92:95], v126 offset:1024
    ds_read_b64 v[72:73], v127 offset:64
    v_mfma_f32_16x16x32_f16 v[12:15], v[40:43], v[44:47], v[12:15]
    ds_read_b64 v[74:75], v127 offset:72
    ds_read_b128 v[76:79], v126 offset:1536
    s_waitcnt lgkmcnt(7)
    v_mfma_f32_16x16x32_f16 v[12:15], v[64:67], v[68:71], v[12:15]
    ds_read_b64 v[96:97], v127 offset:576
    ds_read_b64 v[98:99], v127 offset:584
    v_mfma_f32_16x16x32_f16 v[16:19], v[40:43], v[68:71], v[16:19]
    ds_read_b128 v[100:103], v126 offset:2048
    s_waitcnt lgkmcnt(9)
    v_mfma_f32_16x16x32_f16 v[16:19], v[64:67], v[80:83], v[16:19]
    v_mfma_f32_16x16x32_f16 v[20:23], v[40:43], v[80:83], v[20:23]
    ds_read_b128 v[112:115], v126 offset:2560
    s_waitcnt lgkmcnt(9)
    v_mfma_f32_16x16x32_f16 v[20:23], v[64:67], v[88:91], v[20:23]
    v_mfma_f32_16x16x32_f16 v[24:27], v[40:43], v[88:91], v[24:27]
    ds_read_b128 v[48:51], v126 offset:3072
    s_waitcnt lgkmcnt(9)
    v_mfma_f32_16x16x32_f16 v[24:27], v[64:67], v[52:55], v[24:27]
    s_waitcnt lgkmcnt(6)
    v_mfma_f32_16x16x32_f16 v[8:11], v[72:75], v[92:95], v[8:11]
    ds_read_b128 v[84:87], v126 offset:3584
    s_waitcnt lgkmcnt(4)
    v_mfma_f32_16x16x32_f16 v[8:11], v[96:99], v[76:79], v[8:11]
    ds_read_b128 v[56:59], v126 offset:448
    v_mfma_f32_16x16x32_f16 v[12:15], v[72:75], v[76:79], v[12:15]
    ds_read_b128 v[104:107], v126 offset:960
    ds_read_b64 v[108:109], v127 offset:0
    s_waitcnt lgkmcnt(6)
    v_mfma_f32_16x16x32_f16 v[12:15], v[96:99], v[100:103], v[12:15]
    ds_read_b64 v[110:111], v127 offset:8
    v_mfma_f32_16x16x32_f16 v[16:19], v[72:75], v[100:103], v[16:19]
    ds_read_b128 v[60:63], v126 offset:1472
    ds_read_b64 v[44:45], v127 offset:512
    s_waitcnt lgkmcnt(8)
    v_mfma_f32_16x16x32_f16 v[16:19], v[96:99], v[112:115], v[16:19]
    ds_read_b64 v[46:47], v127 offset:520
    v_mfma_f32_16x16x32_f16 v[20:23], v[72:75], v[112:115], v[20:23]
    s_waitcnt lgkmcnt(8)
    v_mfma_f32_16x16x32_f16 v[20:23], v[96:99], v[48:51], v[20:23]
    ds_read_b128 v[68:71], v126 offset:1984
    ds_read_b64 v[80:81], v127 offset:1024
    v_mfma_f32_16x16x32_f16 v[24:27], v[72:75], v[48:51], v[24:27]
    ds_read_b64 v[82:83], v127 offset:1032
    s_waitcnt lgkmcnt(10)
    v_mfma_f32_16x16x32_f16 v[24:27], v[96:99], v[84:87], v[24:27]
    s_waitcnt lgkmcnt(9)
    v_mfma_f32_16x16x32_f16 v[12:15], v[116:119], v[56:59], v[12:15]
    s_waitcnt lgkmcnt(6)
    v_mfma_f32_16x16x32_f16 v[8:11], v[108:111], v[104:107], v[8:11]
    ds_read_b128 v[40:43], v126 offset:2496
    v_mfma_f32_16x16x32_f16 v[16:19], v[116:119], v[104:107], v[16:19]
    s_waitcnt lgkmcnt(4)
    v_mfma_f32_16x16x32_f16 v[8:11], v[44:47], v[60:63], v[8:11]
    v_mfma_f32_16x16x32_f16 v[12:15], v[108:111], v[60:63], v[12:15]
    ds_read_b128 v[88:91], v126 offset:3008
    v_mfma_f32_16x16x32_f16 v[20:23], v[116:119], v[60:63], v[20:23]
    ds_read_b32 v7, v6 offset:1644
    s_waitcnt lgkmcnt(3)
    v_mfma_f32_16x16x32_f16 v[8:11], v[80:83], v[68:71], v[8:11]
    v_mfma_f32_16x16x32_f16 v[12:15], v[44:47], v[68:71], v[12:15]
    ds_read_b128 v[64:67], v126 offset:3520
    v_mfma_f32_16x16x32_f16 v[16:19], v[108:111], v[68:71], v[16:19]
    v_mfma_f32_16x16x32_f16 v[24:27], v[116:119], v[68:71], v[24:27]
    ds_read_b128 v[52:55], v126 offset:4032
    s_waitcnt lgkmcnt(4)
    v_mfma_f32_16x16x32_f16 v[12:15], v[80:83], v[40:43], v[12:15]
    s_waitcnt lgkmcnt(2)
    v_readfirstlane_b32 s56, v7
    s_nop 0
    s_cmp_ge_u32 s56, 10
    s_cbranch_scc1 CH_WOK
    s_mov_b32 s49, 0
CH_WSP:
    s_sleep 1
    ds_read_b32 v7, v6 offset:1644
    s_add_u32 s49, s49, 1
    s_waitcnt lgkmcnt(0)
    v_readfirstlane_b32 s56, v7
    s_nop 0
    s_cmp_ge_u32 s56, 10
    s_cbranch_scc1 CH_WOK
    s_cmp_lt_u32 s49, 60000
    s_cbranch_scc1 CH_WSP
CH_WOK:
    v_mfma_f32_16x16x32_f16 v[16:19], v[44:47], v[40:43], v[16:19]
    ds_read_b64_tr_b16 v[92:93], v124 offset:0
    ds_read_b64_tr_b16 v[94:95], v124 offset:32
    v_mfma_f32_16x16x32_f16 v[20:23], v[108:111], v[40:43], v[20:23]
    ds_read2_b32 v[76:77], v125 offset0:41 offset1:105
    ds_read2_b32 v[78:79], v125 offset0:40 offset1:104
    v_mfma_f32_16x16x32_f16 v[16:19], v[80:83], v[88:91], v[16:19]
    ds_read2_b32 v[100:101], v125 offset0:25 offset1:89
    ds_read2_b32 v[102:103], v125 offset0:24 offset1:88
    v_mfma_f32_16x16x32_f16 v[20:23], v[44:47], v[88:91], v[20:23]
    ds_read_b64_tr_b16 v[112:113], v124 offset:256
    ds_read_b64_tr_b16 v[114:115], v124 offset:288
    v_mfma_f32_16x16x32_f16 v[24:27], v[108:111], v[88:91], v[24:27]
    ds_read2_b32 v[72:73], v125 offset0:33 offset1:97
    ds_read2_b32 v[74:75], v125 offset0:32 offset1:96
    s_waitcnt lgkmcnt(11)
    v_mfma_f32_16x16x32_f16 v[20:23], v[80:83], v[64:67], v[20:23]
    ds_read2_b32 v[48:49], v125 offset0:17 offset1:81
    ds_read2_b32 v[50:51], v125 offset0:16 offset1:80
    v_mfma_f32_16x16x32_f16 v[24:27], v[44:47], v[64:67], v[24:27]
    ds_read_b64_tr_b16 v[96:97], v124 offset:512
    s_waitcnt lgkmcnt(13)
    v_mfma_f32_16x16x32_f16 v[24:27], v[80:83], v[52:55], v[24:27]
    ds_read_b64_tr_b16 v[98:99], v124 offset:544
    s_waitcnt lgkmcnt(12)
    s_waitcnt lgkmcnt(10)
    v_mfma_f32_16x16x32_f16 v[12:15], v[92:95], v[76:79], v[12:15]
    ds_read2_b32 v[84:85], v125 offset0:9 offset1:73
    ds_read2_b32 v[86:87], v125 offset0:8 offset1:72
    s_waitcnt lgkmcnt(10)
    v_mfma_f32_16x16x32_f16 v[8:11], v[92:95], v[100:103], v[8:11]
    ds_read_b64_tr_b16 v[56:57], v124 offset:768
    ds_read_b64_tr_b16 v[58:59], v124 offset:800
    s_waitcnt lgkmcnt(10)
    s_waitcnt lgkmcnt(8)
    v_mfma_f32_16x16x32_f16 v[12:15], v[112:115], v[72:75], v[12:15]
    ds_read2_b32 v[104:105], v125 offset0:1 offset1:65
    ds_read2_b32 v[106:107], v125 offset0:0 offset1:64
    s_waitcnt lgkmcnt(8)
    v_mfma_f32_16x16x32_f16 v[8:11], v[112:115], v[48:51], v[8:11]
    ds_read_b64_tr_b16 v[60:61], v124 offset:1024
    ds_read_b64_tr_b16 v[62:63], v124 offset:1056
    s_waitcnt lgkmcnt(8)
    v_mfma_f32_16x16x32_f16 v[16:19], v[96:99], v[76:79], v[16:19]
    ds_read_b64_tr_b16 v[68:69], v124 offset:1280
    ds_read_b64_tr_b16 v[70:71], v124 offset:1312
    v_mfma_f32_16x16x32_f16 v[12:15], v[96:99], v[100:103], v[12:15]
    s_waitcnt lgkmcnt(8)
    v_mfma_f32_16x16x32_f16 v[8:11], v[96:99], v[84:87], v[8:11]
    s_waitcnt lgkmcnt(6)
    v_mfma_f32_16x16x32_f16 v[16:19], v[56:59], v[72:75], v[16:19]
    ds_read_b64_tr_b16 v[40:41], v124 offset:1536
    ds_read_b64_tr_b16 v[42:43], v124 offset:1568
    v_mfma_f32_16x16x32_f16 v[12:15], v[56:59], v[48:51], v[12:15]
    s_waitcnt lgkmcnt(6)
    v_mfma_f32_16x16x32_f16 v[8:11], v[56:59], v[104:107], v[8:11]
    s_waitcnt lgkmcnt(4)
    v_mfma_f32_16x16x32_f16 v[20:23], v[60:63], v[76:79], v[20:23]
    ds_read_b64_tr_b16 v[108:109], v124 offset:1792
    ds_read_b64_tr_b16 v[110:111], v124 offset:1824
    v_mfma_f32_16x16x32_f16 v[16:19], v[60:63], v[100:103], v[16:19]
    v_mfma_f32_16x16x32_f16 v[12:15], v[60:63], v[84:87], v[12:15]
    s_waitcnt lgkmcnt(4)
    v_mfma_f32_16x16x32_f16 v[20:23], v[68:71], v[72:75], v[20:23]
    ds_read_b64_tr_b16 v[88:89], v124 offset:2048
    ds_read_b64_tr_b16 v[90:91], v124 offset:2080
    v_mfma_f32_16x16x32_f16 v[16:19], v[68:71], v[48:51], v[16:19]
    v_mfma_f32_16x16x32_f16 v[12:15], v[68:71], v[104:107], v[12:15]
    ds_read_b64_tr_b16 v[44:45], v124 offset:2304
    ds_read_b64_tr_b16 v[46:47], v124 offset:2336
    s_waitcnt lgkmcnt(6)
    v_mfma_f32_16x16x32_f16 v[24:27], v[40:43], v[76:79], v[24:27]
    v_mfma_f32_16x16x32_f16 v[20:23], v[40:43], v[100:103], v[20:23]
    ds_read_b64_tr_b16 v[64:65], v124 offset:2560
    ds_read_b64_tr_b16 v[66:67], v124 offset:2592
    v_mfma_f32_16x16x32_f16 v[16:19], v[40:43], v[84:87], v[16:19]
    ds_read_b64_tr_b16 v[80:81], v124 offset:2816
    ds_read_b64_tr_b16 v[82:83], v124 offset:2848
    s_waitcnt lgkmcnt(8)
    v_mfma_f32_16x16x32_f16 v[24:27], v[108:111], v[72:75], v[24:27]
    ds_read_b64_tr_b16 v[52:53], v121 offset:0
    ds_read_b64_tr_b16 v[54:55], v121 offset:64
    v_mfma_f32_16x16x32_f16 v[20:23], v[108:111], v[48:51], v[20:23]
    ds_read2_b32 v[92:93], v122 offset0:3 offset1:2
    ds_read2_b32 v[94:95], v122 offset0:1 offset1:0
    v_mfma_f32_16x16x32_f16 v[16:19], v[108:111], v[104:107], v[16:19]
    ds_read2_b32 v[112:113], v122 offset0:19 offset1:18
    ds_read2_b32 v[114:115], v122 offset0:17 offset1:16
    s_waitcnt lgkmcnt(12)
    v_mfma_f32_16x16x32_f16 v[24:27], v[88:91], v[100:103], v[24:27]
    ds_read2_b32 v[96:97], v122 offset0:35 offset1:34
    ds_read2_b32 v[98:99], v122 offset0:33 offset1:32
    v_mfma_f32_16x16x32_f16 v[20:23], v[88:91], v[84:87], v[20:23]
    s_waitcnt lgkmcnt(12)
    v_mfma_f32_16x16x32_f16 v[24:27], v[44:47], v[48:51], v[24:27]
    ds_read2_b32 v[56:57], v122 offset0:51 offset1:50
    ds_read2_b32 v[58:59], v122 offset0:49 offset1:48
    v_mfma_f32_16x16x32_f16 v[20:23], v[44:47], v[104:107], v[20:23]
    s_waitcnt lgkmcnt(12)
    v_mfma_f32_16x16x32_f16 v[24:27], v[64:67], v[84:87], v[24:27]
    ds_read_b64_tr_b16 v[60:61], v121 offset:512
    ds_read_b64_tr_b16 v[62:63], v121 offset:576
    s_waitcnt lgkmcnt(12)
    v_mfma_f32_16x16x32_f16 v[24:27], v[80:83], v[104:107], v[24:27]
    ds_read_b64_tr_b16 v[68:69], v121 offset:1024
    ds_read_b64_tr_b16 v[70:71], v121 offset:1088
    s_waitcnt lgkmcnt(12)
    s_waitcnt lgkmcnt(10)
    v_mfma_f32_16x16x32_f16 v[12:15], v[52:55], v[92:95], v[12:15]
    ds_read_b64_tr_b16 v[76:77], v121 offset:1536
    ds_read_b64_tr_b16 v[78:79], v121 offset:1600
    s_waitcnt lgkmcnt(10)
    v_mfma_f32_16x16x32_f16 v[16:19], v[52:55], v[112:115], v[16:19]
    s_waitcnt lgkmcnt(8)
    v_mfma_f32_16x16x32_f16 v[20:23], v[52:55], v[96:99], v[20:23]
    s_waitcnt lgkmcnt(6)
    v_mfma_f32_16x16x32_f16 v[24:27], v[52:55], v[56:59], v[24:27]
    s_waitcnt lgkmcnt(4)
    v_mfma_f32_16x16x32_f16 v[16:19], v[60:63], v[92:95], v[16:19]
    v_mfma_f32_16x16x32_f16 v[20:23], v[60:63], v[112:115], v[20:23]
    v_mfma_f32_16x16x32_f16 v[24:27], v[60:63], v[96:99], v[24:27]
    s_waitcnt lgkmcnt(2)
    v_mfma_f32_16x16x32_f16 v[20:23], v[68:71], v[92:95], v[20:23]
    v_mfma_f32_16x16x32_f16 v[24:27], v[68:71], v[112:115], v[24:27]
    s_waitcnt lgkmcnt(0)
    v_mfma_f32_16x16x32_f16 v[24:27], v[76:79], v[92:95], v[24:27]
    v_pk_mul_f32 v[8:9], v[8:9], s[58:59] op_sel_hi:[1,0]
    v_pk_mul_f32 v[10:11], v[10:11], s[58:59] op_sel_hi:[1,0]
    v_cvt_pk_bf16_f32 v8, v8, v9
    v_cvt_pk_bf16_f32 v9, v10, v11
    ds_write_b64 v123, v[8:9] offset:3584
    v_pk_mul_f32 v[12:13], v[12:13], s[58:59] op_sel_hi:[1,0]
    v_pk_mul_f32 v[14:15], v[14:15], s[58:59] op_sel_hi:[1,0]
    v_cvt_pk_bf16_f32 v12, v12, v13
    v_cvt_pk_bf16_f32 v13, v14, v15
    ds_write_b64 v123, v[12:13] offset:4096
    v_pk_mul_f32 v[16:17], v[16:17], s[58:59] op_sel_hi:[1,0]
    v_pk_mul_f32 v[18:19], v[18:19], s[58:59] op_sel_hi:[1,0]
    v_cvt_pk_bf16_f32 v16, v16, v17
    v_cvt_pk_bf16_f32 v17, v18, v19
    ds_write_b64 v123, v[16:17] offset:4608
    v_pk_mul_f32 v[20:21], v[20:21], s[58:59] op_sel_hi:[1,0]
    v_pk_mul_f32 v[22:23], v[22:23], s[58:59] op_sel_hi:[1,0]
    v_cvt_pk_bf16_f32 v20, v20, v21
    v_cvt_pk_bf16_f32 v21, v22, v23
    ds_write_b64 v123, v[20:21] offset:5120
    v_pk_mul_f32 v[24:25], v[24:25], s[58:59] op_sel_hi:[1,0]
    v_pk_mul_f32 v[26:27], v[26:27], s[58:59] op_sel_hi:[1,0]
    v_cvt_pk_bf16_f32 v24, v24, v25
    v_cvt_pk_bf16_f32 v25, v26, v27
    ds_write_b64 v123, v[24:25] offset:5632
    s_branch CV_DONE
CV_LIGHT:
    s_lshl_b32 s57, s46, 2
    v_mov_b32 v4, s57
    ds_read_b128 v[40:43], v126 offset:384
    ds_read_b64 v[44:45], v127 offset:960
    ds_read_b64 v[46:47], v127 offset:968
    ds_read_b64 v[48:49], v127 offset:448
    ds_read_b64 v[50:51], v127 offset:456
    ds_read_b32 v4, v4 offset:1648
    v_mov_b32 v6, 0
    ds_read_b128 v[52:55], v126 offset:896
    ds_read_b128 v[56:59], v126 offset:1408
    ds_read_b128 v[60:63], v126 offset:320
    ds_read_b64 v[64:65], v127 offset:896
    ds_read_b64 v[66:67], v127 offset:904
    s_waitcnt lgkmcnt(8)
    v_mfma_f32_16x16x32_f16 v[8:11], v[44:47], v[40:43], 0
    ds_read_b64 v[68:69], v127 offset:384
    ds_read_b64 v[70:71], v127 offset:392
    s_waitcnt lgkmcnt(8)
    v_mfma_f32_16x16x32_f16 v[12:15], v[48:51], v[40:43], 0
    ds_read_b128 v[72:75], v126 offset:832
    s_waitcnt lgkmcnt(7)
    v_mfma_f32_16x16x32_f16 v[12:15], v[44:47], v[52:55], v[12:15]
    v_mfma_f32_16x16x32_f16 v[16:19], v[48:51], v[52:55], 0
    ds_read_b128 v[76:79], v126 offset:1344
    s_waitcnt lgkmcnt(7)
    v_mfma_f32_16x16x32_f16 v[16:19], v[44:47], v[56:59], v[16:19]
    ds_read_b128 v[80:83], v126 offset:256
    ds_read_b64 v[84:85], v127 offset:832
    s_waitcnt lgkmcnt(6)
    v_mfma_f32_16x16x32_f16 v[8:11], v[64:67], v[60:63], v[8:11]
    ds_read_b64 v[86:87], v127 offset:840
    ds_read_b64 v[88:89], v127 offset:320
    s_waitcnt lgkmcnt(6)
    v_mfma_f32_16x16x32_f16 v[12:15], v[68:71], v[60:63], v[12:15]
    ds_read_b64 v[90:91], v127 offset:328
    ds_read_b128 v[92:95], v126 offset:768
    s_waitcnt lgkmcnt(7)
    v_mfma_f32_16x16x32_f16 v[12:15], v[64:67], v[72:75], v[12:15]
    v_mfma_f32_16x16x32_f16 v[16:19], v[68:71], v[72:75], v[16:19]
    ds_read_b128 v[96:99], v126 offset:1280
    s_waitcnt lgkmcnt(7)
    v_mfma_f32_16x16x32_f16 v[16:19], v[64:67], v[76:79], v[16:19]
    ds_read_b128 v[100:103], v126 offset:192
    ds_read_b64 v[104:105], v127 offset:768
    s_waitcnt lgkmcnt(6)
    v_mfma_f32_16x16x32_f16 v[8:11], v[84:87], v[80:83], v[8:11]
    ds_read_b64 v[106:107], v127 offset:776
    ds_read_b64 v[108:109], v127 offset:256
    s_waitcnt lgkmcnt(6)
    v_mfma_f32_16x16x32_f16 v[12:15], v[88:91], v[80:83], v[12:15]
    ds_read_b64 v[110:111], v127 offset:264
    ds_read_b128 v[112:115], v126 offset:704
    s_waitcnt lgkmcnt(7)
    v_mfma_f32_16x16x32_f16 v[12:15], v[84:87], v[92:95], v[12:15]
    v_readfirstlane_b32 s58, v4
    v_mfma_f32_16x16x32_f16 v[16:19], v[88:91], v[92:95], v[16:19]
    ds_read_b128 v[40:43], v126 offset:1216
    s_waitcnt lgkmcnt(7)
    v_mfma_f32_16x16x32_f16 v[16:19], v[84:87], v[96:99], v[16:19]
    ds_read_b128 v[48:51], v126 offset:128
    ds_read_b64 v[52:53], v127 offset:704
    s_waitcnt lgkmcnt(6)
    v_mfma_f32_16x16x32_f16 v[8:11], v[104:107], v[100:103], v[8:11]
    ds_read_b64 v[54:55], v127 offset:712
    ds_read_b64 v[44:45], v127 offset:192
    s_waitcnt lgkmcnt(6)
    v_mfma_f32_16x16x32_f16 v[12:15], v[108:111], v[100:103], v[12:15]
    ds_read_b64 v[46:47], v127 offset:200
    ds_read_b128 v[56:59], v126 offset:640
    s_waitcnt lgkmcnt(7)
    v_mfma_f32_16x16x32_f16 v[12:15], v[104:107], v[112:115], v[12:15]
    v_mfma_f32_16x16x32_f16 v[16:19], v[108:111], v[112:115], v[16:19]
    ds_read_b128 v[60:63], v126 offset:1152
    s_waitcnt lgkmcnt(7)
    v_mfma_f32_16x16x32_f16 v[16:19], v[104:107], v[40:43], v[16:19]
    ds_read_b128 v[68:71], v126 offset:64
    ds_read_b64 v[72:73], v127 offset:640
    s_waitcnt lgkmcnt(6)
    v_mfma_f32_16x16x32_f16 v[8:11], v[52:55], v[48:51], v[8:11]
    ds_read_b64 v[74:75], v127 offset:648
    ds_read_b64 v[64:65], v127 offset:128
    s_waitcnt lgkmcnt(6)
    v_mfma_f32_16x16x32_f16 v[12:15], v[44:47], v[48:51], v[12:15]
    ds_read_b64 v[66:67], v127 offset:136
    ds_read_b128 v[76:79], v126 offset:576
    s_waitcnt lgkmcnt(7)
    v_mfma_f32_16x16x32_f16 v[12:15], v[52:55], v[56:59], v[12:15]
    v_mfma_f32_16x16x32_f16 v[16:19], v[44:47], v[56:59], v[16:19]
    ds_read_b128 v[80:83], v126 offset:1088
    s_waitcnt lgkmcnt(7)
    v_mfma_f32_16x16x32_f16 v[16:19], v[52:55], v[60:63], v[16:19]
    ds_read_b128 v[88:91], v126 offset:0
    ds_read_b64 v[92:93], v127 offset:576
    s_waitcnt lgkmcnt(6)
    v_mfma_f32_16x16x32_f16 v[8:11], v[72:75], v[68:71], v[8:11]
    ds_read_b64 v[94:95], v127 offset:584
    ds_read_b64 v[84:85], v127 offset:64
    s_waitcnt lgkmcnt(6)
    v_mfma_f32_16x16x32_f16 v[12:15], v[64:67], v[68:71], v[12:15]
    ds_read_b64 v[86:87], v127 offset:72
    ds_read_b128 v[96:99], v126 offset:512
    s_waitcnt lgkmcnt(7)
    v_mfma_f32_16x16x32_f16 v[12:15], v[72:75], v[76:79], v[12:15]
    v_mfma_f32_16x16x32_f16 v[16:19], v[64:67], v[76:79], v[16:19]
    ds_read_b128 v[100:103], v126 offset:1024
    s_waitcnt lgkmcnt(7)
    v_mfma_f32_16x16x32_f16 v[16:19], v[72:75], v[80:83], v[16:19]
    ds_read_b128 v[108:111], v126 offset:448
    ds_read_b64 v[112:113], v127 offset:1024
    s_waitcnt lgkmcnt(6)
    v_mfma_f32_16x16x32_f16 v[8:11], v[92:95], v[88:91], v[8:11]
    ds_read_b32 v7, v6 offset:1644
    ds_read_b64 v[114:115], v127 offset:1032
    s_waitcnt lgkmcnt(6)
    v_mfma_f32_16x16x32_f16 v[12:15], v[84:87], v[88:91], v[12:15]
    ds_read_b64 v[104:105], v127 offset:512
    ds_read_b64 v[106:107], v127 offset:520
    s_waitcnt lgkmcnt(7)
    v_mfma_f32_16x16x32_f16 v[12:15], v[92:95], v[96:99], v[12:15]
    ds_read_b64 v[40:41], v127 offset:0
    ds_read_b64 v[42:43], v127 offset:8
    v_mfma_f32_16x16x32_f16 v[16:19], v[84:87], v[96:99], v[16:19]
    ds_read_b128 v[48:51], v126 offset:960
    s_waitcnt lgkmcnt(9)
    v_mfma_f32_16x16x32_f16 v[16:19], v[92:95], v[100:103], v[16:19]
    ds_read_b128 v[44:47], v126 offset:1472
    s_waitcnt lgkmcnt(6)
    v_mfma_f32_16x16x32_f16 v[8:11], v[112:115], v[108:111], v[8:11]
    v_readfirstlane_b32 s56, v7
    s_nop 0
    s_cmp_ge_u32 s56, 10
    s_cbranch_scc1 CL_WOK
    s_mov_b32 s49, 0
CL_WSP:
    s_sleep 1
    ds_read_b32 v7, v6 offset:1644
    s_add_u32 s49, s49, 1
    s_waitcnt lgkmcnt(0)
    v_readfirstlane_b32 s56, v7
    s_nop 0
    s_cmp_ge_u32 s56, 10
    s_cbranch_scc1 CL_WOK
    s_cmp_lt_u32 s49, 60000
    s_cbranch_scc1 CL_WSP
CL_WOK:
    s_waitcnt lgkmcnt(4)
    v_mfma_f32_16x16x32_f16 v[12:15], v[104:107], v[108:111], v[12:15]
    ds_read_b64_tr_b16 v[56:57], v124 offset:0
    ds_read_b64_tr_b16 v[58:59], v124 offset:32
    s_waitcnt lgkmcnt(4)
    v_mfma_f32_16x16x32_f16 v[16:19], v[40:43], v[108:111], v[16:19]
    ds_read2_b32 v[52:53], v125 offset0:9 offset1:73
    ds_read2_b32 v[54:55], v125 offset0:8 offset1:72
    s_waitcnt lgkmcnt(5)
    v_mfma_f32_16x16x32_f16 v[12:15], v[112:115], v[48:51], v[12:15]
    ds_read_b64_tr_b16 v[60:61], v124 offset:256
    ds_read_b64_tr_b16 v[62:63], v124 offset:288
    v_mfma_f32_16x16x32_f16 v[16:19], v[104:107], v[48:51], v[16:19]
    ds_read2_b32 v[68:69], v125 offset0:1 offset1:65
    ds_read2_b32 v[70:71], v125 offset0:0 offset1:64
    s_waitcnt lgkmcnt(8)
    v_mfma_f32_16x16x32_f16 v[16:19], v[112:115], v[44:47], v[16:19]
    s_waitcnt lgkmcnt(6)
    s_waitcnt lgkmcnt(4)
    v_mfma_f32_16x16x32_f16 v[16:19], v[56:59], v[52:55], v[16:19]
    s_waitcnt lgkmcnt(2)
    s_waitcnt lgkmcnt(0)
    v_mfma_f32_16x16x32_f16 v[16:19], v[60:63], v[68:71], v[16:19]
    v_pk_mul_f32 v[8:9], v[8:9], s[58:59] op_sel_hi:[1,0]
    v_pk_mul_f32 v[10:11], v[10:11], s[58:59] op_sel_hi:[1,0]
    v_cvt_pk_bf16_f32 v8, v8, v9
    v_cvt_pk_bf16_f32 v9, v10, v11
    ds_write_b64 v123, v[8:9] offset:2048
    v_pk_mul_f32 v[12:13], v[12:13], s[58:59] op_sel_hi:[1,0]
    v_pk_mul_f32 v[14:15], v[14:15], s[58:59] op_sel_hi:[1,0]
    v_cvt_pk_bf16_f32 v12, v12, v13
    v_cvt_pk_bf16_f32 v13, v14, v15
    ds_write_b64 v123, v[12:13] offset:2560
    v_pk_mul_f32 v[16:17], v[16:17], s[58:59] op_sel_hi:[1,0]
    v_pk_mul_f32 v[18:19], v[18:19], s[58:59] op_sel_hi:[1,0]
    v_cvt_pk_bf16_f32 v16, v16, v17
    v_cvt_pk_bf16_f32 v17, v18, v19
    ds_write_b64 v123, v[16:17] offset:3072
    s_branch CV_DONE
CV_WIN:
    s_setprio 3
    s_cmp_eq_u32 s46, 9
    s_cbranch_scc1 CV_WZ
    s_mul_i32 s56, s46, 86
    s_lshr_b32 s56, s56, 8
    s_mul_i32 s57, s56, 3
    s_sub_u32 s57, s46, s57
    s_lshl_b32 s58, s57, 10
    s_mul_i32 s59, s56, 4608
    s_add_u32 s59, s59, s58
    s_add_u32 s59, s59, 107728
    v_lshl_add_u32 v8, v1, 4, s59
    ds_read_b128 v[12:15], v8
    ds_read_b128 v[16:19], v8 offset:16
    s_mul_i32 s59, s56, 10608
    s_add_u32 s59, s59, s58
    s_add_u32 s59, s59, 14368
    v_lshl_add_u32 v9, v1, 4, s59
    s_waitcnt lgkmcnt(0)
    v_alignbit_b32 v24, v13, v12, 16
    v_alignbit_b32 v25, v14, v13, 16
    v_alignbit_b32 v26, v15, v14, 16
    v_alignbit_b32 v27, v16, v15, 16
    v_alignbit_b32 v28, v17, v16, 16
    v_alignbit_b32 v29, v18, v17, 16
    v_alignbit_b32 v30, v19, v18, 16
    v_pk_add_f16 v32, v25, v26
    v_pk_add_f16 v33, v26, v27
    v_pk_add_f16 v34, v27, v28
    v_pk_add_f16 v35, v28, v29
    v_pk_add_f16 v32, v32, v14
    v_pk_add_f16 v33, v33, v15
    v_pk_add_f16 v34, v34, v16
    v_pk_add_f16 v35, v35, v17
    ds_write_b128 v9, v[32:35] offset:0
    v_pk_add_f16 v36, v13, v15
    v_pk_add_f16 v37, v14, v16
    v_pk_add_f16 v38, v15, v17
    v_pk_add_f16 v39, v16, v18
    v_pk_add_f16 v36, v36, v32
    v_pk_add_f16 v37, v37, v33
    v_pk_add_f16 v38, v38, v34
    v_pk_add_f16 v39, v39, v35
    ds_write_b128 v9, v[36:39] offset:3200
    s_cmp_eq_u32 s57, 2
    s_cbranch_scc1 CV_WE
    v_pk_add_f16 v40, v24, v27
    v_pk_add_f16 v41, v25, v28
    v_pk_add_f16 v42, v26, v29
    v_pk_add_f16 v43, v27, v30
    v_pk_add_f16 v40, v40, v36
    v_pk_add_f16 v41, v41, v37
    v_pk_add_f16 v42, v42, v38
    v_pk_add_f16 v43, v43, v39
    ds_write_b128 v9, v[40:43] offset:6400
    v_pk_add_f16 v44, v12, v16
    v_pk_add_f16 v45, v13, v17
    v_pk_add_f16 v46, v14, v18
    v_pk_add_f16 v47, v15, v19
    v_pk_add_f16 v44, v44, v40
    v_pk_add_f16 v45, v45, v41
    v_pk_add_f16 v46, v46, v42
    v_pk_add_f16 v47, v47, v43
    ds_write_b128 v9, v[44:47] offset:8528
    s_branch CV_WE
CV_WZ:
    v_mov_b32 v12, 0
    v_mov_b32 v13, 0
    v_mov_b32 v14, 0
    v_mov_b32 v15, 0
    v_lshrrev_b32 v8, 1, v1
    v_mul_u32_u24 v8, 10608, v8
    v_and_b32 v9, 1, v1
    v_lshl_add_u32 v8, v9, 4, v8
    s_mov_b64 exec, 63
    ds_write_b128 v8, v[12:15] offset:14336
    ds_write_b128 v8, v[12:15] offset:17536
    ds_write_b128 v8, v[12:15] offset:20736
    ds_write_b128 v8, v[12:15] offset:22864
    s_mov_b64 exec, -1
CV_WE:
    s_nop 0
    v_mov_b32 v8, 0
    v_mov_b32 v9, 1
    s_waitcnt lgkmcnt(0)
    s_mov_b64 exec, 1
    ds_add_u32 v8, v9 offset:1644
    s_mov_b64 exec, -1
    s_cmp_lt_u32 s2, 128
    s_cbranch_scc1 CV_DONE
    s_cmp_lg_u32 s3, 14
    s_cbranch_scc1 CV_DONE
    s_and_b32 s56, s2, 7
    s_add_u32 s56, s56, 64
    s_bfe_u32 s57, s2, 0x30003
    s_mul_i32 s58, s57, 663552
    s_lshl_b32 s59, s56, 7
    s_add_u32 s58, s58, s59
    v_min_u32 v9, 35, v1
    v_mul_u32_u24 v8, 9216, v9
    v_add_u32 v8, s58, v8
    v_add_u32 v10, 331776, v8
    s_mul_i32 s58, s56, 73728
    s_mul_i32 s59, s57, 9216
    s_add_u32 s58, s58, s59
    v_lshl_add_u32 v9, v9, 8, s58
    global_load_dword v12, v8, s[22:23]
    global_load_dword v13, v10, s[22:23]
    global_load_dword v14, v8, s[24:25]
    global_load_dword v15, v10, s[24:25]
    global_load_dword v16, v9, s[26:27]
    global_load_dword v17, v9, s[26:27] offset:128
CV_DONE:
    v_lshrrev_b32 v44, 7, v0
    v_lshlrev_b32 v44, 5, v44
    v_and_b32 v45, 30, v0
    v_bfe_u32 v46, v0, 6, 1
    v_add3_u32 v44, v44, v45, v46
    v_mul_u32_u24 v44, 12288, v44
    v_and_b32 v45, 32, v0
    v_and_b32 v46, 1, v0
    v_lshlrev_b32 v46, 4, v46
    v_add3_u32 v44, v44, v45, v46
    v_lshlrev_b32 v45, 2, v0
    v_mov_b32 v43, s48
    s_lshl_b32 s38, s2, 6
    s_add_u32 s38, s38, 3149824
    s_waitcnt lgkmcnt(0)
    s_barrier
    ds_read_b32 v40, v45 offset:2048
    ds_read_b32 v41, v45 offset:6144
    ds_read_b32 v42, v45 offset:10240
    s_waitcnt lgkmcnt(0)
    buffer_store_dwordx4 v[40:43], v44, s[40:43], s38 offen sc1
    s_cmp_ge_u32 s2, 184
    s_cbranch_scc1 FFN_B
    s_cmp_ge_u32 s2, 128
    s_cbranch_scc1 FIN
    s_cmp_ge_u32 s3, 8
    s_cbranch_scc1 LN2_H
    s_setprio 3
    s_cmp_lt_u32 s3, 4
    s_cbranch_scc1 LN2_A
    s_and_b32 s34, s3, 3
    s_mul_i32 s34, s34, 48
    v_add_u32 v4, s34, v3
    v_mul_u32_u24 v6, 6, v4
    v_and_b32 v6, -4, v6
    global_load_dwordx2 v[48:49], v6, s[16:17] offset:0
    global_load_dwordx2 v[50:51], v6, s[20:21] offset:0
    global_load_dwordx2 v[52:53], v6, s[16:17] offset:96
    global_load_dwordx2 v[54:55], v6, s[20:21] offset:96
    global_load_dwordx2 v[56:57], v6, s[16:17] offset:192
    global_load_dwordx2 v[58:59], v6, s[20:21] offset:192
    v_and_b32 v24, 1, v0
    s_mov_b32 s39, 0x02020000
    v_mul_lo_u32 v24, v24, s39
    v_add_u32 v24, 0x01000c0c, v24
    v_add_u32 v25, s39, v24
    v_add_u32 v26, s39, v25
    s_mov_b32 s52, 0x3ae38e39
    s_mov_b32 s54, 0x00010001
    s_mov_b32 s55, 0x00010001
    v_lshlrev_b32 v22, 6, v5
    s_and_b32 s34, s3, 3
    s_lshl_b32 s34, s34, 4
    v_add_u32 v21, s34, v22
    s_waitcnt vmcnt(7)
    v_perm_b32 v64, v29, v28, v24
    v_perm_b32 v65, v31, v30, v24
    v_perm_b32 v66, v29, v28, v25
    v_perm_b32 v67, v31, v30, v25
    v_perm_b32 v68, v29, v28, v26
    v_perm_b32 v69, v31, v30, v26
    v_pk_mul_f32 v[42:43], v[64:65], v[64:65]
    v_pk_add_f32 v[40:41], v[66:67], v[64:65]
    v_pk_fma_f32 v[42:43], v[66:67], v[66:67], v[42:43]
    v_pk_add_f32 v[40:41], v[68:69], v[40:41]
    v_pk_fma_f32 v[42:43], v[68:69], v[68:69], v[42:43]
    v_perm_b32 v70, v33, v32, v24
    v_perm_b32 v71, v35, v34, v24
    v_perm_b32 v72, v33, v32, v25
    v_perm_b32 v73, v35, v34, v25
    v_perm_b32 v74, v33, v32, v26
    v_perm_b32 v75, v35, v34, v26
    v_pk_add_f32 v[40:41], v[70:71], v[40:41]
    v_pk_fma_f32 v[42:43], v[70:71], v[70:71], v[42:43]
    v_pk_add_f32 v[40:41], v[72:73], v[40:41]
    v_pk_fma_f32 v[42:43], v[72:73], v[72:73], v[42:43]
    v_pk_add_f32 v[40:41], v[74:75], v[40:41]
    v_pk_fma_f32 v[42:43], v[74:75], v[74:75], v[42:43]
    v_perm_b32 v76, v37, v36, v24
    v_perm_b32 v77, v39, v38, v24
    v_perm_b32 v78, v37, v36, v25
    v_perm_b32 v79, v39, v38, v25
    v_perm_b32 v80, v37, v36, v26
    v_perm_b32 v81, v39, v38, v26
    v_pk_add_f32 v[40:41], v[76:77], v[40:41]
    v_pk_fma_f32 v[42:43], v[76:77], v[76:77], v[42:43]
    v_pk_add_f32 v[40:41], v[78:79], v[40:41]
    v_pk_fma_f32 v[42:43], v[78:79], v[78:79], v[42:43]
    v_pk_add_f32 v[40:41], v[80:81], v[40:41]
    v_pk_fma_f32 v[42:43], v[80:81], v[80:81], v[42:43]
    s_nop 0
    v_add_f32_dpp v40, v40, v40 row_ror:8 row_mask:0xf bank_mask:0xf
    v_add_f32_dpp v41, v41, v41 row_ror:8 row_mask:0xf bank_mask:0xf
    v_add_f32_dpp v42, v42, v42 row_ror:8 row_mask:0xf bank_mask:0xf
    v_add_f32_dpp v43, v43, v43 row_ror:8 row_mask:0xf bank_mask:0xf
    v_add_f32_dpp v40, v40, v40 row_ror:4 row_mask:0xf bank_mask:0xf
    v_add_f32_dpp v41, v41, v41 row_ror:4 row_mask:0xf bank_mask:0xf
    v_add_f32_dpp v42, v42, v42 row_ror:4 row_mask:0xf bank_mask:0xf
    v_add_f32_dpp v43, v43, v43 row_ror:4 row_mask:0xf bank_mask:0xf
    v_add_f32_dpp v40, v40, v40 row_ror:2 row_mask:0xf bank_mask:0xf
    v_add_f32_dpp v41, v41, v41 row_ror:2 row_mask:0xf bank_mask:0xf
    v_add_f32_dpp v42, v42, v42 row_ror:2 row_mask:0xf bank_mask:0xf
    v_add_f32_dpp v43, v43, v43 row_ror:2 row_mask:0xf bank_mask:0xf
    v_add_f32_dpp v40, v40, v40 row_ror:1 row_mask:0xf bank_mask:0xf
    v_add_f32_dpp v41, v41, v41 row_ror:1 row_mask:0xf bank_mask:0xf
    v_add_f32_dpp v42, v42, v42 row_ror:1 row_mask:0xf bank_mask:0xf
    v_add_f32_dpp v43, v43, v43 row_ror:1 row_mask:0xf bank_mask:0xf
    v_max_f32 v43, 0, v43
    s_mov_b64 exec, s[54:55]
    ds_write_b128 v21, v[40:43] offset:256
    s_mov_b64 exec, -1
    s_mov_b32 s49, 0
LB_SPIN:
    ds_read_b128 v[32:35], v22 offset:256
    ds_read_b128 v[36:39], v22 offset:272
    ds_read_b128 v[40:43], v22 offset:288
    ds_read_b128 v[44:47], v22 offset:304
    s_add_u32 s49, s49, 1
    s_waitcnt lgkmcnt(0)
    v_max3_u32 v30, v35, v39, v43
    v_max_u32 v30, v30, v47
    v_cmp_eq_u32 vcc, -1, v30
    s_nop 0
    s_cbranch_vccz LB_GO
    s_cmp_lt_u32 s49, 60000
    s_cbranch_scc1 LB_SPIN
LB_GO:
    v_pk_add_f32 v[32:33], v[32:33], v[36:37]
    v_pk_add_f32 v[34:35], v[34:35], v[38:39]
    v_pk_add_f32 v[40:41], v[40:41], v[44:45]
    v_pk_add_f32 v[42:43], v[42:43], v[46:47]
    v_pk_add_f32 v[32:33], v[32:33], v[40:41]
    v_pk_add_f32 v[60:61], v[34:35], v[42:43]
    v_pk_mul_f32 v[32:33], v[32:33], s[52:53] op_sel_hi:[1,0]
    v_pk_mul_f32 v[60:61], v[60:61], s[52:53] op_sel_hi:[1,0]
    v_pk_fma_f32 v[60:61], v[32:33], v[32:33], v[60:61] neg_lo:[1,0,0] neg_hi:[1,0,0]
    v_max_f32 v60, 0, v60
    v_max_f32 v61, 0, v61
    v_cvt_pk_bf16_f32 v30, v60, v61
    v_lshlrev_b32 v60, 16, v30
    v_and_b32 v61, 0xffff0000, v30
    v_add_f32 v60, 0x3727c5ac, v60
    v_add_f32 v61, 0x3727c5ac, v61
    v_cvt_pk_bf16_f32 v30, v60, v61
    v_lshlrev_b32 v60, 16, v30
    v_and_b32 v61, 0xffff0000, v30
    v_sqrt_f32 v60, v60
    v_sqrt_f32 v61, v61
    v_cvt_pk_bf16_f32 v31, v32, v33
    v_lshlrev_b32 v32, 16, v31
    v_and_b32 v33, 0xffff0000, v31
    v_cvt_pk_bf16_f32 v30, v60, v61
    v_lshlrev_b32 v60, 16, v30
    v_and_b32 v61, 0xffff0000, v30
    v_rcp_f32 v60, v60
    v_rcp_f32 v61, v61
    v_pk_add_f32 v[82:83], v[64:65], v[32:33] neg_lo:[0,1] neg_hi:[0,1]
    v_pk_add_f32 v[84:85], v[66:67], v[32:33] neg_lo:[0,1] neg_hi:[0,1]
    v_pk_add_f32 v[86:87], v[68:69], v[32:33] neg_lo:[0,1] neg_hi:[0,1]
    v_pk_add_f32 v[88:89], v[70:71], v[32:33] neg_lo:[0,1] neg_hi:[0,1]
    v_pk_add_f32 v[90:91], v[72:73], v[32:33] neg_lo:[0,1] neg_hi:[0,1]
    v_pk_add_f32 v[92:93], v[74:75], v[32:33] neg_lo:[0,1] neg_hi:[0,1]
    v_pk_add_f32 v[94:95], v[76:77], v[32:33] neg_lo:[0,1] neg_hi:[0,1]
    v_pk_add_f32 v[96:97], v[78:79], v[32:33] neg_lo:[0,1] neg_hi:[0,1]
    v_pk_add_f32 v[98:99], v[80:81], v[32:33] neg_lo:[0,1] neg_hi:[0,1]
    s_branch LN2_X
LN2_A:
    v_and_b32 v24, 1, v0
    s_mov_b32 s39, 0x02020000
    v_mul_lo_u32 v24, v24, s39
    v_add_u32 v24, 0x01000c0c, v24
    v_add_u32 v25, s39, v24
    v_add_u32 v26, s39, v25
LN2_X:
    v_cvt_pk_bf16_f32 v30, v82, v83
    v_lshlrev_b32 v82, 16, v30
    v_and_b32 v83, 0xffff0000, v30
    v_pk_mul_f32 v[82:83], v[82:83], v[60:61]
    v_cvt_pk_bf16_f32 v30, v82, v83
    v_lshlrev_b32 v82, 16, v30
    v_and_b32 v83, 0xffff0000, v30
    v_cvt_pk_bf16_f32 v30, v84, v85
    v_lshlrev_b32 v84, 16, v30
    v_and_b32 v85, 0xffff0000, v30
    v_pk_mul_f32 v[84:85], v[84:85], v[60:61]
    v_cvt_pk_bf16_f32 v30, v84, v85
    v_lshlrev_b32 v84, 16, v30
    v_and_b32 v85, 0xffff0000, v30
    v_cvt_pk_bf16_f32 v30, v86, v87
    v_lshlrev_b32 v86, 16, v30
    v_and_b32 v87, 0xffff0000, v30
    v_pk_mul_f32 v[86:87], v[86:87], v[60:61]
    v_cvt_pk_bf16_f32 v30, v86, v87
    v_lshlrev_b32 v86, 16, v30
    v_and_b32 v87, 0xffff0000, v30
    v_cvt_pk_bf16_f32 v30, v88, v89
    v_lshlrev_b32 v88, 16, v30
    v_and_b32 v89, 0xffff0000, v30
    v_pk_mul_f32 v[88:89], v[88:89], v[60:61]
    v_cvt_pk_bf16_f32 v30, v88, v89
    v_lshlrev_b32 v88, 16, v30
    v_and_b32 v89, 0xffff0000, v30
    v_cvt_pk_bf16_f32 v30, v90, v91
    v_lshlrev_b32 v90, 16, v30
    v_and_b32 v91, 0xffff0000, v30
    v_pk_mul_f32 v[90:91], v[90:91], v[60:61]
    v_cvt_pk_bf16_f32 v30, v90, v91
    v_lshlrev_b32 v90, 16, v30
    v_and_b32 v91, 0xffff0000, v30
    v_cvt_pk_bf16_f32 v30, v92, v93
    v_lshlrev_b32 v92, 16, v30
    v_and_b32 v93, 0xffff0000, v30
    v_pk_mul_f32 v[92:93], v[92:93], v[60:61]
    v_cvt_pk_bf16_f32 v30, v92, v93
    v_lshlrev_b32 v92, 16, v30
    v_and_b32 v93, 0xffff0000, v30
    v_cvt_pk_bf16_f32 v30, v94, v95
    v_lshlrev_b32 v94, 16, v30
    v_and_b32 v95, 0xffff0000, v30
    v_pk_mul_f32 v[94:95], v[94:95], v[60:61]
    v_cvt_pk_bf16_f32 v30, v94, v95
    v_lshlrev_b32 v94, 16, v30
    v_and_b32 v95, 0xffff0000, v30
    v_cvt_pk_bf16_f32 v30, v96, v97
    v_lshlrev_b32 v96, 16, v30
    v_and_b32 v97, 0xffff0000, v30
    v_pk_mul_f32 v[96:97], v[96:97], v[60:61]
    v_cvt_pk_bf16_f32 v30, v96, v97
    v_lshlrev_b32 v96, 16, v30
    v_and_b32 v97, 0xffff0000, v30
    v_cvt_pk_bf16_f32 v30, v98, v99
    v_lshlrev_b32 v98, 16, v30
    v_and_b32 v99, 0xffff0000, v30
    v_pk_mul_f32 v[98:99], v[98:99], v[60:61]
    v_cvt_pk_bf16_f32 v30, v98, v99
    v_lshlrev_b32 v98, 16, v30
    v_and_b32 v99, 0xffff0000, v30
    s_lshr_b32 s33, s3, 2
    s_lshl_b32 s35, s33, 7
    s_add_u32 s35, s35, s2
    v_lshlrev_b32 v28, 6, v4
    v_lshl_add_u32 v28, v5, 4, v28
    s_mul_i32 s38, s35, 12288
    s_add_u32 s38, s38, 3149824
    s_waitcnt vmcnt(0)
    buffer_load_dwordx4 v[8:11], v28, s[40:43], s38 offen offset:0 sc1
    buffer_load_dwordx4 v[12:15], v28, s[40:43], s38 offen offset:1024 sc1
    buffer_load_dwordx4 v[16:19], v28, s[40:43], s38 offen offset:2048 sc1
    v_perm_b32 v40, v49, v48, v24
    v_perm_b32 v100, v51, v50, v24
    v_pk_mul_f32 v[82:83], v[82:83], v[40:41] op_sel_hi:[1,0]
    v_cvt_pk_bf16_f32 v30, v82, v83
    v_lshlrev_b32 v82, 16, v30
    v_and_b32 v83, 0xffff0000, v30
    v_pk_add_f32 v[110:111], v[82:83], v[64:65]
    v_perm_b32 v40, v49, v48, v25
    v_perm_b32 v101, v51, v50, v25
    v_pk_mul_f32 v[84:85], v[84:85], v[40:41] op_sel_hi:[1,0]
    v_cvt_pk_bf16_f32 v30, v84, v85
    v_lshlrev_b32 v84, 16, v30
    v_and_b32 v85, 0xffff0000, v30
    v_pk_add_f32 v[112:113], v[84:85], v[66:67]
    v_perm_b32 v40, v49, v48, v26
    v_perm_b32 v102, v51, v50, v26
    v_pk_mul_f32 v[86:87], v[86:87], v[40:41] op_sel_hi:[1,0]
    v_cvt_pk_bf16_f32 v30, v86, v87
    v_lshlrev_b32 v86, 16, v30
    v_and_b32 v87, 0xffff0000, v30
    v_pk_add_f32 v[114:115], v[86:87], v[68:69]
    v_perm_b32 v40, v53, v52, v24
    v_perm_b32 v103, v55, v54, v24
    v_pk_mul_f32 v[88:89], v[88:89], v[40:41] op_sel_hi:[1,0]
    v_cvt_pk_bf16_f32 v30, v88, v89
    v_lshlrev_b32 v88, 16, v30
    v_and_b32 v89, 0xffff0000, v30
    v_pk_add_f32 v[116:117], v[88:89], v[70:71]
    v_perm_b32 v40, v53, v52, v25
    v_perm_b32 v104, v55, v54, v25
    v_pk_mul_f32 v[90:91], v[90:91], v[40:41] op_sel_hi:[1,0]
    v_cvt_pk_bf16_f32 v30, v90, v91
    v_lshlrev_b32 v90, 16, v30
    v_and_b32 v91, 0xffff0000, v30
    v_pk_add_f32 v[118:119], v[90:91], v[72:73]
    v_perm_b32 v40, v53, v52, v26
    v_perm_b32 v105, v55, v54, v26
    v_pk_mul_f32 v[92:93], v[92:93], v[40:41] op_sel_hi:[1,0]
    v_cvt_pk_bf16_f32 v30, v92, v93
    v_lshlrev_b32 v92, 16, v30
    v_and_b32 v93, 0xffff0000, v30
    v_pk_add_f32 v[120:121], v[92:93], v[74:75]
    v_perm_b32 v40, v57, v56, v24
    v_perm_b32 v106, v59, v58, v24
    v_pk_mul_f32 v[94:95], v[94:95], v[40:41] op_sel_hi:[1,0]
    v_cvt_pk_bf16_f32 v30, v94, v95
    v_lshlrev_b32 v94, 16, v30
    v_and_b32 v95, 0xffff0000, v30
    v_pk_add_f32 v[122:123], v[94:95], v[76:77]
    v_perm_b32 v40, v57, v56, v25
    v_perm_b32 v107, v59, v58, v25
    v_pk_mul_f32 v[96:97], v[96:97], v[40:41] op_sel_hi:[1,0]
    v_cvt_pk_bf16_f32 v30, v96, v97
    v_lshlrev_b32 v96, 16, v30
    v_and_b32 v97, 0xffff0000, v30
    v_pk_add_f32 v[124:125], v[96:97], v[78:79]
    v_perm_b32 v40, v57, v56, v26
    v_perm_b32 v108, v59, v58, v26
    v_pk_mul_f32 v[98:99], v[98:99], v[40:41] op_sel_hi:[1,0]
    v_cvt_pk_bf16_f32 v30, v98, v99
    v_lshlrev_b32 v98, 16, v30
    v_and_b32 v99, 0xffff0000, v30
    v_pk_add_f32 v[126:127], v[98:99], v[80:81]
    v_add_f32 v30, v100, v101
    v_add_f32 v30, v30, v102
    v_add_f32 v30, v30, v103
    v_add_f32 v30, v30, v104
    v_add_f32 v30, v30, v105
    v_add_f32 v30, v30, v106
    v_add_f32 v30, v30, v107
    v_add_f32 v30, v30, v108
    s_nop 1
    v_add_f32_dpp v30, v30, v30 row_ror:8 row_mask:0xf bank_mask:0xf
    s_nop 1
    v_add_f32_dpp v30, v30, v30 row_ror:4 row_mask:0xf bank_mask:0xf
    s_nop 1
    v_add_f32_dpp v30, v30, v30 row_ror:2 row_mask:0xf bank_mask:0xf
    s_nop 1
    v_add_f32_dpp v30, v30, v30 row_ror:1 row_mask:0xf bank_mask:0xf
    s_lshl_b32 s34, s33, 9
    v_lshl_add_u32 v22, v5, 7, s34
    s_and_b32 s34, s3, 3
    s_lshl_b32 s34, s34, 5
    v_add_u32 v21, s34, v22
    ds_write_b32 v21, v30 offset:536
    s_lshl_b32 s39, s35, 5
    s_add_u32 s39, s39, 6295552
    v_lshlrev_b32 v31, 3, v5
    s_lshl_b32 s34, s33, 5
    v_add_u32 v29, s34, v31
    s_lshl_b32 s34, s35, 3
    s_sub_u32 s34, 0xffff, s34
    v_lshlrev_b32 v27, 1, v5
    v_sub_u32 v27, s34, v27
    v_add_u32 v26, -1, v27
    s_mov_b32 s36, 0xffff0000
    s_mov_b32 s49, 0
P_7:
    s_add_u32 s49, s49, 1
    s_waitcnt vmcnt(0)
    v_cmp_ne_u32 s[6:7], s48, v11
    v_cmp_ne_u32 s[8:9], s48, v15
    v_cmp_ne_u32 s[10:11], s48, v19
    s_or_b64 s[50:51], s[6:7], s[8:9]
    s_or_b64 s[50:51], s[50:51], s[10:11]
    s_cbranch_scc0 PD_8
    s_or_b32 s50, s6, s7
    s_lshr_b32 s51, s50, 16
    s_or_b32 s50, s50, s51
    s_pack_ll_b32_b16 exec_lo, s50, s50
    s_mov_b32 exec_hi, exec_lo
    s_cbranch_execz PS_9
    buffer_load_dwordx4 v[8:11], v28, s[40:43], s38 offen offset:0 sc1
PS_9:
    s_or_b32 s50, s8, s9
    s_lshr_b32 s51, s50, 16
    s_or_b32 s50, s50, s51
    s_pack_ll_b32_b16 exec_lo, s50, s50
    s_mov_b32 exec_hi, exec_lo
    s_cbranch_execz PS_10
    buffer_load_dwordx4 v[12:15], v28, s[40:43], s38 offen offset:1024 sc1
PS_10:
    s_or_b32 s50, s10, s11
    s_lshr_b32 s51, s50, 16
    s_or_b32 s50, s50, s51
    s_pack_ll_b32_b16 exec_lo, s50, s50
    s_mov_b32 exec_hi, exec_lo
    s_cbranch_execz PS_11
    buffer_load_dwordx4 v[16:19], v28, s[40:43], s38 offen offset:2048 sc1
PS_11:
    s_mov_b64 exec, -1
    s_cmp_lt_u32 s49, 60000
    s_cbranch_scc1 P_7
    s_waitcnt vmcnt(0)
PD_8:
    v_lshlrev_b32 v44, 16, v8
    v_and_b32 v45, 0xffff0000, v8
    v_lshlrev_b32 v46, 16, v9
    v_and_b32 v47, 0xffff0000, v9
    v_lshlrev_b32 v48, 16, v10
    v_and_b32 v49, 0xffff0000, v10
    v_lshlrev_b32 v50, 16, v12
    v_and_b32 v51, 0xffff0000, v12
    v_lshlrev_b32 v52, 16, v13
    v_and_b32 v53, 0xffff0000, v13
    v_lshlrev_b32 v54, 16, v14
    v_and_b32 v55, 0xffff0000, v14
    v_lshlrev_b32 v56, 16, v16
    v_and_b32 v57, 0xffff0000, v16
    v_lshlrev_b32 v58, 16, v17
    v_and_b32 v59, 0xffff0000, v17
    v_lshlrev_b32 v60, 16, v18
    v_and_b32 v61, 0xffff0000, v18
    v_pk_add_f32 v[110:111], v[110:111], v[44:45]
    v_pk_add_f32 v[112:113], v[112:113], v[46:47]
    v_pk_add_f32 v[114:115], v[114:115], v[48:49]
    v_pk_add_f32 v[116:117], v[116:117], v[50:51]
    v_pk_add_f32 v[118:119], v[118:119], v[52:53]
    v_pk_add_f32 v[120:121], v[120:121], v[54:55]
    v_pk_add_f32 v[122:123], v[122:123], v[56:57]
    v_pk_add_f32 v[124:125], v[124:125], v[58:59]
    v_pk_add_f32 v[126:127], v[126:127], v[60:61]
    v_pk_mul_f32 v[34:35], v[110:111], v[110:111]
    v_pk_mul_f32 v[36:37], v[110:111], v[100:101] op_sel:[0,0] op_sel_hi:[1,0]
    v_pk_add_f32 v[32:33], v[112:113], v[110:111]
    v_pk_fma_f32 v[34:35], v[112:113], v[112:113], v[34:35]
    v_pk_fma_f32 v[36:37], v[112:113], v[100:101], v[36:37] op_sel:[0,1,0] op_sel_hi:[1,1,1]
    v_pk_add_f32 v[32:33], v[114:115], v[32:33]
    v_pk_fma_f32 v[34:35], v[114:115], v[114:115], v[34:35]
    v_pk_fma_f32 v[36:37], v[114:115], v[102:103], v[36:37] op_sel:[0,0,0] op_sel_hi:[1,0,1]
    v_pk_add_f32 v[32:33], v[116:117], v[32:33]
    v_pk_fma_f32 v[34:35], v[116:117], v[116:117], v[34:35]
    v_pk_fma_f32 v[36:37], v[116:117], v[102:103], v[36:37] op_sel:[0,1,0] op_sel_hi:[1,1,1]
    v_pk_add_f32 v[32:33], v[118:119], v[32:33]
    v_pk_fma_f32 v[34:35], v[118:119], v[118:119], v[34:35]
    v_pk_fma_f32 v[36:37], v[118:119], v[104:105], v[36:37] op_sel:[0,0,0] op_sel_hi:[1,0,1]
    v_pk_add_f32 v[32:33], v[120:121], v[32:33]
    v_pk_fma_f32 v[34:35], v[120:121], v[120:121], v[34:35]
    v_pk_fma_f32 v[36:37], v[120:121], v[104:105], v[36:37] op_sel:[0,1,0] op_sel_hi:[1,1,1]
    v_pk_add_f32 v[32:33], v[122:123], v[32:33]
    v_pk_fma_f32 v[34:35], v[122:123], v[122:123], v[34:35]
    v_pk_fma_f32 v[36:37], v[122:123], v[106:107], v[36:37] op_sel:[0,0,0] op_sel_hi:[1,0,1]
    v_pk_add_f32 v[32:33], v[124:125], v[32:33]
    v_pk_fma_f32 v[34:35], v[124:125], v[124:125], v[34:35]
    v_pk_fma_f32 v[36:37], v[124:125], v[106:107], v[36:37] op_sel:[0,1,0] op_sel_hi:[1,1,1]
    v_pk_add_f32 v[32:33], v[126:127], v[32:33]
    v_pk_fma_f32 v[34:35], v[126:127], v[126:127], v[34:35]
    v_pk_fma_f32 v[36:37], v[126:127], v[108:109], v[36:37] op_sel:[0,0,0] op_sel_hi:[1,0,1]
    v_add_f32_dpp v32, v32, v32 row_ror:8 row_mask:0xf bank_mask:0xf
    v_add_f32_dpp v33, v33, v33 row_ror:8 row_mask:0xf bank_mask:0xf
    v_add_f32_dpp v34, v34, v34 row_ror:8 row_mask:0xf bank_mask:0xf
    v_add_f32_dpp v35, v35, v35 row_ror:8 row_mask:0xf bank_mask:0xf
    v_add_f32_dpp v36, v36, v36 row_ror:8 row_mask:0xf bank_mask:0xf
    v_add_f32_dpp v37, v37, v37 row_ror:8 row_mask:0xf bank_mask:0xf
    v_add_f32_dpp v32, v32, v32 row_ror:4 row_mask:0xf bank_mask:0xf
    v_add_f32_dpp v33, v33, v33 row_ror:4 row_mask:0xf bank_mask:0xf
    v_add_f32_dpp v34, v34, v34 row_ror:4 row_mask:0xf bank_mask:0xf
    v_add_f32_dpp v35, v35, v35 row_ror:4 row_mask:0xf bank_mask:0xf
    v_add_f32_dpp v36, v36, v36 row_ror:4 row_mask:0xf bank_mask:0xf
    v_add_f32_dpp v37, v37, v37 row_ror:4 row_mask:0xf bank_mask:0xf
    v_add_f32_dpp v32, v32, v32 row_ror:2 row_mask:0xf bank_mask:0xf
    v_add_f32_dpp v33, v33, v33 row_ror:2 row_mask:0xf bank_mask:0xf
    v_add_f32_dpp v34, v34, v34 row_ror:2 row_mask:0xf bank_mask:0xf
    v_add_f32_dpp v35, v35, v35 row_ror:2 row_mask:0xf bank_mask:0xf
    v_add_f32_dpp v36, v36, v36 row_ror:2 row_mask:0xf bank_mask:0xf
    v_add_f32_dpp v37, v37, v37 row_ror:2 row_mask:0xf bank_mask:0xf
    v_add_f32_dpp v32, v32, v32 row_ror:1 row_mask:0xf bank_mask:0xf
    v_add_f32_dpp v33, v33, v33 row_ror:1 row_mask:0xf bank_mask:0xf
    v_add_f32_dpp v34, v34, v34 row_ror:1 row_mask:0xf bank_mask:0xf
    v_add_f32_dpp v35, v35, v35 row_ror:1 row_mask:0xf bank_mask:0xf
    v_add_f32_dpp v36, v36, v36 row_ror:1 row_mask:0xf bank_mask:0xf
    v_add_f32_dpp v37, v37, v37 row_ror:1 row_mask:0xf bank_mask:0xf
    s_mov_b64 exec, s[54:55]
    ds_write_b128 v21, v[32:35] offset:512
    ds_write_b64 v21, v[36:37] offset:528
    s_mov_b64 exec, -1
    s_waitcnt lgkmcnt(0)
    s_barrier
    ds_read_b128 v[32:35], v22 offset:512
    ds_read_b128 v[36:39], v22 offset:528
    ds_read_b128 v[110:113], v22 offset:544
    ds_read_b128 v[114:117], v22 offset:560
    ds_read_b128 v[118:121], v22 offset:576
    ds_read_b128 v[122:125], v22 offset:592
    ds_read_b128 v[8:11], v22 offset:608
    ds_read_b128 v[12:15], v22 offset:624
    s_waitcnt lgkmcnt(4)
    v_pk_add_f32 v[32:33], v[32:33], v[110:111]
    v_pk_add_f32 v[34:35], v[34:35], v[112:113]
    v_pk_add_f32 v[36:37], v[36:37], v[114:115]
    v_add_f32 v38, v38, v116
    s_waitcnt lgkmcnt(0)
    v_pk_add_f32 v[118:119], v[118:119], v[8:9]
    v_pk_add_f32 v[120:121], v[120:121], v[10:11]
    v_pk_add_f32 v[122:123], v[122:123], v[12:13]
    v_add_f32 v124, v124, v14
    v_pk_add_f32 v[32:33], v[32:33], v[118:119]
    v_pk_add_f32 v[34:35], v[34:35], v[120:121]
    v_pk_add_f32 v[36:37], v[36:37], v[122:123]
    v_add_f32 v38, v38, v124
    v_pk_mul_f32 v[32:33], v[32:33], s[52:53] op_sel_hi:[1,0]
    v_pk_mul_f32 v[34:35], v[34:35], s[52:53] op_sel_hi:[1,0]
    v_pk_fma_f32 v[34:35], v[32:33], v[32:33], v[34:35] neg_lo:[1,0,0] neg_hi:[1,0,0]
    v_max_f32 v34, 0, v34
    v_max_f32 v35, 0, v35
    v_cvt_pk_bf16_f32 v40, v34, v35
    v_lshlrev_b32 v34, 16, v40
    v_and_b32 v35, 0xffff0000, v40
    v_add_f32 v34, 0x3727c5ac, v34
    v_add_f32 v35, 0x3727c5ac, v35
    v_cvt_pk_bf16_f32 v40, v34, v35
    v_lshlrev_b32 v34, 16, v40
    v_and_b32 v35, 0xffff0000, v40
    v_sqrt_f32 v34, v34
    v_sqrt_f32 v35, v35
    v_cvt_pk_bf16_f32 v41, v32, v33
    v_lshlrev_b32 v32, 16, v41
    v_and_b32 v33, 0xffff0000, v41
    v_cvt_pk_bf16_f32 v40, v34, v35
    v_lshlrev_b32 v34, 16, v40
    v_and_b32 v35, 0xffff0000, v40
    v_rcp_f32 v34, v34
    v_rcp_f32 v35, v35
    s_mul_i32 s34, s33, 5
    s_cmp_lg_u32 s3, s34
    s_cbranch_scc1 NOKEY
    v_pk_fma_f32 v[36:37], v[32:33], v[38:39], v[36:37] op_sel_hi:[1,0,1] neg_lo:[1,0,0] neg_hi:[1,0,0]
    v_pk_mul_f32 v[36:37], v[36:37], v[34:35]
    v_cvt_pk_bf16_f32 v40, v36, v37
    v_pk_ashrrev_i16 v41, 15, v40 op_sel_hi:[0,1]
    v_or_b32 v41, 0x80008000, v41
    v_xor_b32 v18, v40, v41
    s_mov_b64 exec, s[54:55]
    buffer_store_dwordx2 v[18:19], v31, s[40:43], s39 offen sc1
    v_lshl_or_b32 v40, v18, 16, v27
    v_and_or_b32 v41, v18, s36, v26
    ds_write_b64 v29, v[40:41] offset:1536
    s_mov_b64 exec, -1
    s_waitcnt lgkmcnt(0)
NOKEY:
    s_barrier
    s_setprio 1
    v_mul_u32_u24 v30, 12, v4
    v_mul_u32_u24 v31, 2304, v5
    s_mul_i32 s34, s33, 9216
    v_add3_u32 v30, v30, v31, s34
    v_pk_add_f32 v[44:45], v[44:45], v[82:83]
    v_pk_add_f32 v[46:47], v[46:47], v[84:85]
    v_pk_add_f32 v[48:49], v[48:49], v[86:87]
    v_cvt_pk_bf16_f32 v40, v44, v45
    v_lshlrev_b32 v44, 16, v40
    v_and_b32 v45, 0xffff0000, v40
    v_cvt_pk_bf16_f32 v41, v46, v47
    v_lshlrev_b32 v46, 16, v41
    v_and_b32 v47, 0xffff0000, v41
    v_cvt_pk_bf16_f32 v42, v48, v49
    v_lshlrev_b32 v48, 16, v42
    v_and_b32 v49, 0xffff0000, v42
    v_pk_add_f32 v[44:45], v[44:45], v[64:65]
    v_pk_add_f32 v[46:47], v[46:47], v[66:67]
    v_pk_add_f32 v[48:49], v[48:49], v[68:69]
    v_cvt_pk_bf16_f32 v8, v44, v45
    v_lshlrev_b32 v44, 16, v8
    v_and_b32 v45, 0xffff0000, v8
    v_cvt_pk_bf16_f32 v9, v46, v47
    v_lshlrev_b32 v46, 16, v9
    v_and_b32 v47, 0xffff0000, v9
    v_cvt_pk_bf16_f32 v10, v48, v49
    v_lshlrev_b32 v48, 16, v10
    v_and_b32 v49, 0xffff0000, v10
    v_pk_add_f32 v[82:83], v[44:45], v[32:33] neg_lo:[0,1] neg_hi:[0,1]
    v_pk_add_f32 v[84:85], v[46:47], v[32:33] neg_lo:[0,1] neg_hi:[0,1]
    v_pk_add_f32 v[86:87], v[48:49], v[32:33] neg_lo:[0,1] neg_hi:[0,1]
    ds_write_b32 v30, v8 offset:32768
    ds_write_b32 v30, v9 offset:32772
    ds_write_b32 v30, v10 offset:32776
    v_cvt_pk_bf16_f32 v40, v82, v83
    v_lshlrev_b32 v82, 16, v40
    v_and_b32 v83, 0xffff0000, v40
    v_cvt_pk_bf16_f32 v41, v84, v85
    v_lshlrev_b32 v84, 16, v41
    v_and_b32 v85, 0xffff0000, v41
    v_cvt_pk_bf16_f32 v42, v86, v87
    v_lshlrev_b32 v86, 16, v42
    v_and_b32 v87, 0xffff0000, v42
    v_pk_mul_f32 v[82:83], v[82:83], v[34:35]
    v_pk_mul_f32 v[84:85], v[84:85], v[34:35]
    v_pk_mul_f32 v[86:87], v[86:87], v[34:35]
    v_cvt_pk_bf16_f32 v11, v82, v83
    v_lshlrev_b32 v82, 16, v11
    v_and_b32 v83, 0xffff0000, v11
    v_cvt_pk_bf16_f32 v12, v84, v85
    v_lshlrev_b32 v84, 16, v12
    v_and_b32 v85, 0xffff0000, v12
    v_cvt_pk_bf16_f32 v13, v86, v87
    v_lshlrev_b32 v86, 16, v13
    v_and_b32 v87, 0xffff0000, v13
    v_pk_add_f32 v[82:83], v[82:83], v[44:45]
    v_pk_add_f32 v[84:85], v[84:85], v[46:47]
    v_pk_add_f32 v[86:87], v[86:87], v[48:49]
    ds_write_b32 v30, v11 offset:14336
    ds_write_b32 v30, v12 offset:14340
    ds_write_b32 v30, v13 offset:14344
    v_cvt_pk_bf16_f32 v14, v82, v83
    v_cvt_pk_bf16_f32 v15, v84, v85
    v_cvt_pk_bf16_f32 v16, v86, v87
    ds_write_b32 v30, v14 offset:51200
    ds_write_b32 v30, v15 offset:51204
    ds_write_b32 v30, v16 offset:51208
    v_pk_add_f32 v[50:51], v[50:51], v[88:89]
    v_pk_add_f32 v[52:53], v[52:53], v[90:91]
    v_pk_add_f32 v[54:55], v[54:55], v[92:93]
    v_cvt_pk_bf16_f32 v40, v50, v51
    v_lshlrev_b32 v50, 16, v40
    v_and_b32 v51, 0xffff0000, v40
    v_cvt_pk_bf16_f32 v41, v52, v53
    v_lshlrev_b32 v52, 16, v41
    v_and_b32 v53, 0xffff0000, v41
    v_cvt_pk_bf16_f32 v42, v54, v55
    v_lshlrev_b32 v54, 16, v42
    v_and_b32 v55, 0xffff0000, v42
    v_pk_add_f32 v[50:51], v[50:51], v[70:71]
    v_pk_add_f32 v[52:53], v[52:53], v[72:73]
    v_pk_add_f32 v[54:55], v[54:55], v[74:75]
    v_cvt_pk_bf16_f32 v8, v50, v51
    v_lshlrev_b32 v50, 16, v8
    v_and_b32 v51, 0xffff0000, v8
    v_cvt_pk_bf16_f32 v9, v52, v53
    v_lshlrev_b32 v52, 16, v9
    v_and_b32 v53, 0xffff0000, v9
    v_cvt_pk_bf16_f32 v10, v54, v55
    v_lshlrev_b32 v54, 16, v10
    v_and_b32 v55, 0xffff0000, v10
    v_pk_add_f32 v[88:89], v[50:51], v[32:33] neg_lo:[0,1] neg_hi:[0,1]
    v_pk_add_f32 v[90:91], v[52:53], v[32:33] neg_lo:[0,1] neg_hi:[0,1]
    v_pk_add_f32 v[92:93], v[54:55], v[32:33] neg_lo:[0,1] neg_hi:[0,1]
    ds_write_b32 v30, v8 offset:32960
    ds_write_b32 v30, v9 offset:32964
    ds_write_b32 v30, v10 offset:32968
    v_cvt_pk_bf16_f32 v40, v88, v89
    v_lshlrev_b32 v88, 16, v40
    v_and_b32 v89, 0xffff0000, v40
    v_cvt_pk_bf16_f32 v41, v90, v91
    v_lshlrev_b32 v90, 16, v41
    v_and_b32 v91, 0xffff0000, v41
    v_cvt_pk_bf16_f32 v42, v92, v93
    v_lshlrev_b32 v92, 16, v42
    v_and_b32 v93, 0xffff0000, v42
    v_pk_mul_f32 v[88:89], v[88:89], v[34:35]
    v_pk_mul_f32 v[90:91], v[90:91], v[34:35]
    v_pk_mul_f32 v[92:93], v[92:93], v[34:35]
    v_cvt_pk_bf16_f32 v11, v88, v89
    v_lshlrev_b32 v88, 16, v11
    v_and_b32 v89, 0xffff0000, v11
    v_cvt_pk_bf16_f32 v12, v90, v91
    v_lshlrev_b32 v90, 16, v12
    v_and_b32 v91, 0xffff0000, v12
    v_cvt_pk_bf16_f32 v13, v92, v93
    v_lshlrev_b32 v92, 16, v13
    v_and_b32 v93, 0xffff0000, v13
    v_pk_add_f32 v[88:89], v[88:89], v[50:51]
    v_pk_add_f32 v[90:91], v[90:91], v[52:53]
    v_pk_add_f32 v[92:93], v[92:93], v[54:55]
    ds_write_b32 v30, v11 offset:14528
    ds_write_b32 v30, v12 offset:14532
    ds_write_b32 v30, v13 offset:14536
    v_cvt_pk_bf16_f32 v14, v88, v89
    v_cvt_pk_bf16_f32 v15, v90, v91
    v_cvt_pk_bf16_f32 v16, v92, v93
    ds_write_b32 v30, v14 offset:51392
    ds_write_b32 v30, v15 offset:51396
    ds_write_b32 v30, v16 offset:51400
    v_pk_add_f32 v[56:57], v[56:57], v[94:95]
    v_pk_add_f32 v[58:59], v[58:59], v[96:97]
    v_pk_add_f32 v[60:61], v[60:61], v[98:99]
    v_cvt_pk_bf16_f32 v40, v56, v57
    v_lshlrev_b32 v56, 16, v40
    v_and_b32 v57, 0xffff0000, v40
    v_cvt_pk_bf16_f32 v41, v58, v59
    v_lshlrev_b32 v58, 16, v41
    v_and_b32 v59, 0xffff0000, v41
    v_cvt_pk_bf16_f32 v42, v60, v61
    v_lshlrev_b32 v60, 16, v42
    v_and_b32 v61, 0xffff0000, v42
    v_pk_add_f32 v[56:57], v[56:57], v[76:77]
    v_pk_add_f32 v[58:59], v[58:59], v[78:79]
    v_pk_add_f32 v[60:61], v[60:61], v[80:81]
    v_cvt_pk_bf16_f32 v8, v56, v57
    v_lshlrev_b32 v56, 16, v8
    v_and_b32 v57, 0xffff0000, v8
    v_cvt_pk_bf16_f32 v9, v58, v59
    v_lshlrev_b32 v58, 16, v9
    v_and_b32 v59, 0xffff0000, v9
    v_cvt_pk_bf16_f32 v10, v60, v61
    v_lshlrev_b32 v60, 16, v10
    v_and_b32 v61, 0xffff0000, v10
    v_pk_add_f32 v[94:95], v[56:57], v[32:33] neg_lo:[0,1] neg_hi:[0,1]
    v_pk_add_f32 v[96:97], v[58:59], v[32:33] neg_lo:[0,1] neg_hi:[0,1]
    v_pk_add_f32 v[98:99], v[60:61], v[32:33] neg_lo:[0,1] neg_hi:[0,1]
    ds_write_b32 v30, v8 offset:33152
    ds_write_b32 v30, v9 offset:33156
    ds_write_b32 v30, v10 offset:33160
    v_cvt_pk_bf16_f32 v40, v94, v95
    v_lshlrev_b32 v94, 16, v40
    v_and_b32 v95, 0xffff0000, v40
    v_cvt_pk_bf16_f32 v41, v96, v97
    v_lshlrev_b32 v96, 16, v41
    v_and_b32 v97, 0xffff0000, v41
    v_cvt_pk_bf16_f32 v42, v98, v99
    v_lshlrev_b32 v98, 16, v42
    v_and_b32 v99, 0xffff0000, v42
    v_pk_mul_f32 v[94:95], v[94:95], v[34:35]
    v_pk_mul_f32 v[96:97], v[96:97], v[34:35]
    v_pk_mul_f32 v[98:99], v[98:99], v[34:35]
    v_cvt_pk_bf16_f32 v11, v94, v95
    v_lshlrev_b32 v94, 16, v11
    v_and_b32 v95, 0xffff0000, v11
    v_cvt_pk_bf16_f32 v12, v96, v97
    v_lshlrev_b32 v96, 16, v12
    v_and_b32 v97, 0xffff0000, v12
    v_cvt_pk_bf16_f32 v13, v98, v99
    v_lshlrev_b32 v98, 16, v13
    v_and_b32 v99, 0xffff0000, v13
    v_pk_add_f32 v[94:95], v[94:95], v[56:57]
    v_pk_add_f32 v[96:97], v[96:97], v[58:59]
    v_pk_add_f32 v[98:99], v[98:99], v[60:61]
    ds_write_b32 v30, v11 offset:14720
    ds_write_b32 v30, v12 offset:14724
    ds_write_b32 v30, v13 offset:14728
    v_cvt_pk_bf16_f32 v14, v94, v95
    v_cvt_pk_bf16_f32 v15, v96, v97
    v_cvt_pk_bf16_f32 v16, v98, v99
    ds_write_b32 v30, v14 offset:51584
    ds_write_b32 v30, v15 offset:51588
    ds_write_b32 v30, v16 offset:51592
    s_waitcnt lgkmcnt(0)
    s_barrier
    s_branch FIN
LN2_H:
    s_setprio 2
    v_and_b32 v11, 511, v0
    v_lshlrev_b32 v10, 4, v11
    s_mov_b32 s39, 6295552
    v_lshlrev_b32 v16, 2, v11
    v_sub_u32 v16, 0xffff, v16
    v_add_u32 v17, -1, v16
    v_add_u32 v18, -2, v16
    v_add_u32 v19, -3, v16
    v_lshlrev_b32 v8, 2, v3
    v_and_b32 v32, 127, v0
    v_mul_u32_u24 v33, 24, v32
    s_bitcmp1_b32 s3, 1
    s_cselect_b32 s37, 18432, 0
    s_cselect_b32 s36, 1, 0
    v_add_u32 v33, s37, v33
    s_add_u32 s36, s36, 96
    v_cmp_gt_u32 s[44:45], s36, v32
    s_movk_i32 s36, 96
    v_cmp_eq_u32 s[46:47], s36, v32
    v_lshlrev_b32 v32, 4, v32
    v_mov_b32 v27, s48
    s_mov_b32 s17, 0
    s_mov_b32 s18, 0
    s_mov_b32 s12, 0xffff0000
    s_mov_b32 s32, s28
    s_and_b32 s33, s29, 0xffff
    s_mov_b32 s34, 0x00240000
    s_mov_b32 s35, 0x00020000
    s_barrier
    s_barrier
    ds_read_b32 v8, v8 offset:1536
    s_sleep 2
    buffer_load_dwordx4 v[12:15], v10, s[40:43], s39 offen sc1
    s_waitcnt lgkmcnt(0)
RANK:
    v_mov_b32 v9, v8
    s_nop 1
    v_max_u32_dpp v9, v9, v9 row_ror:8 row_mask:0xf bank_mask:0xf
    s_nop 1
    v_max_u32_dpp v9, v9, v9 row_ror:4 row_mask:0xf bank_mask:0xf
    s_nop 1
    v_max_u32_dpp v9, v9, v9 row_ror:2 row_mask:0xf bank_mask:0xf
    s_nop 1
    v_max_u32_dpp v9, v9, v9 row_ror:1 row_mask:0xf bank_mask:0xf
    v_cmp_ne_u32 vcc, v8, v9
    v_readfirstlane_b32 s15, v9
    s_nop 0
    v_cndmask_b32 v8, 0, v8, vcc
    v_mov_b32 v9, v8
    s_nop 1
    v_max_u32_dpp v9, v9, v9 row_ror:8 row_mask:0xf bank_mask:0xf
    s_nop 1
    v_max_u32_dpp v9, v9, v9 row_ror:4 row_mask:0xf bank_mask:0xf
    s_nop 1
    v_max_u32_dpp v9, v9, v9 row_ror:2 row_mask:0xf bank_mask:0xf
    s_nop 1
    v_max_u32_dpp v9, v9, v9 row_ror:1 row_mask:0xf bank_mask:0xf
    v_cmp_ne_u32 vcc, v8, v9
    v_readfirstlane_b32 s16, v9
    s_nop 0
    v_cndmask_b32 v8, 0, v8, vcc
    s_bitcmp1_b32 s3, 2
    s_cselect_b32 s19, s16, s15
    s_not_b32 s13, s19
    s_bfe_u32 s14, s13, 0x1000a
    s_and_b32 s13, s13, 7
    s_lshl_b32 s14, s14, 3
    s_or_b32 s4, s13, s14
    s_lshr_b32 s5, s4, 1
    s_mul_i32 s5, s5, 2304
    v_add_u32 v34, s5, v33
    s_bitcmp1_b32 s4, 0
    s_mov_b32 s5, 0x05040100
    s_cselect_b32 s5, 0x07060302, s5
    v_mov_b32 v28, s19
    v_mov_b32 v29, s18
    s_cmp_lg_u32 s18, 0
    s_cbranch_scc1 RK_C2
    s_mov_b32 s49, 0
    s_branch PC_14
P_12:
    buffer_load_dwordx4 v[12:15], v10, s[40:43], s39 offen sc1
PC_14:
    s_add_u32 s49, s49, 1
    s_waitcnt vmcnt(0)
    v_cmp_ne_u32 vcc, s48, v13
    v_cmp_ne_u32 s[50:51], s48, v15
    s_nop 0
    s_or_b64 vcc, vcc, s[50:51]
    s_cbranch_vccz PD_13
    s_cmp_lt_u32 s49, 60000
    s_cbranch_scc1 P_12
PD_13:
    v_lshl_or_b32 v16, v12, 16, v16
    v_and_or_b32 v17, v12, s12, v17
    v_lshl_or_b32 v18, v14, 16, v18
    v_and_or_b32 v19, v14, s12, v19
RK_C2:
    v_cmp_lt_u32 s[20:21], s15, v16
    v_cmp_lt_u32 s[22:23], s15, v17
    v_cmp_lt_u32 s[24:25], s15, v18
    v_cmp_lt_u32 s[26:27], s15, v19
    s_bcnt1_i32_b64 s56, s[20:21]
    s_bcnt1_i32_b64 s57, s[22:23]
    s_bcnt1_i32_b64 s58, s[24:25]
    s_bcnt1_i32_b64 s59, s[26:27]
    v_cmp_lt_u32 s[20:21], s16, v16
    v_cmp_lt_u32 s[22:23], s16, v17
    v_cmp_lt_u32 s[24:25], s16, v18
    v_cmp_lt_u32 s[26:27], s16, v19
    s_add_u32 s56, s56, s57
    s_add_u32 s58, s58, s59
    s_add_u32 s13, s56, s58
    s_bcnt1_i32_b64 s56, s[20:21]
    s_bcnt1_i32_b64 s57, s[22:23]
    s_bcnt1_i32_b64 s58, s[24:25]
    s_bcnt1_i32_b64 s59, s[26:27]
    s_add_u32 s56, s56, s57
    s_add_u32 s58, s58, s59
    s_add_u32 s56, s56, s58
    s_pack_ll_b32_b16 s13, s13, s56
    v_mov_b32 v20, s13
    s_mov_b64 exec, 1
    ds_add_u32 v29, v20 offset:1600
    s_mov_b64 exec, -1
    s_waitcnt lgkmcnt(0)
    s_barrier
    ds_read_b32 v29, v29 offset:1600
    ds_read_b64 v[36:37], v34 offset:14336
    ds_read_b64 v[38:39], v34 offset:14344
    ds_read_b64 v[40:41], v34 offset:14352
    s_waitcnt lgkmcnt(3)
    v_readfirstlane_b32 s56, v29
    s_nop 0
    s_lshr_b32 s57, s56, 16
    s_and_b32 s56, s56, 0xffff
    s_cmp_ge_u32 s56, 8
    s_cbranch_scc1 RK_DONE
    s_bitcmp1_b32 s3, 2
    s_cselect_b32 s58, s57, s56
    s_cmp_ge_u32 s58, 8
    s_cbranch_scc1 RK_NP
    s_mul_i32 s59, s58, 1536
    s_add_u32 s59, s59, 6303744
    s_lshl_b32 s58, s58, 11
    s_add_u32 s58, s58, 6316032
    s_bitcmp1_b32 s3, 1
    s_cselect_b32 s58, s58, s59
    s_waitcnt lgkmcnt(0)
    v_perm_b32 v24, v37, v36, s5
    v_perm_b32 v25, v39, v38, s5
    v_perm_b32 v26, v41, v40, s5
    v_cndmask_b32 v24, v24, v28, s[46:47]
    s_mov_b64 exec, s[44:45]
    buffer_store_dwordx4 v[24:27], v32, s[40:43], s58 offen sc1
    s_mov_b64 exec, -1
RK_NP:
    s_not_b32 s13, s15
    s_bfe_u32 s14, s13, 0x1000a
    s_and_b32 s13, s13, 7
    s_lshl_b32 s14, s14, 3
    s_or_b32 s4, s13, s14
    s_bitset1_b32 s17, s4
    s_cmp_ge_u32 s57, 8
    s_cbranch_scc1 RK_DONE
    s_not_b32 s13, s16
    s_bfe_u32 s14, s13, 0x1000a
    s_and_b32 s13, s13, 7
    s_lshl_b32 s14, s14, 3
    s_or_b32 s4, s13, s14
    s_bitset1_b32 s17, s4
    s_add_u32 s18, s18, 4
    s_waitcnt lgkmcnt(0)
    s_cmp_lt_u32 s18, 32
    s_cbranch_scc1 RANK
RK_DONE:
    s_sub_u32 s4, s3, 8
    s_mul_i32 s5, s4, 2304
    v_lshl_add_u32 v8, v1, 5, s5
    s_waitcnt lgkmcnt(0)
    ds_read_b128 v[40:43], v8 offset:51200
    ds_read_b128 v[44:47], v8 offset:51216
    ds_read_b128 v[48:51], v8 offset:53248
    ds_read_b128 v[52:55], v8 offset:53264
    s_lshr_b32 s6, s4, 2
    s_lshl_b32 s6, s6, 7
    s_add_u32 s6, s6, s2
    s_mul_i32 s6, s6, 9216
    s_and_b32 s7, s4, 3
    s_mul_i32 s7, s7, 2304
    s_add_u32 s6, s6, s7
    s_lshl_b32 s4, s4, 1
    s_lshr_b32 s17, s17, s4
    v_lshlrev_b32 v8, 4, v1
    s_mov_b32 s36, 0x05040100
    s_mov_b32 s37, 0x07060302
    s_sleep 8
    s_waitcnt lgkmcnt(0)
    s_bitcmp1_b32 s17, 0
    s_cbranch_scc1 OS_15
    v_perm_b32 v56, v41, v40, s36
    v_perm_b32 v57, v43, v42, s36
    v_perm_b32 v58, v45, v44, s36
    v_perm_b32 v59, v47, v46, s36
    v_perm_b32 v60, v49, v48, s36
    v_perm_b32 v61, v51, v50, s36
    v_perm_b32 v62, v53, v52, s36
    v_perm_b32 v63, v55, v54, s36
    buffer_store_dwordx4 v[56:59], v8, s[32:35], s6 offen offset:0
    s_mov_b64 exec, 0xff
    buffer_store_dwordx4 v[60:63], v8, s[32:35], s6 offen offset:1024
    s_mov_b64 exec, -1
OS_15:
    s_bitcmp1_b32 s17, 1
    s_cbranch_scc1 OS_16
    v_perm_b32 v64, v41, v40, s37
    v_perm_b32 v65, v43, v42, s37
    v_perm_b32 v66, v45, v44, s37
    v_perm_b32 v67, v47, v46, s37
    v_perm_b32 v68, v49, v48, s37
    v_perm_b32 v69, v51, v50, s37
    v_perm_b32 v70, v53, v52, s37
    v_perm_b32 v71, v55, v54, s37
    buffer_store_dwordx4 v[64:67], v8, s[32:35], s6 offen offset:1152
    s_mov_b64 exec, 0xff
    buffer_store_dwordx4 v[68:71], v8, s[32:35], s6 offen offset:2176
    s_mov_b64 exec, -1
OS_16:
    s_branch FIN
FFN_CK:
    s_waitcnt lgkmcnt(0)
    s_mul_i32 s48, s48, 1664525
    s_add_u32 s48, s48, 1013904223
FFN_C:
    s_barrier
    s_sub_u32 s44, s2, 192
    s_branch FFN_L
FFN_B:
    s_barrier
    s_sub_u32 s44, s2, 120
FFN_L:
    s_setprio 0
    s_cmp_ge_u32 s3, 8
    s_cbranch_scc1 F_L2
    s_lshr_b32 s56, s3, 2
    s_cmp_eq_u32 s56, 0
    s_cselect_b64 s[36:37], s[22:23], s[24:25]
    s_mov_b32 s32, s36
    s_and_b32 s33, s37, 0xffff
    s_mov_b32 s34, 0x00510000
    s_mov_b32 s35, 0x00020000
    v_lshrrev_b32 v7, 3, v1
    v_mul_u32_u24 v7, 9216, v7
    v_and_b32 v8, 7, v1
    v_bfe_u32 v9, v1, 4, 1
    s_lshl_b32 s57, s56, 2
    v_xor_b32 v8, v8, v9
    v_xor_b32 v8, s57, v8
    v_xor_b32 v9, 2, v8
    v_lshl_add_u32 v8, v8, 4, v7
    v_lshl_add_u32 v9, v9, 4, v7
    s_and_b32 s57, s3, 3
    s_mul_i32 s58, s57, 1327104
    s_lshl_b32 s59, s44, 7
    s_add_u32 s58, s58, s59
    s_mul_i32 s57, s3, 18432
    s_add_u32 s57, s57, 2048
    s_mov_b32 m0, s57
    s_nop 0
    buffer_load_dwordx4 v8, s[32:35], s58 offen nt lds
    s_add_u32 m0, m0, 1024
    s_add_u32 s58, s58, 73728
    buffer_load_dwordx4 v9, s[32:35], s58 offen nt lds
    s_add_u32 m0, m0, 1024
    s_add_u32 s58, s58, 73728
    buffer_load_dwordx4 v8, s[32:35], s58 offen nt lds
    s_add_u32 m0, m0, 1024
    s_add_u32 s58, s58, 73728
    buffer_load_dwordx4 v9, s[32:35], s58 offen nt lds
    s_add_u32 m0, m0, 1024
    s_add_u32 s58, s58, 73728
    buffer_load_dwordx4 v8, s[32:35], s58 offen nt lds
    s_add_u32 m0, m0, 1024
    s_add_u32 s58, s58, 73728
    buffer_load_dwordx4 v9, s[32:35], s58 offen nt lds
    s_add_u32 m0, m0, 1024
    s_add_u32 s58, s58, 73728
    buffer_load_dwordx4 v8, s[32:35], s58 offen nt lds
    s_add_u32 m0, m0, 1024
    s_add_u32 s58, s58, 73728
    buffer_load_dwordx4 v9, s[32:35], s58 offen nt lds
    s_add_u32 m0, m0, 1024
    s_add_u32 s58, s58, 73728
    buffer_load_dwordx4 v8, s[32:35], s58 offen nt lds
    s_add_u32 m0, m0, 1024
    s_add_u32 s58, s58, 73728
    buffer_load_dwordx4 v9, s[32:35], s58 offen nt lds
    s_add_u32 m0, m0, 1024
    s_add_u32 s58, s58, 73728
    buffer_load_dwordx4 v8, s[32:35], s58 offen nt lds
    s_add_u32 m0, m0, 1024
    s_add_u32 s58, s58, 73728
    buffer_load_dwordx4 v9, s[32:35], s58 offen nt lds
    s_add_u32 m0, m0, 1024
    s_add_u32 s58, s58, 73728
    buffer_load_dwordx4 v8, s[32:35], s58 offen nt lds
    s_add_u32 m0, m0, 1024
    s_add_u32 s58, s58, 73728
    buffer_load_dwordx4 v9, s[32:35], s58 offen nt lds
    s_add_u32 m0, m0, 1024
    s_add_u32 s58, s58, 73728
    buffer_load_dwordx4 v8, s[32:35], s58 offen nt lds
    s_add_u32 m0, m0, 1024
    s_add_u32 s58, s58, 73728
    buffer_load_dwordx4 v9, s[32:35], s58 offen nt lds
    s_add_u32 m0, m0, 1024
    s_add_u32 s58, s58, 73728
    buffer_load_dwordx4 v8, s[32:35], s58 offen nt lds
    s_add_u32 m0, m0, 1024
    s_add_u32 s58, s58, 73728
    buffer_load_dwordx4 v9, s[32:35], s58 offen nt lds
    v_bfe_u32 v7, v1, 2, 2
    v_bfe_u32 v8, v1, 1, 1
    v_lshl_add_u32 v9, v5, 3, v7
    v_lshlrev_b32 v9, 7, v9
    v_mul_u32_u24 v10, 73728, v8
    v_add_u32 v9, v9, v10
    v_lshrrev_b32 v7, 1, v7
    v_and_b32 v10, 1, v5
    v_lshl_add_u32 v7, v10, 1, v7
    v_lshl_add_u32 v7, v8, 2, v7
    v_xor_b32 v7, s3, v7
    v_lshl_add_u32 v9, v7, 4, v9
    v_and_b32 v7, 1, v1
    v_lshl_add_u32 v9, v7, 3, v9
    v_add_u32 v9, 2048, v9
    v_add_u32 v10, 36864, v9
    s_waitcnt vmcnt(0)
    s_barrier
    ds_read_b64_tr_b16 v[56:57], v9 offset:0
    ds_read_b64_tr_b16 v[58:59], v9 offset:512
    ds_read_b64_tr_b16 v[60:61], v9 offset:4096
    ds_read_b64_tr_b16 v[62:63], v9 offset:4608
    ds_read_b64_tr_b16 v[64:65], v9 offset:8192
    ds_read_b64_tr_b16 v[66:67], v9 offset:8704
    ds_read_b64_tr_b16 v[68:69], v9 offset:12288
    ds_read_b64_tr_b16 v[70:71], v9 offset:12800
    ds_read_b64_tr_b16 v[72:73], v9 offset:16384
    ds_read_b64_tr_b16 v[74:75], v9 offset:16896
    ds_read_b64_tr_b16 v[76:77], v9 offset:20480
    ds_read_b64_tr_b16 v[78:79], v9 offset:20992
    ds_read_b64_tr_b16 v[80:81], v9 offset:24576
    ds_read_b64_tr_b16 v[82:83], v9 offset:25088
    s_waitcnt lgkmcnt(12)
    ds_read_b64_tr_b16 v[84:85], v9 offset:28672
    ds_read_b64_tr_b16 v[86:87], v9 offset:29184
    s_waitcnt lgkmcnt(12)
    ds_read_b64_tr_b16 v[88:89], v9 offset:32768
    ds_read_b64_tr_b16 v[90:91], v9 offset:33280
    s_waitcnt lgkmcnt(12)
    ds_read_b64_tr_b16 v[92:93], v10 offset:0
    ds_read_b64_tr_b16 v[94:95], v10 offset:512
    s_waitcnt lgkmcnt(12)
    ds_read_b64_tr_b16 v[96:97], v10 offset:4096
    ds_read_b64_tr_b16 v[98:99], v10 offset:4608
    s_waitcnt lgkmcnt(12)
    ds_read_b64_tr_b16 v[100:101], v10 offset:8192
    ds_read_b64_tr_b16 v[102:103], v10 offset:8704
    s_waitcnt lgkmcnt(12)
    ds_read_b64_tr_b16 v[104:105], v10 offset:12288
    ds_read_b64_tr_b16 v[106:107], v10 offset:12800
    s_waitcnt lgkmcnt(12)
    ds_read_b64_tr_b16 v[108:109], v10 offset:16384
    ds_read_b64_tr_b16 v[110:111], v10 offset:16896
    s_waitcnt lgkmcnt(12)
    ds_read_b64_tr_b16 v[112:113], v10 offset:20480
    ds_read_b64_tr_b16 v[114:115], v10 offset:20992
    s_waitcnt lgkmcnt(12)
    ds_read_b64_tr_b16 v[116:117], v10 offset:24576
    ds_read_b64_tr_b16 v[118:119], v10 offset:25088
    s_waitcnt lgkmcnt(12)
    ds_read_b64_tr_b16 v[120:121], v10 offset:28672
    ds_read_b64_tr_b16 v[122:123], v10 offset:29184
    s_waitcnt lgkmcnt(12)
    ds_read_b64_tr_b16 v[124:125], v10 offset:32768
    ds_read_b64_tr_b16 v[126:127], v10 offset:33280
    v_lshlrev_b32 v7, 4, v1
    v_and_b32 v20, 31, v1
    v_lshlrev_b32 v21, 4, v20
    s_mul_i32 s38, s3, 1536
    s_add_u32 s38, s38, 6303744
    s_mul_i32 s39, s3, 1168
    v_mul_u32_u24 v22, 12, v1
    v_add_u32 v22, s39, v22
    v_mul_u32_u24 v23, 12, v20
    v_add_u32 v23, s39, v23
    v_and_b32 v6, 7, v1
    v_mul_u32_u24 v4, 1168, v6
    v_lshl_add_u32 v4, v5, 4, v4
    v_mul_u32_u24 v6, 144, v6
    v_and_b32 v20, 1, v5
    v_lshl_add_u32 v6, v20, 3, v6
    v_lshrrev_b32 v20, 1, v5
    v_lshl_add_u32 v6, v20, 2, v6
    s_lshl_b32 s39, s3, 4
    v_add_u32 v6, s39, v6
    s_mov_b32 s56, 0x00ff00ff
    s_mov_b32 s57, 0x00ff00ff
    s_waitcnt lgkmcnt(0)
    s_setprio 3
    s_barrier
    s_sleep 6
    s_mov_b32 s49, 0
P_17:
    buffer_load_dwordx4 v[12:15], v7, s[40:43], s38 offen sc1
    buffer_load_dwordx4 v[16:19], v21, s[40:43], s38 offen offset:1024 sc1
PC_19:
    s_add_u32 s49, s49, 1
    s_waitcnt vmcnt(0)
    v_cmp_ne_u32 vcc, s48, v15
    v_cmp_ne_u32 s[50:51], s48, v19
    s_nop 0
    s_or_b64 vcc, vcc, s[50:51]
    s_cbranch_vccz PD_18
    s_cmp_lt_u32 s49, 60000
    s_cbranch_scc1 P_17
PD_18:
    ds_write_b32 v22, v12 offset:2048
    ds_write_b32 v22, v13 offset:2052
    ds_write_b32 v22, v14 offset:2056
    ds_write_b32 v23, v16 offset:2816
    ds_write_b32 v23, v17 offset:2820
    ds_write_b32 v23, v18 offset:2824
    s_waitcnt lgkmcnt(0)
    s_barrier
    ds_read_b128 v[12:15], v4 offset:2048
    ds_read_b128 v[16:19], v4 offset:2112
    ds_read_b128 v[20:23], v4 offset:2176
    ds_read_b128 v[24:27], v4 offset:2240
    ds_read_b128 v[28:31], v4 offset:2304
    ds_read_b128 v[32:35], v4 offset:2368
    ds_read_b128 v[36:39], v4 offset:2432
    ds_read_b128 v[40:43], v4 offset:2496
    ds_read_b128 v[44:47], v4 offset:2560
    ds_read_b128 v[48:51], v4 offset:2624
    ds_read_b128 v[52:55], v4 offset:2688
    s_waitcnt lgkmcnt(10)
    v_mfma_f32_16x16x32_bf16 v[8:11], v[56:59], v[12:15], 0
    ds_read_b128 v[12:15], v4 offset:2752
    s_waitcnt lgkmcnt(10)
    v_mfma_f32_16x16x32_bf16 v[8:11], v[60:63], v[16:19], v[8:11]
    ds_read_b128 v[16:19], v4 offset:2816
    s_waitcnt lgkmcnt(10)
    v_mfma_f32_16x16x32_bf16 v[8:11], v[64:67], v[20:23], v[8:11]
    ds_read_b128 v[20:23], v4 offset:2880
    s_waitcnt lgkmcnt(10)
    v_mfma_f32_16x16x32_bf16 v[8:11], v[68:71], v[24:27], v[8:11]
    ds_read_b128 v[24:27], v4 offset:2944
    s_waitcnt lgkmcnt(10)
    v_mfma_f32_16x16x32_bf16 v[8:11], v[72:75], v[28:31], v[8:11]
    ds_read_b128 v[28:31], v4 offset:3008
    s_waitcnt lgkmcnt(10)
    v_mfma_f32_16x16x32_bf16 v[8:11], v[76:79], v[32:35], v[8:11]
    ds_read_b128 v[32:35], v4 offset:3072
    s_waitcnt lgkmcnt(10)
    v_mfma_f32_16x16x32_bf16 v[8:11], v[80:83], v[36:39], v[8:11]
    ds_read_b128 v[36:39], v4 offset:3136
    s_waitcnt lgkmcnt(10)
    v_mfma_f32_16x16x32_bf16 v[8:11], v[84:87], v[40:43], v[8:11]
    s_waitcnt lgkmcnt(9)
    v_mfma_f32_16x16x32_bf16 v[8:11], v[88:91], v[44:47], v[8:11]
    s_waitcnt lgkmcnt(8)
    v_mfma_f32_16x16x32_bf16 v[8:11], v[92:95], v[48:51], v[8:11]
    s_waitcnt lgkmcnt(7)
    v_mfma_f32_16x16x32_bf16 v[8:11], v[96:99], v[52:55], v[8:11]
    s_waitcnt lgkmcnt(6)
    v_mfma_f32_16x16x32_bf16 v[8:11], v[100:103], v[12:15], v[8:11]
    s_waitcnt lgkmcnt(5)
    v_mfma_f32_16x16x32_bf16 v[8:11], v[104:107], v[16:19], v[8:11]
    s_waitcnt lgkmcnt(4)
    v_mfma_f32_16x16x32_bf16 v[8:11], v[108:111], v[20:23], v[8:11]
    s_waitcnt lgkmcnt(3)
    v_mfma_f32_16x16x32_bf16 v[8:11], v[112:115], v[24:27], v[8:11]
    s_waitcnt lgkmcnt(2)
    v_mfma_f32_16x16x32_bf16 v[8:11], v[116:119], v[28:31], v[8:11]
    s_waitcnt lgkmcnt(1)
    v_mfma_f32_16x16x32_bf16 v[8:11], v[120:123], v[32:35], v[8:11]
    s_waitcnt lgkmcnt(0)
    v_mfma_f32_16x16x32_bf16 v[8:11], v[124:127], v[36:39], v[8:11]
    s_nop 7
    v_permlane32_swap_b32 v8, v10
    v_permlane32_swap_b32 v9, v11
    v_cvt_pk_bf16_f32 v12, v8, v9
    v_lshlrev_b32 v8, 16, v12
    v_and_b32 v9, 0xffff0000, v12
    v_cvt_pk_bf16_f32 v13, v10, v11
    v_lshlrev_b32 v10, 16, v13
    v_and_b32 v11, 0xffff0000, v13
    v_mul_f32 v12, 0xbfb8aa3b, v8
    v_mul_f32 v13, 0xbfb8aa3b, v9
    v_exp_f32 v12, v12
    v_exp_f32 v13, v13
    v_add_f32 v12, 1.0, v12
    v_add_f32 v13, 1.0, v13
    v_rcp_f32 v12, v12
    v_rcp_f32 v13, v13
    s_nop 0
    v_pk_mul_f32 v[8:9], v[8:9], v[12:13]
    v_cvt_pk_bf16_f32 v12, v8, v9
    v_lshlrev_b32 v8, 16, v12
    v_and_b32 v9, 0xffff0000, v12
    v_pk_mul_f32 v[8:9], v[8:9], v[10:11]
    v_cvt_pk_bf16_f32 v8, v8, v9
    s_mov_b64 exec, s[56:57]
    ds_write_b32 v6, v8 offset:11392
    s_mov_b64 exec, -1
    s_waitcnt lgkmcnt(0)
    s_barrier
    s_branch F_R
F_L2:
    s_cmp_ge_u32 s3, 14
    s_cbranch_scc1 F_E
    s_sub_u32 s45, s3, 8
    s_mul_i32 s56, s44, 73728
    s_mul_i32 s57, s45, 192
    s_add_u32 s56, s56, s57
    v_mul_u32_u24 v7, 9216, v5
    v_mul_u32_u24 v8, 12, v3
    v_add3_u32 v7, v7, v8, s56
    global_load_dwordx3 v[64:66], v7, s[26:27] offset:0 nt
    global_load_dwordx3 v[68:70], v7, s[26:27] offset:1152 nt
    global_load_dwordx3 v[72:74], v7, s[26:27] offset:2304 nt
    global_load_dwordx3 v[76:78], v7, s[26:27] offset:3456 nt
    v_add_u32 v7, 4608, v7
    global_load_dwordx3 v[80:82], v7, s[26:27] offset:0 nt
    global_load_dwordx3 v[84:86], v7, s[26:27] offset:1152 nt
    global_load_dwordx3 v[88:90], v7, s[26:27] offset:2304 nt
    global_load_dwordx3 v[92:94], v7, s[26:27] offset:3456 nt
    v_add_u32 v7, 32256, v7
    global_load_dwordx3 v[96:98], v7, s[26:27] offset:0 nt
    global_load_dwordx3 v[100:102], v7, s[26:27] offset:1152 nt
    global_load_dwordx3 v[104:106], v7, s[26:27] offset:2304 nt
    global_load_dwordx3 v[108:110], v7, s[26:27] offset:3456 nt
    v_add_u32 v7, 4608, v7
    global_load_dwordx3 v[112:114], v7, s[26:27] offset:0 nt
    global_load_dwordx3 v[116:118], v7, s[26:27] offset:1152 nt
    global_load_dwordx3 v[120:122], v7, s[26:27] offset:2304 nt
    global_load_dwordx3 v[124:126], v7, s[26:27] offset:3456 nt
    v_and_b32 v6, 7, v1
    v_mul_u32_u24 v4, 144, v6
    v_lshl_add_u32 v4, v5, 4, v4
    s_mov_b32 s58, 110592
    v_mul_lo_u32 v6, v6, s58
    v_lshl_add_u32 v6, v5, 4, v6
    s_mul_i32 s36, s45, 18432
    s_lshl_b32 s37, s44, 8
    s_add_u32 s36, s36, s37
    s_add_u32 s36, s36, 6332416
    s_mov_b32 s56, 0x05040100
    s_mov_b32 s57, 0x07060302
    s_barrier
    s_waitcnt vmcnt(0)
    v_perm_b32 v16, v68, v64, s56
    v_perm_b32 v17, v76, v72, s56
    v_perm_b32 v18, v84, v80, s56
    v_perm_b32 v19, v92, v88, s56
    v_perm_b32 v20, v68, v64, s57
    v_perm_b32 v21, v76, v72, s57
    v_perm_b32 v22, v84, v80, s57
    v_perm_b32 v23, v92, v88, s57
    v_perm_b32 v24, v69, v65, s56
    v_perm_b32 v25, v77, v73, s56
    v_perm_b32 v26, v85, v81, s56
    v_perm_b32 v27, v93, v89, s56
    v_perm_b32 v28, v69, v65, s57
    v_perm_b32 v29, v77, v73, s57
    v_perm_b32 v30, v85, v81, s57
    v_perm_b32 v31, v93, v89, s57
    v_perm_b32 v32, v70, v66, s56
    v_perm_b32 v33, v78, v74, s56
    v_perm_b32 v34, v86, v82, s56
    v_perm_b32 v35, v94, v90, s56
    v_perm_b32 v36, v70, v66, s57
    v_perm_b32 v37, v78, v74, s57
    v_perm_b32 v38, v86, v82, s57
    v_perm_b32 v39, v94, v90, s57
    v_perm_b32 v40, v100, v96, s56
    v_perm_b32 v41, v108, v104, s56
    v_perm_b32 v42, v116, v112, s56
    v_perm_b32 v43, v124, v120, s56
    v_perm_b32 v44, v100, v96, s57
    v_perm_b32 v45, v108, v104, s57
    v_perm_b32 v46, v116, v112, s57
    v_perm_b32 v47, v124, v120, s57
    v_perm_b32 v48, v101, v97, s56
    v_perm_b32 v49, v109, v105, s56
    v_perm_b32 v50, v117, v113, s56
    v_perm_b32 v51, v125, v121, s56
    v_perm_b32 v52, v101, v97, s57
    v_perm_b32 v53, v109, v105, s57
    v_perm_b32 v54, v117, v113, s57
    v_perm_b32 v55, v125, v121, s57
    v_perm_b32 v56, v102, v98, s56
    v_perm_b32 v57, v110, v106, s56
    v_perm_b32 v58, v118, v114, s56
    v_perm_b32 v59, v126, v122, s56
    v_perm_b32 v60, v102, v98, s57
    v_perm_b32 v61, v110, v106, s57
    v_perm_b32 v62, v118, v114, s57
    v_perm_b32 v63, v126, v122, s57
    v_mov_b32 v91, s48
    v_mov_b32 v95, s48
    v_mov_b32 v99, s48
    v_mov_b32 v103, s48
    s_mov_b32 s56, 0x00ff00ff
    s_mov_b32 s57, 0x00ff00ff
    s_setprio 3
    s_barrier
    s_barrier
    s_barrier
    ds_read_b128 v[8:11], v4 offset:11392
    ds_read_b128 v[12:15], v4 offset:11456
    s_waitcnt lgkmcnt(1)
    v_mfma_f32_16x16x32_bf16 v[64:67], v[16:19], v[8:11], 0
    v_mfma_f32_16x16x32_bf16 v[68:71], v[20:23], v[8:11], 0
    v_mfma_f32_16x16x32_bf16 v[72:75], v[24:27], v[8:11], 0
    v_mfma_f32_16x16x32_bf16 v[76:79], v[28:31], v[8:11], 0
    v_mfma_f32_16x16x32_bf16 v[80:83], v[32:35], v[8:11], 0
    v_mfma_f32_16x16x32_bf16 v[84:87], v[36:39], v[8:11], 0
    s_waitcnt lgkmcnt(0)
    v_mfma_f32_16x16x32_bf16 v[64:67], v[40:43], v[12:15], v[64:67]
    v_mfma_f32_16x16x32_bf16 v[68:71], v[44:47], v[12:15], v[68:71]
    v_mfma_f32_16x16x32_bf16 v[72:75], v[48:51], v[12:15], v[72:75]
    v_mfma_f32_16x16x32_bf16 v[76:79], v[52:55], v[12:15], v[76:79]
    v_mfma_f32_16x16x32_bf16 v[80:83], v[56:59], v[12:15], v[80:83]
    v_mfma_f32_16x16x32_bf16 v[84:87], v[60:63], v[12:15], v[84:87]
    s_mov_b64 exec, s[56:57]
    s_nop 2
    v_cvt_pk_bf16_f32 v88, v64, v68
    v_cvt_pk_bf16_f32 v92, v65, v69
    v_cvt_pk_bf16_f32 v96, v66, v70
    v_cvt_pk_bf16_f32 v100, v67, v71
    v_cvt_pk_bf16_f32 v89, v72, v76
    v_cvt_pk_bf16_f32 v93, v73, v77
    v_cvt_pk_bf16_f32 v97, v74, v78
    v_cvt_pk_bf16_f32 v101, v75, v79
    v_cvt_pk_bf16_f32 v90, v80, v84
    buffer_store_dwordx4 v[88:91], v6, s[40:43], s36 offen offset:0 sc1
    v_cvt_pk_bf16_f32 v94, v81, v85
    buffer_store_dwordx4 v[92:95], v6, s[40:43], s36 offen offset:64 sc1
    v_cvt_pk_bf16_f32 v98, v82, v86
    buffer_store_dwordx4 v[96:99], v6, s[40:43], s36 offen offset:128 sc1
    v_cvt_pk_bf16_f32 v102, v83, v87
    buffer_store_dwordx4 v[100:103], v6, s[40:43], s36 offen offset:192 sc1
    s_mov_b64 exec, -1
    s_branch F_R
F_E:
    s_cmp_eq_u32 s3, 15
    s_cbranch_scc1 F_E15
    s_barrier
    v_lshlrev_b32 v7, 4, v1
    s_lshl_b32 s38, s44, 5
    s_add_u32 s38, s38, 6295552
    s_mov_b64 exec, 1
    s_mov_b32 s49, 0
P_20:
    buffer_load_dwordx4 v[8:11], v7, s[40:43], s38 offen sc1
PC_22:
    s_add_u32 s49, s49, 1
    s_waitcnt vmcnt(0)
    v_cmp_ne_u32 vcc, s48, v11
    s_nop 0
    s_cbranch_vccz PD_21
    s_sleep 4
    s_cmp_lt_u32 s49, 60000
    s_cbranch_scc1 P_20
PD_21:
    s_mov_b64 exec, -1
    s_mov_b32 s38, 6295552
    s_mov_b32 s39, 6299648
    s_mov_b32 s49, 0
    buffer_load_dwordx4 v[8:11], v7, s[40:43], s38 offen offset:0 sc1
    buffer_load_dwordx4 v[12:15], v7, s[40:43], s38 offen offset:1024 sc1
    buffer_load_dwordx4 v[16:19], v7, s[40:43], s38 offen offset:2048 sc1
    buffer_load_dwordx4 v[20:23], v7, s[40:43], s38 offen offset:3072 sc1
    buffer_load_dwordx4 v[24:27], v7, s[40:43], s39 offen offset:0 sc1
    buffer_load_dwordx4 v[28:31], v7, s[40:43], s39 offen offset:1024 sc1
    buffer_load_dwordx4 v[32:35], v7, s[40:43], s39 offen offset:2048 sc1
    buffer_load_dwordx4 v[36:39], v7, s[40:43], s39 offen offset:3072 sc1
P_23:
    s_add_u32 s49, s49, 1
    s_waitcnt vmcnt(0)
    v_cmp_ne_u32 s[4:5], s48, v11
    v_cmp_ne_u32 s[6:7], s48, v15
    v_cmp_ne_u32 s[8:9], s48, v19
    v_cmp_ne_u32 s[10:11], s48, v23
    v_cmp_ne_u32 s[12:13], s48, v27
    v_cmp_ne_u32 s[14:15], s48, v31
    v_cmp_ne_u32 s[16:17], s48, v35
    v_cmp_ne_u32 s[18:19], s48, v39
    s_or_b64 s[50:51], s[4:5], s[6:7]
    s_or_b64 s[50:51], s[50:51], s[8:9]
    s_or_b64 s[50:51], s[50:51], s[10:11]
    s_or_b64 s[50:51], s[50:51], s[12:13]
    s_or_b64 s[50:51], s[50:51], s[14:15]
    s_or_b64 s[50:51], s[50:51], s[16:17]
    s_or_b64 s[50:51], s[50:51], s[18:19]
    s_cbranch_scc0 PD_24
    s_sleep 1
    s_wqm_b64 exec, s[4:5]
    s_cbranch_execz PS_25
    buffer_load_dwordx4 v[8:11], v7, s[40:43], s38 offen offset:0 sc1
PS_25:
    s_wqm_b64 exec, s[6:7]
    s_cbranch_execz PS_26
    buffer_load_dwordx4 v[12:15], v7, s[40:43], s38 offen offset:1024 sc1
PS_26:
    s_wqm_b64 exec, s[8:9]
    s_cbranch_execz PS_27
    buffer_load_dwordx4 v[16:19], v7, s[40:43], s38 offen offset:2048 sc1
PS_27:
    s_wqm_b64 exec, s[10:11]
    s_cbranch_execz PS_28
    buffer_load_dwordx4 v[20:23], v7, s[40:43], s38 offen offset:3072 sc1
PS_28:
    s_wqm_b64 exec, s[12:13]
    s_cbranch_execz PS_29
    buffer_load_dwordx4 v[24:27], v7, s[40:43], s39 offen offset:0 sc1
PS_29:
    s_wqm_b64 exec, s[14:15]
    s_cbranch_execz PS_30
    buffer_load_dwordx4 v[28:31], v7, s[40:43], s39 offen offset:1024 sc1
PS_30:
    s_wqm_b64 exec, s[16:17]
    s_cbranch_execz PS_31
    buffer_load_dwordx4 v[32:35], v7, s[40:43], s39 offen offset:2048 sc1
PS_31:
    s_wqm_b64 exec, s[18:19]
    s_cbranch_execz PS_32
    buffer_load_dwordx4 v[36:39], v7, s[40:43], s39 offen offset:3072 sc1
PS_32:
    s_mov_b64 exec, -1
    s_cmp_lt_u32 s49, 60000
    s_cbranch_scc1 P_23
    s_waitcnt vmcnt(0)
PD_24:
    s_barrier
    s_barrier
    s_barrier
    s_branch F_R
F_E15:
    s_mov_b32 s32, s28
    s_and_b32 s33, s29, 0xffff
    s_mov_b32 s34, 0x00240000
    s_mov_b32 s35, 0x00020000
    s_mul_i32 s56, s44, 43
    s_lshr_b32 s56, s56, 8
    s_min_u32 s56, s56, 7
    s_mul_i32 s57, s56, 6
    s_sub_u32 s57, s44, s57
    s_min_u32 s57, s57, 5
    v_and_b32 v12, 3, v1
    v_bfe_u32 v13, v1, 2, 2
    v_lshl_add_u32 v12, v12, 2, v13
    s_lshl_b32 s57, s57, 4
    v_add_u32 v13, s57, v12
    v_mul_u32_u24 v12, 12, v13
    v_lshrrev_b32 v14, 1, v5
    v_lshl_add_u32 v12, v14, 1, v12
    v_add_u32 v25, 8, v12
    v_and_b32 v15, 1, v5
    v_lshl_add_u32 v12, v15, 2, v12
    v_lshlrev_b32 v13, 4, v13
    v_cmp_eq_u32 s[46:47], 1, v15
    v_mov_b32 v15, 1536
    v_lshlrev_b32 v14, 4, v14
    s_lshl_b32 s38, s56, 11
    s_add_u32 s38, s38, 6316032
    s_mul_i32 s57, s56, 1168
    v_add_u32 v26, s57, v12
    v_add_u32 v27, s57, v25
    v_lshlrev_b32 v11, 3, v1
    s_barrier
    s_barrier
    s_barrier
    s_cmp_ge_u32 s44, 48
    s_cbranch_scc1 FIN
    buffer_load_dwordx4 v[16:19], v13, s[40:43], s38 offen sc1
    buffer_load_dwordx4 v[20:23], v15, s[40:43], s38 offen sc1
    ds_read_u16 v26, v26 offset:2048
    ds_read_u16 v27, v27 offset:2048
    s_barrier
    s_mov_b32 s49, 0
    s_branch PC_35
P_33:
    buffer_load_dwordx4 v[16:19], v13, s[40:43], s38 offen sc1
    buffer_load_dwordx4 v[20:23], v15, s[40:43], s38 offen sc1
PC_35:
    s_add_u32 s49, s49, 1
    s_waitcnt vmcnt(0)
    v_cmp_ne_u32 vcc, s48, v19
    v_cmp_ne_u32 s[50:51], s48, v23
    s_nop 0
    s_or_b64 vcc, vcc, s[50:51]
    s_cbranch_vccz PD_34
    s_cmp_lt_u32 s49, 60000
    s_cbranch_scc1 P_33
PD_34:
    v_cndmask_b32 v16, v16, v17, s[46:47]
    v_lshrrev_b32 v16, v14, v16
    v_lshrrev_b32 v17, v14, v18
    v_lshlrev_b32 v16, 16, v16
    v_lshlrev_b32 v17, 16, v17
    v_readfirstlane_b32 s45, v20
    s_nop 0
    s_lshr_b32 s56, s45, 16
    s_xor_b32 s57, s56, 0x8000
    s_xor_b32 s58, s56, 0xffff
    s_bitcmp1_b32 s56, 15
    s_cselect_b32 s56, s57, s58
    s_lshl_b32 s56, s56, 16
    v_mov_b32 v18, 0xbfb8aa3b
    v_mul_f32 v18, s56, v18
    v_exp_f32 v18, v18
    s_and_b32 s45, s45, 0x7ff
    s_sub_u32 s45, 0x7ff, s45
    s_mul_i32 s45, s45, 1152
    v_add_f32 v18, 1.0, v18
    v_rcp_f32 v18, v18
    s_waitcnt lgkmcnt(0)
    v_lshlrev_b32 v26, 16, v26
    v_lshlrev_b32 v27, 16, v27
    v_cvt_pk_bf16_f32 v18, v18, v18
    v_lshlrev_b32 v18, 16, v18
    s_setprio 3
    s_barrier
    s_barrier
    ds_read_b64 v[32:33], v11 offset:12544
    ds_read_b64 v[34:35], v11 offset:13056
    ds_read_b64 v[36:37], v11 offset:13568
    ds_read_b64 v[38:39], v11 offset:14080
    ds_read_b64 v[40:41], v11 offset:14592
    ds_read_b64 v[42:43], v11 offset:15104
    ds_read_b64 v[44:45], v11 offset:15616
    ds_read_b64 v[46:47], v11 offset:16128
    ds_read_b64 v[48:49], v11 offset:16640
    s_waitcnt lgkmcnt(7)
    v_pk_add_f32 v[32:33], v[32:33], v[34:35]
    s_waitcnt lgkmcnt(5)
    v_pk_add_f32 v[36:37], v[36:37], v[38:39]
    s_waitcnt lgkmcnt(3)
    v_pk_add_f32 v[40:41], v[40:41], v[42:43]
    s_waitcnt lgkmcnt(1)
    v_pk_add_f32 v[44:45], v[44:45], v[46:47]
    v_pk_add_f32 v[32:33], v[32:33], v[36:37]
    v_pk_add_f32 v[40:41], v[40:41], v[44:45]
    s_waitcnt lgkmcnt(0)
    v_pk_add_f32 v[32:33], v[32:33], v[48:49]
    v_pk_add_f32 v[32:33], v[32:33], v[40:41]
    v_cvt_pk_bf16_f32 v34, v32, v33
    v_lshlrev_b32 v32, 16, v34
    v_and_b32 v33, 0xffff0000, v34
    v_pk_mul_f32 v[32:33], v[32:33], v[18:19] op_sel_hi:[1,0]
    v_cvt_pk_bf16_f32 v34, v32, v33
    v_lshlrev_b32 v32, 16, v34
    v_and_b32 v33, 0xffff0000, v34
    v_pk_add_f32 v[32:33], v[32:33], v[26:27]
    v_cvt_pk_bf16_f32 v34, v32, v33
    v_lshlrev_b32 v32, 16, v34
    v_and_b32 v33, 0xffff0000, v34
    v_pk_add_f32 v[32:33], v[32:33], v[16:17]
    v_cvt_pk_bf16_f32 v32, v32, v33
    buffer_store_short v32, v12, s[32:35], s45 offen
    s_mov_b32 exec_lo, 0xffff
    s_mov_b32 exec_hi, 0xffff
    buffer_store_short_d16_hi v32, v25, s[32:35], s45 offen
    s_cmp_lg_u32 s44, 0
    s_cbranch_scc1 F_NE
    s_mov_b64 exec, 1
    v_mov_b32 v6, 0
    v_mov_b32 v7, s48
    buffer_store_dword v7, v6, s[40:43], 0 offen sc1
F_NE:
    s_mov_b64 exec, -1
    s_branch FIN
F_R:
    s_cmp_ge_u32 s44, 48
    s_cbranch_scc1 FIN
    s_min_u32 s45, s3, 8
    s_lshl_b32 s39, s45, 11
    s_mul_i32 s38, s44, 18432
    s_add_u32 s38, s38, s39
    s_add_u32 s38, s38, 6332416
    v_lshlrev_b32 v10, 4, v1
    s_lshl_b32 s39, s45, 9
    v_lshl_add_u32 v11, v1, 3, s39
    s_waitcnt vmcnt(0)
    s_barrier
    s_sub_u32 s39, s3, 8
    s_cmp_lt_u32 s39, 6
    s_cbranch_scc1 FIN
    s_mov_b32 s49, 0
    buffer_load_dwordx4 v[32:35], v10, s[40:43], s38 offen offset:0 sc1
    buffer_load_dwordx4 v[36:39], v10, s[40:43], s38 offen offset:1024 sc1
P_36:
    s_add_u32 s49, s49, 1
    s_waitcnt vmcnt(0)
    v_cmp_ne_u32 s[4:5], s48, v35
    v_cmp_ne_u32 s[6:7], s48, v39
    s_nop 0
    s_or_b64 s[50:51], s[4:5], s[6:7]
    s_cbranch_scc0 PD_37
    s_wqm_b64 exec, s[4:5]
    s_cbranch_execz PS_38
    buffer_load_dwordx4 v[32:35], v10, s[40:43], s38 offen offset:0 sc1
PS_38:
    s_wqm_b64 exec, s[6:7]
    s_cbranch_execz PS_39
    buffer_load_dwordx4 v[36:39], v10, s[40:43], s38 offen offset:1024 sc1
PS_39:
    s_mov_b64 exec, -1
    s_cmp_lt_u32 s49, 60000
    s_cbranch_scc1 P_36
    s_waitcnt vmcnt(0)
PD_37:
    v_lshlrev_b32 v12, 16, v32
    v_and_b32 v13, 0xffff0000, v32
    v_lshlrev_b32 v14, 16, v33
    v_and_b32 v15, 0xffff0000, v33
    v_lshlrev_b32 v16, 16, v34
    v_and_b32 v17, 0xffff0000, v34
    v_lshlrev_b32 v18, 16, v36
    v_and_b32 v19, 0xffff0000, v36
    v_lshlrev_b32 v20, 16, v37
    v_and_b32 v21, 0xffff0000, v37
    v_lshlrev_b32 v22, 16, v38
    v_and_b32 v23, 0xffff0000, v38
    v_pk_add_f32 v[12:13], v[12:13], v[18:19]
    v_pk_add_f32 v[14:15], v[14:15], v[20:21]
    v_pk_add_f32 v[16:17], v[16:17], v[22:23]
    v_permlane32_swap_b32 v12, v13
    v_permlane32_swap_b32 v14, v15
    v_permlane32_swap_b32 v16, v17
    v_add_f32 v12, v12, v13
    v_add_f32 v14, v14, v15
    v_add_f32 v13, v16, v17
    v_add_f32 v15, v16, v17
    v_permlane16_swap_b32 v12, v14
    s_nop 0
    v_permlane16_swap_b32 v13, v15
    v_pk_add_f32 v[12:13], v[12:13], v[14:15]
    ds_write_b64 v11, v[12:13] offset:12544
    s_waitcnt lgkmcnt(0)
    s_barrier
FIN:
END:
    s_endpgm
.section .rodata,"a"
.p2align 6
.amdhsa_kernel sequential_preLN__ssm_conv_s4d__moe_arch_mod__prompt_kernel
  .amdhsa_next_free_vgpr 128
  .amdhsa_next_free_sgpr 102
  .amdhsa_accum_offset 128
  .amdhsa_group_segment_fixed_size 0
  .amdhsa_kernarg_size 120
  .amdhsa_user_sgpr_count 2
  .amdhsa_user_sgpr_kernarg_segment_ptr 1
  .amdhsa_system_sgpr_workgroup_id_x 1
.end_amdhsa_kernel
.text
```

```asm
; @launch grid=(256,1,1) block=(1024,1,1) lds=149504
.amdgcn_target "amdgcn-amd-amdhsa--gfx950"
.text
.globl sequential_preLN__ssm_conv_s4d__moe_arch_mod__prompt_kernel
.p2align 8
.type sequential_preLN__ssm_conv_s4d__moe_arch_mod__prompt_kernel,@function
sequential_preLN__ssm_conv_s4d__moe_arch_mod__prompt_kernel:
KSTART:
    s_cmp_ge_u32 s2, 256
    s_cbranch_scc1 END
    s_load_dwordx16 s[4:19], s[0:1], 0
    s_load_dwordx2 s[30:31], s[0:1], 112
    s_load_dwordx8 s[20:27], s[0:1], 64
    s_load_dwordx2 s[28:29], s[0:1], 96
    v_lshrrev_b32 v2, 6, v0
    v_and_b32 v3, 15, v0
    v_readfirstlane_b32 s3, v2
    v_bfe_u32 v5, v0, 4, 2
    v_and_b32 v1, 63, v0
    s_cmp_ge_u32 s3, 4
    s_cbranch_scc1 KLOAD
    s_setprio 3
    v_add_u32 v20, -128, v0
    v_ashrrev_i32 v20, 31, v20
    v_lshlrev_b32 v21, 2, v0
    ds_write_b32 v21, v20
    v_mad_u32_u24 v4, v2, 48, v3
    v_mul_u32_u24 v6, 6, v4
    v_and_b32 v6, -4, v6
    s_mul_i32 s32, s2, 9216
    v_mul_u32_u24 v7, 2304, v5
    v_add3_u32 v7, v7, v6, s32
    v_mov_b32 v62, 0
    s_waitcnt lgkmcnt(0)
    global_load_dwordx2 v[8:9], v7, s[4:5] offset:0
    global_load_dwordx2 v[10:11], v7, s[4:5] offset:1152
    global_load_dwordx2 v[12:13], v7, s[4:5] offset:96
    global_load_dwordx2 v[14:15], v7, s[4:5] offset:1248
    global_load_dwordx2 v[16:17], v7, s[4:5] offset:192
    global_load_dwordx2 v[18:19], v7, s[4:5] offset:1344
    global_load_dword v51, v62, s[30:31]
    s_barrier
    s_branch LNMAIN
KLOAD:
    s_cmp_lt_u32 s2, 192
    s_cbranch_scc1 KL1
    s_getpc_b64 s[56:57]
F_PC:
    v_add_u32 v8, -256, v0
    v_lshlrev_b32 v8, 6, v8
    v_min_u32 v8, END-F_PC, v8
    v_mov_b32 v9, 0
    v_lshl_add_u64 v[8:9], v[8:9], 0, s[56:57]
    global_load_dword v2, v[8:9], off
    s_barrier
    s_branch FFN_CK
KL1:
    s_sub_u32 s32, s3, 4
    s_lshr_b32 s33, s32, 2
    s_add_u32 s39, s32, s33
    s_mul_i32 s34, s2, 3
    s_add_u32 s34, s34, s33
    s_lshl_b32 s35, s34, 8
    v_lshl_add_u32 v13, v1, 2, s35
    s_and_b32 s36, s39, 1
    s_lshl_b32 s36, s36, 7
    s_add_u32 s35, s35, s36
    v_lshl_add_u32 v12, v1, 1, s35
    s_lshl_b32 s35, s34, 1
    v_mov_b32 v15, s35
    s_waitcnt lgkmcnt(0)
    global_load_ushort v41, v15, s[14:15]
    global_load_ushort v44, v12, s[6:7]
    global_load_ushort v45, v12, s[8:9]
    s_bitcmp1_b32 s39, 1
    s_cbranch_scc1 KL2
    global_load_dword v42, v13, s[10:11]
    global_load_dword v43, v13, s[12:13]
    global_load_ushort v46, v12, s[10:11]
    global_load_ushort v47, v12, s[12:13]
KL2:
    s_barrier
    s_load_dword s48, s[30:31], 0
    s_mov_b32 s40, s30
    s_and_b32 s41, s31, 0xffff
    s_mov_b32 s42, 0x10000000
    s_mov_b32 s43, 0x00020000
    s_setprio 1
    s_and_b32 s39, s39, 3
    v_mov_b32 v16, 0
    v_mov_b32 v17, 0
    v_mov_b32 v18, 0
    v_mov_b32 v19, 0
    s_and_b32 s56, s3, 3
    s_lshr_b32 s57, s32, 3
    s_sub_u32 s46, s32, s57
    s_cmp_eq_u32 s56, 3
    s_cselect_b32 s47, 2, 0
    s_cselect_b32 s46, s33, s46
    s_cmp_lt_u32 s32, 3
    s_cselect_b32 s47, 1, s47
    s_and_b32 s38, s32, 3
    s_mul_i32 s56, s33, 29376
    s_add_u32 s56, s56, 2048
    s_mul_i32 s57, s33, 5696
    s_add_u32 s57, s57, 90176
    v_and_b32 v14, 255, v0
    v_cmp_gt_u32 vcc, 100, v14
    v_lshl_add_u32 v14, v14, 4, s57
    ds_write_b128 v14, v[16:19]
    s_mul_i32 s58, s33, 4608
    s_add_u32 s58, s58, 107264
    v_lshl_add_u32 v15, v1, 4, s58
    s_mov_b64 exec, vcc
    ds_write_b128 v14, v[16:19] offset:4096
    s_mov_b64 exec, 0x3fffffff
    ds_write_b128 v15, v[16:19]
    s_mov_b64 exec, -1
    s_and_b32 s58, s38, 1
    s_lshl_b32 s59, s58, 4
    s_add_u32 s59, s59, 22
    v_add_u32 v14, s59, v3
    v_mul_u32_u24 v14, 544, v14
    v_lshl_add_u32 v15, v5, 4, s56
    v_and_b32 v16, 3, v1
    v_mul_u32_u24 v16, 1218, v16
    v_add_u32 v16, s57, v16
    s_cmp_ge_u32 s38, 2
    s_cbranch_scc1 CC_T
    s_mov_b32 s52, 0x45670123
    s_mov_b32 s53, 0xabcc89aa
    v_lshlrev_b32 v17, 2, v3
    v_lshrrev_b64 v[18:19], v17, s[52:53]
    v_and_b32 v18, 15, v18
    v_mul_u32_u24 v18, 544, v18
    v_add_u32 v8, v18, v15
    v_add_u32 v9, v14, v15
    s_lshl_b32 s58, s58, 8
    s_sub_u32 s58, s57, s58
    s_add_u32 s58, s58, 1080
    v_and_b32 v17, 1, v5
    v_lshlrev_b32 v17, 3, v17
    v_lshl_add_u32 v17, v3, 4, v17
    v_lshrrev_b32 v18, 1, v5
    v_lshl_add_u32 v17, v18, 9, v17
    v_sub_u32 v10, s58, v17
    v_bfe_u32 v17, v1, 2, 1
    v_lshlrev_b32 v17, 1, v17
    v_sub_u32 v11, v16, v17
    v_add_u32 v11, 62, v11
    s_branch CC_2
CC_T:
    v_min_u32 v18, 8, v3
    v_add_u32 v18, 13, v18
    v_mul_u32_u24 v18, 544, v18
    v_add_u32 v9, v18, v15
    v_add_u32 v8, v14, v15
    v_and_b32 v17, 1, v3
    v_lshlrev_b32 v17, 8, v17
    v_lshrrev_b32 v18, 1, v3
    v_lshl_add_u32 v17, v18, 6, v17
    v_lshlrev_b32 v18, 6, v3
    v_add_u32 v18, 256, v18
    v_cmp_lt_u32 vcc, 3, v3
    s_nop 1
    v_cndmask_b32 v17, v17, v18, vcc
    s_lshl_b32 s58, s58, 5
    s_add_u32 s58, s58, s57
    s_add_u32 s58, s58, 4928
    v_lshl_add_u32 v17, v5, 3, v17
    v_add_u32 v10, s58, v17
    v_add_u32 v11, 1088, v16
CC_2:
    s_and_b32 s58, s39, 1
    s_lshl_b32 s58, s58, 8
    s_add_u32 s58, s58, s56
    s_mov_b32 m0, s58
    s_cmp_eq_u32 s47, 0
    s_cbranch_scc1 CC_END
    s_mul_i32 s57, s46, 5696
    s_add_u32 s57, s57, 90176
    s_mul_i32 s58, s46, 10608
    s_add_u32 s58, s58, 16296
    v_and_b32 v16, 3, v3
    v_mul_u32_u24 v17, 1218, v16
    v_lshlrev_b32 v18, 3, v5
    v_sub_u32 v18, v18, v3
    v_lshl_add_u32 v17, v18, 1, v17
    v_add3_u32 v127, v17, s57, 32
    s_mul_i32 s59, s46, 4608
    s_add_u32 s59, s59, 107264
    v_lshlrev_b32 v17, 5, v3
    v_lshl_add_u32 v17, v5, 4, v17
    v_add_u32 v126, s59, v17
    v_lshlrev_b32 v17, 1, v5
    v_sub_u32 v17, v3, v17
    s_add_u32 s59, s57, 4892
    v_lshl_add_u32 v125, v17, 2, s59
    v_bfe_u32 v19, v1, 2, 1
    v_bfe_u32 v20, v1, 3, 1
    v_lshl_add_u32 v21, v16, 3, s58
    v_mul_u32_u24 v17, 3192, v20
    v_lshlrev_b32 v22, 4, v19
    v_sub_u32 v17, v17, v22
    v_lshl_add_u32 v17, v5, 6, v17
    v_add3_u32 v124, v17, v21, -8
    s_mul_i32 s59, s46, 4736
    v_mul_u32_u24 v17, 144, v5
    v_lshl_add_u32 v17, v3, 3, v17
    v_add_u32 v123, s59, v17
    s_cmp_eq_u32 s47, 2
    s_cbranch_scc1 CC_END
    v_lshlrev_b32 v17, 2, v5
    v_sub_u32 v17, v3, v17
    s_add_u32 s59, s57, 5428
    v_lshl_add_u32 v122, v17, 2, s59
    v_mul_u32_u24 v17, 2112, v19
    v_lshl_add_u32 v17, v20, 5, v17
    v_lshl_add_u32 v17, v5, 7, v17
    v_add_u32 v17, 6384, v17
    v_add_u32 v121, v17, v21
    s_add_u32 s59, s57, 5308
    v_mov_b32 v120, s59
    s_mov_b32 s52, -1
    s_mov_b32 s53, 0
    v_sub_u32 v17, 14, v18
    v_med3_i32 v17, v17, 0, 4
    v_lshlrev_b32 v17, 4, v17
    v_lshlrev_b64 v[22:23], v17, s[52:53]
    v_mov_b32 v116, v23
    v_sub_u32 v17, 12, v18
    v_med3_i32 v17, v17, 0, 4
    v_lshlrev_b32 v17, 4, v17
    v_lshlrev_b64 v[22:23], v17, s[52:53]
    v_mov_b32 v117, v23
    v_sub_u32 v17, 10, v18
    v_med3_i32 v17, v17, 0, 4
    v_lshlrev_b32 v17, 4, v17
    v_lshlrev_b64 v[22:23], v17, s[52:53]
    v_mov_b32 v118, v23
    v_sub_u32 v17, 8, v18
    v_med3_i32 v17, v17, 0, 4
    v_lshlrev_b32 v17, 4, v17
    v_lshlrev_b64 v[22:23], v17, s[52:53]
    v_mov_b32 v119, v23
CC_END:
    s_waitcnt vmcnt(0)
    v_lshlrev_b32 v41, 16, v41
    v_lshlrev_b32 v44, 16, v44
    v_mul_f32 v41, 0x3fb8aa3b, v41
    v_mul_f32 v44, 0x3fb8aa3b, v44
    v_exp_f32 v41, v41
    v_exp_f32 v44, v44
    v_lshlrev_b32 v45, 16, v45
    v_mul_f32 v45, 0.15915494, v45
    v_cvt_pk_bf16_f32 v14, v41, v44
    v_lshlrev_b32 v41, 16, v14
    v_and_b32 v44, 0xffff0000, v14
    v_mul_f32 v13, v45, v41
    v_mul_f32 v44, v44, v41
    v_rndne_f32 v14, v13
    v_mul_f32 v12, 0xbfb8aa3b, v44
    v_sub_f32 v13, v13, v14
    s_bitcmp0_b32 s39, 1
    s_cbranch_scc1 KG_A
    v_mul_f32 v14, 0x41000000, v12
    v_mul_f32 v15, 0x41000000, v13
    v_exp_f32 v14, v14
    v_cos_f32 v32, v15
    v_sin_f32 v33, v15
    v_mul_f32 v32, v32, v14
    v_mul_f32 v33, v33, v14
    v_mov_b32 v16, 0x3c00
    ds_write_addtid_b32 v16 offset:11968
    v_pk_mul_f32 v[36:37], v[32:33], v[32:33] op_sel:[0,0] op_sel_hi:[1,0]
    v_pk_fma_f32 v[36:37], v[32:33], v[32:33], v[36:37] op_sel:[1,1,0] op_sel_hi:[0,1,1] neg_lo:[1,0,0]
    v_cvt_pk_f16_f32 v17, v32, v33
    ds_write_addtid_b32 v17 offset:12512
    v_pk_mul_f32 v[34:35], v[36:37], v[32:33] op_sel:[0,0] op_sel_hi:[1,0]
    v_pk_fma_f32 v[34:35], v[36:37], v[32:33], v[34:35] op_sel:[1,1,0] op_sel_hi:[0,1,1] neg_lo:[1,0,0]
    v_cvt_pk_f16_f32 v18, v36, v37
    ds_write_addtid_b32 v18 offset:13056
    v_pk_mul_f32 v[36:37], v[34:35], v[32:33] op_sel:[0,0] op_sel_hi:[1,0]
    v_pk_fma_f32 v[36:37], v[34:35], v[32:33], v[36:37] op_sel:[1,1,0] op_sel_hi:[0,1,1] neg_lo:[1,0,0]
    v_cvt_pk_f16_f32 v19, v34, v35
    ds_write_addtid_b32 v19 offset:13600
    v_pk_mul_f32 v[34:35], v[36:37], v[32:33] op_sel:[0,0] op_sel_hi:[1,0]
    v_pk_fma_f32 v[34:35], v[36:37], v[32:33], v[34:35] op_sel:[1,1,0] op_sel_hi:[0,1,1] neg_lo:[1,0,0]
    v_cvt_pk_f16_f32 v20, v36, v37
    ds_write_addtid_b32 v20 offset:14144
    v_pk_mul_f32 v[36:37], v[34:35], v[32:33] op_sel:[0,0] op_sel_hi:[1,0]
    v_pk_fma_f32 v[36:37], v[34:35], v[32:33], v[36:37] op_sel:[1,1,0] op_sel_hi:[0,1,1] neg_lo:[1,0,0]
    v_cvt_pk_f16_f32 v21, v34, v35
    ds_write_addtid_b32 v21 offset:14688
    v_pk_mul_f32 v[34:35], v[36:37], v[32:33] op_sel:[0,0] op_sel_hi:[1,0]
    v_pk_fma_f32 v[34:35], v[36:37], v[32:33], v[34:35] op_sel:[1,1,0] op_sel_hi:[0,1,1] neg_lo:[1,0,0]
    v_cvt_pk_f16_f32 v22, v36, v37
    ds_write_addtid_b32 v22 offset:15232
    v_pk_mul_f32 v[36:37], v[34:35], v[32:33] op_sel:[0,0] op_sel_hi:[1,0]
    v_pk_fma_f32 v[36:37], v[34:35], v[32:33], v[36:37] op_sel:[1,1,0] op_sel_hi:[0,1,1] neg_lo:[1,0,0]
    v_cvt_pk_f16_f32 v23, v34, v35
    ds_write_addtid_b32 v23 offset:15776
    v_pk_mul_f32 v[34:35], v[36:37], v[32:33] op_sel:[0,0] op_sel_hi:[1,0]
    v_pk_fma_f32 v[34:35], v[36:37], v[32:33], v[34:35] op_sel:[1,1,0] op_sel_hi:[0,1,1] neg_lo:[1,0,0]
    v_cvt_pk_f16_f32 v24, v36, v37
    ds_write_addtid_b32 v24 offset:16320
    v_pk_mul_f32 v[36:37], v[34:35], v[32:33] op_sel:[0,0] op_sel_hi:[1,0]
    v_pk_fma_f32 v[36:37], v[34:35], v[32:33], v[36:37] op_sel:[1,1,0] op_sel_hi:[0,1,1] neg_lo:[1,0,0]
    v_cvt_pk_f16_f32 v25, v34, v35
    ds_write_addtid_b32 v25 offset:16864
    v_pk_mul_f32 v[34:35], v[36:37], v[32:33] op_sel:[0,0] op_sel_hi:[1,0]
    v_pk_fma_f32 v[34:35], v[36:37], v[32:33], v[34:35] op_sel:[1,1,0] op_sel_hi:[0,1,1] neg_lo:[1,0,0]
    v_cvt_pk_f16_f32 v26, v36, v37
    ds_write_addtid_b32 v26 offset:17408
    v_pk_mul_f32 v[36:37], v[34:35], v[32:33] op_sel:[0,0] op_sel_hi:[1,0]
    v_pk_fma_f32 v[36:37], v[34:35], v[32:33], v[36:37] op_sel:[1,1,0] op_sel_hi:[0,1,1] neg_lo:[1,0,0]
    v_cvt_pk_f16_f32 v27, v34, v35
    ds_write_addtid_b32 v27 offset:17952
    v_pk_mul_f32 v[34:35], v[36:37], v[32:33] op_sel:[0,0] op_sel_hi:[1,0]
    v_pk_fma_f32 v[34:35], v[36:37], v[32:33], v[34:35] op_sel:[1,1,0] op_sel_hi:[0,1,1] neg_lo:[1,0,0]
    v_cvt_pk_f16_f32 v28, v36, v37
    ds_write_addtid_b32 v28 offset:18496
    v_pk_mul_f32 v[36:37], v[34:35], v[32:33] op_sel:[0,0] op_sel_hi:[1,0]
    v_pk_fma_f32 v[36:37], v[34:35], v[32:33], v[36:37] op_sel:[1,1,0] op_sel_hi:[0,1,1] neg_lo:[1,0,0]
    v_cvt_pk_f16_f32 v29, v34, v35
    ds_write_addtid_b32 v29 offset:19040
    v_pk_mul_f32 v[34:35], v[36:37], v[32:33] op_sel:[0,0] op_sel_hi:[1,0]
    v_pk_fma_f32 v[34:35], v[36:37], v[32:33], v[34:35] op_sel:[1,1,0] op_sel_hi:[0,1,1] neg_lo:[1,0,0]
    v_cvt_pk_f16_f32 v30, v36, v37
    ds_write_addtid_b32 v30 offset:19584
    v_pk_mul_f32 v[36:37], v[34:35], v[32:33] op_sel:[0,0] op_sel_hi:[1,0]
    v_pk_fma_f32 v[36:37], v[34:35], v[32:33], v[36:37] op_sel:[1,1,0] op_sel_hi:[0,1,1] neg_lo:[1,0,0]
    v_cvt_pk_f16_f32 v31, v34, v35
    ds_write_addtid_b32 v31 offset:20128
    v_cvt_pk_f16_f32 v38, v36, v37
    ds_write_addtid_b32 v38 offset:20672
    v_pk_mul_f16 v33, v17, v38 op_sel:[0,0] op_sel_hi:[1,0]
    v_pk_fma_f16 v33, v17, v38, v33 op_sel:[1,1,0] op_sel_hi:[0,1,1] neg_lo:[1,0,0]
    ds_write_addtid_b32 v33 offset:21216
    v_pk_mul_f16 v34, v18, v38 op_sel:[0,0] op_sel_hi:[1,0]
    v_pk_fma_f16 v34, v18, v38, v34 op_sel:[1,1,0] op_sel_hi:[0,1,1] neg_lo:[1,0,0]
    ds_write_addtid_b32 v34 offset:21760
    v_pk_mul_f16 v35, v19, v38 op_sel:[0,0] op_sel_hi:[1,0]
    v_pk_fma_f16 v35, v19, v38, v35 op_sel:[1,1,0] op_sel_hi:[0,1,1] neg_lo:[1,0,0]
    ds_write_addtid_b32 v35 offset:22304
    v_pk_mul_f16 v32, v20, v38 op_sel:[0,0] op_sel_hi:[1,0]
    v_pk_fma_f16 v32, v20, v38, v32 op_sel:[1,1,0] op_sel_hi:[0,1,1] neg_lo:[1,0,0]
    ds_write_addtid_b32 v32 offset:22848
    v_pk_mul_f16 v33, v21, v38 op_sel:[0,0] op_sel_hi:[1,0]
    v_pk_fma_f16 v33, v21, v38, v33 op_sel:[1,1,0] op_sel_hi:[0,1,1] neg_lo:[1,0,0]
    ds_write_addtid_b32 v33 offset:23392
    v_pk_mul_f16 v34, v22, v38 op_sel:[0,0] op_sel_hi:[1,0]
    v_pk_fma_f16 v34, v22, v38, v34 op_sel:[1,1,0] op_sel_hi:[0,1,1] neg_lo:[1,0,0]
    ds_write_addtid_b32 v34 offset:23936
    v_pk_mul_f16 v35, v23, v38 op_sel:[0,0] op_sel_hi:[1,0]
    v_pk_fma_f16 v35, v23, v38, v35 op_sel:[1,1,0] op_sel_hi:[0,1,1] neg_lo:[1,0,0]
    ds_write_addtid_b32 v35 offset:24480
    v_pk_mul_f16 v32, v24, v38 op_sel:[0,0] op_sel_hi:[1,0]
    v_pk_fma_f16 v32, v24, v38, v32 op_sel:[1,1,0] op_sel_hi:[0,1,1] neg_lo:[1,0,0]
    ds_write_addtid_b32 v32 offset:25024
    v_pk_mul_f16 v33, v25, v38 op_sel:[0,0] op_sel_hi:[1,0]
    v_pk_fma_f16 v33, v25, v38, v33 op_sel:[1,1,0] op_sel_hi:[0,1,1] neg_lo:[1,0,0]
    ds_write_addtid_b32 v33 offset:25568
    v_pk_mul_f16 v34, v26, v38 op_sel:[0,0] op_sel_hi:[1,0]
    v_pk_fma_f16 v34, v26, v38, v34 op_sel:[1,1,0] op_sel_hi:[0,1,1] neg_lo:[1,0,0]
    ds_write_addtid_b32 v34 offset:26112
    v_pk_mul_f16 v35, v27, v38 op_sel:[0,0] op_sel_hi:[1,0]
    v_pk_fma_f16 v35, v27, v38, v35 op_sel:[1,1,0] op_sel_hi:[0,1,1] neg_lo:[1,0,0]
    ds_write_addtid_b32 v35 offset:26656
    v_pk_mul_f16 v32, v28, v38 op_sel:[0,0] op_sel_hi:[1,0]
    v_pk_fma_f16 v32, v28, v38, v32 op_sel:[1,1,0] op_sel_hi:[0,1,1] neg_lo:[1,0,0]
    ds_write_addtid_b32 v32 offset:27200
    v_pk_mul_f16 v33, v29, v38 op_sel:[0,0] op_sel_hi:[1,0]
    v_pk_fma_f16 v33, v29, v38, v33 op_sel:[1,1,0] op_sel_hi:[0,1,1] neg_lo:[1,0,0]
    ds_write_addtid_b32 v33 offset:27744
    v_pk_mul_f16 v34, v30, v38 op_sel:[0,0] op_sel_hi:[1,0]
    v_pk_fma_f16 v34, v30, v38, v34 op_sel:[1,1,0] op_sel_hi:[0,1,1] neg_lo:[1,0,0]
    ds_write_addtid_b32 v34 offset:28288
    v_pk_mul_f16 v35, v31, v38 op_sel:[0,0] op_sel_hi:[1,0]
    v_pk_fma_f16 v35, v31, v38, v35 op_sel:[1,1,0] op_sel_hi:[0,1,1] neg_lo:[1,0,0]
    ds_write_addtid_b32 v35 offset:28832
    s_branch KG_END
KG_A:
    v_and_b32 v42, 0x7fff7fff, v42
    v_and_b32 v43, 0x7fff7fff, v43
    v_pk_max_u16 v42, v42, v43
    v_lshlrev_b32 v43, 16, v42
    v_max_u32 v42, v42, v43
    v_exp_f32 v14, v12
    v_cos_f32 v16, v13
    v_max_u32_dpp v42, v42, v42 row_ror:8 row_mask:0xf bank_mask:0xf
    v_sin_f32 v17, v13
    v_mul_f32 v16, v16, v14
    v_max_u32_dpp v42, v42, v42 row_ror:4 row_mask:0xf bank_mask:0xf
    v_mul_f32 v17, v17, v14
    v_mul_f32 v14, 0x43800000, v12
    v_max_u32_dpp v42, v42, v42 row_ror:2 row_mask:0xf bank_mask:0xf
    v_mul_f32 v15, 0x43800000, v13
    v_exp_f32 v14, v14
    v_max_u32_dpp v42, v42, v42 row_ror:1 row_mask:0xf bank_mask:0xf
    v_cos_f32 v18, v15
    v_sin_f32 v19, v15
    v_max_u32_dpp v42, v42, v42 row_bcast:15 row_mask:0xa bank_mask:0xf
    v_mul_f32 v18, v18, v14
    v_mul_f32 v19, v19, v14
    v_max_u32_dpp v42, v42, v42 row_bcast:31 row_mask:0xc bank_mask:0xf
    v_lshlrev_b32 v46, 16, v46
    v_lshlrev_b32 v47, 16, v47
    v_readlane_b32 s56, v42, 63
    s_nop 0
    s_lshr_b32 s56, s56, 23
    s_max_u32 s56, s56, 6
    s_sub_u32 s57, 260, s56
    s_lshl_b32 s57, s57, 23
    s_sub_u32 s56, s56, 5
    s_lshl_b32 s56, s56, 23
    v_mul_f32 v46, s57, v46
    v_mul_f32 v47, s57, v47
    v_mul_f32 v41, s56, v41
    s_lshl_b32 s56, s33, 2
    v_mov_b32 v14, s56
    s_mov_b64 exec, 1
    ds_write_b32 v14, v41 offset:560
    s_mov_b64 exec, -1
    v_cvt_pk_f16_f32 v32, v46, -v47
    ds_write_addtid_b32 v32 offset:11424
    v_pk_mul_f32 v[24:25], v[46:47], v[18:19] op_sel:[0,0] op_sel_hi:[1,0]
    v_pk_fma_f32 v[24:25], v[46:47], v[18:19], v[24:25] op_sel:[1,1,0] op_sel_hi:[0,1,1] neg_lo:[1,0,0]
    v_cvt_pk_f16_f32 v33, v24, -v25
    ds_write_addtid_b32 v33 offset:4352
    v_pk_mul_f32 v[22:23], v[46:47], v[16:17] op_sel:[0,0] op_sel_hi:[1,0]
    v_pk_fma_f32 v[22:23], v[46:47], v[16:17], v[22:23] op_sel:[1,1,0] op_sel_hi:[0,1,1] neg_lo:[1,0,0]
    v_cvt_pk_f16_f32 v34, v22, -v23
    ds_write_addtid_b32 v34 offset:0
    v_pk_mul_f32 v[20:21], v[22:23], v[16:17] op_sel:[0,0] op_sel_hi:[1,0]
    v_pk_fma_f32 v[20:21], v[22:23], v[16:17], v[20:21] op_sel:[1,1,0] op_sel_hi:[0,1,1] neg_lo:[1,0,0]
    v_cvt_pk_f16_f32 v35, v20, -v21
    ds_write_addtid_b32 v35 offset:544
    v_pk_mul_f32 v[24:25], v[20:21], v[18:19] op_sel:[0,0] op_sel_hi:[1,0]
    v_pk_fma_f32 v[24:25], v[20:21], v[18:19], v[24:25] op_sel:[1,1,0] op_sel_hi:[0,1,1] neg_lo:[1,0,0]
    v_cvt_pk_f16_f32 v36, v24, -v25
    ds_write_addtid_b32 v36 offset:4896
    v_pk_mul_f32 v[22:23], v[20:21], v[16:17] op_sel:[0,0] op_sel_hi:[1,0]
    v_pk_fma_f32 v[22:23], v[20:21], v[16:17], v[22:23] op_sel:[1,1,0] op_sel_hi:[0,1,1] neg_lo:[1,0,0]
    v_cvt_pk_f16_f32 v37, v22, -v23
    ds_write_addtid_b32 v37 offset:1088
    v_pk_mul_f32 v[20:21], v[22:23], v[16:17] op_sel:[0,0] op_sel_hi:[1,0]
    v_pk_fma_f32 v[20:21], v[22:23], v[16:17], v[20:21] op_sel:[1,1,0] op_sel_hi:[0,1,1] neg_lo:[1,0,0]
    v_cvt_pk_f16_f32 v32, v20, -v21
    ds_write_addtid_b32 v32 offset:1632
    v_pk_mul_f32 v[24:25], v[20:21], v[18:19] op_sel:[0,0] op_sel_hi:[1,0]
    v_pk_fma_f32 v[24:25], v[20:21], v[18:19], v[24:25] op_sel:[1,1,0] op_sel_hi:[0,1,1] neg_lo:[1,0,0]
    v_cvt_pk_f16_f32 v33, v24, -v25
    ds_write_addtid_b32 v33 offset:5440
    v_pk_mul_f32 v[26:27], v[24:25], v[18:19] op_sel:[0,0] op_sel_hi:[1,0]
    v_pk_fma_f32 v[26:27], v[24:25], v[18:19], v[26:27] op_sel:[1,1,0] op_sel_hi:[0,1,1] neg_lo:[1,0,0]
    v_cvt_pk_f16_f32 v34, v26, -v27
    ds_write_addtid_b32 v34 offset:7072
    v_pk_mul_f32 v[24:25], v[26:27], v[18:19] op_sel:[0,0] op_sel_hi:[1,0]
    v_pk_fma_f32 v[24:25], v[26:27], v[18:19], v[24:25] op_sel:[1,1,0] op_sel_hi:[0,1,1] neg_lo:[1,0,0]
    v_cvt_pk_f16_f32 v35, v24, -v25
    ds_write_addtid_b32 v35 offset:8160
    v_pk_mul_f32 v[22:23], v[20:21], v[16:17] op_sel:[0,0] op_sel_hi:[1,0]
    v_pk_fma_f32 v[22:23], v[20:21], v[16:17], v[22:23] op_sel:[1,1,0] op_sel_hi:[0,1,1] neg_lo:[1,0,0]
    v_cvt_pk_f16_f32 v36, v22, -v23
    ds_write_addtid_b32 v36 offset:2176
    v_pk_mul_f32 v[20:21], v[22:23], v[16:17] op_sel:[0,0] op_sel_hi:[1,0]
    v_pk_fma_f32 v[20:21], v[22:23], v[16:17], v[20:21] op_sel:[1,1,0] op_sel_hi:[0,1,1] neg_lo:[1,0,0]
    v_cvt_pk_f16_f32 v37, v20, -v21
    ds_write_addtid_b32 v37 offset:2720
    v_pk_mul_f32 v[24:25], v[20:21], v[18:19] op_sel:[0,0] op_sel_hi:[1,0]
    v_pk_fma_f32 v[24:25], v[20:21], v[18:19], v[24:25] op_sel:[1,1,0] op_sel_hi:[0,1,1] neg_lo:[1,0,0]
    v_cvt_pk_f16_f32 v32, v24, -v25
    ds_write_addtid_b32 v32 offset:5984
    v_pk_mul_f32 v[22:23], v[20:21], v[16:17] op_sel:[0,0] op_sel_hi:[1,0]
    v_pk_fma_f32 v[22:23], v[20:21], v[16:17], v[22:23] op_sel:[1,1,0] op_sel_hi:[0,1,1] neg_lo:[1,0,0]
    v_cvt_pk_f16_f32 v33, v22, -v23
    ds_write_addtid_b32 v33 offset:3264
    v_pk_mul_f32 v[20:21], v[22:23], v[16:17] op_sel:[0,0] op_sel_hi:[1,0]
    v_pk_fma_f32 v[20:21], v[22:23], v[16:17], v[20:21] op_sel:[1,1,0] op_sel_hi:[0,1,1] neg_lo:[1,0,0]
    v_cvt_pk_f16_f32 v34, v20, -v21
    ds_write_addtid_b32 v34 offset:3808
    v_pk_mul_f32 v[24:25], v[20:21], v[18:19] op_sel:[0,0] op_sel_hi:[1,0]
    v_pk_fma_f32 v[24:25], v[20:21], v[18:19], v[24:25] op_sel:[1,1,0] op_sel_hi:[0,1,1] neg_lo:[1,0,0]
    v_cvt_pk_f16_f32 v35, v24, -v25
    ds_write_addtid_b32 v35 offset:6528
    v_pk_mul_f32 v[26:27], v[24:25], v[18:19] op_sel:[0,0] op_sel_hi:[1,0]
    v_pk_fma_f32 v[26:27], v[24:25], v[18:19], v[26:27] op_sel:[1,1,0] op_sel_hi:[0,1,1] neg_lo:[1,0,0]
    v_cvt_pk_f16_f32 v36, v26, -v27
    ds_write_addtid_b32 v36 offset:7616
    v_pk_mul_f32 v[24:25], v[26:27], v[18:19] op_sel:[0,0] op_sel_hi:[1,0]
    v_pk_fma_f32 v[24:25], v[26:27], v[18:19], v[24:25] op_sel:[1,1,0] op_sel_hi:[0,1,1] neg_lo:[1,0,0]
    v_cvt_pk_f16_f32 v37, v24, -v25
    ds_write_addtid_b32 v37 offset:8704
    v_pk_mul_f32 v[26:27], v[24:25], v[18:19] op_sel:[0,0] op_sel_hi:[1,0]
    v_pk_fma_f32 v[26:27], v[24:25], v[18:19], v[26:27] op_sel:[1,1,0] op_sel_hi:[0,1,1] neg_lo:[1,0,0]
    v_cvt_pk_f16_f32 v32, v26, -v27
    ds_write_addtid_b32 v32 offset:9248
    v_pk_mul_f32 v[24:25], v[26:27], v[18:19] op_sel:[0,0] op_sel_hi:[1,0]
    v_pk_fma_f32 v[24:25], v[26:27], v[18:19], v[24:25] op_sel:[1,1,0] op_sel_hi:[0,1,1] neg_lo:[1,0,0]
    v_cvt_pk_f16_f32 v33, v24, -v25
    ds_write_addtid_b32 v33 offset:9792
    v_pk_mul_f32 v[26:27], v[24:25], v[18:19] op_sel:[0,0] op_sel_hi:[1,0]
    v_pk_fma_f32 v[26:27], v[24:25], v[18:19], v[26:27] op_sel:[1,1,0] op_sel_hi:[0,1,1] neg_lo:[1,0,0]
    v_cvt_pk_f16_f32 v34, v26, -v27
    ds_write_addtid_b32 v34 offset:10336
    v_pk_mul_f32 v[24:25], v[26:27], v[18:19] op_sel:[0,0] op_sel_hi:[1,0]
    v_pk_fma_f32 v[24:25], v[26:27], v[18:19], v[24:25] op_sel:[1,1,0] op_sel_hi:[0,1,1] neg_lo:[1,0,0]
    v_cvt_pk_f16_f32 v35, v24, -v25
    ds_write_addtid_b32 v35 offset:10880
KG_END:
    s_lshl_b32 s56, s33, 2
    v_mov_b32 v14, s56
    v_mov_b32 v15, 1
    s_waitcnt lgkmcnt(0)
    s_mov_b64 exec, 1
    ds_add_u32 v14, v15 offset:544
    s_mov_b64 exec, -1
    s_mul_i32 s48, s48, 1664525
    s_add_u32 s48, s48, 1013904223
    s_mov_b32 s49, 0
KG_SPIN:
    ds_read_b32 v15, v14 offset:544
    s_add_u32 s49, s49, 1
    s_waitcnt lgkmcnt(0)
    v_readfirstlane_b32 s56, v15
    s_nop 0
    s_cmp_ge_u32 s56, 4
    s_cbranch_scc1 KG_GO
    s_sleep 1
    s_cmp_lt_u32 s49, 60000
    s_cbranch_scc1 KG_SPIN
KG_GO:
    s_setprio 2
    ds_read_b128 v[12:15], v8 offset:0
    ds_read_b128 v[16:19], v9 offset:0
    ds_read_b128 v[20:23], v8 offset:64
    ds_read_b128 v[24:27], v9 offset:64
    ds_read_b128 v[28:31], v8 offset:128
    ds_read_b128 v[32:35], v9 offset:128
    ds_read_b128 v[36:39], v8 offset:192
    ds_read_b128 v[40:43], v9 offset:192
    s_waitcnt lgkmcnt(6)
    v_mfma_f32_16x16x32_f16 v[44:47], v[12:15], v[16:19], 0
    ds_read_b128 v[12:15], v8 offset:256
    ds_read_b128 v[16:19], v9 offset:256
    s_waitcnt lgkmcnt(6)
    v_mfma_f32_16x16x32_f16 v[44:47], v[20:23], v[24:27], v[44:47]
    ds_read_b128 v[20:23], v8 offset:320
    ds_read_b128 v[24:27], v9 offset:320
    s_waitcnt lgkmcnt(6)
    v_mfma_f32_16x16x32_f16 v[44:47], v[28:31], v[32:35], v[44:47]
    ds_read_b128 v[28:31], v8 offset:384
    ds_read_b128 v[32:35], v9 offset:384
    s_waitcnt lgkmcnt(6)
    v_mfma_f32_16x16x32_f16 v[44:47], v[36:39], v[40:43], v[44:47]
    ds_read_b128 v[36:39], v8 offset:448
    ds_read_b128 v[40:43], v9 offset:448
    s_waitcnt lgkmcnt(6)
    v_mfma_f32_16x16x32_f16 v[44:47], v[12:15], v[16:19], v[44:47]
    s_waitcnt lgkmcnt(4)
    v_mfma_f32_16x16x32_f16 v[44:47], v[20:23], v[24:27], v[44:47]
    s_waitcnt lgkmcnt(2)
    v_mfma_f32_16x16x32_f16 v[44:47], v[28:31], v[32:35], v[44:47]
    s_waitcnt lgkmcnt(0)
    v_mfma_f32_16x16x32_f16 v[44:47], v[36:39], v[40:43], v[44:47]
    s_nop 7
    v_cvt_pk_f16_f32 v12, v44, v45
    v_cvt_pk_f16_f32 v13, v46, v47
    s_cmp_ge_u32 s38, 2
    s_cbranch_scc1 KG_WT
    v_cvt_pk_f16_f32 v14, v45, v46
    ds_write_b64 v10, v[12:13]
    ds_write_b16 v10, v12 offset:1218
    ds_write_b32 v10, v14 offset:1220
    ds_write_b16_d16_hi v10, v13 offset:1224
    ds_write_b32 v10, v12 offset:2436
    ds_write_b32 v10, v13 offset:2440
    ds_write_b16 v10, v12 offset:3654
    ds_write_b32 v10, v14 offset:3656
    ds_write_b16_d16_hi v10, v13 offset:3660
    s_cmp_eq_u32 s38, 0
    s_cbranch_scc1 KG_WD
    v_readlane_b32 s56, v12, 63
    s_mov_b64 exec, 0xff
    s_nop 0
    v_mov_b32 v15, s56
    ds_write_b16 v11, v15
    s_branch KG_WD
KG_WT:
    v_readlane_b32 s56, v12, 8
    s_mov_b32 exec_lo, 0x00ff00ff
    s_mov_b32 exec_hi, 0x00ff00ff
    ds_write_b64 v10, v[12:13]
    s_cmp_eq_u32 s38, 3
    s_cbranch_scc1 KG_WD
    s_mov_b64 exec, 15
    v_mov_b32 v15, s56
    ds_write_b16 v11, v15
KG_WD:
    s_mov_b64 exec, -1
    s_cmp_ge_u32 s3, 8
    s_cbranch_scc1 CV_B4
    s_cmp_ge_u32 s2, 128
    s_cbranch_scc1 CV_B4
    s_and_b32 s34, s3, 3
    s_mul_i32 s34, s34, 48
    v_add_u32 v4, s34, v3
    v_mul_u32_u24 v6, 6, v4
    v_and_b32 v6, -4, v6
    s_mul_i32 s34, s2, 9216
    s_add_u32 s34, s34, 1179648
    v_mul_u32_u24 v7, 2304, v5
    v_add3_u32 v7, v7, v6, s34
    global_load_dwordx2 v[28:29], v7, s[4:5] offset:0
    global_load_dwordx2 v[30:31], v7, s[4:5] offset:1152
    global_load_dwordx2 v[32:33], v7, s[4:5] offset:96
    global_load_dwordx2 v[34:35], v7, s[4:5] offset:1248
    global_load_dwordx2 v[36:37], v7, s[4:5] offset:192
    global_load_dwordx2 v[38:39], v7, s[4:5] offset:1344
    v_lshlrev_b32 v7, 4, v5
    s_lshl_b32 s34, s2, 6
    s_add_u32 s34, s34, 6475776
    buffer_load_dwordx4 v[40:43], v7, s[40:43], s34 offen sc1
CV_B4:
    s_waitcnt lgkmcnt(0)
    s_barrier
    s_cmp_eq_u32 s47, 0
    s_cbranch_scc1 CV_WIN
    s_setprio 2
    s_cmp_eq_u32 s47, 2
    s_cbranch_scc1 CV_LIGHT
    s_lshl_b32 s57, s46, 2
    v_mov_b32 v4, s57
    ds_read_b128 v[44:47], v126 offset:1408
    ds_read_b64 v[48:49], v127 offset:448
    ds_read_b64 v[50:51], v127 offset:456
    ds_read_b128 v[52:55], v126 offset:1920
    ds_read_b64 v[56:57], v127 offset:960
    ds_read_b32 v4, v4 offset:560
    ds_read_b32 v120, v120
    v_mov_b32 v6, 0
    ds_read_b64 v[58:59], v127 offset:968
    ds_read_b128 v[60:63], v126 offset:2432
    ds_read_b128 v[64:67], v126 offset:2944
    ds_read_b128 v[68:71], v126 offset:3456
    s_waitcnt lgkmcnt(8)
    v_mfma_f32_16x16x32_f16 v[8:11], v[48:51], v[44:47], 0
    ds_read_b128 v[72:75], v126 offset:3968
    s_waitcnt lgkmcnt(4)
    v_mfma_f32_16x16x32_f16 v[8:11], v[56:59], v[52:55], v[8:11]
    ds_read_b128 v[76:79], v126 offset:1344
    ds_read_b64 v[80:81], v127 offset:384
    v_mfma_f32_16x16x32_f16 v[12:15], v[48:51], v[52:55], 0
    ds_read_b64 v[82:83], v127 offset:392
    ds_read_b128 v[84:87], v126 offset:1856
    s_waitcnt lgkmcnt(7)
    v_mfma_f32_16x16x32_f16 v[12:15], v[56:59], v[60:63], v[12:15]
    ds_read_b64 v[88:89], v127 offset:896
    ds_read_b64 v[90:91], v127 offset:904
    v_mfma_f32_16x16x32_f16 v[16:19], v[48:51], v[60:63], 0
    ds_read_b128 v[92:95], v126 offset:2368
    s_waitcnt lgkmcnt(9)
    v_mfma_f32_16x16x32_f16 v[16:19], v[56:59], v[64:67], v[16:19]
    v_mfma_f32_16x16x32_f16 v[20:23], v[48:51], v[64:67], 0
    ds_read_b128 v[96:99], v126 offset:2880
    s_waitcnt lgkmcnt(9)
    v_mfma_f32_16x16x32_f16 v[20:23], v[56:59], v[68:71], v[20:23]
    v_mfma_f32_16x16x32_f16 v[24:27], v[48:51], v[68:71], 0
    ds_read_b128 v[100:103], v126 offset:3392
    s_waitcnt lgkmcnt(9)
    v_mfma_f32_16x16x32_f16 v[24:27], v[56:59], v[72:75], v[24:27]
    s_waitcnt lgkmcnt(6)
    v_mfma_f32_16x16x32_f16 v[8:11], v[80:83], v[76:79], v[8:11]
    ds_read_b128 v[104:107], v126 offset:3904
    s_waitcnt lgkmcnt(4)
    v_mfma_f32_16x16x32_f16 v[8:11], v[88:91], v[84:87], v[8:11]
    ds_read_b128 v[108:111], v126 offset:1280
    ds_read_b64 v[112:113], v127 offset:320
    v_mfma_f32_16x16x32_f16 v[12:15], v[80:83], v[84:87], v[12:15]
    v_readfirstlane_b32 s58, v4
    s_waitcnt lgkmcnt(5)
    v_mfma_f32_16x16x32_f16 v[12:15], v[88:91], v[92:95], v[12:15]
    ds_read_b64 v[114:115], v127 offset:328
    ds_read_b128 v[44:47], v126 offset:1792
    v_mfma_f32_16x16x32_f16 v[16:19], v[80:83], v[92:95], v[16:19]
    s_mov_b32 s56, 0x03020302
    v_perm_b32 v120, v120, v120, s56
    s_waitcnt lgkmcnt(6)
    v_mfma_f32_16x16x32_f16 v[16:19], v[88:91], v[96:99], v[16:19]
    ds_read_b64 v[52:53], v127 offset:832
    ds_read_b64 v[54:55], v127 offset:840
    v_mfma_f32_16x16x32_f16 v[20:23], v[80:83], v[96:99], v[20:23]
    v_and_b32 v116, v116, v120
    v_and_b32 v117, v117, v120
    s_waitcnt lgkmcnt(7)
    v_mfma_f32_16x16x32_f16 v[20:23], v[88:91], v[100:103], v[20:23]
    ds_read_b128 v[60:63], v126 offset:2304
    ds_read_b128 v[64:67], v126 offset:2816
    v_mfma_f32_16x16x32_f16 v[24:27], v[80:83], v[100:103], v[24:27]
    v_and_b32 v118, v118, v120
    v_and_b32 v119, v119, v120
    s_waitcnt lgkmcnt(8)
    v_mfma_f32_16x16x32_f16 v[24:27], v[88:91], v[104:107], v[24:27]
    ds_read_b128 v[48:51], v126 offset:3328
    s_waitcnt lgkmcnt(6)
    v_mfma_f32_16x16x32_f16 v[8:11], v[112:115], v[108:111], v[8:11]
    ds_read_b128 v[68:71], v126 offset:3840
    s_waitcnt lgkmcnt(4)
    v_mfma_f32_16x16x32_f16 v[8:11], v[52:55], v[44:47], v[8:11]
    ds_read_b128 v[56:59], v126 offset:1216
    ds_read_b64 v[72:73], v127 offset:256
    v_mfma_f32_16x16x32_f16 v[12:15], v[112:115], v[44:47], v[12:15]
    ds_read_b64 v[74:75], v127 offset:264
    ds_read_b128 v[76:79], v126 offset:1728
    s_waitcnt lgkmcnt(7)
    v_mfma_f32_16x16x32_f16 v[12:15], v[52:55], v[60:63], v[12:15]
    ds_read_b64 v[84:85], v127 offset:768
    ds_read_b64 v[86:87], v127 offset:776
    v_mfma_f32_16x16x32_f16 v[16:19], v[112:115], v[60:63], v[16:19]
    ds_read_b128 v[92:95], v126 offset:2240
    s_waitcnt lgkmcnt(9)
    v_mfma_f32_16x16x32_f16 v[16:19], v[52:55], v[64:67], v[16:19]
    v_mfma_f32_16x16x32_f16 v[20:23], v[112:115], v[64:67], v[20:23]
    ds_read_b128 v[96:99], v126 offset:2752
    s_waitcnt lgkmcnt(9)
    v_mfma_f32_16x16x32_f16 v[20:23], v[52:55], v[48:51], v[20:23]
    v_mfma_f32_16x16x32_f16 v[24:27], v[112:115], v[48:51], v[24:27]
    ds_read_b128 v[80:83], v126 offset:3264
    s_waitcnt lgkmcnt(9)
    v_mfma_f32_16x16x32_f16 v[24:27], v[52:55], v[68:71], v[24:27]
    s_waitcnt lgkmcnt(6)
    v_mfma_f32_16x16x32_f16 v[8:11], v[72:75], v[56:59], v[8:11]
    ds_read_b128 v[100:103], v126 offset:3776
    s_waitcnt lgkmcnt(4)
    v_mfma_f32_16x16x32_f16 v[8:11], v[84:87], v[76:79], v[8:11]
    ds_read_b128 v[88:91], v126 offset:1152
    ds_read_b64 v[104:105], v127 offset:192
    v_mfma_f32_16x16x32_f16 v[12:15], v[72:75], v[76:79], v[12:15]
    ds_read_b64 v[106:107], v127 offset:200
    ds_read_b128 v[108:111], v126 offset:1664
    s_waitcnt lgkmcnt(7)
    v_mfma_f32_16x16x32_f16 v[12:15], v[84:87], v[92:95], v[12:15]
    ds_read_b64 v[44:45], v127 offset:704
    ds_read_b64 v[46:47], v127 offset:712
    v_mfma_f32_16x16x32_f16 v[16:19], v[72:75], v[92:95], v[16:19]
    ds_read_b128 v[60:63], v126 offset:2176
    s_waitcnt lgkmcnt(9)
    v_mfma_f32_16x16x32_f16 v[16:19], v[84:87], v[96:99], v[16:19]
    v_mfma_f32_16x16x32_f16 v[20:23], v[72:75], v[96:99], v[20:23]
    ds_read_b128 v[64:67], v126 offset:2688
    s_waitcnt lgkmcnt(9)
    v_mfma_f32_16x16x32_f16 v[20:23], v[84:87], v[80:83], v[20:23]
    v_mfma_f32_16x16x32_f16 v[24:27], v[72:75], v[80:83], v[24:27]
    ds_read_b128 v[112:115], v126 offset:3200
    s_waitcnt lgkmcnt(9)
    v_mfma_f32_16x16x32_f16 v[24:27], v[84:87], v[100:103], v[24:27]
    s_waitcnt lgkmcnt(6)
    v_mfma_f32_16x16x32_f16 v[8:11], v[104:107], v[88:91], v[8:11]
    ds_read_b128 v[48:51], v126 offset:3712
    s_waitcnt lgkmcnt(4)
    v_mfma_f32_16x16x32_f16 v[8:11], v[44:47], v[108:111], v[8:11]
    ds_read_b128 v[52:55], v126 offset:1088
    ds_read_b64 v[68:69], v127 offset:128
    v_mfma_f32_16x16x32_f16 v[12:15], v[104:107], v[108:111], v[12:15]
    ds_read_b64 v[70:71], v127 offset:136
    ds_read_b128 v[56:59], v126 offset:1600
    s_waitcnt lgkmcnt(7)
    v_mfma_f32_16x16x32_f16 v[12:15], v[44:47], v[60:63], v[12:15]
    ds_read_b64 v[76:77], v127 offset:640
    ds_read_b64 v[78:79], v127 offset:648
    v_mfma_f32_16x16x32_f16 v[16:19], v[104:107], v[60:63], v[16:19]
    ds_read_b128 v[92:95], v126 offset:2112
    s_waitcnt lgkmcnt(9)
    v_mfma_f32_16x16x32_f16 v[16:19], v[44:47], v[64:67], v[16:19]
    v_mfma_f32_16x16x32_f16 v[20:23], v[104:107], v[64:67], v[20:23]
    ds_read_b128 v[96:99], v126 offset:2624
    s_waitcnt lgkmcnt(9)
    v_mfma_f32_16x16x32_f16 v[20:23], v[44:47], v[112:115], v[20:23]
    v_mfma_f32_16x16x32_f16 v[24:27], v[104:107], v[112:115], v[24:27]
    ds_read_b128 v[72:75], v126 offset:3136
    s_waitcnt lgkmcnt(9)
    v_mfma_f32_16x16x32_f16 v[24:27], v[44:47], v[48:51], v[24:27]
    s_waitcnt lgkmcnt(6)
    v_mfma_f32_16x16x32_f16 v[8:11], v[68:71], v[52:55], v[8:11]
    ds_read_b128 v[80:83], v126 offset:3648
    s_waitcnt lgkmcnt(4)
    v_mfma_f32_16x16x32_f16 v[8:11], v[76:79], v[56:59], v[8:11]
    ds_read_b128 v[84:87], v126 offset:1024
    ds_read_b64 v[100:101], v127 offset:64
    v_mfma_f32_16x16x32_f16 v[12:15], v[68:71], v[56:59], v[12:15]
    ds_read_b64 v[102:103], v127 offset:72
    ds_read_b128 v[88:91], v126 offset:1536
    s_waitcnt lgkmcnt(7)
    v_mfma_f32_16x16x32_f16 v[12:15], v[76:79], v[92:95], v[12:15]
    ds_read_b64 v[108:109], v127 offset:576
    ds_read_b64 v[110:111], v127 offset:584
    v_mfma_f32_16x16x32_f16 v[16:19], v[68:71], v[92:95], v[16:19]
    ds_read_b128 v[60:63], v126 offset:2048
    s_waitcnt lgkmcnt(9)
    v_mfma_f32_16x16x32_f16 v[16:19], v[76:79], v[96:99], v[16:19]
    v_mfma_f32_16x16x32_f16 v[20:23], v[68:71], v[96:99], v[20:23]
    ds_read_b128 v[64:67], v126 offset:2560
    s_waitcnt lgkmcnt(9)
    v_mfma_f32_16x16x32_f16 v[20:23], v[76:79], v[72:75], v[20:23]
    v_mfma_f32_16x16x32_f16 v[24:27], v[68:71], v[72:75], v[24:27]
    ds_read_b128 v[104:107], v126 offset:3072
    s_waitcnt lgkmcnt(9)
    v_mfma_f32_16x16x32_f16 v[24:27], v[76:79], v[80:83], v[24:27]
    s_waitcnt lgkmcnt(6)
    v_mfma_f32_16x16x32_f16 v[8:11], v[100:103], v[84:87], v[8:11]
    ds_read_b128 v[112:115], v126 offset:3584
    s_waitcnt lgkmcnt(4)
    v_mfma_f32_16x16x32_f16 v[8:11], v[108:111], v[88:91], v[8:11]
    ds_read_b128 v[44:47], v126 offset:448
    v_mfma_f32_16x16x32_f16 v[12:15], v[100:103], v[88:91], v[12:15]
    ds_read_b128 v[48:51], v126 offset:960
    ds_read_b64 v[52:53], v127 offset:0
    s_waitcnt lgkmcnt(6)
    v_mfma_f32_16x16x32_f16 v[12:15], v[108:111], v[60:63], v[12:15]
    ds_read_b64 v[54:55], v127 offset:8
    v_mfma_f32_16x16x32_f16 v[16:19], v[100:103], v[60:63], v[16:19]
    ds_read_b128 v[56:59], v126 offset:1472
    ds_read_b64 v[92:93], v127 offset:512
    s_waitcnt lgkmcnt(8)
    v_mfma_f32_16x16x32_f16 v[16:19], v[108:111], v[64:67], v[16:19]
    ds_read_b64 v[94:95], v127 offset:520
    v_mfma_f32_16x16x32_f16 v[20:23], v[100:103], v[64:67], v[20:23]
    s_waitcnt lgkmcnt(8)
    v_mfma_f32_16x16x32_f16 v[20:23], v[108:111], v[104:107], v[20:23]
    ds_read_b128 v[96:99], v126 offset:1984
    ds_read_b64 v[68:69], v127 offset:1024
    v_mfma_f32_16x16x32_f16 v[24:27], v[100:103], v[104:107], v[24:27]
    ds_read_b64 v[70:71], v127 offset:1032
    s_waitcnt lgkmcnt(10)
    v_mfma_f32_16x16x32_f16 v[24:27], v[108:111], v[112:115], v[24:27]
    s_waitcnt lgkmcnt(9)
    v_mfma_f32_16x16x32_f16 v[12:15], v[116:119], v[44:47], v[12:15]
    s_waitcnt lgkmcnt(6)
    v_mfma_f32_16x16x32_f16 v[8:11], v[52:55], v[48:51], v[8:11]
    ds_read_b128 v[72:75], v126 offset:2496
    v_mfma_f32_16x16x32_f16 v[16:19], v[116:119], v[48:51], v[16:19]
    s_waitcnt lgkmcnt(4)
    v_mfma_f32_16x16x32_f16 v[8:11], v[92:95], v[56:59], v[8:11]
    v_mfma_f32_16x16x32_f16 v[12:15], v[52:55], v[56:59], v[12:15]
    ds_read_b128 v[76:79], v126 offset:3008
    v_mfma_f32_16x16x32_f16 v[20:23], v[116:119], v[56:59], v[20:23]
    ds_read_b32 v7, v6 offset:556
    s_waitcnt lgkmcnt(3)
    v_mfma_f32_16x16x32_f16 v[8:11], v[68:71], v[96:99], v[8:11]
    v_mfma_f32_16x16x32_f16 v[12:15], v[92:95], v[96:99], v[12:15]
    ds_read_b128 v[80:83], v126 offset:3520
    v_mfma_f32_16x16x32_f16 v[16:19], v[52:55], v[96:99], v[16:19]
    v_mfma_f32_16x16x32_f16 v[24:27], v[116:119], v[96:99], v[24:27]
    ds_read_b128 v[84:87], v126 offset:4032
    s_waitcnt lgkmcnt(4)
    v_mfma_f32_16x16x32_f16 v[12:15], v[68:71], v[72:75], v[12:15]
    s_waitcnt lgkmcnt(2)
    v_readfirstlane_b32 s56, v7
    s_nop 0
    s_cmp_ge_u32 s56, 10
    s_cbranch_scc1 CH_WOK
    s_mov_b32 s49, 0
CH_WSP:
    s_sleep 1
    ds_read_b32 v7, v6 offset:556
    s_add_u32 s49, s49, 1
    s_waitcnt lgkmcnt(0)
    v_readfirstlane_b32 s56, v7
    s_nop 0
    s_cmp_ge_u32 s56, 10
    s_cbranch_scc1 CH_WOK
    s_cmp_lt_u32 s49, 60000
    s_cbranch_scc1 CH_WSP
CH_WOK:
    v_mfma_f32_16x16x32_f16 v[16:19], v[92:95], v[72:75], v[16:19]
    ds_read_b64_tr_b16 v[88:89], v124 offset:0
    ds_read_b64_tr_b16 v[90:91], v124 offset:32
    v_mfma_f32_16x16x32_f16 v[20:23], v[52:55], v[72:75], v[20:23]
    ds_read2_b32 v[60:61], v125 offset0:41 offset1:105
    ds_read2_b32 v[62:63], v125 offset0:40 offset1:104
    v_mfma_f32_16x16x32_f16 v[16:19], v[68:71], v[76:79], v[16:19]
    ds_read2_b32 v[64:65], v125 offset0:25 offset1:89
    ds_read2_b32 v[66:67], v125 offset0:24 offset1:88
    v_mfma_f32_16x16x32_f16 v[20:23], v[92:95], v[76:79], v[20:23]
    ds_read_b64_tr_b16 v[100:101], v124 offset:256
    ds_read_b64_tr_b16 v[102:103], v124 offset:288
    v_mfma_f32_16x16x32_f16 v[24:27], v[52:55], v[76:79], v[24:27]
    ds_read2_b32 v[104:105], v125 offset0:33 offset1:97
    ds_read2_b32 v[106:107], v125 offset0:32 offset1:96
    s_waitcnt lgkmcnt(11)
    v_mfma_f32_16x16x32_f16 v[20:23], v[68:71], v[80:83], v[20:23]
    ds_read2_b32 v[108:109], v125 offset0:17 offset1:81
    ds_read2_b32 v[110:111], v125 offset0:16 offset1:80
    v_mfma_f32_16x16x32_f16 v[24:27], v[92:95], v[80:83], v[24:27]
    ds_read_b64_tr_b16 v[112:113], v124 offset:512
    s_waitcnt lgkmcnt(13)
    v_mfma_f32_16x16x32_f16 v[24:27], v[68:71], v[84:87], v[24:27]
    ds_read_b64_tr_b16 v[114:115], v124 offset:544
    s_waitcnt lgkmcnt(12)
    s_waitcnt lgkmcnt(10)
    v_mfma_f32_16x16x32_f16 v[12:15], v[88:91], v[60:63], v[12:15]
    ds_read2_b32 v[44:45], v125 offset0:9 offset1:73
    ds_read2_b32 v[46:47], v125 offset0:8 offset1:72
    s_waitcnt lgkmcnt(10)
    v_mfma_f32_16x16x32_f16 v[8:11], v[88:91], v[64:67], v[8:11]
    ds_read_b64_tr_b16 v[48:49], v124 offset:768
    ds_read_b64_tr_b16 v[50:51], v124 offset:800
    s_waitcnt lgkmcnt(10)
    s_waitcnt lgkmcnt(8)
    v_mfma_f32_16x16x32_f16 v[12:15], v[100:103], v[104:107], v[12:15]
    ds_read2_b32 v[56:57], v125 offset0:1 offset1:65
    ds_read2_b32 v[58:59], v125 offset0:0 offset1:64
    s_waitcnt lgkmcnt(8)
    v_mfma_f32_16x16x32_f16 v[8:11], v[100:103], v[108:111], v[8:11]
    ds_read_b64_tr_b16 v[96:97], v124 offset:1024
    ds_read_b64_tr_b16 v[98:99], v124 offset:1056
    s_waitcnt lgkmcnt(8)
    v_mfma_f32_16x16x32_f16 v[16:19], v[112:115], v[60:63], v[16:19]
    ds_read_b64_tr_b16 v[72:73], v124 offset:1280
    ds_read_b64_tr_b16 v[74:75], v124 offset:1312
    v_mfma_f32_16x16x32_f16 v[12:15], v[112:115], v[64:67], v[12:15]
    s_waitcnt lgkmcnt(8)
    v_mfma_f32_16x16x32_f16 v[8:11], v[112:115], v[44:47], v[8:11]
    s_waitcnt lgkmcnt(6)
    v_mfma_f32_16x16x32_f16 v[16:19], v[48:51], v[104:107], v[16:19]
    ds_read_b64_tr_b16 v[52:53], v124 offset:1536
    ds_read_b64_tr_b16 v[54:55], v124 offset:1568
    v_mfma_f32_16x16x32_f16 v[12:15], v[48:51], v[108:111], v[12:15]
    s_waitcnt lgkmcnt(6)
    v_mfma_f32_16x16x32_f16 v[8:11], v[48:51], v[56:59], v[8:11]
    s_waitcnt lgkmcnt(4)
    v_mfma_f32_16x16x32_f16 v[20:23], v[96:99], v[60:63], v[20:23]
    ds_read_b64_tr_b16 v[76:77], v124 offset:1792
    ds_read_b64_tr_b16 v[78:79], v124 offset:1824
    v_mfma_f32_16x16x32_f16 v[16:19], v[96:99], v[64:67], v[16:19]
    v_mfma_f32_16x16x32_f16 v[12:15], v[96:99], v[44:47], v[12:15]
    s_waitcnt lgkmcnt(4)
    v_mfma_f32_16x16x32_f16 v[20:23], v[72:75], v[104:107], v[20:23]
    ds_read_b64_tr_b16 v[92:93], v124 offset:2048
    ds_read_b64_tr_b16 v[94:95], v124 offset:2080
    v_mfma_f32_16x16x32_f16 v[16:19], v[72:75], v[108:111], v[16:19]
    v_mfma_f32_16x16x32_f16 v[12:15], v[72:75], v[56:59], v[12:15]
    ds_read_b64_tr_b16 v[80:81], v124 offset:2304
    ds_read_b64_tr_b16 v[82:83], v124 offset:2336
    s_waitcnt lgkmcnt(6)
    v_mfma_f32_16x16x32_f16 v[24:27], v[52:55], v[60:63], v[24:27]
    v_mfma_f32_16x16x32_f16 v[20:23], v[52:55], v[64:67], v[20:23]
    ds_read_b64_tr_b16 v[68:69], v124 offset:2560
    ds_read_b64_tr_b16 v[70:71], v124 offset:2592
    v_mfma_f32_16x16x32_f16 v[16:19], v[52:55], v[44:47], v[16:19]
    ds_read_b64_tr_b16 v[84:85], v124 offset:2816
    ds_read_b64_tr_b16 v[86:87], v124 offset:2848
    s_waitcnt lgkmcnt(8)
    v_mfma_f32_16x16x32_f16 v[24:27], v[76:79], v[104:107], v[24:27]
    ds_read_b64_tr_b16 v[88:89], v121 offset:0
    ds_read_b64_tr_b16 v[90:91], v121 offset:64
    v_mfma_f32_16x16x32_f16 v[20:23], v[76:79], v[108:111], v[20:23]
    ds_read2_b32 v[100:101], v122 offset0:3 offset1:2
    ds_read2_b32 v[102:103], v122 offset0:1 offset1:0
    v_mfma_f32_16x16x32_f16 v[16:19], v[76:79], v[56:59], v[16:19]
    ds_read2_b32 v[112:113], v122 offset0:19 offset1:18
    ds_read2_b32 v[114:115], v122 offset0:17 offset1:16
    s_waitcnt lgkmcnt(12)
    v_mfma_f32_16x16x32_f16 v[24:27], v[92:95], v[64:67], v[24:27]
    ds_read2_b32 v[48:49], v122 offset0:35 offset1:34
    ds_read2_b32 v[50:51], v122 offset0:33 offset1:32
    v_mfma_f32_16x16x32_f16 v[20:23], v[92:95], v[44:47], v[20:23]
    s_waitcnt lgkmcnt(12)
    v_mfma_f32_16x16x32_f16 v[24:27], v[80:83], v[108:111], v[24:27]
    ds_read2_b32 v[96:97], v122 offset0:51 offset1:50
    ds_read2_b32 v[98:99], v122 offset0:49 offset1:48
    v_mfma_f32_16x16x32_f16 v[20:23], v[80:83], v[56:59], v[20:23]
    s_waitcnt lgkmcnt(12)
    v_mfma_f32_16x16x32_f16 v[24:27], v[68:71], v[44:47], v[24:27]
    ds_read_b64_tr_b16 v[72:73], v121 offset:512
    ds_read_b64_tr_b16 v[74:75], v121 offset:576
    s_waitcnt lgkmcnt(12)
    v_mfma_f32_16x16x32_f16 v[24:27], v[84:87], v[56:59], v[24:27]
    ds_read_b64_tr_b16 v[60:61], v121 offset:1024
    ds_read_b64_tr_b16 v[62:63], v121 offset:1088
    s_waitcnt lgkmcnt(12)
    s_waitcnt lgkmcnt(10)
    v_mfma_f32_16x16x32_f16 v[12:15], v[88:91], v[100:103], v[12:15]
    ds_read_b64_tr_b16 v[52:53], v121 offset:1536
    ds_read_b64_tr_b16 v[54:55], v121 offset:1600
    s_waitcnt lgkmcnt(10)
    v_mfma_f32_16x16x32_f16 v[16:19], v[88:91], v[112:115], v[16:19]
    s_waitcnt lgkmcnt(8)
    v_mfma_f32_16x16x32_f16 v[20:23], v[88:91], v[48:51], v[20:23]
    s_waitcnt lgkmcnt(6)
    v_mfma_f32_16x16x32_f16 v[24:27], v[88:91], v[96:99], v[24:27]
    s_waitcnt lgkmcnt(4)
    v_mfma_f32_16x16x32_f16 v[16:19], v[72:75], v[100:103], v[16:19]
    v_mfma_f32_16x16x32_f16 v[20:23], v[72:75], v[112:115], v[20:23]
    v_mfma_f32_16x16x32_f16 v[24:27], v[72:75], v[48:51], v[24:27]
    s_waitcnt lgkmcnt(2)
    v_mfma_f32_16x16x32_f16 v[20:23], v[60:63], v[100:103], v[20:23]
    v_mfma_f32_16x16x32_f16 v[24:27], v[60:63], v[112:115], v[24:27]
    s_waitcnt lgkmcnt(0)
    v_mfma_f32_16x16x32_f16 v[24:27], v[52:55], v[100:103], v[24:27]
    v_pk_mul_f32 v[8:9], v[8:9], s[58:59] op_sel_hi:[1,0]
    v_pk_mul_f32 v[10:11], v[10:11], s[58:59] op_sel_hi:[1,0]
    v_cvt_pk_bf16_f32 v8, v8, v9
    v_cvt_pk_bf16_f32 v9, v10, v11
    ds_write_b64 v123, v[8:9] offset:3824
    v_pk_mul_f32 v[12:13], v[12:13], s[58:59] op_sel_hi:[1,0]
    v_pk_mul_f32 v[14:15], v[14:15], s[58:59] op_sel_hi:[1,0]
    v_cvt_pk_bf16_f32 v12, v12, v13
    v_cvt_pk_bf16_f32 v13, v14, v15
    ds_write_b64 v123, v[12:13] offset:4416
    v_pk_mul_f32 v[16:17], v[16:17], s[58:59] op_sel_hi:[1,0]
    v_pk_mul_f32 v[18:19], v[18:19], s[58:59] op_sel_hi:[1,0]
    v_cvt_pk_bf16_f32 v16, v16, v17
    v_cvt_pk_bf16_f32 v17, v18, v19
    ds_write_b64 v123, v[16:17] offset:5008
    v_pk_mul_f32 v[20:21], v[20:21], s[58:59] op_sel_hi:[1,0]
    v_pk_mul_f32 v[22:23], v[22:23], s[58:59] op_sel_hi:[1,0]
    v_cvt_pk_bf16_f32 v20, v20, v21
    v_cvt_pk_bf16_f32 v21, v22, v23
    ds_write_b64 v123, v[20:21] offset:5600
    v_pk_mul_f32 v[24:25], v[24:25], s[58:59] op_sel_hi:[1,0]
    v_pk_mul_f32 v[26:27], v[26:27], s[58:59] op_sel_hi:[1,0]
    v_cvt_pk_bf16_f32 v24, v24, v25
    v_cvt_pk_bf16_f32 v25, v26, v27
    ds_write_b64 v123, v[24:25] offset:6192
    s_branch CV_DONE
CV_LIGHT:
    s_lshl_b32 s57, s46, 2
    v_mov_b32 v4, s57
    ds_read_b128 v[44:47], v126 offset:384
    ds_read_b64 v[48:49], v127 offset:960
    ds_read_b64 v[50:51], v127 offset:968
    ds_read_b64 v[52:53], v127 offset:448
    ds_read_b64 v[54:55], v127 offset:456
    ds_read_b32 v4, v4 offset:560
    v_mov_b32 v6, 0
    ds_read_b128 v[56:59], v126 offset:896
    ds_read_b128 v[60:63], v126 offset:1408
    ds_read_b128 v[64:67], v126 offset:320
    ds_read_b64 v[68:69], v127 offset:896
    ds_read_b64 v[70:71], v127 offset:904
    s_waitcnt lgkmcnt(8)
    v_mfma_f32_16x16x32_f16 v[8:11], v[48:51], v[44:47], 0
    ds_read_b64 v[72:73], v127 offset:384
    ds_read_b64 v[74:75], v127 offset:392
    s_waitcnt lgkmcnt(8)
    v_mfma_f32_16x16x32_f16 v[12:15], v[52:55], v[44:47], 0
    ds_read_b128 v[76:79], v126 offset:832
    s_waitcnt lgkmcnt(7)
    v_mfma_f32_16x16x32_f16 v[12:15], v[48:51], v[56:59], v[12:15]
    v_mfma_f32_16x16x32_f16 v[16:19], v[52:55], v[56:59], 0
    ds_read_b128 v[80:83], v126 offset:1344
    s_waitcnt lgkmcnt(7)
    v_mfma_f32_16x16x32_f16 v[16:19], v[48:51], v[60:63], v[16:19]
    ds_read_b128 v[84:87], v126 offset:256
    ds_read_b64 v[88:89], v127 offset:832
    s_waitcnt lgkmcnt(6)
    v_mfma_f32_16x16x32_f16 v[8:11], v[68:71], v[64:67], v[8:11]
    ds_read_b64 v[90:91], v127 offset:840
    ds_read_b64 v[92:93], v127 offset:320
    s_waitcnt lgkmcnt(6)
    v_mfma_f32_16x16x32_f16 v[12:15], v[72:75], v[64:67], v[12:15]
    ds_read_b64 v[94:95], v127 offset:328
    ds_read_b128 v[96:99], v126 offset:768
    s_waitcnt lgkmcnt(7)
    v_mfma_f32_16x16x32_f16 v[12:15], v[68:71], v[76:79], v[12:15]
    v_mfma_f32_16x16x32_f16 v[16:19], v[72:75], v[76:79], v[16:19]
    ds_read_b128 v[100:103], v126 offset:1280
    s_waitcnt lgkmcnt(7)
    v_mfma_f32_16x16x32_f16 v[16:19], v[68:71], v[80:83], v[16:19]
    ds_read_b128 v[104:107], v126 offset:192
    ds_read_b64 v[108:109], v127 offset:768
    s_waitcnt lgkmcnt(6)
    v_mfma_f32_16x16x32_f16 v[8:11], v[88:91], v[84:87], v[8:11]
    ds_read_b64 v[110:111], v127 offset:776
    ds_read_b64 v[112:113], v127 offset:256
    s_waitcnt lgkmcnt(6)
    v_mfma_f32_16x16x32_f16 v[12:15], v[92:95], v[84:87], v[12:15]
    ds_read_b64 v[114:115], v127 offset:264
    ds_read_b128 v[44:47], v126 offset:704
    s_waitcnt lgkmcnt(7)
    v_mfma_f32_16x16x32_f16 v[12:15], v[88:91], v[96:99], v[12:15]
    v_readfirstlane_b32 s58, v4
    v_mfma_f32_16x16x32_f16 v[16:19], v[92:95], v[96:99], v[16:19]
    ds_read_b128 v[52:55], v126 offset:1216
    s_waitcnt lgkmcnt(7)
    v_mfma_f32_16x16x32_f16 v[16:19], v[88:91], v[100:103], v[16:19]
    ds_read_b128 v[56:59], v126 offset:128
    ds_read_b64 v[48:49], v127 offset:704
    s_waitcnt lgkmcnt(6)
    v_mfma_f32_16x16x32_f16 v[8:11], v[108:111], v[104:107], v[8:11]
    ds_read_b64 v[50:51], v127 offset:712
    ds_read_b64 v[60:61], v127 offset:192
    s_waitcnt lgkmcnt(6)
    v_mfma_f32_16x16x32_f16 v[12:15], v[112:115], v[104:107], v[12:15]
    ds_read_b64 v[62:63], v127 offset:200
    ds_read_b128 v[64:67], v126 offset:640
    s_waitcnt lgkmcnt(7)
    v_mfma_f32_16x16x32_f16 v[12:15], v[108:111], v[44:47], v[12:15]
    v_mfma_f32_16x16x32_f16 v[16:19], v[112:115], v[44:47], v[16:19]
    ds_read_b128 v[72:75], v126 offset:1152
    s_waitcnt lgkmcnt(7)
    v_mfma_f32_16x16x32_f16 v[16:19], v[108:111], v[52:55], v[16:19]
    ds_read_b128 v[76:79], v126 offset:64
    ds_read_b64 v[68:69], v127 offset:640
    s_waitcnt lgkmcnt(6)
    v_mfma_f32_16x16x32_f16 v[8:11], v[48:51], v[56:59], v[8:11]
    ds_read_b64 v[70:71], v127 offset:648
    ds_read_b64 v[80:81], v127 offset:128
    s_waitcnt lgkmcnt(6)
    v_mfma_f32_16x16x32_f16 v[12:15], v[60:63], v[56:59], v[12:15]
    ds_read_b64 v[82:83], v127 offset:136
    ds_read_b128 v[84:87], v126 offset:576
    s_waitcnt lgkmcnt(7)
    v_mfma_f32_16x16x32_f16 v[12:15], v[48:51], v[64:67], v[12:15]
    v_mfma_f32_16x16x32_f16 v[16:19], v[60:63], v[64:67], v[16:19]
    ds_read_b128 v[92:95], v126 offset:1088
    s_waitcnt lgkmcnt(7)
    v_mfma_f32_16x16x32_f16 v[16:19], v[48:51], v[72:75], v[16:19]
    ds_read_b128 v[96:99], v126 offset:0
    ds_read_b64 v[88:89], v127 offset:576
    s_waitcnt lgkmcnt(6)
    v_mfma_f32_16x16x32_f16 v[8:11], v[68:71], v[76:79], v[8:11]
    ds_read_b64 v[90:91], v127 offset:584
    ds_read_b64 v[100:101], v127 offset:64
    s_waitcnt lgkmcnt(6)
    v_mfma_f32_16x16x32_f16 v[12:15], v[80:83], v[76:79], v[12:15]
    ds_read_b64 v[102:103], v127 offset:72
    ds_read_b128 v[104:107], v126 offset:512
    s_waitcnt lgkmcnt(7)
    v_mfma_f32_16x16x32_f16 v[12:15], v[68:71], v[84:87], v[12:15]
    v_mfma_f32_16x16x32_f16 v[16:19], v[80:83], v[84:87], v[16:19]
    ds_read_b128 v[112:115], v126 offset:1024
    s_waitcnt lgkmcnt(7)
    v_mfma_f32_16x16x32_f16 v[16:19], v[68:71], v[92:95], v[16:19]
    ds_read_b128 v[44:47], v126 offset:448
    ds_read_b64 v[108:109], v127 offset:1024
    s_waitcnt lgkmcnt(6)
    v_mfma_f32_16x16x32_f16 v[8:11], v[88:91], v[96:99], v[8:11]
    ds_read_b32 v7, v6 offset:556
    ds_read_b64 v[110:111], v127 offset:1032
    s_waitcnt lgkmcnt(6)
    v_mfma_f32_16x16x32_f16 v[12:15], v[100:103], v[96:99], v[12:15]
    ds_read_b64 v[52:53], v127 offset:512
    ds_read_b64 v[54:55], v127 offset:520
    s_waitcnt lgkmcnt(7)
    v_mfma_f32_16x16x32_f16 v[12:15], v[88:91], v[104:107], v[12:15]
    ds_read_b64 v[56:57], v127 offset:0
    ds_read_b64 v[58:59], v127 offset:8
    v_mfma_f32_16x16x32_f16 v[16:19], v[100:103], v[104:107], v[16:19]
    ds_read_b128 v[60:63], v126 offset:960
    s_waitcnt lgkmcnt(9)
    v_mfma_f32_16x16x32_f16 v[16:19], v[88:91], v[112:115], v[16:19]
    ds_read_b128 v[64:67], v126 offset:1472
    s_waitcnt lgkmcnt(6)
    v_mfma_f32_16x16x32_f16 v[8:11], v[108:111], v[44:47], v[8:11]
    v_readfirstlane_b32 s56, v7
    s_nop 0
    s_cmp_ge_u32 s56, 10
    s_cbranch_scc1 CL_WOK
    s_mov_b32 s49, 0
CL_WSP:
    s_sleep 1
    ds_read_b32 v7, v6 offset:556
    s_add_u32 s49, s49, 1
    s_waitcnt lgkmcnt(0)
    v_readfirstlane_b32 s56, v7
    s_nop 0
    s_cmp_ge_u32 s56, 10
    s_cbranch_scc1 CL_WOK
    s_cmp_lt_u32 s49, 60000
    s_cbranch_scc1 CL_WSP
CL_WOK:
    s_waitcnt lgkmcnt(4)
    v_mfma_f32_16x16x32_f16 v[12:15], v[52:55], v[44:47], v[12:15]
    ds_read_b64_tr_b16 v[48:49], v124 offset:0
    ds_read_b64_tr_b16 v[50:51], v124 offset:32
    s_waitcnt lgkmcnt(4)
    v_mfma_f32_16x16x32_f16 v[16:19], v[56:59], v[44:47], v[16:19]
    ds_read2_b32 v[72:73], v125 offset0:9 offset1:73
    ds_read2_b32 v[74:75], v125 offset0:8 offset1:72
    s_waitcnt lgkmcnt(5)
    v_mfma_f32_16x16x32_f16 v[12:15], v[108:111], v[60:63], v[12:15]
    ds_read_b64_tr_b16 v[76:77], v124 offset:256
    ds_read_b64_tr_b16 v[78:79], v124 offset:288
    v_mfma_f32_16x16x32_f16 v[16:19], v[52:55], v[60:63], v[16:19]
    ds_read2_b32 v[80:81], v125 offset0:1 offset1:65
    ds_read2_b32 v[82:83], v125 offset0:0 offset1:64
    s_waitcnt lgkmcnt(8)
    v_mfma_f32_16x16x32_f16 v[16:19], v[108:111], v[64:67], v[16:19]
    s_waitcnt lgkmcnt(6)
    s_waitcnt lgkmcnt(4)
    v_mfma_f32_16x16x32_f16 v[16:19], v[48:51], v[72:75], v[16:19]
    s_waitcnt lgkmcnt(2)
    s_waitcnt lgkmcnt(0)
    v_mfma_f32_16x16x32_f16 v[16:19], v[76:79], v[80:83], v[16:19]
    v_pk_mul_f32 v[8:9], v[8:9], s[58:59] op_sel_hi:[1,0]
    v_pk_mul_f32 v[10:11], v[10:11], s[58:59] op_sel_hi:[1,0]
    v_cvt_pk_bf16_f32 v8, v8, v9
    v_cvt_pk_bf16_f32 v9, v10, v11
    ds_write_b64 v123, v[8:9] offset:2048
    v_pk_mul_f32 v[12:13], v[12:13], s[58:59] op_sel_hi:[1,0]
    v_pk_mul_f32 v[14:15], v[14:15], s[58:59] op_sel_hi:[1,0]
    v_cvt_pk_bf16_f32 v12, v12, v13
    v_cvt_pk_bf16_f32 v13, v14, v15
    ds_write_b64 v123, v[12:13] offset:2640
    v_pk_mul_f32 v[16:17], v[16:17], s[58:59] op_sel_hi:[1,0]
    v_pk_mul_f32 v[18:19], v[18:19], s[58:59] op_sel_hi:[1,0]
    v_cvt_pk_bf16_f32 v16, v16, v17
    v_cvt_pk_bf16_f32 v17, v18, v19
    ds_write_b64 v123, v[16:17] offset:3232
    s_branch CV_DONE
CV_WIN:
    s_setprio 3
    s_cmp_eq_u32 s46, 9
    s_cbranch_scc1 CV_WZ
    s_mul_i32 s56, s46, 86
    s_lshr_b32 s56, s56, 8
    s_mul_i32 s57, s56, 3
    s_sub_u32 s57, s46, s57
    s_lshl_b32 s58, s57, 10
    s_mul_i32 s59, s56, 4608
    s_add_u32 s59, s59, s58
    s_add_u32 s59, s59, 107728
    v_lshl_add_u32 v8, v1, 4, s59
    ds_read_b128 v[12:15], v8
    ds_read_b128 v[16:19], v8 offset:16
    s_mul_i32 s59, s56, 10608
    s_add_u32 s59, s59, s58
    s_add_u32 s59, s59, 16288
    v_lshl_add_u32 v9, v1, 4, s59
    s_waitcnt lgkmcnt(0)
    v_alignbit_b32 v24, v13, v12, 16
    v_alignbit_b32 v25, v14, v13, 16
    v_alignbit_b32 v26, v15, v14, 16
    v_alignbit_b32 v27, v16, v15, 16
    v_alignbit_b32 v28, v17, v16, 16
    v_alignbit_b32 v29, v18, v17, 16
    v_alignbit_b32 v30, v19, v18, 16
    v_pk_add_f16 v32, v25, v26
    v_pk_add_f16 v33, v26, v27
    v_pk_add_f16 v34, v27, v28
    v_pk_add_f16 v35, v28, v29
    v_pk_add_f16 v32, v32, v14
    v_pk_add_f16 v33, v33, v15
    v_pk_add_f16 v34, v34, v16
    v_pk_add_f16 v35, v35, v17
    ds_write_b128 v9, v[32:35] offset:0
    v_pk_add_f16 v36, v13, v15
    v_pk_add_f16 v37, v14, v16
    v_pk_add_f16 v38, v15, v17
    v_pk_add_f16 v39, v16, v18
    v_pk_add_f16 v36, v36, v32
    v_pk_add_f16 v37, v37, v33
    v_pk_add_f16 v38, v38, v34
    v_pk_add_f16 v39, v39, v35
    ds_write_b128 v9, v[36:39] offset:3200
    s_cmp_eq_u32 s57, 2
    s_cbranch_scc1 CV_WE
    v_pk_add_f16 v40, v24, v27
    v_pk_add_f16 v41, v25, v28
    v_pk_add_f16 v42, v26, v29
    v_pk_add_f16 v43, v27, v30
    v_pk_add_f16 v40, v40, v36
    v_pk_add_f16 v41, v41, v37
    v_pk_add_f16 v42, v42, v38
    v_pk_add_f16 v43, v43, v39
    ds_write_b128 v9, v[40:43] offset:6400
    v_pk_add_f16 v44, v12, v16
    v_pk_add_f16 v45, v13, v17
    v_pk_add_f16 v46, v14, v18
    v_pk_add_f16 v47, v15, v19
    v_pk_add_f16 v44, v44, v40
    v_pk_add_f16 v45, v45, v41
    v_pk_add_f16 v46, v46, v42
    v_pk_add_f16 v47, v47, v43
    ds_write_b128 v9, v[44:47] offset:8528
    s_branch CV_WE
CV_WZ:
    v_mov_b32 v12, 0
    v_mov_b32 v13, 0
    v_mov_b32 v14, 0
    v_mov_b32 v15, 0
    v_lshrrev_b32 v8, 1, v1
    v_mul_u32_u24 v8, 10608, v8
    v_and_b32 v9, 1, v1
    v_lshl_add_u32 v8, v9, 4, v8
    s_mov_b64 exec, 63
    ds_write_b128 v8, v[12:15] offset:16256
    ds_write_b128 v8, v[12:15] offset:19456
    ds_write_b128 v8, v[12:15] offset:22656
    ds_write_b128 v8, v[12:15] offset:24784
    s_mov_b64 exec, -1
CV_WE:
    s_nop 0
    v_mov_b32 v8, 0
    v_mov_b32 v9, 1
    s_waitcnt lgkmcnt(0)
    s_mov_b64 exec, 1
    ds_add_u32 v8, v9 offset:556
    s_mov_b64 exec, -1
    s_cmp_lg_u32 s3, 14
    s_cbranch_scc1 CV_DONE
    s_and_b32 s56, s2, 7
    v_min_u32 v9, 35, v1
    v_mul_u32_u24 v8, 9216, v9
    s_cmp_ge_u32 s2, 128
    s_cbranch_scc1 CV_PB
    s_lshr_b32 s57, s2, 3
    s_mul_i32 s58, s57, 331776
    s_lshl_b32 s59, s56, 10
    s_add_u32 s58, s58, s59
    v_add_u32 v8, s58, v8
    global_load_dword v2, v8, s[24:25] offset:384
    s_branch CV_DONE
CV_PB:
    s_add_u32 s56, s56, 64
    s_bfe_u32 s57, s2, 0x30003
    s_mul_i32 s58, s57, 663552
    s_lshl_b32 s59, s56, 7
    s_add_u32 s58, s58, s59
    v_add_u32 v8, s58, v8
    v_add_u32 v10, 331776, v8
    s_mul_i32 s58, s56, 73728
    s_mul_i32 s59, s57, 9216
    s_add_u32 s58, s58, s59
    v_lshl_add_u32 v9, v9, 8, s58
    global_load_dword v2, v8, s[22:23]
    global_load_dword v2, v10, s[22:23]
    global_load_dword v2, v8, s[24:25]
    global_load_dword v2, v10, s[24:25]
    global_load_dword v2, v9, s[26:27]
    global_load_dword v2, v9, s[26:27] offset:128
CV_DONE:
    v_lshrrev_b32 v20, 8, v0
    v_and_b32 v21, 4, v0
    v_add_u32 v20, v20, v21
    v_mul_u32_u24 v20, 592, v20
    v_bfe_u32 v21, v0, 3, 1
    v_bfe_u32 v22, v0, 1, 1
    v_lshl_add_u32 v21, v21, 1, v22
    v_mul_u32_u24 v21, 144, v21
    v_bfe_u32 v22, v0, 4, 4
    v_lshl_add_u32 v21, v22, 3, v21
    v_and_b32 v22, 1, v0
    v_lshl_add_u32 v21, v22, 2, v21
    v_add_u32 v21, v20, v21
    v_lshlrev_b32 v20, 4, v0
    v_mov_b32 v47, s48
    s_lshl_b32 s38, s2, 14
    s_add_u32 s38, s38, 3149824
    s_waitcnt lgkmcnt(0)
    s_barrier
    ds_read_b32 v44, v21 offset:2048
    ds_read_b32 v45, v21 offset:6784
    ds_read_b32 v46, v21 offset:11520
    s_waitcnt lgkmcnt(0)
    buffer_store_dwordx4 v[44:47], v20, s[40:43], s38 offen sc1
    s_cmp_ge_u32 s2, 184
    s_cbranch_scc1 FFN_B
    s_cmp_ge_u32 s2, 128
    s_cbranch_scc1 FIN
    s_cmp_ge_u32 s3, 8
    s_cbranch_scc1 LN2_H
    s_setprio 3
    s_cmp_lt_u32 s3, 4
    s_cbranch_scc1 LN2_A
    s_and_b32 s35, s3, 3
    s_mul_i32 s35, s35, 768
    v_mul_u32_u24 v23, 48, v3
    v_add_u32 v23, s35, v23
    v_add_u32 v23, 121088, v23
    ds_read_b128 v[48:51], v23 offset:0
    ds_read_b128 v[52:55], v23 offset:16
    ds_read_b128 v[56:59], v23 offset:32
    s_and_b32 s34, s3, 3
    s_mul_i32 s34, s34, 48
    v_add_u32 v4, s34, v3
    v_mul_u32_u24 v6, 6, v4
    v_and_b32 v6, -4, v6
    v_and_b32 v24, 1, v0
    s_mov_b32 s39, 0x02020000
    v_mul_lo_u32 v24, v24, s39
    v_add_u32 v24, 0x01000c0c, v24
    v_add_u32 v25, s39, v24
    v_add_u32 v26, s39, v25
    s_mov_b32 s52, 0x3ae38e39
    s_mov_b32 s54, 0x00010001
    s_mov_b32 s55, 0x00010001
    s_waitcnt vmcnt(1)
    v_perm_b32 v64, v29, v28, v24
    v_perm_b32 v65, v31, v30, v24
    v_perm_b32 v66, v29, v28, v25
    v_perm_b32 v67, v31, v30, v25
    v_perm_b32 v68, v29, v28, v26
    v_perm_b32 v69, v31, v30, v26
    v_perm_b32 v70, v33, v32, v24
    v_perm_b32 v71, v35, v34, v24
    v_perm_b32 v72, v33, v32, v25
    v_perm_b32 v73, v35, v34, v25
    v_perm_b32 v74, v33, v32, v26
    v_perm_b32 v75, v35, v34, v26
    v_perm_b32 v76, v37, v36, v24
    v_perm_b32 v77, v39, v38, v24
    v_perm_b32 v78, v37, v36, v25
    v_perm_b32 v79, v39, v38, v25
    v_perm_b32 v80, v37, v36, v26
    v_perm_b32 v81, v39, v38, v26
    v_cmp_ne_u32 vcc, s48, v43
    s_nop 0
    s_cbranch_vccz LN2_S
    v_lshlrev_b32 v7, 4, v5
    s_lshl_b32 s34, s2, 6
    s_add_u32 s34, s34, 6475776
    s_mov_b32 s49, 0
P_1:
    buffer_load_dwordx4 v[40:43], v7, s[40:43], s34 offen sc1
PC_3:
    s_add_u32 s49, s49, 1
    s_waitcnt vmcnt(0)
    v_cmp_ne_u32 vcc, s48, v43
    s_nop 0
    s_cbranch_vccz PD_2
    s_cmp_lt_u32 s49, 60000
    s_cbranch_scc1 P_1
PD_2:
LN2_S:
    v_lshlrev_b32 v32, 16, v42
    v_and_b32 v33, 0xffff0000, v42
    v_pk_add_f32 v[82:83], v[64:65], v[32:33] neg_lo:[0,1] neg_hi:[0,1]
    v_pk_add_f32 v[84:85], v[66:67], v[32:33] neg_lo:[0,1] neg_hi:[0,1]
    v_pk_add_f32 v[86:87], v[68:69], v[32:33] neg_lo:[0,1] neg_hi:[0,1]
    v_pk_add_f32 v[88:89], v[70:71], v[32:33] neg_lo:[0,1] neg_hi:[0,1]
    v_pk_add_f32 v[90:91], v[72:73], v[32:33] neg_lo:[0,1] neg_hi:[0,1]
    v_pk_add_f32 v[92:93], v[74:75], v[32:33] neg_lo:[0,1] neg_hi:[0,1]
    v_pk_add_f32 v[94:95], v[76:77], v[32:33] neg_lo:[0,1] neg_hi:[0,1]
    v_pk_add_f32 v[96:97], v[78:79], v[32:33] neg_lo:[0,1] neg_hi:[0,1]
    v_pk_add_f32 v[98:99], v[80:81], v[32:33] neg_lo:[0,1] neg_hi:[0,1]
    v_pk_mul_f32 v[82:83], v[82:83], v[40:41]
    v_pk_mul_f32 v[84:85], v[84:85], v[40:41]
    v_pk_mul_f32 v[86:87], v[86:87], v[40:41]
    v_pk_mul_f32 v[88:89], v[88:89], v[40:41]
    v_pk_mul_f32 v[90:91], v[90:91], v[40:41]
    v_pk_mul_f32 v[92:93], v[92:93], v[40:41]
    v_pk_mul_f32 v[94:95], v[94:95], v[40:41]
    v_pk_mul_f32 v[96:97], v[96:97], v[40:41]
    v_pk_mul_f32 v[98:99], v[98:99], v[40:41]
    s_waitcnt lgkmcnt(0)
    s_branch LN2_X
LN2_A:
    v_and_b32 v24, 1, v0
    s_mov_b32 s39, 0x02020000
    v_mul_lo_u32 v24, v24, s39
    v_add_u32 v24, 0x01000c0c, v24
    v_add_u32 v25, s39, v24
    v_add_u32 v26, s39, v25
LN2_X:
    s_lshr_b32 s33, s3, 2
    s_lshl_b32 s35, s33, 7
    s_add_u32 s35, s35, s2
    v_lshlrev_b32 v28, 14, v4
    v_lshl_add_u32 v28, v5, 4, v28
    s_lshl_b32 s44, s2, 7
    s_lshl_b32 s45, s33, 6
    s_add_u32 s44, s44, s45
    s_add_u32 s44, s44, 3149824
    s_add_u32 s45, s44, 262144
    s_add_u32 s46, s44, 524288
    v_perm_b32 v32, v49, v48, v24
    v_perm_b32 v34, v49, v48, v25
    v_perm_b32 v36, v49, v48, v26
    v_perm_b32 v100, v51, v50, v24
    v_perm_b32 v101, v51, v50, v25
    v_perm_b32 v102, v51, v50, v26
    v_pk_fma_f32 v[110:111], v[82:83], v[32:33], v[64:65] op_sel_hi:[1,0,1]
    v_pk_fma_f32 v[112:113], v[84:85], v[34:35], v[66:67] op_sel_hi:[1,0,1]
    v_pk_fma_f32 v[114:115], v[86:87], v[36:37], v[68:69] op_sel_hi:[1,0,1]
    v_perm_b32 v32, v53, v52, v24
    v_perm_b32 v34, v53, v52, v25
    v_perm_b32 v36, v53, v52, v26
    v_perm_b32 v103, v55, v54, v24
    v_perm_b32 v104, v55, v54, v25
    v_perm_b32 v105, v55, v54, v26
    v_pk_fma_f32 v[116:117], v[88:89], v[32:33], v[70:71] op_sel_hi:[1,0,1]
    v_pk_fma_f32 v[118:119], v[90:91], v[34:35], v[72:73] op_sel_hi:[1,0,1]
    v_pk_fma_f32 v[120:121], v[92:93], v[36:37], v[74:75] op_sel_hi:[1,0,1]
    v_perm_b32 v32, v57, v56, v24
    v_perm_b32 v34, v57, v56, v25
    v_perm_b32 v36, v57, v56, v26
    v_perm_b32 v106, v59, v58, v24
    v_perm_b32 v107, v59, v58, v25
    v_perm_b32 v108, v59, v58, v26
    v_pk_fma_f32 v[122:123], v[94:95], v[32:33], v[76:77] op_sel_hi:[1,0,1]
    v_pk_fma_f32 v[124:125], v[96:97], v[34:35], v[78:79] op_sel_hi:[1,0,1]
    v_pk_fma_f32 v[126:127], v[98:99], v[36:37], v[80:81] op_sel_hi:[1,0,1]
    s_waitcnt vmcnt(0)
    buffer_load_dwordx4 v[8:11], v28, s[40:43], s44 offen sc1
    buffer_load_dwordx4 v[12:15], v28, s[40:43], s45 offen sc1
    buffer_load_dwordx4 v[16:19], v28, s[40:43], s46 offen sc1
    v_add_f32 v30, v100, v101
    v_add_f32 v30, v30, v102
    v_add_f32 v30, v30, v103
    v_add_f32 v30, v30, v104
    v_add_f32 v30, v30, v105
    v_add_f32 v30, v30, v106
    v_add_f32 v30, v30, v107
    v_add_f32 v30, v30, v108
    s_nop 1
    v_add_f32_dpp v30, v30, v30 row_ror:8 row_mask:0xf bank_mask:0xf
    s_nop 1
    v_add_f32_dpp v30, v30, v30 row_ror:4 row_mask:0xf bank_mask:0xf
    s_nop 1
    v_add_f32_dpp v30, v30, v30 row_ror:2 row_mask:0xf bank_mask:0xf
    s_nop 1
    v_add_f32_dpp v30, v30, v30 row_ror:1 row_mask:0xf bank_mask:0xf
    s_lshl_b32 s34, s33, 9
    v_lshl_add_u32 v22, v5, 7, s34
    s_and_b32 s34, s3, 3
    s_lshl_b32 s34, s34, 5
    v_add_u32 v21, s34, v22
    ds_write_b32 v21, v30 offset:1048
    s_lshl_b32 s39, s35, 5
    s_add_u32 s39, s39, 6295552
    v_lshlrev_b32 v31, 3, v5
    s_lshl_b32 s34, s33, 5
    v_add_u32 v29, s34, v31
    v_lshl_add_u32 v31, v3, 13, v31
    s_lshl_b32 s34, s35, 3
    s_sub_u32 s34, 0xffff, s34
    v_lshlrev_b32 v27, 1, v5
    v_sub_u32 v27, s34, v27
    v_add_u32 v26, -1, v27
    s_mov_b32 s36, 0xffff0000
    s_mov_b32 s49, 0
P_4:
    s_add_u32 s49, s49, 1
    s_waitcnt vmcnt(0)
    v_cmp_ne_u32 s[6:7], s48, v11
    v_cmp_ne_u32 s[8:9], s48, v15
    v_cmp_ne_u32 s[10:11], s48, v19
    s_or_b64 s[50:51], s[6:7], s[8:9]
    s_or_b64 s[50:51], s[50:51], s[10:11]
    s_cbranch_scc0 PD_5
    s_or_b32 s50, s6, s7
    s_lshr_b32 s51, s50, 16
    s_or_b32 s50, s50, s51
    s_pack_ll_b32_b16 exec_lo, s50, s50
    s_mov_b32 exec_hi, exec_lo
    s_cbranch_execz PS_6
    buffer_load_dwordx4 v[8:11], v28, s[40:43], s44 offen sc1
PS_6:
    s_or_b32 s50, s8, s9
    s_lshr_b32 s51, s50, 16
    s_or_b32 s50, s50, s51
    s_pack_ll_b32_b16 exec_lo, s50, s50
    s_mov_b32 exec_hi, exec_lo
    s_cbranch_execz PS_7
    buffer_load_dwordx4 v[12:15], v28, s[40:43], s45 offen sc1
PS_7:
    s_or_b32 s50, s10, s11
    s_lshr_b32 s51, s50, 16
    s_or_b32 s50, s50, s51
    s_pack_ll_b32_b16 exec_lo, s50, s50
    s_mov_b32 exec_hi, exec_lo
    s_cbranch_execz PS_8
    buffer_load_dwordx4 v[16:19], v28, s[40:43], s46 offen sc1
PS_8:
    s_mov_b64 exec, -1
    s_cmp_lt_u32 s49, 60000
    s_cbranch_scc1 P_4
    s_waitcnt vmcnt(0)
PD_5:
    v_lshlrev_b32 v44, 16, v8
    v_and_b32 v45, 0xffff0000, v8
    v_lshlrev_b32 v46, 16, v9
    v_and_b32 v47, 0xffff0000, v9
    v_lshlrev_b32 v48, 16, v10
    v_and_b32 v49, 0xffff0000, v10
    v_lshlrev_b32 v50, 16, v12
    v_and_b32 v51, 0xffff0000, v12
    v_lshlrev_b32 v52, 16, v13
    v_and_b32 v53, 0xffff0000, v13
    v_lshlrev_b32 v54, 16, v14
    v_and_b32 v55, 0xffff0000, v14
    v_lshlrev_b32 v56, 16, v16
    v_and_b32 v57, 0xffff0000, v16
    v_lshlrev_b32 v58, 16, v17
    v_and_b32 v59, 0xffff0000, v17
    v_lshlrev_b32 v60, 16, v18
    v_and_b32 v61, 0xffff0000, v18
    v_pk_add_f32 v[110:111], v[110:111], v[44:45]
    v_pk_add_f32 v[112:113], v[112:113], v[46:47]
    v_pk_add_f32 v[114:115], v[114:115], v[48:49]
    v_pk_add_f32 v[116:117], v[116:117], v[50:51]
    v_pk_add_f32 v[118:119], v[118:119], v[52:53]
    v_pk_add_f32 v[120:121], v[120:121], v[54:55]
    v_pk_add_f32 v[122:123], v[122:123], v[56:57]
    v_pk_add_f32 v[124:125], v[124:125], v[58:59]
    v_pk_add_f32 v[126:127], v[126:127], v[60:61]
    v_pk_mul_f32 v[34:35], v[110:111], v[110:111]
    v_pk_mul_f32 v[36:37], v[110:111], v[100:101] op_sel:[0,0] op_sel_hi:[1,0]
    v_pk_add_f32 v[32:33], v[112:113], v[110:111]
    v_pk_fma_f32 v[34:35], v[112:113], v[112:113], v[34:35]
    v_pk_fma_f32 v[36:37], v[112:113], v[100:101], v[36:37] op_sel:[0,1,0] op_sel_hi:[1,1,1]
    v_pk_add_f32 v[32:33], v[114:115], v[32:33]
    v_pk_fma_f32 v[34:35], v[114:115], v[114:115], v[34:35]
    v_pk_fma_f32 v[36:37], v[114:115], v[102:103], v[36:37] op_sel:[0,0,0] op_sel_hi:[1,0,1]
    v_pk_add_f32 v[32:33], v[116:117], v[32:33]
    v_pk_fma_f32 v[34:35], v[116:117], v[116:117], v[34:35]
    v_pk_fma_f32 v[36:37], v[116:117], v[102:103], v[36:37] op_sel:[0,1,0] op_sel_hi:[1,1,1]
    v_pk_add_f32 v[32:33], v[118:119], v[32:33]
    v_pk_fma_f32 v[34:35], v[118:119], v[118:119], v[34:35]
    v_pk_fma_f32 v[36:37], v[118:119], v[104:105], v[36:37] op_sel:[0,0,0] op_sel_hi:[1,0,1]
    v_pk_add_f32 v[32:33], v[120:121], v[32:33]
    v_pk_fma_f32 v[34:35], v[120:121], v[120:121], v[34:35]
    v_pk_fma_f32 v[36:37], v[120:121], v[104:105], v[36:37] op_sel:[0,1,0] op_sel_hi:[1,1,1]
    v_pk_add_f32 v[32:33], v[122:123], v[32:33]
    v_pk_fma_f32 v[34:35], v[122:123], v[122:123], v[34:35]
    v_pk_fma_f32 v[36:37], v[122:123], v[106:107], v[36:37] op_sel:[0,0,0] op_sel_hi:[1,0,1]
    v_pk_add_f32 v[32:33], v[124:125], v[32:33]
    v_pk_fma_f32 v[34:35], v[124:125], v[124:125], v[34:35]
    v_pk_fma_f32 v[36:37], v[124:125], v[106:107], v[36:37] op_sel:[0,1,0] op_sel_hi:[1,1,1]
    v_pk_add_f32 v[32:33], v[126:127], v[32:33]
    v_pk_fma_f32 v[34:35], v[126:127], v[126:127], v[34:35]
    v_pk_fma_f32 v[36:37], v[126:127], v[108:109], v[36:37] op_sel:[0,0,0] op_sel_hi:[1,0,1]
    v_add_f32_dpp v32, v32, v32 row_ror:8 row_mask:0xf bank_mask:0xf
    v_add_f32_dpp v33, v33, v33 row_ror:8 row_mask:0xf bank_mask:0xf
    v_add_f32_dpp v34, v34, v34 row_ror:8 row_mask:0xf bank_mask:0xf
    v_add_f32_dpp v35, v35, v35 row_ror:8 row_mask:0xf bank_mask:0xf
    v_add_f32_dpp v36, v36, v36 row_ror:8 row_mask:0xf bank_mask:0xf
    v_add_f32_dpp v37, v37, v37 row_ror:8 row_mask:0xf bank_mask:0xf
    v_add_f32_dpp v32, v32, v32 row_ror:4 row_mask:0xf bank_mask:0xf
    v_add_f32_dpp v33, v33, v33 row_ror:4 row_mask:0xf bank_mask:0xf
    v_add_f32_dpp v34, v34, v34 row_ror:4 row_mask:0xf bank_mask:0xf
    v_add_f32_dpp v35, v35, v35 row_ror:4 row_mask:0xf bank_mask:0xf
    v_add_f32_dpp v36, v36, v36 row_ror:4 row_mask:0xf bank_mask:0xf
    v_add_f32_dpp v37, v37, v37 row_ror:4 row_mask:0xf bank_mask:0xf
    v_add_f32_dpp v32, v32, v32 row_ror:2 row_mask:0xf bank_mask:0xf
    v_add_f32_dpp v33, v33, v33 row_ror:2 row_mask:0xf bank_mask:0xf
    v_add_f32_dpp v34, v34, v34 row_ror:2 row_mask:0xf bank_mask:0xf
    v_add_f32_dpp v35, v35, v35 row_ror:2 row_mask:0xf bank_mask:0xf
    v_add_f32_dpp v36, v36, v36 row_ror:2 row_mask:0xf bank_mask:0xf
    v_add_f32_dpp v37, v37, v37 row_ror:2 row_mask:0xf bank_mask:0xf
    v_add_f32_dpp v32, v32, v32 row_ror:1 row_mask:0xf bank_mask:0xf
    v_add_f32_dpp v33, v33, v33 row_ror:1 row_mask:0xf bank_mask:0xf
    v_add_f32_dpp v34, v34, v34 row_ror:1 row_mask:0xf bank_mask:0xf
    v_add_f32_dpp v35, v35, v35 row_ror:1 row_mask:0xf bank_mask:0xf
    v_add_f32_dpp v36, v36, v36 row_ror:1 row_mask:0xf bank_mask:0xf
    v_add_f32_dpp v37, v37, v37 row_ror:1 row_mask:0xf bank_mask:0xf
    s_mov_b64 exec, s[54:55]
    ds_write_b128 v21, v[32:35] offset:1024
    ds_write_b64 v21, v[36:37] offset:1040
    s_mov_b64 exec, -1
    s_mul_i32 s34, s33, 5
    s_cmp_eq_u32 s3, s34
    s_cbranch_scc1 LN2_P
    s_setprio 1
LN2_P:
    s_waitcnt lgkmcnt(0)
    s_barrier
    ds_read_b128 v[32:35], v22 offset:1024
    ds_read_b128 v[36:39], v22 offset:1040
    ds_read_b128 v[64:67], v22 offset:1056
    ds_read_b128 v[68:71], v22 offset:1072
    ds_read_b128 v[72:75], v22 offset:1088
    ds_read_b128 v[76:79], v22 offset:1104
    ds_read_b128 v[8:11], v22 offset:1120
    ds_read_b128 v[12:15], v22 offset:1136
    s_waitcnt lgkmcnt(4)
    v_pk_add_f32 v[32:33], v[32:33], v[64:65]
    v_pk_add_f32 v[34:35], v[34:35], v[66:67]
    v_pk_add_f32 v[36:37], v[36:37], v[68:69]
    v_add_f32 v38, v38, v70
    s_waitcnt lgkmcnt(0)
    v_pk_add_f32 v[72:73], v[72:73], v[8:9]
    v_pk_add_f32 v[74:75], v[74:75], v[10:11]
    v_pk_add_f32 v[76:77], v[76:77], v[12:13]
    v_add_f32 v78, v78, v14
    v_pk_add_f32 v[32:33], v[32:33], v[72:73]
    v_pk_add_f32 v[34:35], v[34:35], v[74:75]
    v_pk_add_f32 v[36:37], v[36:37], v[76:77]
    v_add_f32 v38, v38, v78
    v_pk_mul_f32 v[32:33], v[32:33], s[52:53] op_sel_hi:[1,0]
    v_pk_mul_f32 v[34:35], v[34:35], s[52:53] op_sel_hi:[1,0]
    v_pk_fma_f32 v[34:35], v[32:33], v[32:33], v[34:35] neg_lo:[1,0,0] neg_hi:[1,0,0]
    v_max_f32 v34, 0, v34
    v_max_f32 v35, 0, v35
    v_cvt_pk_bf16_f32 v40, v34, v35
    v_lshlrev_b32 v34, 16, v40
    v_and_b32 v35, 0xffff0000, v40
    v_add_f32 v34, 0x3727c5ac, v34
    v_add_f32 v35, 0x3727c5ac, v35
    v_cvt_pk_bf16_f32 v40, v34, v35
    v_lshlrev_b32 v34, 16, v40
    v_and_b32 v35, 0xffff0000, v40
    v_sqrt_f32 v34, v34
    v_sqrt_f32 v35, v35
    v_cvt_pk_bf16_f32 v41, v32, v33
    v_lshlrev_b32 v32, 16, v41
    v_and_b32 v33, 0xffff0000, v41
    v_cvt_pk_bf16_f32 v40, v34, v35
    v_lshlrev_b32 v34, 16, v40
    v_and_b32 v35, 0xffff0000, v40
    v_rcp_f32 v34, v34
    v_rcp_f32 v35, v35
    s_cmp_lg_u32 s3, s34
    s_cbranch_scc1 NOKEY
    v_pk_fma_f32 v[36:37], v[32:33], v[38:39], v[36:37] op_sel_hi:[1,0,1] neg_lo:[1,0,0] neg_hi:[1,0,0]
    v_pk_mul_f32 v[36:37], v[36:37], v[34:35]
    v_cvt_pk_bf16_f32 v40, v36, v37
    v_pk_ashrrev_i16 v41, 15, v40 op_sel_hi:[0,1]
    v_or_b32 v41, 0x80008000, v41
    v_xor_b32 v18, v40, v41
    s_mov_b32 exec_lo, 0x00ff00ff
    s_mov_b32 exec_hi, 0x00ff00ff
    buffer_store_dwordx2 v[18:19], v31, s[40:43], s39 offen sc1
    v_lshl_or_b32 v40, v18, 16, v27
    v_and_or_b32 v41, v18, s36, v26
    ds_write_b64 v29, v[40:41] offset:576
    s_mov_b64 exec, -1
    s_waitcnt lgkmcnt(0)
NOKEY:
    s_barrier
    s_setprio 1
    v_mul_u32_u24 v30, 12, v4
    v_mul_u32_u24 v31, 2304, v5
    s_mul_i32 s34, s33, 9216
    v_add3_u32 v30, v30, v31, s34
    v_add_u32 v29, 34688, v30
    v_add_u32 v31, 53120, v30
    v_add_u32 v30, 16256, v30
    v_cvt_pk_bf16_f32 v44, v110, v111
    v_cvt_pk_bf16_f32 v45, v112, v113
    v_cvt_pk_bf16_f32 v46, v114, v115
    v_lshlrev_b32 v110, 16, v44
    v_and_b32 v111, 0xffff0000, v44
    v_lshlrev_b32 v112, 16, v45
    v_and_b32 v113, 0xffff0000, v45
    v_lshlrev_b32 v114, 16, v46
    v_and_b32 v115, 0xffff0000, v46
    v_pk_add_f32 v[82:83], v[110:111], v[32:33] neg_lo:[0,1] neg_hi:[0,1]
    v_pk_add_f32 v[84:85], v[112:113], v[32:33] neg_lo:[0,1] neg_hi:[0,1]
    v_pk_add_f32 v[86:87], v[114:115], v[32:33] neg_lo:[0,1] neg_hi:[0,1]
    v_pk_mul_f32 v[82:83], v[82:83], v[34:35]
    v_pk_mul_f32 v[84:85], v[84:85], v[34:35]
    v_pk_mul_f32 v[86:87], v[86:87], v[34:35]
    v_cvt_pk_bf16_f32 v47, v82, v83
    v_cvt_pk_bf16_f32 v48, v84, v85
    v_cvt_pk_bf16_f32 v49, v86, v87
    v_pk_add_f32 v[82:83], v[82:83], v[110:111]
    v_pk_add_f32 v[84:85], v[84:85], v[112:113]
    v_pk_add_f32 v[86:87], v[86:87], v[114:115]
    v_cvt_pk_bf16_f32 v50, v82, v83
    v_cvt_pk_bf16_f32 v51, v84, v85
    v_cvt_pk_bf16_f32 v52, v86, v87
    ds_write2_b32 v29, v44, v45 offset0:0 offset1:1
    ds_write_b32 v29, v46 offset:8
    ds_write2_b32 v30, v47, v48 offset0:0 offset1:1
    ds_write_b32 v30, v49 offset:8
    ds_write2_b32 v31, v50, v51 offset0:0 offset1:1
    ds_write_b32 v31, v52 offset:8
    v_cvt_pk_bf16_f32 v53, v116, v117
    v_cvt_pk_bf16_f32 v54, v118, v119
    v_cvt_pk_bf16_f32 v55, v120, v121
    v_lshlrev_b32 v116, 16, v53
    v_and_b32 v117, 0xffff0000, v53
    v_lshlrev_b32 v118, 16, v54
    v_and_b32 v119, 0xffff0000, v54
    v_lshlrev_b32 v120, 16, v55
    v_and_b32 v121, 0xffff0000, v55
    v_pk_add_f32 v[88:89], v[116:117], v[32:33] neg_lo:[0,1] neg_hi:[0,1]
    v_pk_add_f32 v[90:91], v[118:119], v[32:33] neg_lo:[0,1] neg_hi:[0,1]
    v_pk_add_f32 v[92:93], v[120:121], v[32:33] neg_lo:[0,1] neg_hi:[0,1]
    v_pk_mul_f32 v[88:89], v[88:89], v[34:35]
    v_pk_mul_f32 v[90:91], v[90:91], v[34:35]
    v_pk_mul_f32 v[92:93], v[92:93], v[34:35]
    v_cvt_pk_bf16_f32 v56, v88, v89
    v_cvt_pk_bf16_f32 v57, v90, v91
    v_cvt_pk_bf16_f32 v58, v92, v93
    v_pk_add_f32 v[88:89], v[88:89], v[116:117]
    v_pk_add_f32 v[90:91], v[90:91], v[118:119]
    v_pk_add_f32 v[92:93], v[92:93], v[120:121]
    v_cvt_pk_bf16_f32 v59, v88, v89
    v_cvt_pk_bf16_f32 v60, v90, v91
    v_cvt_pk_bf16_f32 v61, v92, v93
    ds_write2_b32 v29, v53, v54 offset0:48 offset1:49
    ds_write_b32 v29, v55 offset:200
    ds_write2_b32 v30, v56, v57 offset0:48 offset1:49
    ds_write_b32 v30, v58 offset:200
    ds_write2_b32 v31, v59, v60 offset0:48 offset1:49
    ds_write_b32 v31, v61 offset:200
    v_cvt_pk_bf16_f32 v44, v122, v123
    v_cvt_pk_bf16_f32 v45, v124, v125
    v_cvt_pk_bf16_f32 v46, v126, v127
    v_lshlrev_b32 v122, 16, v44
    v_and_b32 v123, 0xffff0000, v44
    v_lshlrev_b32 v124, 16, v45
    v_and_b32 v125, 0xffff0000, v45
    v_lshlrev_b32 v126, 16, v46
    v_and_b32 v127, 0xffff0000, v46
    v_pk_add_f32 v[94:95], v[122:123], v[32:33] neg_lo:[0,1] neg_hi:[0,1]
    v_pk_add_f32 v[96:97], v[124:125], v[32:33] neg_lo:[0,1] neg_hi:[0,1]
    v_pk_add_f32 v[98:99], v[126:127], v[32:33] neg_lo:[0,1] neg_hi:[0,1]
    v_pk_mul_f32 v[94:95], v[94:95], v[34:35]
    v_pk_mul_f32 v[96:97], v[96:97], v[34:35]
    v_pk_mul_f32 v[98:99], v[98:99], v[34:35]
    v_cvt_pk_bf16_f32 v47, v94, v95
    v_cvt_pk_bf16_f32 v48, v96, v97
    v_cvt_pk_bf16_f32 v49, v98, v99
    v_pk_add_f32 v[94:95], v[94:95], v[122:123]
    v_pk_add_f32 v[96:97], v[96:97], v[124:125]
    v_pk_add_f32 v[98:99], v[98:99], v[126:127]
    v_cvt_pk_bf16_f32 v50, v94, v95
    v_cvt_pk_bf16_f32 v51, v96, v97
    v_cvt_pk_bf16_f32 v52, v98, v99
    ds_write2_b32 v29, v44, v45 offset0:96 offset1:97
    ds_write_b32 v29, v46 offset:392
    ds_write2_b32 v30, v47, v48 offset0:96 offset1:97
    ds_write_b32 v30, v49 offset:392
    ds_write2_b32 v31, v50, v51 offset0:96 offset1:97
    ds_write_b32 v31, v52 offset:392
    s_waitcnt lgkmcnt(0)
    s_barrier
    s_branch FIN
LN2_H:
    s_setprio 2
    v_and_b32 v11, 511, v0
    v_lshlrev_b32 v10, 4, v11
    s_and_b32 s39, s2, 7
    s_lshl_b32 s39, s39, 13
    s_add_u32 s39, s39, 6295552
    v_lshlrev_b32 v16, 2, v11
    v_sub_u32 v16, 0xffff, v16
    v_add_u32 v17, -1, v16
    v_add_u32 v18, -2, v16
    v_add_u32 v19, -3, v16
    v_lshlrev_b32 v8, 2, v3
    v_and_b32 v32, 127, v0
    v_mul_u32_u24 v33, 24, v32
    s_bitcmp1_b32 s3, 1
    s_cselect_b32 s37, 18432, 0
    s_cselect_b32 s36, 1, 0
    v_add_u32 v33, s37, v33
    s_add_u32 s36, s36, 96
    v_cmp_gt_u32 s[44:45], s36, v32
    s_movk_i32 s36, 96
    v_cmp_eq_u32 s[46:47], s36, v32
    v_lshlrev_b32 v32, 4, v32
    v_mov_b32 v27, s48
    s_mov_b32 s17, 0
    s_mov_b32 s18, 0
    s_mov_b32 s12, 0xffff0000
    s_mov_b32 s32, s28
    s_and_b32 s33, s29, 0xffff
    s_mov_b32 s34, 0x00240000
    s_mov_b32 s35, 0x00020000
    s_barrier
    s_barrier
    ds_read_b32 v8, v8 offset:576
    s_sleep 2
    buffer_load_dwordx4 v[12:15], v10, s[40:43], s39 offen sc1
    s_waitcnt lgkmcnt(0)
RANK:
    v_mov_b32 v9, v8
    s_nop 1
    v_max_u32_dpp v9, v9, v9 row_ror:8 row_mask:0xf bank_mask:0xf
    s_nop 1
    v_max_u32_dpp v9, v9, v9 row_ror:4 row_mask:0xf bank_mask:0xf
    s_nop 1
    v_max_u32_dpp v9, v9, v9 row_ror:2 row_mask:0xf bank_mask:0xf
    s_nop 1
    v_max_u32_dpp v9, v9, v9 row_ror:1 row_mask:0xf bank_mask:0xf
    v_cmp_ne_u32 vcc, v8, v9
    v_readfirstlane_b32 s15, v9
    s_nop 0
    v_cndmask_b32 v8, 0, v8, vcc
    v_mov_b32 v9, v8
    s_nop 1
    v_max_u32_dpp v9, v9, v9 row_ror:8 row_mask:0xf bank_mask:0xf
    s_nop 1
    v_max_u32_dpp v9, v9, v9 row_ror:4 row_mask:0xf bank_mask:0xf
    s_nop 1
    v_max_u32_dpp v9, v9, v9 row_ror:2 row_mask:0xf bank_mask:0xf
    s_nop 1
    v_max_u32_dpp v9, v9, v9 row_ror:1 row_mask:0xf bank_mask:0xf
    v_cmp_ne_u32 vcc, v8, v9
    v_readfirstlane_b32 s16, v9
    s_nop 0
    v_cndmask_b32 v8, 0, v8, vcc
    s_bitcmp1_b32 s3, 2
    s_cselect_b32 s19, s16, s15
    s_not_b32 s13, s19
    s_bfe_u32 s14, s13, 0x1000a
    s_and_b32 s13, s13, 7
    s_lshl_b32 s14, s14, 3
    s_or_b32 s4, s13, s14
    s_lshr_b32 s5, s4, 1
    s_mul_i32 s5, s5, 2304
    v_add_u32 v34, s5, v33
    s_bitcmp1_b32 s4, 0
    s_mov_b32 s5, 0x05040100
    s_cselect_b32 s5, 0x07060302, s5
    v_mov_b32 v28, s19
    v_mov_b32 v29, s18
    s_cmp_lg_u32 s18, 0
    s_cbranch_scc1 RK_C2
    s_mov_b32 s49, 0
    s_branch PC_11
P_9:
    buffer_load_dwordx4 v[12:15], v10, s[40:43], s39 offen sc1
PC_11:
    s_add_u32 s49, s49, 1
    s_waitcnt vmcnt(0)
    v_cmp_ne_u32 vcc, s48, v13
    v_cmp_ne_u32 s[50:51], s48, v15
    s_nop 0
    s_or_b64 vcc, vcc, s[50:51]
    s_cbranch_vccz PD_10
    s_cmp_lt_u32 s49, 60000
    s_cbranch_scc1 P_9
PD_10:
    v_lshl_or_b32 v16, v12, 16, v16
    v_and_or_b32 v17, v12, s12, v17
    v_lshl_or_b32 v18, v14, 16, v18
    v_and_or_b32 v19, v14, s12, v19
RK_C2:
    v_cmp_lt_u32 s[20:21], s15, v16
    v_cmp_lt_u32 s[22:23], s15, v17
    v_cmp_lt_u32 s[24:25], s15, v18
    v_cmp_lt_u32 s[26:27], s15, v19
    s_bcnt1_i32_b64 s56, s[20:21]
    s_bcnt1_i32_b64 s57, s[22:23]
    s_bcnt1_i32_b64 s58, s[24:25]
    s_bcnt1_i32_b64 s59, s[26:27]
    v_cmp_lt_u32 s[20:21], s16, v16
    v_cmp_lt_u32 s[22:23], s16, v17
    v_cmp_lt_u32 s[24:25], s16, v18
    v_cmp_lt_u32 s[26:27], s16, v19
    s_add_u32 s56, s56, s57
    s_add_u32 s58, s58, s59
    s_add_u32 s13, s56, s58
    s_bcnt1_i32_b64 s56, s[20:21]
    s_bcnt1_i32_b64 s57, s[22:23]
    s_bcnt1_i32_b64 s58, s[24:25]
    s_bcnt1_i32_b64 s59, s[26:27]
    s_add_u32 s56, s56, s57
    s_add_u32 s58, s58, s59
    s_add_u32 s56, s56, s58
    s_pack_ll_b32_b16 s13, s13, s56
    v_mov_b32 v20, s13
    s_mov_b64 exec, 1
    ds_add_u32 v29, v20 offset:512
    s_mov_b64 exec, -1
    s_waitcnt lgkmcnt(0)
    s_barrier
    ds_read_b32 v29, v29 offset:512
    ds_read_b64 v[36:37], v34 offset:16256
    ds_read_b64 v[38:39], v34 offset:16264
    ds_read_b64 v[40:41], v34 offset:16272
    s_waitcnt lgkmcnt(3)
    v_readfirstlane_b32 s56, v29
    s_nop 0
    s_lshr_b32 s57, s56, 16
    s_and_b32 s56, s56, 0xffff
    s_cmp_ge_u32 s56, 8
    s_cbranch_scc1 RK_DONE
    s_bitcmp1_b32 s3, 2
    s_cselect_b32 s58, s57, s56
    s_cmp_ge_u32 s58, 8
    s_cbranch_scc1 RK_NP
    s_mul_i32 s59, s58, 1536
    s_add_u32 s59, s59, 6361088
    s_lshl_b32 s58, s58, 11
    s_add_u32 s58, s58, 6459392
    s_bitcmp1_b32 s3, 1
    s_cselect_b32 s58, s58, s59
    s_waitcnt lgkmcnt(0)
    v_perm_b32 v24, v37, v36, s5
    v_perm_b32 v25, v39, v38, s5
    v_perm_b32 v26, v41, v40, s5
    v_cndmask_b32 v24, v24, v28, s[46:47]
    s_mov_b64 exec, s[44:45]
    buffer_store_dwordx4 v[24:27], v32, s[40:43], s58 offen sc1
    s_cbranch_scc1 RK_N2
    s_add_u32 s58, s58, 12288
    buffer_store_dwordx4 v[24:27], v32, s[40:43], s58 offen sc1
    s_add_u32 s58, s58, 12288
    buffer_store_dwordx4 v[24:27], v32, s[40:43], s58 offen sc1
    s_add_u32 s58, s58, 12288
    buffer_store_dwordx4 v[24:27], v32, s[40:43], s58 offen sc1
    s_add_u32 s58, s58, 12288
    buffer_store_dwordx4 v[24:27], v32, s[40:43], s58 offen sc1
    s_add_u32 s58, s58, 12288
    buffer_store_dwordx4 v[24:27], v32, s[40:43], s58 offen sc1
    s_add_u32 s58, s58, 12288
    buffer_store_dwordx4 v[24:27], v32, s[40:43], s58 offen sc1
    s_add_u32 s58, s58, 12288
    buffer_store_dwordx4 v[24:27], v32, s[40:43], s58 offen sc1
RK_N2:
    s_mov_b64 exec, -1
RK_NP:
    s_not_b32 s13, s15
    s_bfe_u32 s14, s13, 0x1000a
    s_and_b32 s13, s13, 7
    s_lshl_b32 s14, s14, 3
    s_or_b32 s4, s13, s14
    s_bitset1_b32 s17, s4
    s_cmp_ge_u32 s57, 8
    s_cbranch_scc1 RK_DONE
    s_not_b32 s13, s16
    s_bfe_u32 s14, s13, 0x1000a
    s_and_b32 s13, s13, 7
    s_lshl_b32 s14, s14, 3
    s_or_b32 s4, s13, s14
    s_bitset1_b32 s17, s4
    s_add_u32 s18, s18, 4
    s_waitcnt lgkmcnt(0)
    s_cmp_lt_u32 s18, 32
    s_cbranch_scc1 RANK
RK_DONE:
    s_sub_u32 s4, s3, 8
    s_mul_i32 s5, s4, 2304
    v_lshl_add_u32 v8, v1, 5, s5
    s_waitcnt lgkmcnt(0)
    ds_read_b128 v[40:43], v8 offset:53120
    ds_read_b128 v[44:47], v8 offset:53136
    ds_read_b128 v[48:51], v8 offset:55168
    ds_read_b128 v[52:55], v8 offset:55184
    s_lshr_b32 s6, s4, 2
    s_lshl_b32 s6, s6, 7
    s_add_u32 s6, s6, s2
    s_mul_i32 s6, s6, 9216
    s_and_b32 s7, s4, 3
    s_mul_i32 s7, s7, 2304
    s_add_u32 s6, s6, s7
    s_lshl_b32 s4, s4, 1
    s_lshr_b32 s17, s17, s4
    v_lshlrev_b32 v8, 4, v1
    s_mov_b32 s36, 0x05040100
    s_mov_b32 s37, 0x07060302
    s_sleep 8
    s_waitcnt lgkmcnt(0)
    s_bitcmp1_b32 s17, 0
    s_cbranch_scc1 OS_12
    v_perm_b32 v56, v41, v40, s36
    v_perm_b32 v57, v43, v42, s36
    v_perm_b32 v58, v45, v44, s36
    v_perm_b32 v59, v47, v46, s36
    v_perm_b32 v60, v49, v48, s36
    v_perm_b32 v61, v51, v50, s36
    v_perm_b32 v62, v53, v52, s36
    v_perm_b32 v63, v55, v54, s36
    buffer_store_dwordx4 v[56:59], v8, s[32:35], s6 offen offset:0
    s_mov_b64 exec, 0xff
    buffer_store_dwordx4 v[60:63], v8, s[32:35], s6 offen offset:1024
    s_mov_b64 exec, -1
OS_12:
    s_bitcmp1_b32 s17, 1
    s_cbranch_scc1 OS_13
    v_perm_b32 v64, v41, v40, s37
    v_perm_b32 v65, v43, v42, s37
    v_perm_b32 v66, v45, v44, s37
    v_perm_b32 v67, v47, v46, s37
    v_perm_b32 v68, v49, v48, s37
    v_perm_b32 v69, v51, v50, s37
    v_perm_b32 v70, v53, v52, s37
    v_perm_b32 v71, v55, v54, s37
    buffer_store_dwordx4 v[64:67], v8, s[32:35], s6 offen offset:1152
    s_mov_b64 exec, 0xff
    buffer_store_dwordx4 v[68:71], v8, s[32:35], s6 offen offset:2176
    s_mov_b64 exec, -1
OS_13:
    s_branch FIN
LNMAIN:
    s_mov_b32 s40, s30
    s_and_b32 s41, s31, 0xffff
    s_mov_b32 s42, 0x10000000
    s_mov_b32 s43, 0x00020000
    v_lshlrev_b32 v22, 6, v5
    v_lshl_add_u32 v21, v2, 4, v22
    s_mov_b32 s47, 0
    v_and_b32 v24, 1, v0
    s_mov_b32 s39, 0x02020000
    v_mul_lo_u32 v24, v24, s39
    v_add_u32 v24, 0x01000c0c, v24
    v_add_u32 v25, s39, v24
    v_add_u32 v26, s39, v25
    s_mov_b32 s52, 0x3ae38e39
    s_mov_b32 s54, 0x00010001
    s_mov_b32 s55, 0x00010001
    v_and_b32 v23, 7, v3
    v_lshlrev_b32 v23, 7, v23
    v_lshrrev_b32 v20, 3, v3
    v_lshl_add_u32 v23, v20, 6, v23
    v_lshl_add_u32 v23, v5, 4, v23
    s_mul_i32 s36, s2, 12288
    s_mul_i32 s37, s3, 3072
    s_add_u32 s36, s36, s37
    s_add_u32 s36, s36, 4096
    s_waitcnt vmcnt(5)
    v_perm_b32 v64, v9, v8, v24
    v_perm_b32 v65, v11, v10, v24
    v_perm_b32 v66, v9, v8, v25
    v_perm_b32 v67, v11, v10, v25
    v_perm_b32 v68, v9, v8, v26
    v_perm_b32 v69, v11, v10, v26
    v_pk_mul_f32 v[42:43], v[64:65], v[64:65]
    v_pk_add_f32 v[40:41], v[66:67], v[64:65]
    v_pk_fma_f32 v[42:43], v[66:67], v[66:67], v[42:43]
    v_pk_add_f32 v[40:41], v[68:69], v[40:41]
    v_pk_fma_f32 v[42:43], v[68:69], v[68:69], v[42:43]
    s_waitcnt vmcnt(3)
    v_perm_b32 v70, v13, v12, v24
    v_perm_b32 v71, v15, v14, v24
    v_perm_b32 v72, v13, v12, v25
    v_perm_b32 v73, v15, v14, v25
    v_perm_b32 v74, v13, v12, v26
    v_perm_b32 v75, v15, v14, v26
    v_pk_add_f32 v[40:41], v[70:71], v[40:41]
    v_pk_fma_f32 v[42:43], v[70:71], v[70:71], v[42:43]
    v_pk_add_f32 v[40:41], v[72:73], v[40:41]
    v_pk_fma_f32 v[42:43], v[72:73], v[72:73], v[42:43]
    v_pk_add_f32 v[40:41], v[74:75], v[40:41]
    v_pk_fma_f32 v[42:43], v[74:75], v[74:75], v[42:43]
    s_waitcnt vmcnt(1)
    v_perm_b32 v76, v17, v16, v24
    v_perm_b32 v77, v19, v18, v24
    v_perm_b32 v78, v17, v16, v25
    v_perm_b32 v79, v19, v18, v25
    v_perm_b32 v80, v17, v16, v26
    v_perm_b32 v81, v19, v18, v26
    v_pk_add_f32 v[40:41], v[76:77], v[40:41]
    v_pk_fma_f32 v[42:43], v[76:77], v[76:77], v[42:43]
    v_pk_add_f32 v[40:41], v[78:79], v[40:41]
    v_pk_fma_f32 v[42:43], v[78:79], v[78:79], v[42:43]
    v_pk_add_f32 v[40:41], v[80:81], v[40:41]
    v_pk_fma_f32 v[42:43], v[80:81], v[80:81], v[42:43]
    s_nop 0
    v_add_f32_dpp v40, v40, v40 row_ror:8 row_mask:0xf bank_mask:0xf
    v_add_f32_dpp v41, v41, v41 row_ror:8 row_mask:0xf bank_mask:0xf
    v_add_f32_dpp v42, v42, v42 row_ror:8 row_mask:0xf bank_mask:0xf
    v_add_f32_dpp v43, v43, v43 row_ror:8 row_mask:0xf bank_mask:0xf
    v_add_f32_dpp v40, v40, v40 row_ror:4 row_mask:0xf bank_mask:0xf
    v_add_f32_dpp v41, v41, v41 row_ror:4 row_mask:0xf bank_mask:0xf
    v_add_f32_dpp v42, v42, v42 row_ror:4 row_mask:0xf bank_mask:0xf
    v_add_f32_dpp v43, v43, v43 row_ror:4 row_mask:0xf bank_mask:0xf
    v_add_f32_dpp v40, v40, v40 row_ror:2 row_mask:0xf bank_mask:0xf
    v_add_f32_dpp v41, v41, v41 row_ror:2 row_mask:0xf bank_mask:0xf
    v_add_f32_dpp v42, v42, v42 row_ror:2 row_mask:0xf bank_mask:0xf
    v_add_f32_dpp v43, v43, v43 row_ror:2 row_mask:0xf bank_mask:0xf
    v_add_f32_dpp v40, v40, v40 row_ror:1 row_mask:0xf bank_mask:0xf
    v_add_f32_dpp v41, v41, v41 row_ror:1 row_mask:0xf bank_mask:0xf
    v_add_f32_dpp v42, v42, v42 row_ror:1 row_mask:0xf bank_mask:0xf
    v_add_f32_dpp v43, v43, v43 row_ror:1 row_mask:0xf bank_mask:0xf
    v_max_f32 v43, 0, v43
    s_mov_b64 exec, s[54:55]
    ds_write_b128 v21, v[40:43] offset:0
    s_mov_b64 exec, -1
    s_waitcnt vmcnt(0)
    v_readfirstlane_b32 s48, v51
    s_nop 0
    s_mul_i32 s48, s48, 1664525
    s_add_u32 s48, s48, 1013904223
    v_mov_b32 v11, s48
    v_mov_b32 v15, s48
    v_mov_b32 v19, s48
    s_mov_b32 s49, 0
LA_SPIN:
    ds_read_b128 v[32:35], v22 offset:0
    ds_read_b128 v[36:39], v22 offset:16
    ds_read_b128 v[40:43], v22 offset:32
    ds_read_b128 v[44:47], v22 offset:48
    s_add_u32 s49, s49, 1
    s_waitcnt lgkmcnt(0)
    v_max3_u32 v30, v35, v39, v43
    v_max_u32 v30, v30, v47
    v_cmp_eq_u32 vcc, -1, v30
    s_nop 0
    s_cbranch_vccz LA_GO
    s_cmp_lt_u32 s49, 60000
    s_cbranch_scc1 LA_SPIN
LA_GO:
    v_pk_add_f32 v[32:33], v[32:33], v[36:37]
    v_pk_add_f32 v[34:35], v[34:35], v[38:39]
    v_pk_add_f32 v[40:41], v[40:41], v[44:45]
    v_pk_add_f32 v[42:43], v[42:43], v[46:47]
    v_pk_add_f32 v[32:33], v[32:33], v[40:41]
    v_pk_add_f32 v[60:61], v[34:35], v[42:43]
    v_pk_mul_f32 v[32:33], v[32:33], s[52:53] op_sel_hi:[1,0]
    v_pk_mul_f32 v[60:61], v[60:61], s[52:53] op_sel_hi:[1,0]
    v_pk_fma_f32 v[60:61], v[32:33], v[32:33], v[60:61] neg_lo:[1,0,0] neg_hi:[1,0,0]
    v_max_f32 v60, 0, v60
    v_max_f32 v61, 0, v61
    v_cvt_pk_bf16_f32 v30, v60, v61
    v_lshlrev_b32 v60, 16, v30
    v_and_b32 v61, 0xffff0000, v30
    v_add_f32 v60, 0x3727c5ac, v60
    v_add_f32 v61, 0x3727c5ac, v61
    v_cvt_pk_bf16_f32 v30, v60, v61
    v_lshlrev_b32 v60, 16, v30
    v_and_b32 v61, 0xffff0000, v30
    v_sqrt_f32 v60, v60
    v_sqrt_f32 v61, v61
    v_cvt_pk_bf16_f32 v31, v32, v33
    v_lshlrev_b32 v32, 16, v31
    v_and_b32 v33, 0xffff0000, v31
    v_cvt_pk_bf16_f32 v30, v60, v61
    v_lshlrev_b32 v60, 16, v30
    v_and_b32 v61, 0xffff0000, v30
    v_rcp_f32 v60, v60
    v_rcp_f32 v61, v61
    v_pk_add_f32 v[82:83], v[64:65], v[32:33] neg_lo:[0,1] neg_hi:[0,1]
    v_pk_add_f32 v[84:85], v[66:67], v[32:33] neg_lo:[0,1] neg_hi:[0,1]
    v_pk_add_f32 v[86:87], v[68:69], v[32:33] neg_lo:[0,1] neg_hi:[0,1]
    v_pk_mul_f32 v[82:83], v[82:83], v[60:61]
    v_pk_mul_f32 v[84:85], v[84:85], v[60:61]
    v_pk_mul_f32 v[86:87], v[86:87], v[60:61]
    v_cvt_pk_f16_f32 v8, v82, v83
    v_cvt_pk_f16_f32 v9, v84, v85
    v_cvt_pk_f16_f32 v10, v86, v87
    buffer_store_dwordx4 v[8:11], v23, s[40:43], s36 offen offset:0 sc1
    v_pk_add_f32 v[88:89], v[70:71], v[32:33] neg_lo:[0,1] neg_hi:[0,1]
    v_pk_add_f32 v[90:91], v[72:73], v[32:33] neg_lo:[0,1] neg_hi:[0,1]
    v_pk_add_f32 v[92:93], v[74:75], v[32:33] neg_lo:[0,1] neg_hi:[0,1]
    v_pk_mul_f32 v[88:89], v[88:89], v[60:61]
    v_pk_mul_f32 v[90:91], v[90:91], v[60:61]
    v_pk_mul_f32 v[92:93], v[92:93], v[60:61]
    v_cvt_pk_f16_f32 v12, v88, v89
    v_cvt_pk_f16_f32 v13, v90, v91
    v_cvt_pk_f16_f32 v14, v92, v93
    buffer_store_dwordx4 v[12:15], v23, s[40:43], s36 offen offset:1024 sc1
    v_pk_add_f32 v[94:95], v[76:77], v[32:33] neg_lo:[0,1] neg_hi:[0,1]
    v_pk_add_f32 v[96:97], v[78:79], v[32:33] neg_lo:[0,1] neg_hi:[0,1]
    v_pk_add_f32 v[98:99], v[80:81], v[32:33] neg_lo:[0,1] neg_hi:[0,1]
    v_pk_mul_f32 v[94:95], v[94:95], v[60:61]
    v_pk_mul_f32 v[96:97], v[96:97], v[60:61]
    v_pk_mul_f32 v[98:99], v[98:99], v[60:61]
    v_cvt_pk_f16_f32 v16, v94, v95
    v_cvt_pk_f16_f32 v17, v96, v97
    v_cvt_pk_f16_f32 v18, v98, v99
    buffer_store_dwordx4 v[16:19], v23, s[40:43], s36 offen offset:2048 sc1
    s_cmp_lt_u32 s2, 128
    s_cbranch_scc1 LN_A
    s_cmp_lg_u32 s3, 0
    s_cbranch_scc1 LN_S
    v_mov_b32 v62, v31
    v_mov_b32 v63, s48
    v_lshlrev_b32 v20, 4, v5
    s_lshl_b32 s36, s2, 6
    s_add_u32 s36, s36, 6467584
    s_mov_b64 exec, s[54:55]
    buffer_store_dwordx4 v[60:63], v20, s[40:43], s36 offen sc1
    s_mov_b64 exec, -1
LN_S:
    s_cmp_ge_u32 s2, 192
    s_cbranch_scc1 FFN_C
    s_branch LN_U
LN_A:
    global_load_dwordx2 v[48:49], v6, s[16:17] offset:0
    global_load_dwordx2 v[50:51], v6, s[20:21] offset:0
    global_load_dwordx2 v[52:53], v6, s[16:17] offset:96
    global_load_dwordx2 v[54:55], v6, s[20:21] offset:96
    global_load_dwordx2 v[56:57], v6, s[16:17] offset:192
    global_load_dwordx2 v[58:59], v6, s[20:21] offset:192
LN_U:
    v_lshlrev_b32 v31, 2, v0
    v_add_u32 v31, 107744, v31
    v_lshrrev_b32 v30, 2, v0
    v_mul_u32_u24 v30, 12288, v30
    v_and_b32 v29, 3, v0
    v_lshl_add_u32 v30, v29, 4, v30
    s_and_b32 s36, s2, 0xf0
    s_lshl_b32 s36, s36, 6
    s_and_b32 s37, s2, 7
    s_lshl_b32 s37, s37, 7
    s_add_u32 s36, s36, s37
    s_and_b32 s37, s2, 8
    s_lshl_b32 s37, s37, 3
    s_add_u32 s36, s36, s37
    s_add_u32 s36, s36, 4096
    s_add_u32 s37, s36, 786432
    s_add_u32 s38, s36, 1572864
    s_add_u32 s39, s36, 2359296
    s_waitcnt vmcnt(0)
    buffer_load_dwordx4 v[32:35], v30, s[40:43], s36 offen sc1
    buffer_load_dwordx4 v[36:39], v30, s[40:43], s37 offen sc1
    buffer_load_dwordx4 v[40:43], v30, s[40:43], s38 offen sc1
    buffer_load_dwordx4 v[44:47], v30, s[40:43], s39 offen sc1
    v_lshl_add_u32 v29, v2, 4, v3
    v_mul_u32_u24 v29, 48, v29
    v_add_u32 v29, 121088, v29
    s_waitcnt vmcnt(4)
    s_mov_b64 exec, 0xffff
    ds_write_b128 v29, v[48:51] offset:0
    ds_write_b128 v29, v[52:55] offset:16
    ds_write_b128 v29, v[56:59] offset:32
    s_mov_b64 exec, -1
    s_mov_b32 s49, 0
P_14:
    s_add_u32 s49, s49, 1
    s_waitcnt vmcnt(0)
    v_cmp_ne_u32 s[6:7], s48, v35
    v_cmp_ne_u32 s[8:9], s48, v39
    v_cmp_ne_u32 s[10:11], s48, v43
    v_cmp_ne_u32 s[12:13], s48, v47
    s_or_b64 s[50:51], s[6:7], s[8:9]
    s_or_b64 s[50:51], s[50:51], s[10:11]
    s_or_b64 s[50:51], s[50:51], s[12:13]
    s_cbranch_scc0 PD_15
    s_sleep 1
    s_wqm_b64 exec, s[6:7]
    s_cbranch_execz PS_16
    buffer_load_dwordx4 v[32:35], v30, s[40:43], s36 offen sc1
PS_16:
    s_wqm_b64 exec, s[8:9]
    s_cbranch_execz PS_17
    buffer_load_dwordx4 v[36:39], v30, s[40:43], s37 offen sc1
PS_17:
    s_wqm_b64 exec, s[10:11]
    s_cbranch_execz PS_18
    buffer_load_dwordx4 v[40:43], v30, s[40:43], s38 offen sc1
PS_18:
    s_wqm_b64 exec, s[12:13]
    s_cbranch_execz PS_19
    buffer_load_dwordx4 v[44:47], v30, s[40:43], s39 offen sc1
PS_19:
    s_mov_b64 exec, -1
    s_cmp_lt_u32 s49, 60000
    s_cbranch_scc1 P_14
    s_waitcnt vmcnt(0)
PD_15:
    ds_write_b32 v31, v32 offset:0
    ds_write_b32 v31, v33 offset:4608
    ds_write_b32 v31, v34 offset:9216
    ds_write_b32 v31, v36 offset:1024
    ds_write_b32 v31, v37 offset:5632
    ds_write_b32 v31, v38 offset:10240
    ds_write_b32 v31, v40 offset:2048
    ds_write_b32 v31, v41 offset:6656
    ds_write_b32 v31, v42 offset:11264
    ds_write_b32 v31, v44 offset:3072
    ds_write_b32 v31, v45 offset:7680
    ds_write_b32 v31, v46 offset:12288
    s_mov_b32 s46, s3
    s_branch CV_B4
FFN_CK:
    s_waitcnt lgkmcnt(0)
    s_load_dword s48, s[30:31], 0
    s_mov_b32 s40, s30
    s_and_b32 s41, s31, 0xffff
    s_mov_b32 s42, 0x10000000
    s_mov_b32 s43, 0x00020000
FFN_C:
    s_and_b32 s56, s2, 7
    s_bfe_u32 s57, s2, 0x30003
    s_lshl_b32 s44, s56, 3
    s_or_b32 s44, s44, s57
    s_branch FFN_L
FFN_B:
    s_barrier
    s_sub_u32 s44, s2, 120
FFN_L:
    s_setprio 0
    s_cmp_ge_u32 s3, 8
    s_cbranch_scc1 F_L2
    s_barrier
    v_bfe_u32 v7, v1, 2, 2
    v_bfe_u32 v8, v1, 1, 1
    v_lshl_add_u32 v9, v5, 3, v7
    v_lshlrev_b32 v9, 7, v9
    v_mul_u32_u24 v10, 73728, v8
    v_add_u32 v9, v9, v10
    v_lshrrev_b32 v7, 1, v7
    v_and_b32 v10, 1, v5
    v_lshl_add_u32 v7, v10, 1, v7
    v_lshl_add_u32 v7, v8, 2, v7
    v_xor_b32 v7, s3, v7
    v_lshl_add_u32 v9, v7, 4, v9
    v_and_b32 v7, 1, v1
    v_lshl_add_u32 v9, v7, 3, v9
    v_add_u32 v9, 2048, v9
    v_add_u32 v10, 36864, v9
    s_cmp_lt_u32 s2, 192
    s_cbranch_scc1 CT_20
    s_cmp_lt_u32 s3, 4
    s_cbranch_scc1 CT_20
    s_waitcnt lgkmcnt(0)
    s_mul_i32 s48, s48, 1664525
    s_add_u32 s48, s48, 1013904223
CT_20:
    s_barrier
    ds_read_b64_tr_b16 v[56:57], v9 offset:0
    ds_read_b64_tr_b16 v[58:59], v9 offset:512
    ds_read_b64_tr_b16 v[60:61], v9 offset:4096
    ds_read_b64_tr_b16 v[62:63], v9 offset:4608
    ds_read_b64_tr_b16 v[64:65], v9 offset:8192
    ds_read_b64_tr_b16 v[66:67], v9 offset:8704
    ds_read_b64_tr_b16 v[68:69], v9 offset:12288
    ds_read_b64_tr_b16 v[70:71], v9 offset:12800
    ds_read_b64_tr_b16 v[72:73], v9 offset:16384
    ds_read_b64_tr_b16 v[74:75], v9 offset:16896
    ds_read_b64_tr_b16 v[76:77], v9 offset:20480
    ds_read_b64_tr_b16 v[78:79], v9 offset:20992
    ds_read_b64_tr_b16 v[80:81], v9 offset:24576
    ds_read_b64_tr_b16 v[82:83], v9 offset:25088
    s_waitcnt lgkmcnt(12)
    ds_read_b64_tr_b16 v[84:85], v9 offset:28672
    ds_read_b64_tr_b16 v[86:87], v9 offset:29184
    s_waitcnt lgkmcnt(12)
    ds_read_b64_tr_b16 v[88:89], v9 offset:32768
    ds_read_b64_tr_b16 v[90:91], v9 offset:33280
    s_waitcnt lgkmcnt(12)
    ds_read_b64_tr_b16 v[92:93], v10 offset:0
    ds_read_b64_tr_b16 v[94:95], v10 offset:512
    s_waitcnt lgkmcnt(12)
    ds_read_b64_tr_b16 v[96:97], v10 offset:4096
    ds_read_b64_tr_b16 v[98:99], v10 offset:4608
    s_waitcnt lgkmcnt(12)
    ds_read_b64_tr_b16 v[100:101], v10 offset:8192
    ds_read_b64_tr_b16 v[102:103], v10 offset:8704
    s_waitcnt lgkmcnt(12)
    ds_read_b64_tr_b16 v[104:105], v10 offset:12288
    ds_read_b64_tr_b16 v[106:107], v10 offset:12800
    s_waitcnt lgkmcnt(12)
    ds_read_b64_tr_b16 v[108:109], v10 offset:16384
    ds_read_b64_tr_b16 v[110:111], v10 offset:16896
    s_waitcnt lgkmcnt(12)
    ds_read_b64_tr_b16 v[112:113], v10 offset:20480
    ds_read_b64_tr_b16 v[114:115], v10 offset:20992
    s_waitcnt lgkmcnt(12)
    ds_read_b64_tr_b16 v[116:117], v10 offset:24576
    ds_read_b64_tr_b16 v[118:119], v10 offset:25088
    s_waitcnt lgkmcnt(12)
    ds_read_b64_tr_b16 v[120:121], v10 offset:28672
    ds_read_b64_tr_b16 v[122:123], v10 offset:29184
    s_waitcnt lgkmcnt(12)
    ds_read_b64_tr_b16 v[124:125], v10 offset:32768
    ds_read_b64_tr_b16 v[126:127], v10 offset:33280
    v_lshlrev_b32 v7, 4, v1
    v_and_b32 v20, 31, v1
    v_lshlrev_b32 v21, 4, v20
    s_mul_i32 s38, s3, 1536
    s_and_b32 s39, s2, 7
    s_mul_i32 s39, s39, 12288
    s_add_u32 s38, s38, s39
    s_add_u32 s38, s38, 6361088
    s_mul_i32 s39, s3, 1168
    v_mul_u32_u24 v22, 12, v1
    v_add_u32 v22, s39, v22
    v_mul_u32_u24 v23, 12, v20
    v_add_u32 v23, s39, v23
    v_and_b32 v6, 7, v1
    v_mul_u32_u24 v4, 1168, v6
    v_lshl_add_u32 v4, v5, 4, v4
    v_mul_u32_u24 v6, 144, v6
    v_and_b32 v20, 1, v5
    v_lshl_add_u32 v6, v20, 3, v6
    v_lshrrev_b32 v20, 1, v5
    v_lshl_add_u32 v6, v20, 2, v6
    s_lshl_b32 s39, s3, 4
    v_add_u32 v6, s39, v6
    s_mov_b32 s56, 0x00ff00ff
    s_mov_b32 s57, 0x00ff00ff
    s_waitcnt lgkmcnt(0)
    s_setprio 3
    s_barrier
    s_sleep 14
    s_mov_b32 s49, 0
P_21:
    buffer_load_dwordx4 v[12:15], v7, s[40:43], s38 offen sc1
    buffer_load_dwordx4 v[16:19], v21, s[40:43], s38 offen offset:1024 sc1
PC_23:
    s_add_u32 s49, s49, 1
    s_waitcnt vmcnt(0)
    v_cmp_ne_u32 vcc, s48, v15
    v_cmp_ne_u32 s[50:51], s48, v19
    s_nop 0
    s_or_b64 vcc, vcc, s[50:51]
    s_cbranch_vccz PD_22
    s_cmp_lt_u32 s49, 60000
    s_cbranch_scc1 P_21
PD_22:
    ds_write_b32 v22, v12 offset:2048
    ds_write_b32 v22, v13 offset:2052
    ds_write_b32 v22, v14 offset:2056
    ds_write_b32 v23, v16 offset:2816
    ds_write_b32 v23, v17 offset:2820
    ds_write_b32 v23, v18 offset:2824
    s_waitcnt lgkmcnt(0)
    s_barrier
    ds_read_b128 v[12:15], v4 offset:2048
    ds_read_b128 v[16:19], v4 offset:2112
    ds_read_b128 v[20:23], v4 offset:2176
    ds_read_b128 v[24:27], v4 offset:2240
    ds_read_b128 v[28:31], v4 offset:2304
    ds_read_b128 v[32:35], v4 offset:2368
    ds_read_b128 v[36:39], v4 offset:2432
    ds_read_b128 v[40:43], v4 offset:2496
    ds_read_b128 v[44:47], v4 offset:2560
    ds_read_b128 v[48:51], v4 offset:2624
    ds_read_b128 v[52:55], v4 offset:2688
    s_waitcnt lgkmcnt(10)
    v_mfma_f32_16x16x32_bf16 v[8:11], v[56:59], v[12:15], 0
    ds_read_b128 v[12:15], v4 offset:2752
    s_waitcnt lgkmcnt(10)
    v_mfma_f32_16x16x32_bf16 v[8:11], v[60:63], v[16:19], v[8:11]
    ds_read_b128 v[16:19], v4 offset:2816
    s_waitcnt lgkmcnt(10)
    v_mfma_f32_16x16x32_bf16 v[8:11], v[64:67], v[20:23], v[8:11]
    ds_read_b128 v[20:23], v4 offset:2880
    s_waitcnt lgkmcnt(10)
    v_mfma_f32_16x16x32_bf16 v[8:11], v[68:71], v[24:27], v[8:11]
    ds_read_b128 v[24:27], v4 offset:2944
    s_waitcnt lgkmcnt(10)
    v_mfma_f32_16x16x32_bf16 v[8:11], v[72:75], v[28:31], v[8:11]
    ds_read_b128 v[28:31], v4 offset:3008
    s_waitcnt lgkmcnt(10)
    v_mfma_f32_16x16x32_bf16 v[8:11], v[76:79], v[32:35], v[8:11]
    ds_read_b128 v[32:35], v4 offset:3072
    s_waitcnt lgkmcnt(10)
    v_mfma_f32_16x16x32_bf16 v[8:11], v[80:83], v[36:39], v[8:11]
    ds_read_b128 v[36:39], v4 offset:3136
    s_waitcnt lgkmcnt(10)
    v_mfma_f32_16x16x32_bf16 v[8:11], v[84:87], v[40:43], v[8:11]
    s_waitcnt lgkmcnt(9)
    v_mfma_f32_16x16x32_bf16 v[8:11], v[88:91], v[44:47], v[8:11]
    s_waitcnt lgkmcnt(8)
    v_mfma_f32_16x16x32_bf16 v[8:11], v[92:95], v[48:51], v[8:11]
    s_waitcnt lgkmcnt(7)
    v_mfma_f32_16x16x32_bf16 v[8:11], v[96:99], v[52:55], v[8:11]
    s_waitcnt lgkmcnt(6)
    v_mfma_f32_16x16x32_bf16 v[8:11], v[100:103], v[12:15], v[8:11]
    s_waitcnt lgkmcnt(5)
    v_mfma_f32_16x16x32_bf16 v[8:11], v[104:107], v[16:19], v[8:11]
    s_waitcnt lgkmcnt(4)
    v_mfma_f32_16x16x32_bf16 v[8:11], v[108:111], v[20:23], v[8:11]
    s_waitcnt lgkmcnt(3)
    v_mfma_f32_16x16x32_bf16 v[8:11], v[112:115], v[24:27], v[8:11]
    s_waitcnt lgkmcnt(2)
    v_mfma_f32_16x16x32_bf16 v[8:11], v[116:119], v[28:31], v[8:11]
    s_waitcnt lgkmcnt(1)
    v_mfma_f32_16x16x32_bf16 v[8:11], v[120:123], v[32:35], v[8:11]
    s_waitcnt lgkmcnt(0)
    v_mfma_f32_16x16x32_bf16 v[8:11], v[124:127], v[36:39], v[8:11]
    s_nop 7
    v_permlane32_swap_b32 v8, v10
    v_permlane32_swap_b32 v9, v11
    v_cvt_pk_bf16_f32 v12, v8, v9
    v_lshlrev_b32 v8, 16, v12
    v_and_b32 v9, 0xffff0000, v12
    v_cvt_pk_bf16_f32 v13, v10, v11
    v_lshlrev_b32 v10, 16, v13
    v_and_b32 v11, 0xffff0000, v13
    v_mul_f32 v12, 0xbfb8aa3b, v8
    v_mul_f32 v13, 0xbfb8aa3b, v9
    v_exp_f32 v12, v12
    v_exp_f32 v13, v13
    v_add_f32 v12, 1.0, v12
    v_add_f32 v13, 1.0, v13
    v_rcp_f32 v12, v12
    v_rcp_f32 v13, v13
    s_nop 0
    v_pk_mul_f32 v[8:9], v[8:9], v[12:13]
    v_cvt_pk_bf16_f32 v12, v8, v9
    v_lshlrev_b32 v8, 16, v12
    v_and_b32 v9, 0xffff0000, v12
    v_pk_mul_f32 v[8:9], v[8:9], v[10:11]
    v_cvt_pk_bf16_f32 v8, v8, v9
    s_mov_b64 exec, s[56:57]
    ds_write_b32 v6, v8 offset:11392
    s_mov_b64 exec, -1
    s_waitcnt lgkmcnt(0)
    s_barrier
    s_branch F_R
F_L2:
    s_and_b32 s56, s3, 3
    s_cmp_eq_u32 s56, 3
    s_cbranch_scc1 F_E
    s_lshr_b32 s45, s3, 2
    s_sub_u32 s45, s3, s45
    s_sub_u32 s45, s45, 6
    s_mul_i32 s56, s44, 73728
    s_mul_i32 s57, s45, 192
    s_add_u32 s56, s56, s57
    v_mul_u32_u24 v7, 9216, v5
    v_mul_u32_u24 v8, 12, v3
    v_add3_u32 v7, v7, v8, s56
    s_cmp_ge_u32 s45, 3
    s_cselect_b64 s[36:37], s[24:25], s[22:23]
    s_cselect_b32 s57, 4, 0
    s_cselect_b32 s56, 3, 0
    s_mov_b32 s32, s36
    s_and_b32 s33, s37, 0xffff
    s_mov_b32 s34, 0x00510000
    s_mov_b32 s35, 0x00020000
    v_lshrrev_b32 v27, 3, v1
    v_mul_u32_u24 v27, 9216, v27
    v_and_b32 v28, 7, v1
    v_bfe_u32 v29, v1, 4, 1
    v_xor_b32 v28, v28, v29
    v_xor_b32 v28, s57, v28
    v_xor_b32 v29, 2, v28
    v_lshl_add_u32 v28, v28, 4, v27
    v_lshl_add_u32 v29, v29, 4, v27
    s_sub_u32 s57, s45, s56
    s_mul_i32 s58, s57, 1769472
    s_lshl_b32 s59, s44, 7
    s_add_u32 s58, s58, s59
    s_mul_i32 s57, s45, 24576
    s_add_u32 s57, s57, 2048
    s_mov_b32 m0, s57
    s_nop 0
    buffer_load_dwordx4 v28, s[32:35], s58 offen nt lds
    s_add_u32 m0, m0, 1024
    s_add_u32 s58, s58, 73728
    buffer_load_dwordx4 v29, s[32:35], s58 offen nt lds
    s_add_u32 m0, m0, 1024
    s_add_u32 s58, s58, 73728
    buffer_load_dwordx4 v28, s[32:35], s58 offen nt lds
    s_add_u32 m0, m0, 1024
    s_add_u32 s58, s58, 73728
    s_barrier
    buffer_load_dwordx4 v29, s[32:35], s58 offen nt lds
    s_add_u32 m0, m0, 1024
    s_add_u32 s58, s58, 73728
    buffer_load_dwordx4 v28, s[32:35], s58 offen nt lds
    s_add_u32 m0, m0, 1024
    s_add_u32 s58, s58, 73728
    buffer_load_dwordx4 v29, s[32:35], s58 offen nt lds
    s_add_u32 m0, m0, 1024
    s_add_u32 s58, s58, 73728
    buffer_load_dwordx4 v28, s[32:35], s58 offen nt lds
    s_add_u32 m0, m0, 1024
    s_add_u32 s58, s58, 73728
    buffer_load_dwordx4 v29, s[32:35], s58 offen nt lds
    s_add_u32 m0, m0, 1024
    s_add_u32 s58, s58, 73728
    buffer_load_dwordx4 v28, s[32:35], s58 offen nt lds
    s_add_u32 m0, m0, 1024
    s_add_u32 s58, s58, 73728
    buffer_load_dwordx4 v29, s[32:35], s58 offen nt lds
    s_add_u32 m0, m0, 1024
    s_add_u32 s58, s58, 73728
    buffer_load_dwordx4 v28, s[32:35], s58 offen nt lds
    s_add_u32 m0, m0, 1024
    s_add_u32 s58, s58, 73728
    buffer_load_dwordx4 v29, s[32:35], s58 offen nt lds
    s_add_u32 m0, m0, 1024
    s_add_u32 s58, s58, 73728
    buffer_load_dwordx4 v28, s[32:35], s58 offen nt lds
    s_add_u32 m0, m0, 1024
    s_add_u32 s58, s58, 73728
    buffer_load_dwordx4 v29, s[32:35], s58 offen nt lds
    s_add_u32 m0, m0, 1024
    s_add_u32 s58, s58, 73728
    buffer_load_dwordx4 v28, s[32:35], s58 offen nt lds
    s_add_u32 m0, m0, 1024
    s_add_u32 s58, s58, 73728
    buffer_load_dwordx4 v29, s[32:35], s58 offen nt lds
    s_add_u32 m0, m0, 1024
    s_add_u32 s58, s58, 73728
    buffer_load_dwordx4 v28, s[32:35], s58 offen nt lds
    s_add_u32 m0, m0, 1024
    s_add_u32 s58, s58, 73728
    buffer_load_dwordx4 v29, s[32:35], s58 offen nt lds
    s_add_u32 m0, m0, 1024
    s_add_u32 s58, s58, 73728
    buffer_load_dwordx4 v28, s[32:35], s58 offen nt lds
    s_add_u32 m0, m0, 1024
    s_add_u32 s58, s58, 73728
    buffer_load_dwordx4 v29, s[32:35], s58 offen nt lds
    s_add_u32 m0, m0, 1024
    s_add_u32 s58, s58, 73728
    buffer_load_dwordx4 v28, s[32:35], s58 offen nt lds
    s_add_u32 m0, m0, 1024
    s_add_u32 s58, s58, 73728
    buffer_load_dwordx4 v29, s[32:35], s58 offen nt lds
    s_add_u32 m0, m0, 1024
    s_add_u32 s58, s58, 73728
    buffer_load_dwordx4 v28, s[32:35], s58 offen nt lds
    s_add_u32 m0, m0, 1024
    s_add_u32 s58, s58, 73728
    buffer_load_dwordx4 v29, s[32:35], s58 offen nt lds
    global_load_dwordx3 v[64:66], v7, s[26:27] offset:0 nt
    global_load_dwordx3 v[68:70], v7, s[26:27] offset:1152 nt
    global_load_dwordx3 v[72:74], v7, s[26:27] offset:2304 nt
    global_load_dwordx3 v[76:78], v7, s[26:27] offset:3456 nt
    v_add_u32 v7, 4608, v7
    global_load_dwordx3 v[80:82], v7, s[26:27] offset:0 nt
    global_load_dwordx3 v[84:86], v7, s[26:27] offset:1152 nt
    global_load_dwordx3 v[88:90], v7, s[26:27] offset:2304 nt
    global_load_dwordx3 v[92:94], v7, s[26:27] offset:3456 nt
    v_add_u32 v7, 32256, v7
    global_load_dwordx3 v[96:98], v7, s[26:27] offset:0 nt
    global_load_dwordx3 v[100:102], v7, s[26:27] offset:1152 nt
    global_load_dwordx3 v[104:106], v7, s[26:27] offset:2304 nt
    global_load_dwordx3 v[108:110], v7, s[26:27] offset:3456 nt
    v_add_u32 v7, 4608, v7
    global_load_dwordx3 v[112:114], v7, s[26:27] offset:0 nt
    global_load_dwordx3 v[116:118], v7, s[26:27] offset:1152 nt
    global_load_dwordx3 v[120:122], v7, s[26:27] offset:2304 nt
    global_load_dwordx3 v[124:126], v7, s[26:27] offset:3456 nt
    s_waitcnt vmcnt(16)
    s_cmp_lt_u32 s2, 192
    s_cbranch_scc1 CT_24
    s_cmp_lt_u32 s3, 4
    s_cbranch_scc1 CT_24
    s_waitcnt lgkmcnt(0)
    s_mul_i32 s48, s48, 1664525
    s_add_u32 s48, s48, 1013904223
CT_24:
    v_and_b32 v6, 7, v1
    v_mul_u32_u24 v4, 144, v6
    v_lshl_add_u32 v4, v5, 4, v4
    v_mul_u32_u24 v6, 1536, v6
    v_lshl_add_u32 v6, v5, 4, v6
    v_and_b32 v8, 8, v1
    v_lshl_add_u32 v6, v8, 3, v6
    s_mul_i32 s36, s44, 12288
    s_lshl_b32 s37, s45, 8
    s_add_u32 s36, s36, s37
    s_add_u32 s36, s36, 6483968
    s_mov_b32 s56, 0x05040100
    s_mov_b32 s57, 0x07060302
    s_barrier
    s_waitcnt vmcnt(0)
    v_perm_b32 v16, v68, v64, s56
    v_perm_b32 v17, v76, v72, s56
    v_perm_b32 v18, v84, v80, s56
    v_perm_b32 v19, v92, v88, s56
    v_perm_b32 v20, v68, v64, s57
    v_perm_b32 v21, v76, v72, s57
    v_perm_b32 v22, v84, v80, s57
    v_perm_b32 v23, v92, v88, s57
    v_perm_b32 v24, v69, v65, s56
    v_perm_b32 v25, v77, v73, s56
    v_perm_b32 v26, v85, v81, s56
    v_perm_b32 v27, v93, v89, s56
    v_perm_b32 v28, v69, v65, s57
    v_perm_b32 v29, v77, v73, s57
    v_perm_b32 v30, v85, v81, s57
    v_perm_b32 v31, v93, v89, s57
    v_perm_b32 v32, v70, v66, s56
    v_perm_b32 v33, v78, v74, s56
    v_perm_b32 v34, v86, v82, s56
    v_perm_b32 v35, v94, v90, s56
    v_perm_b32 v36, v70, v66, s57
    v_perm_b32 v37, v78, v74, s57
    v_perm_b32 v38, v86, v82, s57
    v_perm_b32 v39, v94, v90, s57
    v_perm_b32 v40, v100, v96, s56
    v_perm_b32 v41, v108, v104, s56
    v_perm_b32 v42, v116, v112, s56
    v_perm_b32 v43, v124, v120, s56
    v_perm_b32 v44, v100, v96, s57
    v_perm_b32 v45, v108, v104, s57
    v_perm_b32 v46, v116, v112, s57
    v_perm_b32 v47, v124, v120, s57
    v_perm_b32 v48, v101, v97, s56
    v_perm_b32 v49, v109, v105, s56
    v_perm_b32 v50, v117, v113, s56
    v_perm_b32 v51, v125, v121, s56
    v_perm_b32 v52, v101, v97, s57
    v_perm_b32 v53, v109, v105, s57
    v_perm_b32 v54, v117, v113, s57
    v_perm_b32 v55, v125, v121, s57
    v_perm_b32 v56, v102, v98, s56
    v_perm_b32 v57, v110, v106, s56
    v_perm_b32 v58, v118, v114, s56
    v_perm_b32 v59, v126, v122, s56
    v_perm_b32 v60, v102, v98, s57
    v_perm_b32 v61, v110, v106, s57
    v_perm_b32 v62, v118, v114, s57
    v_perm_b32 v63, v126, v122, s57
    v_mov_b32 v91, s48
    v_mov_b32 v95, s48
    s_mov_b32 s56, 0xff00ff00
    s_mov_b32 s57, 0xff00ff00
    s_setprio 3
    s_barrier
    s_barrier
    s_barrier
    ds_read_b128 v[8:11], v4 offset:11392
    ds_read_b128 v[12:15], v4 offset:11456
    s_waitcnt lgkmcnt(1)
    v_mfma_f32_16x16x32_bf16 v[64:67], v[16:19], v[8:11], 0
    v_mfma_f32_16x16x32_bf16 v[68:71], v[20:23], v[8:11], 0
    v_mfma_f32_16x16x32_bf16 v[72:75], v[24:27], v[8:11], 0
    v_mfma_f32_16x16x32_bf16 v[76:79], v[28:31], v[8:11], 0
    v_mfma_f32_16x16x32_bf16 v[80:83], v[32:35], v[8:11], 0
    v_mfma_f32_16x16x32_bf16 v[84:87], v[36:39], v[8:11], 0
    s_waitcnt lgkmcnt(0)
    v_mfma_f32_16x16x32_bf16 v[64:67], v[40:43], v[12:15], v[64:67]
    v_mfma_f32_16x16x32_bf16 v[68:71], v[44:47], v[12:15], v[68:71]
    v_mfma_f32_16x16x32_bf16 v[72:75], v[48:51], v[12:15], v[72:75]
    v_mfma_f32_16x16x32_bf16 v[76:79], v[52:55], v[12:15], v[76:79]
    v_mfma_f32_16x16x32_bf16 v[80:83], v[56:59], v[12:15], v[80:83]
    v_mfma_f32_16x16x32_bf16 v[84:87], v[60:63], v[12:15], v[84:87]
    s_nop 3
    v_cvt_pk_bf16_f32 v88, v64, v68
    s_nop 0
    v_cvt_pk_bf16_f32 v89, v72, v76
    s_nop 0
    v_cvt_pk_bf16_f32 v90, v80, v84
    v_cvt_pk_bf16_f32 v92, v66, v70
    v_cvt_pk_bf16_f32 v93, v74, v78
    v_cvt_pk_bf16_f32 v94, v82, v86
    s_mov_b64 exec, s[56:57]
    v_cvt_pk_bf16_f32 v88, v65, v69
    v_cvt_pk_bf16_f32 v89, v73, v77
    v_cvt_pk_bf16_f32 v90, v81, v85
    v_cvt_pk_bf16_f32 v92, v67, v71
    v_cvt_pk_bf16_f32 v93, v75, v79
    v_cvt_pk_bf16_f32 v94, v83, v87
    s_mov_b64 exec, -1
    buffer_store_dwordx4 v[88:91], v6, s[40:43], s36 offen offset:0 sc1
    buffer_store_dwordx4 v[92:95], v6, s[40:43], s36 offen offset:128 sc1
    s_branch F_R
F_E:
    s_barrier
    s_cmp_lt_u32 s2, 192
    s_cbranch_scc1 CT_25
    s_cmp_lt_u32 s3, 4
    s_cbranch_scc1 CT_25
    s_waitcnt lgkmcnt(0)
    s_mul_i32 s48, s48, 1664525
    s_add_u32 s48, s48, 1013904223
CT_25:
    s_cmp_eq_u32 s3, 15
    s_cbranch_scc1 F_E15
    s_barrier
    v_lshlrev_b32 v7, 4, v1
    s_and_b32 s37, s2, 7
    s_lshl_b32 s37, s37, 13
    s_add_u32 s37, s37, 6295552
    s_lshl_b32 s38, s44, 5
    s_add_u32 s38, s38, s37
    s_mov_b64 exec, 1
    s_mov_b32 s49, 0
P_26:
    buffer_load_dwordx4 v[8:11], v7, s[40:43], s38 offen sc1
PC_28:
    s_add_u32 s49, s49, 1
    s_waitcnt vmcnt(0)
    v_cmp_ne_u32 vcc, s48, v11
    s_nop 0
    s_cbranch_vccz PD_27
    s_sleep 4
    s_cmp_lt_u32 s49, 60000
    s_cbranch_scc1 P_26
PD_27:
    s_mov_b64 exec, -1
    s_mov_b32 s38, s37
    s_add_u32 s39, s37, 4096
    s_mov_b32 s49, 0
    buffer_load_dwordx4 v[8:11], v7, s[40:43], s38 offen offset:0 sc1
    buffer_load_dwordx4 v[12:15], v7, s[40:43], s38 offen offset:1024 sc1
    buffer_load_dwordx4 v[16:19], v7, s[40:43], s38 offen offset:2048 sc1
    buffer_load_dwordx4 v[20:23], v7, s[40:43], s38 offen offset:3072 sc1
    buffer_load_dwordx4 v[24:27], v7, s[40:43], s39 offen offset:0 sc1
    buffer_load_dwordx4 v[28:31], v7, s[40:43], s39 offen offset:1024 sc1
    buffer_load_dwordx4 v[32:35], v7, s[40:43], s39 offen offset:2048 sc1
    buffer_load_dwordx4 v[36:39], v7, s[40:43], s39 offen offset:3072 sc1
P_29:
    s_add_u32 s49, s49, 1
    s_waitcnt vmcnt(0)
    v_cmp_ne_u32 s[4:5], s48, v11
    v_cmp_ne_u32 s[6:7], s48, v15
    v_cmp_ne_u32 s[8:9], s48, v19
    v_cmp_ne_u32 s[10:11], s48, v23
    v_cmp_ne_u32 s[12:13], s48, v27
    v_cmp_ne_u32 s[14:15], s48, v31
    v_cmp_ne_u32 s[16:17], s48, v35
    v_cmp_ne_u32 s[18:19], s48, v39
    s_or_b64 s[50:51], s[4:5], s[6:7]
    s_or_b64 s[50:51], s[50:51], s[8:9]
    s_or_b64 s[50:51], s[50:51], s[10:11]
    s_or_b64 s[50:51], s[50:51], s[12:13]
    s_or_b64 s[50:51], s[50:51], s[14:15]
    s_or_b64 s[50:51], s[50:51], s[16:17]
    s_or_b64 s[50:51], s[50:51], s[18:19]
    s_cbranch_scc0 PD_30
    s_sleep 1
    s_wqm_b64 exec, s[4:5]
    s_cbranch_execz PS_31
    buffer_load_dwordx4 v[8:11], v7, s[40:43], s38 offen offset:0 sc1
PS_31:
    s_wqm_b64 exec, s[6:7]
    s_cbranch_execz PS_32
    buffer_load_dwordx4 v[12:15], v7, s[40:43], s38 offen offset:1024 sc1
PS_32:
    s_wqm_b64 exec, s[8:9]
    s_cbranch_execz PS_33
    buffer_load_dwordx4 v[16:19], v7, s[40:43], s38 offen offset:2048 sc1
PS_33:
    s_wqm_b64 exec, s[10:11]
    s_cbranch_execz PS_34
    buffer_load_dwordx4 v[20:23], v7, s[40:43], s38 offen offset:3072 sc1
PS_34:
    s_wqm_b64 exec, s[12:13]
    s_cbranch_execz PS_35
    buffer_load_dwordx4 v[24:27], v7, s[40:43], s39 offen offset:0 sc1
PS_35:
    s_wqm_b64 exec, s[14:15]
    s_cbranch_execz PS_36
    buffer_load_dwordx4 v[28:31], v7, s[40:43], s39 offen offset:1024 sc1
PS_36:
    s_wqm_b64 exec, s[16:17]
    s_cbranch_execz PS_37
    buffer_load_dwordx4 v[32:35], v7, s[40:43], s39 offen offset:2048 sc1
PS_37:
    s_wqm_b64 exec, s[18:19]
    s_cbranch_execz PS_38
    buffer_load_dwordx4 v[36:39], v7, s[40:43], s39 offen offset:3072 sc1
PS_38:
    s_mov_b64 exec, -1
    s_cmp_lt_u32 s49, 60000
    s_cbranch_scc1 P_29
    s_waitcnt vmcnt(0)
PD_30:
    s_barrier
    s_barrier
    s_barrier
    s_branch F_R
F_E15:
    s_mov_b32 s32, s28
    s_and_b32 s33, s29, 0xffff
    s_mov_b32 s34, 0x00240000
    s_mov_b32 s35, 0x00020000
    s_mul_i32 s56, s44, 43
    s_lshr_b32 s56, s56, 8
    s_min_u32 s56, s56, 7
    s_mul_i32 s57, s56, 6
    s_sub_u32 s57, s44, s57
    s_min_u32 s57, s57, 5
    v_and_b32 v12, 3, v1
    v_bfe_u32 v13, v1, 2, 2
    v_lshl_add_u32 v12, v12, 2, v13
    s_lshl_b32 s57, s57, 4
    v_add_u32 v13, s57, v12
    v_mul_u32_u24 v12, 12, v13
    v_lshrrev_b32 v14, 1, v5
    v_lshl_add_u32 v12, v14, 1, v12
    v_add_u32 v25, 8, v12
    v_and_b32 v15, 1, v5
    v_lshl_add_u32 v12, v15, 2, v12
    v_lshlrev_b32 v13, 4, v13
    v_cmp_eq_u32 s[46:47], 1, v15
    v_mov_b32 v15, 1536
    v_lshlrev_b32 v14, 4, v14
    s_lshl_b32 s38, s56, 11
    s_add_u32 s38, s38, 6459392
    s_mul_i32 s57, s56, 1168
    v_add_u32 v26, s57, v12
    v_add_u32 v27, s57, v25
    v_lshlrev_b32 v11, 3, v1
    s_barrier
    s_barrier
    s_barrier
    s_cmp_ge_u32 s44, 48
    s_cbranch_scc1 FIN
    buffer_load_dwordx4 v[16:19], v13, s[40:43], s38 offen sc1
    buffer_load_dwordx4 v[20:23], v15, s[40:43], s38 offen sc1
    ds_read_u16 v26, v26 offset:2048
    ds_read_u16 v27, v27 offset:2048
    s_barrier
    s_mov_b32 s49, 0
    s_branch PC_41
P_39:
    buffer_load_dwordx4 v[16:19], v13, s[40:43], s38 offen sc1
    buffer_load_dwordx4 v[20:23], v15, s[40:43], s38 offen sc1
PC_41:
    s_add_u32 s49, s49, 1
    s_waitcnt vmcnt(0)
    v_cmp_ne_u32 vcc, s48, v19
    v_cmp_ne_u32 s[50:51], s48, v23
    s_nop 0
    s_or_b64 vcc, vcc, s[50:51]
    s_cbranch_vccz PD_40
    s_cmp_lt_u32 s49, 60000
    s_cbranch_scc1 P_39
PD_40:
    v_cndmask_b32 v16, v16, v17, s[46:47]
    v_lshrrev_b32 v16, v14, v16
    v_lshrrev_b32 v17, v14, v18
    v_lshlrev_b32 v16, 16, v16
    v_lshlrev_b32 v17, 16, v17
    v_readfirstlane_b32 s45, v20
    s_nop 0
    s_lshr_b32 s56, s45, 16
    s_xor_b32 s57, s56, 0x8000
    s_xor_b32 s58, s56, 0xffff
    s_bitcmp1_b32 s56, 15
    s_cselect_b32 s56, s57, s58
    s_lshl_b32 s56, s56, 16
    v_mov_b32 v18, 0xbfb8aa3b
    v_mul_f32 v18, s56, v18
    v_exp_f32 v18, v18
    s_and_b32 s45, s45, 0x7ff
    s_sub_u32 s45, 0x7ff, s45
    s_mul_i32 s45, s45, 1152
    v_add_f32 v18, 1.0, v18
    v_rcp_f32 v18, v18
    s_waitcnt lgkmcnt(0)
    v_lshlrev_b32 v26, 16, v26
    v_lshlrev_b32 v27, 16, v27
    v_cvt_pk_bf16_f32 v18, v18, v18
    v_lshlrev_b32 v18, 16, v18
    s_setprio 3
    s_barrier
    s_barrier
    ds_read_b64 v[32:33], v11 offset:12544
    ds_read_b64 v[34:35], v11 offset:13056
    ds_read_b64 v[36:37], v11 offset:13568
    ds_read_b64 v[38:39], v11 offset:14080
    ds_read_b64 v[40:41], v11 offset:14592
    ds_read_b64 v[42:43], v11 offset:15104
    ds_read_b64 v[44:45], v11 offset:15616
    ds_read_b64 v[46:47], v11 offset:16128
    ds_read_b64 v[48:49], v11 offset:16640
    s_waitcnt lgkmcnt(7)
    v_pk_add_f32 v[32:33], v[32:33], v[34:35]
    s_waitcnt lgkmcnt(5)
    v_pk_add_f32 v[36:37], v[36:37], v[38:39]
    s_waitcnt lgkmcnt(3)
    v_pk_add_f32 v[40:41], v[40:41], v[42:43]
    s_waitcnt lgkmcnt(1)
    v_pk_add_f32 v[44:45], v[44:45], v[46:47]
    v_pk_add_f32 v[32:33], v[32:33], v[36:37]
    v_pk_add_f32 v[40:41], v[40:41], v[44:45]
    s_waitcnt lgkmcnt(0)
    v_pk_add_f32 v[32:33], v[32:33], v[48:49]
    v_pk_add_f32 v[32:33], v[32:33], v[40:41]
    v_cvt_pk_bf16_f32 v34, v32, v33
    v_lshlrev_b32 v32, 16, v34
    v_and_b32 v33, 0xffff0000, v34
    v_pk_mul_f32 v[32:33], v[32:33], v[18:19] op_sel_hi:[1,0]
    v_cvt_pk_bf16_f32 v34, v32, v33
    v_lshlrev_b32 v32, 16, v34
    v_and_b32 v33, 0xffff0000, v34
    v_pk_add_f32 v[32:33], v[32:33], v[26:27]
    v_cvt_pk_bf16_f32 v34, v32, v33
    v_lshlrev_b32 v32, 16, v34
    v_and_b32 v33, 0xffff0000, v34
    v_pk_add_f32 v[32:33], v[32:33], v[16:17]
    v_cvt_pk_bf16_f32 v32, v32, v33
    buffer_store_short v32, v12, s[32:35], s45 offen
    s_mov_b32 exec_lo, 0xffff
    s_mov_b32 exec_hi, 0xffff
    buffer_store_short_d16_hi v32, v25, s[32:35], s45 offen
    s_cmp_lg_u32 s44, 0
    s_cbranch_scc1 F_NE
    s_mov_b64 exec, 1
    v_mov_b32 v6, 0
    v_mov_b32 v7, s48
    buffer_store_dword v7, v6, s[40:43], 0 offen sc1
F_NE:
    s_mov_b64 exec, -1
    s_branch FIN
F_R:
    s_cmp_ge_u32 s44, 48
    s_cbranch_scc1 FIN
    s_min_u32 s45, s3, 8
    s_mul_i32 s39, s45, 98304
    s_lshl_b32 s38, s44, 8
    s_add_u32 s38, s38, s39
    s_add_u32 s38, s38, 6483968
    s_add_u32 s37, s38, 49152
    v_mul_u32_u24 v10, 12288, v5
    v_lshl_add_u32 v10, v3, 4, v10
    s_lshl_b32 s39, s45, 9
    v_lshl_add_u32 v11, v1, 3, s39
    s_waitcnt vmcnt(0)
    s_barrier
    s_lshl_b32 s39, 1, s3
    s_and_b32 s39, s39, 0x7700
    s_cbranch_scc1 FIN
    s_mov_b32 s49, 0
    buffer_load_dwordx4 v[32:35], v10, s[40:43], s38 offen sc1
    buffer_load_dwordx4 v[36:39], v10, s[40:43], s37 offen sc1
P_42:
    s_add_u32 s49, s49, 1
    s_waitcnt vmcnt(0)
    v_cmp_ne_u32 s[4:5], s48, v35
    v_cmp_ne_u32 s[6:7], s48, v39
    s_nop 0
    s_or_b64 s[50:51], s[4:5], s[6:7]
    s_cbranch_scc0 PD_43
    s_wqm_b64 exec, s[4:5]
    s_cbranch_execz PS_44
    buffer_load_dwordx4 v[32:35], v10, s[40:43], s38 offen sc1
PS_44:
    s_wqm_b64 exec, s[6:7]
    s_cbranch_execz PS_45
    buffer_load_dwordx4 v[36:39], v10, s[40:43], s37 offen sc1
PS_45:
    s_mov_b64 exec, -1
    s_cmp_lt_u32 s49, 60000
    s_cbranch_scc1 P_42
    s_waitcnt vmcnt(0)
PD_43:
    v_lshlrev_b32 v12, 16, v32
    v_and_b32 v13, 0xffff0000, v32
    v_lshlrev_b32 v14, 16, v33
    v_and_b32 v15, 0xffff0000, v33
    v_lshlrev_b32 v16, 16, v34
    v_and_b32 v17, 0xffff0000, v34
    v_lshlrev_b32 v18, 16, v36
    v_and_b32 v19, 0xffff0000, v36
    v_lshlrev_b32 v20, 16, v37
    v_and_b32 v21, 0xffff0000, v37
    v_lshlrev_b32 v22, 16, v38
    v_and_b32 v23, 0xffff0000, v38
    v_pk_add_f32 v[12:13], v[12:13], v[18:19]
    v_pk_add_f32 v[14:15], v[14:15], v[20:21]
    v_pk_add_f32 v[16:17], v[16:17], v[22:23]
    v_permlane32_swap_b32 v12, v13
    v_permlane32_swap_b32 v14, v15
    v_permlane32_swap_b32 v16, v17
    v_add_f32 v12, v12, v13
    v_add_f32 v14, v14, v15
    v_add_f32 v13, v16, v17
    v_add_f32 v15, v16, v17
    v_permlane16_swap_b32 v12, v14
    s_nop 0
    v_permlane16_swap_b32 v13, v15
    v_pk_add_f32 v[12:13], v[12:13], v[14:15]
    ds_write_b64 v11, v[12:13] offset:12544
    s_waitcnt lgkmcnt(0)
    s_barrier
FIN:
END:
    s_endpgm
.section .rodata,"a"
.p2align 6
.amdhsa_kernel sequential_preLN__ssm_conv_s4d__moe_arch_mod__prompt_kernel
  .amdhsa_next_free_vgpr 128
  .amdhsa_next_free_sgpr 102
  .amdhsa_accum_offset 128
  .amdhsa_group_segment_fixed_size 0
  .amdhsa_kernarg_size 120
  .amdhsa_user_sgpr_count 2
  .amdhsa_user_sgpr_kernarg_segment_ptr 1
  .amdhsa_system_sgpr_workgroup_id_x 1
.end_amdhsa_kernel
.text
```

```asm
; @launch grid=(256,1,1) block=(1024,1,1) lds=150784
.amdgcn_target "amdgcn-amd-amdhsa--gfx950"
.text
.globl sequential_preLN__ssm_conv_s4d__moe_arch_mod__prompt_kernel
.p2align 8
.type sequential_preLN__ssm_conv_s4d__moe_arch_mod__prompt_kernel,@function
sequential_preLN__ssm_conv_s4d__moe_arch_mod__prompt_kernel:
KSTART:
    s_cmp_ge_u32 s2, 256
    s_cbranch_scc1 END
    s_load_dwordx16 s[4:19], s[0:1], 0
    s_load_dwordx2 s[30:31], s[0:1], 112
    s_load_dwordx8 s[20:27], s[0:1], 64
    s_load_dwordx2 s[28:29], s[0:1], 96
    v_lshrrev_b32 v2, 6, v0
    v_and_b32 v3, 15, v0
    v_readfirstlane_b32 s3, v2
    v_bfe_u32 v5, v0, 4, 2
    v_and_b32 v1, 63, v0
    s_cmp_ge_u32 s3, 4
    s_cbranch_scc1 KLOAD
    s_setprio 3
    v_add_u32 v20, -128, v0
    v_ashrrev_i32 v20, 31, v20
    v_lshlrev_b32 v21, 2, v0
    ds_write_b32 v21, v20
    v_mad_u32_u24 v4, v2, 48, v3
    v_mul_u32_u24 v6, 6, v4
    v_and_b32 v6, -4, v6
    s_mul_i32 s32, s2, 9216
    v_mul_u32_u24 v7, 2304, v5
    v_add3_u32 v7, v7, v6, s32
    v_mov_b32 v62, 0
    s_waitcnt lgkmcnt(0)
    global_load_dwordx2 v[8:9], v7, s[4:5] offset:0 nt
    global_load_dwordx2 v[10:11], v7, s[4:5] offset:1152 nt
    global_load_dwordx2 v[12:13], v7, s[4:5] offset:96 nt
    global_load_dwordx2 v[14:15], v7, s[4:5] offset:1248 nt
    global_load_dwordx2 v[16:17], v7, s[4:5] offset:192 nt
    global_load_dwordx2 v[18:19], v7, s[4:5] offset:1344 nt
    global_load_dword v63, v62, s[30:31]
    s_barrier
    s_branch LNMAIN
KLOAD:
    s_cmp_lt_u32 s2, 192
    s_cbranch_scc1 KL1
    s_getpc_b64 s[56:57]
F_PC:
    v_add_u32 v8, -256, v0
    v_lshlrev_b32 v8, 6, v8
    v_min_u32 v8, END-F_PC, v8
    v_mov_b32 v9, 0
    v_lshl_add_u64 v[8:9], v[8:9], 0, s[56:57]
    global_load_dword v2, v[8:9], off
    s_barrier
    s_branch FFN_CK
KL1:
    s_sub_u32 s32, s3, 4
    s_lshr_b32 s33, s32, 2
    s_add_u32 s39, s32, s33
    s_mul_i32 s34, s2, 3
    s_add_u32 s34, s34, s33
    s_lshl_b32 s35, s34, 8
    v_lshl_add_u32 v13, v1, 2, s35
    s_and_b32 s36, s39, 1
    s_lshl_b32 s36, s36, 7
    s_add_u32 s35, s35, s36
    v_lshl_add_u32 v12, v1, 1, s35
    s_lshl_b32 s35, s34, 1
    v_mov_b32 v15, s35
    s_waitcnt lgkmcnt(0)
    global_load_ushort v41, v15, s[14:15]
    global_load_ushort v44, v12, s[6:7] nt
    global_load_ushort v45, v12, s[8:9] nt
    s_bitcmp1_b32 s39, 1
    s_cbranch_scc1 KL2
    global_load_dword v42, v13, s[10:11] nt
    global_load_dword v43, v13, s[12:13] nt
    global_load_ushort v46, v12, s[10:11] nt
    global_load_ushort v47, v12, s[12:13] nt
KL2:
    s_barrier
    s_load_dword s48, s[30:31], 0
    s_mov_b32 s40, s30
    s_and_b32 s41, s31, 0xffff
    s_mov_b32 s42, 0x10000000
    s_mov_b32 s43, 0x00020000
    s_setprio 1
    s_and_b32 s39, s39, 3
    v_mov_b32 v16, 0
    v_mov_b32 v17, 0
    v_mov_b32 v18, 0
    v_mov_b32 v19, 0
    s_and_b32 s56, s3, 3
    s_lshr_b32 s57, s32, 3
    s_sub_u32 s46, s32, s57
    s_cmp_eq_u32 s56, 3
    s_cselect_b32 s47, 2, 0
    s_cselect_b32 s46, s33, s46
    s_cmp_lt_u32 s32, 3
    s_cselect_b32 s47, 1, s47
    s_and_b32 s38, s32, 3
    s_mul_i32 s56, s33, 29376
    s_add_u32 s56, s56, 3328
    s_mul_i32 s57, s33, 5696
    s_add_u32 s57, s57, 91456
    v_and_b32 v14, 255, v0
    v_cmp_gt_u32 vcc, 100, v14
    v_lshl_add_u32 v14, v14, 4, s57
    ds_write_b128 v14, v[16:19]
    s_mul_i32 s58, s33, 4608
    s_add_u32 s58, s58, 108544
    v_lshl_add_u32 v15, v1, 4, s58
    s_mov_b64 exec, vcc
    ds_write_b128 v14, v[16:19] offset:4096
    s_mov_b64 exec, 0x3fffffff
    ds_write_b128 v15, v[16:19]
    s_mov_b64 exec, -1
    s_and_b32 s58, s38, 1
    s_lshl_b32 s59, s58, 4
    s_add_u32 s59, s59, 22
    v_add_u32 v14, s59, v3
    v_mul_u32_u24 v14, 544, v14
    v_lshl_add_u32 v15, v5, 4, s56
    v_and_b32 v16, 3, v1
    v_mul_u32_u24 v16, 1218, v16
    v_add_u32 v16, s57, v16
    s_cmp_ge_u32 s38, 2
    s_cbranch_scc1 CC_T
    s_mov_b32 s52, 0x89ab0123
    s_mov_b32 s53, 0x4566ed44
    v_lshlrev_b32 v17, 2, v3
    v_lshrrev_b64 v[18:19], v17, s[52:53]
    v_and_b32 v18, 15, v18
    v_mul_u32_u24 v18, 544, v18
    v_add_u32 v8, v18, v15
    v_add_u32 v9, v14, v15
    s_lshl_b32 s58, s58, 8
    s_sub_u32 s58, s57, s58
    s_add_u32 s58, s58, 1080
    v_and_b32 v17, 1, v5
    v_lshlrev_b32 v17, 3, v17
    v_lshl_add_u32 v17, v3, 4, v17
    v_lshrrev_b32 v18, 1, v5
    v_lshl_add_u32 v17, v18, 9, v17
    v_sub_u32 v10, s58, v17
    v_bfe_u32 v17, v1, 2, 1
    v_lshlrev_b32 v17, 1, v17
    v_sub_u32 v11, v16, v17
    v_add_u32 v11, 62, v11
    s_branch CC_2
CC_T:
    s_mov_b32 s52, 0xdcb8a950
    s_mov_b32 s53, 0x0000eeee
    v_lshlrev_b32 v17, 2, v3
    v_lshrrev_b64 v[18:19], v17, s[52:53]
    v_and_b32 v18, 15, v18
    v_add_u32 v18, 7, v18
    v_mul_u32_u24 v18, 544, v18
    v_add_u32 v9, v18, v15
    v_add_u32 v8, v14, v15
    v_and_b32 v17, 1, v3
    v_lshlrev_b32 v17, 8, v17
    v_lshrrev_b32 v18, 1, v3
    v_lshl_add_u32 v17, v18, 6, v17
    v_lshlrev_b32 v18, 6, v3
    v_add_u32 v18, 256, v18
    v_cmp_lt_u32 vcc, 3, v3
    s_nop 1
    v_cndmask_b32 v17, v17, v18, vcc
    s_lshl_b32 s58, s58, 5
    s_add_u32 s58, s58, s57
    s_add_u32 s58, s58, 4928
    v_lshl_add_u32 v17, v5, 3, v17
    v_add_u32 v10, s58, v17
    v_add_u32 v11, 1088, v16
CC_2:
    s_and_b32 s58, s39, 1
    s_lshl_b32 s58, s58, 8
    s_add_u32 s58, s58, s56
    s_mov_b32 m0, s58
    s_cmp_lg_u32 s47, 0
    s_cbranch_scc1 CC_C
    s_mul_i32 s58, s46, 86
    s_lshr_b32 s58, s58, 8
    s_mul_i32 s56, s58, 3
    s_sub_u32 s56, s46, s56
    s_lshl_b32 s58, s58, 10
    s_mul_i32 s59, s56, 4608
    s_add_u32 s59, s59, s58
    s_add_u32 s59, s59, 109008
    v_lshlrev_b32 v50, 4, v1
    v_add_u32 v48, s59, v50
    s_mul_i32 s59, s56, 10608
    s_add_u32 s59, s59, s58
    s_add_u32 s59, s59, 17568
    v_add_u32 v49, s59, v50
    s_lshr_b32 s56, s46, 1
    s_mul_i32 s56, s56, 592
    s_and_b32 s58, s46, 1
    s_lshl_b32 s58, s58, 6
    s_add_u32 s56, s56, s58
    v_bfe_u32 v52, v1, 2, 1
    v_mul_u32_u24 v52, 2368, v52
    v_bfe_u32 v51, v1, 3, 1
    v_bfe_u32 v53, v1, 1, 1
    v_lshl_add_u32 v51, v51, 1, v53
    v_mul_u32_u24 v51, 144, v51
    v_lshl_add_u32 v51, v5, 3, v51
    v_and_b32 v53, 1, v1
    v_lshl_add_u32 v51, v53, 2, v51
    v_add3_u32 v51, v52, v51, s56
    v_mov_b32 v52, 0
    v_mov_b32 v53, 1
    s_branch CC_END
CC_C:
    v_mov_b32 v50, 0
    s_mul_i32 s57, s46, 5696
    s_add_u32 s57, s57, 91456
    s_mul_i32 s58, s46, 10608
    s_add_u32 s58, s58, 17576
    v_and_b32 v16, 3, v3
    v_mul_u32_u24 v17, 1218, v16
    v_lshlrev_b32 v18, 3, v5
    v_sub_u32 v18, v18, v3
    v_lshl_add_u32 v17, v18, 1, v17
    v_add3_u32 v127, v17, s57, 32
    s_mul_i32 s59, s46, 4608
    s_add_u32 s59, s59, 108544
    v_lshlrev_b32 v17, 5, v3
    v_lshl_add_u32 v17, v5, 4, v17
    v_add_u32 v126, s59, v17
    v_lshlrev_b32 v17, 1, v5
    v_sub_u32 v17, v3, v17
    s_add_u32 s59, s57, 4892
    v_lshl_add_u32 v125, v17, 2, s59
    v_bfe_u32 v19, v1, 2, 1
    v_bfe_u32 v20, v1, 3, 1
    v_lshl_add_u32 v21, v16, 3, s58
    v_mul_u32_u24 v17, 3192, v20
    v_lshlrev_b32 v22, 4, v19
    v_sub_u32 v17, v17, v22
    v_lshl_add_u32 v17, v5, 6, v17
    v_add3_u32 v124, v17, v21, -8
    s_mul_i32 s59, s46, 4736
    v_mul_u32_u24 v17, 144, v5
    v_lshl_add_u32 v17, v3, 3, v17
    v_add_u32 v123, s59, v17
    s_cmp_eq_u32 s47, 2
    s_cbranch_scc1 CC_END
    v_lshlrev_b32 v17, 2, v5
    v_sub_u32 v17, v3, v17
    s_add_u32 s59, s57, 5428
    v_lshl_add_u32 v122, v17, 2, s59
    v_mul_u32_u24 v17, 2112, v19
    v_lshl_add_u32 v17, v20, 5, v17
    v_lshl_add_u32 v17, v5, 7, v17
    v_add_u32 v17, 6384, v17
    v_add_u32 v121, v17, v21
    s_add_u32 s59, s57, 5308
    v_mov_b32 v120, s59
    s_mov_b32 s52, -1
    s_mov_b32 s53, 0
    v_sub_u32 v17, 14, v18
    v_med3_i32 v17, v17, 0, 4
    v_lshlrev_b32 v17, 4, v17
    v_lshlrev_b64 v[22:23], v17, s[52:53]
    v_mov_b32 v116, v23
    v_sub_u32 v17, 12, v18
    v_med3_i32 v17, v17, 0, 4
    v_lshlrev_b32 v17, 4, v17
    v_lshlrev_b64 v[22:23], v17, s[52:53]
    v_mov_b32 v117, v23
    v_sub_u32 v17, 10, v18
    v_med3_i32 v17, v17, 0, 4
    v_lshlrev_b32 v17, 4, v17
    v_lshlrev_b64 v[22:23], v17, s[52:53]
    v_mov_b32 v118, v23
    v_sub_u32 v17, 8, v18
    v_med3_i32 v17, v17, 0, 4
    v_lshlrev_b32 v17, 4, v17
    v_lshlrev_b64 v[22:23], v17, s[52:53]
    v_mov_b32 v119, v23
CC_END:
    s_waitcnt vmcnt(0)
    v_lshlrev_b32 v41, 16, v41
    v_lshlrev_b32 v44, 16, v44
    v_mul_f32 v41, 0x3fb8aa3b, v41
    v_mul_f32 v44, 0x3fb8aa3b, v44
    v_exp_f32 v41, v41
    v_exp_f32 v44, v44
    v_lshlrev_b32 v45, 16, v45
    v_mul_f32 v45, 0.15915494, v45
    v_cvt_pk_bf16_f32 v14, v41, v44
    v_lshlrev_b32 v41, 16, v14
    v_and_b32 v44, 0xffff0000, v14
    v_mul_f32 v13, v45, v41
    v_mul_f32 v44, v44, v41
    v_rndne_f32 v14, v13
    v_mul_f32 v12, 0xbfb8aa3b, v44
    v_sub_f32 v13, v13, v14
    s_bitcmp0_b32 s39, 1
    s_cbranch_scc1 KG_A
    v_mul_f32 v14, 0x41000000, v12
    v_mul_f32 v15, 0x41000000, v13
    v_exp_f32 v14, v14
    v_cos_f32 v32, v15
    v_sin_f32 v33, v15
    v_mul_f32 v32, v32, v14
    v_mul_f32 v33, v33, v14
    v_mov_b32 v16, 0x3c00
    ds_write_addtid_b32 v16 offset:11968
    v_pk_mul_f32 v[36:37], v[32:33], v[32:33] op_sel:[0,0] op_sel_hi:[1,0]
    v_pk_fma_f32 v[36:37], v[32:33], v[32:33], v[36:37] op_sel:[1,1,0] op_sel_hi:[0,1,1] neg_lo:[1,0,0]
    v_cvt_pk_f16_f32 v17, v32, v33
    ds_write_addtid_b32 v17 offset:12512
    v_pk_mul_f32 v[34:35], v[36:37], v[32:33] op_sel:[0,0] op_sel_hi:[1,0]
    v_pk_fma_f32 v[34:35], v[36:37], v[32:33], v[34:35] op_sel:[1,1,0] op_sel_hi:[0,1,1] neg_lo:[1,0,0]
    v_cvt_pk_f16_f32 v18, v36, v37
    ds_write_addtid_b32 v18 offset:13056
    v_pk_mul_f32 v[36:37], v[34:35], v[32:33] op_sel:[0,0] op_sel_hi:[1,0]
    v_pk_fma_f32 v[36:37], v[34:35], v[32:33], v[36:37] op_sel:[1,1,0] op_sel_hi:[0,1,1] neg_lo:[1,0,0]
    v_cvt_pk_f16_f32 v19, v34, v35
    ds_write_addtid_b32 v19 offset:13600
    v_pk_mul_f32 v[34:35], v[36:37], v[32:33] op_sel:[0,0] op_sel_hi:[1,0]
    v_pk_fma_f32 v[34:35], v[36:37], v[32:33], v[34:35] op_sel:[1,1,0] op_sel_hi:[0,1,1] neg_lo:[1,0,0]
    v_cvt_pk_f16_f32 v20, v36, v37
    ds_write_addtid_b32 v20 offset:14144
    v_pk_mul_f32 v[36:37], v[34:35], v[32:33] op_sel:[0,0] op_sel_hi:[1,0]
    v_pk_fma_f32 v[36:37], v[34:35], v[32:33], v[36:37] op_sel:[1,1,0] op_sel_hi:[0,1,1] neg_lo:[1,0,0]
    v_cvt_pk_f16_f32 v21, v34, v35
    ds_write_addtid_b32 v21 offset:14688
    v_pk_mul_f32 v[34:35], v[36:37], v[32:33] op_sel:[0,0] op_sel_hi:[1,0]
    v_pk_fma_f32 v[34:35], v[36:37], v[32:33], v[34:35] op_sel:[1,1,0] op_sel_hi:[0,1,1] neg_lo:[1,0,0]
    v_cvt_pk_f16_f32 v22, v36, v37
    ds_write_addtid_b32 v22 offset:15232
    v_pk_mul_f32 v[36:37], v[34:35], v[32:33] op_sel:[0,0] op_sel_hi:[1,0]
    v_pk_fma_f32 v[36:37], v[34:35], v[32:33], v[36:37] op_sel:[1,1,0] op_sel_hi:[0,1,1] neg_lo:[1,0,0]
    v_cvt_pk_f16_f32 v23, v34, v35
    ds_write_addtid_b32 v23 offset:15776
    v_pk_mul_f32 v[34:35], v[36:37], v[32:33] op_sel:[0,0] op_sel_hi:[1,0]
    v_pk_fma_f32 v[34:35], v[36:37], v[32:33], v[34:35] op_sel:[1,1,0] op_sel_hi:[0,1,1] neg_lo:[1,0,0]
    v_cvt_pk_f16_f32 v24, v36, v37
    ds_write_addtid_b32 v24 offset:16320
    v_pk_mul_f32 v[36:37], v[34:35], v[32:33] op_sel:[0,0] op_sel_hi:[1,0]
    v_pk_fma_f32 v[36:37], v[34:35], v[32:33], v[36:37] op_sel:[1,1,0] op_sel_hi:[0,1,1] neg_lo:[1,0,0]
    v_cvt_pk_f16_f32 v25, v34, v35
    ds_write_addtid_b32 v25 offset:16864
    v_pk_mul_f32 v[34:35], v[36:37], v[32:33] op_sel:[0,0] op_sel_hi:[1,0]
    v_pk_fma_f32 v[34:35], v[36:37], v[32:33], v[34:35] op_sel:[1,1,0] op_sel_hi:[0,1,1] neg_lo:[1,0,0]
    v_cvt_pk_f16_f32 v26, v36, v37
    ds_write_addtid_b32 v26 offset:17408
    v_pk_mul_f32 v[36:37], v[34:35], v[32:33] op_sel:[0,0] op_sel_hi:[1,0]
    v_pk_fma_f32 v[36:37], v[34:35], v[32:33], v[36:37] op_sel:[1,1,0] op_sel_hi:[0,1,1] neg_lo:[1,0,0]
    v_cvt_pk_f16_f32 v27, v34, v35
    ds_write_addtid_b32 v27 offset:17952
    v_pk_mul_f32 v[34:35], v[36:37], v[32:33] op_sel:[0,0] op_sel_hi:[1,0]
    v_pk_fma_f32 v[34:35], v[36:37], v[32:33], v[34:35] op_sel:[1,1,0] op_sel_hi:[0,1,1] neg_lo:[1,0,0]
    v_cvt_pk_f16_f32 v28, v36, v37
    ds_write_addtid_b32 v28 offset:18496
    v_pk_mul_f32 v[36:37], v[34:35], v[32:33] op_sel:[0,0] op_sel_hi:[1,0]
    v_pk_fma_f32 v[36:37], v[34:35], v[32:33], v[36:37] op_sel:[1,1,0] op_sel_hi:[0,1,1] neg_lo:[1,0,0]
    v_cvt_pk_f16_f32 v29, v34, v35
    ds_write_addtid_b32 v29 offset:19040
    v_pk_mul_f32 v[34:35], v[36:37], v[32:33] op_sel:[0,0] op_sel_hi:[1,0]
    v_pk_fma_f32 v[34:35], v[36:37], v[32:33], v[34:35] op_sel:[1,1,0] op_sel_hi:[0,1,1] neg_lo:[1,0,0]
    v_cvt_pk_f16_f32 v30, v36, v37
    ds_write_addtid_b32 v30 offset:19584
    v_pk_mul_f32 v[36:37], v[34:35], v[32:33] op_sel:[0,0] op_sel_hi:[1,0]
    v_pk_fma_f32 v[36:37], v[34:35], v[32:33], v[36:37] op_sel:[1,1,0] op_sel_hi:[0,1,1] neg_lo:[1,0,0]
    v_cvt_pk_f16_f32 v31, v34, v35
    ds_write_addtid_b32 v31 offset:20128
    v_cvt_pk_f16_f32 v38, v36, v37
    ds_write_addtid_b32 v38 offset:20672
    v_pk_mul_f16 v33, v17, v38 op_sel:[0,0] op_sel_hi:[1,0]
    v_pk_fma_f16 v33, v17, v38, v33 op_sel:[1,1,0] op_sel_hi:[0,1,1] neg_lo:[1,0,0]
    ds_write_addtid_b32 v33 offset:21216
    v_pk_mul_f16 v34, v18, v38 op_sel:[0,0] op_sel_hi:[1,0]
    v_pk_fma_f16 v34, v18, v38, v34 op_sel:[1,1,0] op_sel_hi:[0,1,1] neg_lo:[1,0,0]
    ds_write_addtid_b32 v34 offset:21760
    v_pk_mul_f16 v35, v19, v38 op_sel:[0,0] op_sel_hi:[1,0]
    v_pk_fma_f16 v35, v19, v38, v35 op_sel:[1,1,0] op_sel_hi:[0,1,1] neg_lo:[1,0,0]
    ds_write_addtid_b32 v35 offset:22304
    v_pk_mul_f16 v32, v20, v38 op_sel:[0,0] op_sel_hi:[1,0]
    v_pk_fma_f16 v32, v20, v38, v32 op_sel:[1,1,0] op_sel_hi:[0,1,1] neg_lo:[1,0,0]
    ds_write_addtid_b32 v32 offset:22848
    v_pk_mul_f16 v33, v21, v38 op_sel:[0,0] op_sel_hi:[1,0]
    v_pk_fma_f16 v33, v21, v38, v33 op_sel:[1,1,0] op_sel_hi:[0,1,1] neg_lo:[1,0,0]
    ds_write_addtid_b32 v33 offset:23392
    v_pk_mul_f16 v34, v22, v38 op_sel:[0,0] op_sel_hi:[1,0]
    v_pk_fma_f16 v34, v22, v38, v34 op_sel:[1,1,0] op_sel_hi:[0,1,1] neg_lo:[1,0,0]
    ds_write_addtid_b32 v34 offset:23936
    v_pk_mul_f16 v35, v23, v38 op_sel:[0,0] op_sel_hi:[1,0]
    v_pk_fma_f16 v35, v23, v38, v35 op_sel:[1,1,0] op_sel_hi:[0,1,1] neg_lo:[1,0,0]
    ds_write_addtid_b32 v35 offset:24480
    v_pk_mul_f16 v32, v24, v38 op_sel:[0,0] op_sel_hi:[1,0]
    v_pk_fma_f16 v32, v24, v38, v32 op_sel:[1,1,0] op_sel_hi:[0,1,1] neg_lo:[1,0,0]
    ds_write_addtid_b32 v32 offset:25024
    v_pk_mul_f16 v33, v25, v38 op_sel:[0,0] op_sel_hi:[1,0]
    v_pk_fma_f16 v33, v25, v38, v33 op_sel:[1,1,0] op_sel_hi:[0,1,1] neg_lo:[1,0,0]
    ds_write_addtid_b32 v33 offset:25568
    v_pk_mul_f16 v34, v26, v38 op_sel:[0,0] op_sel_hi:[1,0]
    v_pk_fma_f16 v34, v26, v38, v34 op_sel:[1,1,0] op_sel_hi:[0,1,1] neg_lo:[1,0,0]
    ds_write_addtid_b32 v34 offset:26112
    v_pk_mul_f16 v35, v27, v38 op_sel:[0,0] op_sel_hi:[1,0]
    v_pk_fma_f16 v35, v27, v38, v35 op_sel:[1,1,0] op_sel_hi:[0,1,1] neg_lo:[1,0,0]
    ds_write_addtid_b32 v35 offset:26656
    v_pk_mul_f16 v32, v28, v38 op_sel:[0,0] op_sel_hi:[1,0]
    v_pk_fma_f16 v32, v28, v38, v32 op_sel:[1,1,0] op_sel_hi:[0,1,1] neg_lo:[1,0,0]
    ds_write_addtid_b32 v32 offset:27200
    v_pk_mul_f16 v33, v29, v38 op_sel:[0,0] op_sel_hi:[1,0]
    v_pk_fma_f16 v33, v29, v38, v33 op_sel:[1,1,0] op_sel_hi:[0,1,1] neg_lo:[1,0,0]
    ds_write_addtid_b32 v33 offset:27744
    v_pk_mul_f16 v34, v30, v38 op_sel:[0,0] op_sel_hi:[1,0]
    v_pk_fma_f16 v34, v30, v38, v34 op_sel:[1,1,0] op_sel_hi:[0,1,1] neg_lo:[1,0,0]
    ds_write_addtid_b32 v34 offset:28288
    v_pk_mul_f16 v35, v31, v38 op_sel:[0,0] op_sel_hi:[1,0]
    v_pk_fma_f16 v35, v31, v38, v35 op_sel:[1,1,0] op_sel_hi:[0,1,1] neg_lo:[1,0,0]
    ds_write_addtid_b32 v35 offset:28832
    s_branch KG_END
KG_A:
    v_and_b32 v42, 0x7fff7fff, v42
    v_and_b32 v43, 0x7fff7fff, v43
    v_pk_max_u16 v42, v42, v43
    v_lshlrev_b32 v43, 16, v42
    v_max_u32 v42, v42, v43
    v_exp_f32 v14, v12
    v_cos_f32 v16, v13
    v_max_u32_dpp v42, v42, v42 row_ror:8 row_mask:0xf bank_mask:0xf
    v_sin_f32 v17, v13
    v_mul_f32 v16, v16, v14
    v_max_u32_dpp v42, v42, v42 row_ror:4 row_mask:0xf bank_mask:0xf
    v_mul_f32 v17, v17, v14
    v_mul_f32 v14, 0x43800000, v12
    v_max_u32_dpp v42, v42, v42 row_ror:2 row_mask:0xf bank_mask:0xf
    v_mul_f32 v15, 0x43800000, v13
    v_exp_f32 v14, v14
    v_max_u32_dpp v42, v42, v42 row_ror:1 row_mask:0xf bank_mask:0xf
    v_cos_f32 v18, v15
    v_sin_f32 v19, v15
    v_max_u32_dpp v42, v42, v42 row_bcast:15 row_mask:0xa bank_mask:0xf
    v_mul_f32 v18, v18, v14
    v_mul_f32 v19, v19, v14
    v_max_u32_dpp v42, v42, v42 row_bcast:31 row_mask:0xc bank_mask:0xf
    v_lshlrev_b32 v46, 16, v46
    v_lshlrev_b32 v47, 16, v47
    v_readlane_b32 s56, v42, 63
    s_nop 0
    s_lshr_b32 s56, s56, 23
    s_max_u32 s56, s56, 6
    s_sub_u32 s57, 260, s56
    s_lshl_b32 s57, s57, 23
    s_sub_u32 s56, s56, 5
    s_lshl_b32 s56, s56, 23
    v_mul_f32 v46, s57, v46
    v_mul_f32 v47, s57, v47
    v_mul_f32 v41, s56, v41
    s_lshl_b32 s56, s33, 2
    v_mov_b32 v14, s56
    s_mov_b64 exec, 1
    ds_write_b32 v14, v41 offset:560
    s_mov_b64 exec, -1
    v_cvt_pk_f16_f32 v32, v46, -v47
    ds_write_addtid_b32 v32 offset:11424
    v_pk_mul_f32 v[24:25], v[46:47], v[18:19] op_sel:[0,0] op_sel_hi:[1,0]
    v_pk_fma_f32 v[24:25], v[46:47], v[18:19], v[24:25] op_sel:[1,1,0] op_sel_hi:[0,1,1] neg_lo:[1,0,0]
    v_cvt_pk_f16_f32 v33, v24, -v25
    ds_write_addtid_b32 v33 offset:7616
    v_pk_mul_f32 v[22:23], v[46:47], v[16:17] op_sel:[0,0] op_sel_hi:[1,0]
    v_pk_fma_f32 v[22:23], v[46:47], v[16:17], v[22:23] op_sel:[1,1,0] op_sel_hi:[0,1,1] neg_lo:[1,0,0]
    v_cvt_pk_f16_f32 v34, v22, -v23
    ds_write_addtid_b32 v34 offset:0
    v_pk_mul_f32 v[20:21], v[22:23], v[16:17] op_sel:[0,0] op_sel_hi:[1,0]
    v_pk_fma_f32 v[20:21], v[22:23], v[16:17], v[20:21] op_sel:[1,1,0] op_sel_hi:[0,1,1] neg_lo:[1,0,0]
    v_cvt_pk_f16_f32 v35, v20, -v21
    ds_write_addtid_b32 v35 offset:544
    v_pk_mul_f32 v[24:25], v[20:21], v[18:19] op_sel:[0,0] op_sel_hi:[1,0]
    v_pk_fma_f32 v[24:25], v[20:21], v[18:19], v[24:25] op_sel:[1,1,0] op_sel_hi:[0,1,1] neg_lo:[1,0,0]
    v_cvt_pk_f16_f32 v36, v24, -v25
    ds_write_addtid_b32 v36 offset:7072
    v_pk_mul_f32 v[22:23], v[20:21], v[16:17] op_sel:[0,0] op_sel_hi:[1,0]
    v_pk_fma_f32 v[22:23], v[20:21], v[16:17], v[22:23] op_sel:[1,1,0] op_sel_hi:[0,1,1] neg_lo:[1,0,0]
    v_cvt_pk_f16_f32 v37, v22, -v23
    ds_write_addtid_b32 v37 offset:1088
    v_pk_mul_f32 v[20:21], v[22:23], v[16:17] op_sel:[0,0] op_sel_hi:[1,0]
    v_pk_fma_f32 v[20:21], v[22:23], v[16:17], v[20:21] op_sel:[1,1,0] op_sel_hi:[0,1,1] neg_lo:[1,0,0]
    v_cvt_pk_f16_f32 v32, v20, -v21
    ds_write_addtid_b32 v32 offset:1632
    v_pk_mul_f32 v[24:25], v[20:21], v[18:19] op_sel:[0,0] op_sel_hi:[1,0]
    v_pk_fma_f32 v[24:25], v[20:21], v[18:19], v[24:25] op_sel:[1,1,0] op_sel_hi:[0,1,1] neg_lo:[1,0,0]
    v_cvt_pk_f16_f32 v33, v24, -v25
    ds_write_addtid_b32 v33 offset:2176
    v_pk_mul_f32 v[26:27], v[24:25], v[18:19] op_sel:[0,0] op_sel_hi:[1,0]
    v_pk_fma_f32 v[26:27], v[24:25], v[18:19], v[26:27] op_sel:[1,1,0] op_sel_hi:[0,1,1] neg_lo:[1,0,0]
    v_cvt_pk_f16_f32 v34, v26, -v27
    ds_write_addtid_b32 v34 offset:3808
    v_pk_mul_f32 v[24:25], v[26:27], v[18:19] op_sel:[0,0] op_sel_hi:[1,0]
    v_pk_fma_f32 v[24:25], v[26:27], v[18:19], v[24:25] op_sel:[1,1,0] op_sel_hi:[0,1,1] neg_lo:[1,0,0]
    v_cvt_pk_f16_f32 v35, v24, -v25
    ds_write_addtid_b32 v35 offset:8704
    v_pk_mul_f32 v[22:23], v[20:21], v[16:17] op_sel:[0,0] op_sel_hi:[1,0]
    v_pk_fma_f32 v[22:23], v[20:21], v[16:17], v[22:23] op_sel:[1,1,0] op_sel_hi:[0,1,1] neg_lo:[1,0,0]
    v_cvt_pk_f16_f32 v36, v22, -v23
    ds_write_addtid_b32 v36 offset:4352
    v_pk_mul_f32 v[20:21], v[22:23], v[16:17] op_sel:[0,0] op_sel_hi:[1,0]
    v_pk_fma_f32 v[20:21], v[22:23], v[16:17], v[20:21] op_sel:[1,1,0] op_sel_hi:[0,1,1] neg_lo:[1,0,0]
    v_cvt_pk_f16_f32 v37, v20, -v21
    ds_write_addtid_b32 v37 offset:4896
    v_pk_mul_f32 v[24:25], v[20:21], v[18:19] op_sel:[0,0] op_sel_hi:[1,0]
    v_pk_fma_f32 v[24:25], v[20:21], v[18:19], v[24:25] op_sel:[1,1,0] op_sel_hi:[0,1,1] neg_lo:[1,0,0]
    v_cvt_pk_f16_f32 v32, v24, -v25
    ds_write_addtid_b32 v32 offset:2720
    v_pk_mul_f32 v[22:23], v[20:21], v[16:17] op_sel:[0,0] op_sel_hi:[1,0]
    v_pk_fma_f32 v[22:23], v[20:21], v[16:17], v[22:23] op_sel:[1,1,0] op_sel_hi:[0,1,1] neg_lo:[1,0,0]
    v_cvt_pk_f16_f32 v33, v22, -v23
    ds_write_addtid_b32 v33 offset:5440
    v_pk_mul_f32 v[20:21], v[22:23], v[16:17] op_sel:[0,0] op_sel_hi:[1,0]
    v_pk_fma_f32 v[20:21], v[22:23], v[16:17], v[20:21] op_sel:[1,1,0] op_sel_hi:[0,1,1] neg_lo:[1,0,0]
    v_cvt_pk_f16_f32 v34, v20, -v21
    ds_write_addtid_b32 v34 offset:5984
    v_pk_mul_f32 v[24:25], v[20:21], v[18:19] op_sel:[0,0] op_sel_hi:[1,0]
    v_pk_fma_f32 v[24:25], v[20:21], v[18:19], v[24:25] op_sel:[1,1,0] op_sel_hi:[0,1,1] neg_lo:[1,0,0]
    v_cvt_pk_f16_f32 v35, v24, -v25
    ds_write_addtid_b32 v35 offset:3264
    v_pk_mul_f32 v[26:27], v[24:25], v[18:19] op_sel:[0,0] op_sel_hi:[1,0]
    v_pk_fma_f32 v[26:27], v[24:25], v[18:19], v[26:27] op_sel:[1,1,0] op_sel_hi:[0,1,1] neg_lo:[1,0,0]
    v_cvt_pk_f16_f32 v36, v26, -v27
    ds_write_addtid_b32 v36 offset:6528
    v_pk_mul_f32 v[24:25], v[26:27], v[18:19] op_sel:[0,0] op_sel_hi:[1,0]
    v_pk_fma_f32 v[24:25], v[26:27], v[18:19], v[24:25] op_sel:[1,1,0] op_sel_hi:[0,1,1] neg_lo:[1,0,0]
    v_cvt_pk_f16_f32 v37, v24, -v25
    ds_write_addtid_b32 v37 offset:9248
    v_pk_mul_f32 v[26:27], v[24:25], v[18:19] op_sel:[0,0] op_sel_hi:[1,0]
    v_pk_fma_f32 v[26:27], v[24:25], v[18:19], v[26:27] op_sel:[1,1,0] op_sel_hi:[0,1,1] neg_lo:[1,0,0]
    v_cvt_pk_f16_f32 v32, v26, -v27
    ds_write_addtid_b32 v32 offset:8160
    v_pk_mul_f32 v[24:25], v[26:27], v[18:19] op_sel:[0,0] op_sel_hi:[1,0]
    v_pk_fma_f32 v[24:25], v[26:27], v[18:19], v[24:25] op_sel:[1,1,0] op_sel_hi:[0,1,1] neg_lo:[1,0,0]
    v_cvt_pk_f16_f32 v33, v24, -v25
    ds_write_addtid_b32 v33 offset:9792
    v_pk_mul_f32 v[26:27], v[24:25], v[18:19] op_sel:[0,0] op_sel_hi:[1,0]
    v_pk_fma_f32 v[26:27], v[24:25], v[18:19], v[26:27] op_sel:[1,1,0] op_sel_hi:[0,1,1] neg_lo:[1,0,0]
    v_cvt_pk_f16_f32 v34, v26, -v27
    ds_write_addtid_b32 v34 offset:10336
    v_pk_mul_f32 v[24:25], v[26:27], v[18:19] op_sel:[0,0] op_sel_hi:[1,0]
    v_pk_fma_f32 v[24:25], v[26:27], v[18:19], v[24:25] op_sel:[1,1,0] op_sel_hi:[0,1,1] neg_lo:[1,0,0]
    v_cvt_pk_f16_f32 v35, v24, -v25
    ds_write_addtid_b32 v35 offset:10880
KG_END:
    s_lshl_b32 s56, s33, 2
    v_mov_b32 v14, s56
    v_mov_b32 v15, 1
    s_waitcnt lgkmcnt(0)
    s_mov_b64 exec, 1
    ds_add_u32 v14, v15 offset:544
    s_mov_b64 exec, -1
    s_mul_i32 s48, s48, 1664525
    s_add_u32 s48, s48, 1013904223
    s_mov_b32 s49, 0
KG_SPIN:
    ds_read_b32 v15, v14 offset:544
    s_add_u32 s49, s49, 1
    s_waitcnt lgkmcnt(0)
    v_readfirstlane_b32 s56, v15
    s_nop 0
    s_cmp_ge_u32 s56, 4
    s_cbranch_scc1 KG_GO
    s_sleep 1
    s_cmp_lt_u32 s49, 60000
    s_cbranch_scc1 KG_SPIN
KG_GO:
    s_setprio 2
    ds_read_b128 v[12:15], v8 offset:0
    ds_read_b128 v[16:19], v9 offset:0
    ds_read_b128 v[20:23], v8 offset:64
    ds_read_b128 v[24:27], v9 offset:64
    ds_read_b128 v[28:31], v8 offset:128
    ds_read_b128 v[32:35], v9 offset:128
    ds_read_b128 v[36:39], v8 offset:192
    ds_read_b128 v[40:43], v9 offset:192
    s_waitcnt lgkmcnt(6)
    v_mfma_f32_16x16x32_f16 v[44:47], v[12:15], v[16:19], 0
    ds_read_b128 v[12:15], v8 offset:256
    ds_read_b128 v[16:19], v9 offset:256
    s_waitcnt lgkmcnt(6)
    v_mfma_f32_16x16x32_f16 v[44:47], v[20:23], v[24:27], v[44:47]
    ds_read_b128 v[20:23], v8 offset:320
    ds_read_b128 v[24:27], v9 offset:320
    s_waitcnt lgkmcnt(6)
    v_mfma_f32_16x16x32_f16 v[44:47], v[28:31], v[32:35], v[44:47]
    ds_read_b128 v[28:31], v8 offset:384
    ds_read_b128 v[32:35], v9 offset:384
    s_waitcnt lgkmcnt(6)
    v_mfma_f32_16x16x32_f16 v[44:47], v[36:39], v[40:43], v[44:47]
    ds_read_b128 v[36:39], v8 offset:448
    ds_read_b128 v[40:43], v9 offset:448
    s_waitcnt lgkmcnt(6)
    v_mfma_f32_16x16x32_f16 v[44:47], v[12:15], v[16:19], v[44:47]
    s_waitcnt lgkmcnt(4)
    v_mfma_f32_16x16x32_f16 v[44:47], v[20:23], v[24:27], v[44:47]
    s_waitcnt lgkmcnt(2)
    v_mfma_f32_16x16x32_f16 v[44:47], v[28:31], v[32:35], v[44:47]
    s_waitcnt lgkmcnt(0)
    v_mfma_f32_16x16x32_f16 v[44:47], v[36:39], v[40:43], v[44:47]
    s_nop 7
    v_cvt_pk_f16_f32 v12, v44, v45
    v_cvt_pk_f16_f32 v13, v46, v47
    s_cmp_ge_u32 s38, 2
    s_cbranch_scc1 KG_WT
    v_cvt_pk_f16_f32 v14, v45, v46
    ds_write_b64 v10, v[12:13]
    ds_write_b16 v10, v12 offset:1218
    ds_write_b32 v10, v14 offset:1220
    ds_write_b16_d16_hi v10, v13 offset:1224
    ds_write_b32 v10, v12 offset:2436
    ds_write_b32 v10, v13 offset:2440
    ds_write_b16 v10, v12 offset:3654
    ds_write_b32 v10, v14 offset:3656
    ds_write_b16_d16_hi v10, v13 offset:3660
    s_cmp_eq_u32 s38, 0
    s_cbranch_scc1 KG_WD
    v_readlane_b32 s56, v12, 63
    s_mov_b64 exec, 0xff
    s_nop 0
    v_mov_b32 v15, s56
    ds_write_b16 v11, v15
    s_branch KG_WD
KG_WT:
    v_readlane_b32 s56, v12, 8
    s_mov_b32 exec_lo, 0x00ff00ff
    s_mov_b32 exec_hi, 0x00ff00ff
    ds_write_b64 v10, v[12:13]
    s_cmp_eq_u32 s38, 3
    s_cbranch_scc1 KG_WD
    s_mov_b64 exec, 15
    v_mov_b32 v15, s56
    ds_write_b16 v11, v15
KG_WD:
    s_mov_b64 exec, -1
    s_lshl_b32 s56, s33, 2
    v_mov_b32 v14, s56
    v_mov_b32 v15, 1
    s_waitcnt lgkmcnt(0)
    s_mov_b64 exec, 1
    ds_add_u32 v14, v15 offset:640
    s_mov_b64 exec, -1
    s_cmp_eq_u32 s47, 0
    s_cbranch_scc1 CV_B4
    s_lshl_b32 s57, s46, 2
    v_mov_b32 v4, s57
    v_mov_b32 v6, 0
    s_mov_b32 s59, 0x03020302
    s_mov_b32 s49, 0
CV_SP:
    ds_read_b32 v15, v4 offset:640
    s_add_u32 s49, s49, 1
    s_waitcnt lgkmcnt(0)
    v_readfirstlane_b32 s56, v15
    s_nop 0
    s_cmp_ge_u32 s56, 4
    s_cbranch_scc1 CV_GO
    s_sleep 1
    s_cmp_lt_u32 s49, 60000
    s_cbranch_scc1 CV_SP
CV_GO:
    s_setprio 2
    s_cmp_eq_u32 s47, 2
    s_cbranch_scc1 CV_LIGHT
    ds_read_b32 v4, v4 offset:560
    ds_read_b32 v120, v120
    ds_read_b64 v[28:29], v127 offset:448
    ds_read_b64 v[30:31], v127 offset:456
    ds_read_b64 v[32:33], v127 offset:960
    ds_read_b64 v[34:35], v127 offset:968
    ds_read_b64 v[36:37], v127 offset:384
    ds_read_b64 v[38:39], v127 offset:392
    ds_read_b64 v[40:41], v127 offset:896
    ds_read_b64 v[42:43], v127 offset:904
    s_waitcnt lgkmcnt(8)
    v_readfirstlane_b32 s58, v4
    v_perm_b32 v120, v120, v120, s59
    v_and_b32 v116, v116, v120
    v_and_b32 v117, v117, v120
    v_and_b32 v118, v118, v120
    v_and_b32 v119, v119, v120
    s_waitcnt lgkmcnt(0)
    s_barrier
    ds_read_b128 v[44:47], v126 offset:1408
    ds_read_b128 v[48:51], v126 offset:1920
    ds_read_b128 v[52:55], v126 offset:2432
    ds_read_b128 v[56:59], v126 offset:2944
    ds_read_b128 v[60:63], v126 offset:3456
    ds_read_b128 v[64:67], v126 offset:3968
    ds_read_b128 v[68:71], v126 offset:1344
    s_waitcnt lgkmcnt(6)
    v_mfma_f32_16x16x32_f16 v[8:11], v[28:31], v[44:47], 0
    ds_read_b128 v[72:75], v126 offset:1856
    s_waitcnt lgkmcnt(6)
    v_mfma_f32_16x16x32_f16 v[8:11], v[32:35], v[48:51], v[8:11]
    v_mfma_f32_16x16x32_f16 v[12:15], v[28:31], v[48:51], 0
    ds_read_b128 v[76:79], v126 offset:2368
    s_waitcnt lgkmcnt(6)
    v_mfma_f32_16x16x32_f16 v[12:15], v[32:35], v[52:55], v[12:15]
    v_mfma_f32_16x16x32_f16 v[16:19], v[28:31], v[52:55], 0
    ds_read_b128 v[80:83], v126 offset:2880
    s_waitcnt lgkmcnt(6)
    v_mfma_f32_16x16x32_f16 v[16:19], v[32:35], v[56:59], v[16:19]
    v_mfma_f32_16x16x32_f16 v[20:23], v[28:31], v[56:59], 0
    ds_read_b128 v[84:87], v126 offset:3392
    s_waitcnt lgkmcnt(6)
    v_mfma_f32_16x16x32_f16 v[20:23], v[32:35], v[60:63], v[20:23]
    v_mfma_f32_16x16x32_f16 v[24:27], v[28:31], v[60:63], 0
    ds_read_b128 v[88:91], v126 offset:3904
    s_waitcnt lgkmcnt(6)
    v_mfma_f32_16x16x32_f16 v[24:27], v[32:35], v[64:67], v[24:27]
    ds_read_b128 v[92:95], v126 offset:1280
    s_waitcnt lgkmcnt(6)
    v_mfma_f32_16x16x32_f16 v[8:11], v[36:39], v[68:71], v[8:11]
    ds_read_b64 v[96:97], v127 offset:320
    s_waitcnt lgkmcnt(6)
    v_mfma_f32_16x16x32_f16 v[8:11], v[40:43], v[72:75], v[8:11]
    ds_read_b64 v[98:99], v127 offset:328
    v_mfma_f32_16x16x32_f16 v[12:15], v[36:39], v[72:75], v[12:15]
    ds_read_b128 v[100:103], v126 offset:1792
    s_waitcnt lgkmcnt(7)
    v_mfma_f32_16x16x32_f16 v[12:15], v[40:43], v[76:79], v[12:15]
    ds_read_b64 v[104:105], v127 offset:832
    v_mfma_f32_16x16x32_f16 v[16:19], v[36:39], v[76:79], v[16:19]
    ds_read_b64 v[106:107], v127 offset:840
    s_waitcnt lgkmcnt(8)
    v_mfma_f32_16x16x32_f16 v[16:19], v[40:43], v[80:83], v[16:19]
    ds_read_b128 v[108:111], v126 offset:2304
    v_mfma_f32_16x16x32_f16 v[20:23], v[36:39], v[80:83], v[20:23]
    ds_read_b128 v[112:115], v126 offset:2816
    s_waitcnt lgkmcnt(9)
    v_mfma_f32_16x16x32_f16 v[20:23], v[40:43], v[84:87], v[20:23]
    ds_read_b128 v[44:47], v126 offset:3328
    v_mfma_f32_16x16x32_f16 v[24:27], v[36:39], v[84:87], v[24:27]
    ds_read_b128 v[48:51], v126 offset:3840
    s_waitcnt lgkmcnt(10)
    v_mfma_f32_16x16x32_f16 v[24:27], v[40:43], v[88:91], v[24:27]
    ds_read_b128 v[52:55], v126 offset:1216
    s_waitcnt lgkmcnt(8)
    v_mfma_f32_16x16x32_f16 v[8:11], v[96:99], v[92:95], v[8:11]
    ds_read_b64 v[56:57], v127 offset:256
    s_waitcnt lgkmcnt(6)
    v_mfma_f32_16x16x32_f16 v[8:11], v[104:107], v[100:103], v[8:11]
    ds_read_b64 v[58:59], v127 offset:264
    v_mfma_f32_16x16x32_f16 v[12:15], v[96:99], v[100:103], v[12:15]
    ds_read_b128 v[28:31], v126 offset:1728
    s_waitcnt lgkmcnt(7)
    v_mfma_f32_16x16x32_f16 v[12:15], v[104:107], v[108:111], v[12:15]
    ds_read_b64 v[60:61], v127 offset:768
    v_mfma_f32_16x16x32_f16 v[16:19], v[96:99], v[108:111], v[16:19]
    ds_read_b64 v[62:63], v127 offset:776
    s_waitcnt lgkmcnt(8)
    v_mfma_f32_16x16x32_f16 v[16:19], v[104:107], v[112:115], v[16:19]
    ds_read_b128 v[32:35], v126 offset:2240
    v_mfma_f32_16x16x32_f16 v[20:23], v[96:99], v[112:115], v[20:23]
    ds_read_b128 v[64:67], v126 offset:2752
    s_waitcnt lgkmcnt(9)
    v_mfma_f32_16x16x32_f16 v[20:23], v[104:107], v[44:47], v[20:23]
    ds_read_b128 v[68:71], v126 offset:3264
    v_mfma_f32_16x16x32_f16 v[24:27], v[96:99], v[44:47], v[24:27]
    ds_read_b128 v[72:75], v126 offset:3776
    s_waitcnt lgkmcnt(10)
    v_mfma_f32_16x16x32_f16 v[24:27], v[104:107], v[48:51], v[24:27]
    ds_read_b128 v[76:79], v126 offset:1152
    s_waitcnt lgkmcnt(8)
    v_mfma_f32_16x16x32_f16 v[8:11], v[56:59], v[52:55], v[8:11]
    ds_read_b64 v[80:81], v127 offset:192
    s_waitcnt lgkmcnt(6)
    v_mfma_f32_16x16x32_f16 v[8:11], v[60:63], v[28:31], v[8:11]
    ds_read_b64 v[82:83], v127 offset:200
    v_mfma_f32_16x16x32_f16 v[12:15], v[56:59], v[28:31], v[12:15]
    ds_read_b128 v[36:39], v126 offset:1664
    s_waitcnt lgkmcnt(7)
    v_mfma_f32_16x16x32_f16 v[12:15], v[60:63], v[32:35], v[12:15]
    ds_read_b64 v[84:85], v127 offset:704
    v_mfma_f32_16x16x32_f16 v[16:19], v[56:59], v[32:35], v[16:19]
    ds_read_b64 v[86:87], v127 offset:712
    s_waitcnt lgkmcnt(8)
    v_mfma_f32_16x16x32_f16 v[16:19], v[60:63], v[64:67], v[16:19]
    ds_read_b128 v[40:43], v126 offset:2176
    v_mfma_f32_16x16x32_f16 v[20:23], v[56:59], v[64:67], v[20:23]
    ds_read_b128 v[88:91], v126 offset:2688
    s_waitcnt lgkmcnt(9)
    v_mfma_f32_16x16x32_f16 v[20:23], v[60:63], v[68:71], v[20:23]
    ds_read_b128 v[92:95], v126 offset:3200
    v_mfma_f32_16x16x32_f16 v[24:27], v[56:59], v[68:71], v[24:27]
    ds_read_b128 v[100:103], v126 offset:3712
    s_waitcnt lgkmcnt(10)
    v_mfma_f32_16x16x32_f16 v[24:27], v[60:63], v[72:75], v[24:27]
    ds_read_b128 v[108:111], v126 offset:1088
    s_waitcnt lgkmcnt(8)
    v_mfma_f32_16x16x32_f16 v[8:11], v[80:83], v[76:79], v[8:11]
    ds_read_b64 v[112:113], v127 offset:128
    s_waitcnt lgkmcnt(6)
    v_mfma_f32_16x16x32_f16 v[8:11], v[84:87], v[36:39], v[8:11]
    ds_read_b64 v[114:115], v127 offset:136
    v_mfma_f32_16x16x32_f16 v[12:15], v[80:83], v[36:39], v[12:15]
    ds_read_b128 v[96:99], v126 offset:1600
    s_waitcnt lgkmcnt(7)
    v_mfma_f32_16x16x32_f16 v[12:15], v[84:87], v[40:43], v[12:15]
    ds_read_b64 v[44:45], v127 offset:640
    v_mfma_f32_16x16x32_f16 v[16:19], v[80:83], v[40:43], v[16:19]
    ds_read_b64 v[46:47], v127 offset:648
    s_waitcnt lgkmcnt(8)
    v_mfma_f32_16x16x32_f16 v[16:19], v[84:87], v[88:91], v[16:19]
    ds_read_b128 v[104:107], v126 offset:2112
    v_mfma_f32_16x16x32_f16 v[20:23], v[80:83], v[88:91], v[20:23]
    ds_read_b128 v[48:51], v126 offset:2624
    s_waitcnt lgkmcnt(9)
    v_mfma_f32_16x16x32_f16 v[20:23], v[84:87], v[92:95], v[20:23]
    ds_read_b128 v[52:55], v126 offset:3136
    v_mfma_f32_16x16x32_f16 v[24:27], v[80:83], v[92:95], v[24:27]
    ds_read_b128 v[28:31], v126 offset:3648
    s_waitcnt lgkmcnt(10)
    v_mfma_f32_16x16x32_f16 v[24:27], v[84:87], v[100:103], v[24:27]
    ds_read_b128 v[32:35], v126 offset:1024
    s_waitcnt lgkmcnt(8)
    v_mfma_f32_16x16x32_f16 v[8:11], v[112:115], v[108:111], v[8:11]
    ds_read_b64 v[64:65], v127 offset:64
    s_waitcnt lgkmcnt(6)
    v_mfma_f32_16x16x32_f16 v[8:11], v[44:47], v[96:99], v[8:11]
    ds_read_b64 v[66:67], v127 offset:72
    v_mfma_f32_16x16x32_f16 v[12:15], v[112:115], v[96:99], v[12:15]
    ds_read_b128 v[56:59], v126 offset:1536
    s_waitcnt lgkmcnt(7)
    v_mfma_f32_16x16x32_f16 v[12:15], v[44:47], v[104:107], v[12:15]
    ds_read_b64 v[68:69], v127 offset:576
    v_mfma_f32_16x16x32_f16 v[16:19], v[112:115], v[104:107], v[16:19]
    ds_read_b64 v[70:71], v127 offset:584
    s_waitcnt lgkmcnt(8)
    v_mfma_f32_16x16x32_f16 v[16:19], v[44:47], v[48:51], v[16:19]
    ds_read_b128 v[60:63], v126 offset:2048
    v_mfma_f32_16x16x32_f16 v[20:23], v[112:115], v[48:51], v[20:23]
    ds_read_b128 v[72:75], v126 offset:2560
    s_waitcnt lgkmcnt(9)
    v_mfma_f32_16x16x32_f16 v[20:23], v[44:47], v[52:55], v[20:23]
    ds_read_b128 v[76:79], v126 offset:3072
    v_mfma_f32_16x16x32_f16 v[24:27], v[112:115], v[52:55], v[24:27]
    ds_read_b128 v[36:39], v126 offset:3584
    s_waitcnt lgkmcnt(10)
    v_mfma_f32_16x16x32_f16 v[24:27], v[44:47], v[28:31], v[24:27]
    ds_read_b128 v[40:43], v126 offset:448
    s_waitcnt lgkmcnt(8)
    v_mfma_f32_16x16x32_f16 v[8:11], v[64:67], v[32:35], v[8:11]
    ds_read_b128 v[88:91], v126 offset:960
    s_waitcnt lgkmcnt(6)
    v_mfma_f32_16x16x32_f16 v[8:11], v[68:71], v[56:59], v[8:11]
    ds_read_b64 v[80:81], v127 offset:0
    v_mfma_f32_16x16x32_f16 v[12:15], v[64:67], v[56:59], v[12:15]
    ds_read_b64 v[82:83], v127 offset:8
    s_waitcnt lgkmcnt(7)
    v_mfma_f32_16x16x32_f16 v[12:15], v[68:71], v[60:63], v[12:15]
    ds_read_b128 v[92:95], v126 offset:1472
    v_mfma_f32_16x16x32_f16 v[16:19], v[64:67], v[60:63], v[16:19]
    ds_read_b64 v[84:85], v127 offset:512
    s_waitcnt lgkmcnt(8)
    v_mfma_f32_16x16x32_f16 v[16:19], v[68:71], v[72:75], v[16:19]
    ds_read_b64 v[86:87], v127 offset:520
    v_mfma_f32_16x16x32_f16 v[20:23], v[64:67], v[72:75], v[20:23]
    ds_read_b128 v[100:103], v126 offset:1984
    s_waitcnt lgkmcnt(9)
    v_mfma_f32_16x16x32_f16 v[20:23], v[68:71], v[76:79], v[20:23]
    ds_read_b64 v[108:109], v127 offset:1024
    v_mfma_f32_16x16x32_f16 v[24:27], v[64:67], v[76:79], v[24:27]
    ds_read_b64 v[110:111], v127 offset:1032
    s_waitcnt lgkmcnt(10)
    v_mfma_f32_16x16x32_f16 v[24:27], v[68:71], v[36:39], v[24:27]
    ds_read_b128 v[96:99], v126 offset:2496
    s_waitcnt lgkmcnt(10)
    v_mfma_f32_16x16x32_f16 v[12:15], v[116:119], v[40:43], v[12:15]
    s_waitcnt lgkmcnt(7)
    v_mfma_f32_16x16x32_f16 v[8:11], v[80:83], v[88:91], v[8:11]
    v_mfma_f32_16x16x32_f16 v[16:19], v[116:119], v[88:91], v[16:19]
    ds_read_b128 v[104:107], v126 offset:3008
    s_waitcnt lgkmcnt(5)
    v_mfma_f32_16x16x32_f16 v[8:11], v[84:87], v[92:95], v[8:11]
    ds_read_b32 v7, v6 offset:556
    v_mfma_f32_16x16x32_f16 v[12:15], v[80:83], v[92:95], v[12:15]
    v_mfma_f32_16x16x32_f16 v[20:23], v[116:119], v[92:95], v[20:23]
    ds_read_b128 v[48:51], v126 offset:3520
    s_waitcnt lgkmcnt(4)
    v_mfma_f32_16x16x32_f16 v[8:11], v[108:111], v[100:103], v[8:11]
    v_mfma_f32_16x16x32_f16 v[12:15], v[84:87], v[100:103], v[12:15]
    ds_read_b128 v[112:115], v126 offset:4032
    v_mfma_f32_16x16x32_f16 v[16:19], v[80:83], v[100:103], v[16:19]
    s_waitcnt lgkmcnt(2)
    v_readfirstlane_b32 s56, v7
    s_nop 0
    s_cmp_ge_u32 s56, 10
    s_cbranch_scc1 CH_WOK
    s_mov_b32 s49, 0
CH_WSP:
    s_sleep 1
    ds_read_b32 v7, v6 offset:556
    s_add_u32 s49, s49, 1
    s_waitcnt lgkmcnt(0)
    v_readfirstlane_b32 s56, v7
    s_nop 0
    s_cmp_ge_u32 s56, 10
    s_cbranch_scc1 CH_WOK
    s_cmp_lt_u32 s49, 60000
    s_cbranch_scc1 CH_WSP
CH_WOK:
    v_mfma_f32_16x16x32_f16 v[24:27], v[116:119], v[100:103], v[24:27]
    ds_read_b64_tr_b16 v[52:53], v121 offset:0
    v_mfma_f32_16x16x32_f16 v[12:15], v[108:111], v[96:99], v[12:15]
    ds_read_b64_tr_b16 v[54:55], v121 offset:64
    v_mfma_f32_16x16x32_f16 v[16:19], v[84:87], v[96:99], v[16:19]
    ds_read2_b32 v[44:45], v122 offset0:3 offset1:2
    v_mfma_f32_16x16x32_f16 v[20:23], v[80:83], v[96:99], v[20:23]
    ds_read2_b32 v[46:47], v122 offset0:1 offset1:0
    v_mfma_f32_16x16x32_f16 v[16:19], v[108:111], v[104:107], v[16:19]
    ds_read2_b32 v[28:29], v122 offset0:19 offset1:18
    ds_read2_b32 v[30:31], v122 offset0:17 offset1:16
    v_mfma_f32_16x16x32_f16 v[20:23], v[84:87], v[104:107], v[20:23]
    ds_read2_b32 v[32:33], v122 offset0:35 offset1:34
    ds_read2_b32 v[34:35], v122 offset0:33 offset1:32
    v_mfma_f32_16x16x32_f16 v[24:27], v[80:83], v[104:107], v[24:27]
    ds_read2_b32 v[56:57], v122 offset0:51 offset1:50
    ds_read2_b32 v[58:59], v122 offset0:49 offset1:48
    s_waitcnt lgkmcnt(11)
    v_mfma_f32_16x16x32_f16 v[20:23], v[108:111], v[48:51], v[20:23]
    ds_read_b64_tr_b16 v[60:61], v121 offset:512
    ds_read_b64_tr_b16 v[62:63], v121 offset:576
    v_mfma_f32_16x16x32_f16 v[24:27], v[84:87], v[48:51], v[24:27]
    ds_read_b64_tr_b16 v[72:73], v121 offset:1024
    s_waitcnt lgkmcnt(13)
    v_mfma_f32_16x16x32_f16 v[24:27], v[108:111], v[112:115], v[24:27]
    ds_read_b64_tr_b16 v[74:75], v121 offset:1088
    s_waitcnt lgkmcnt(12)
    s_waitcnt lgkmcnt(10)
    v_mfma_f32_16x16x32_f16 v[12:15], v[52:55], v[44:47], v[12:15]
    ds_read_b64_tr_b16 v[64:65], v121 offset:1536
    s_waitcnt lgkmcnt(9)
    v_mfma_f32_16x16x32_f16 v[16:19], v[52:55], v[28:31], v[16:19]
    ds_read_b64_tr_b16 v[66:67], v121 offset:1600
    s_waitcnt lgkmcnt(8)
    v_mfma_f32_16x16x32_f16 v[20:23], v[52:55], v[32:35], v[20:23]
    ds_read_b64_tr_b16 v[76:77], v124 offset:0
    s_waitcnt lgkmcnt(7)
    v_mfma_f32_16x16x32_f16 v[24:27], v[52:55], v[56:59], v[24:27]
    ds_read_b64_tr_b16 v[78:79], v124 offset:32
    ds_read2_b32 v[68:69], v125 offset0:25 offset1:89
    s_waitcnt lgkmcnt(7)
    v_mfma_f32_16x16x32_f16 v[16:19], v[60:63], v[44:47], v[16:19]
    ds_read2_b32 v[70:71], v125 offset0:24 offset1:88
    ds_read2_b32 v[36:37], v125 offset0:41 offset1:105
    v_mfma_f32_16x16x32_f16 v[20:23], v[60:63], v[28:31], v[20:23]
    ds_read2_b32 v[38:39], v125 offset0:40 offset1:104
    ds_read_b64_tr_b16 v[40:41], v124 offset:256
    v_mfma_f32_16x16x32_f16 v[24:27], v[60:63], v[32:35], v[24:27]
    ds_read_b64_tr_b16 v[42:43], v124 offset:288
    ds_read2_b32 v[88:89], v125 offset0:17 offset1:81
    s_waitcnt lgkmcnt(11)
    v_mfma_f32_16x16x32_f16 v[20:23], v[72:75], v[44:47], v[20:23]
    ds_read2_b32 v[90:91], v125 offset0:16 offset1:80
    ds_read2_b32 v[92:93], v125 offset0:33 offset1:97
    v_mfma_f32_16x16x32_f16 v[24:27], v[72:75], v[28:31], v[24:27]
    ds_read2_b32 v[94:95], v125 offset0:32 offset1:96
    s_waitcnt lgkmcnt(12)
    v_mfma_f32_16x16x32_f16 v[24:27], v[64:67], v[44:47], v[24:27]
    ds_read_b64_tr_b16 v[100:101], v124 offset:512
    ds_read_b64_tr_b16 v[102:103], v124 offset:544
    s_waitcnt lgkmcnt(12)
    s_waitcnt lgkmcnt(10)
    v_mfma_f32_16x16x32_f16 v[8:11], v[76:79], v[68:71], v[8:11]
    ds_read2_b32 v[96:97], v125 offset0:9 offset1:73
    ds_read2_b32 v[98:99], v125 offset0:8 offset1:72
    s_waitcnt lgkmcnt(10)
    v_mfma_f32_16x16x32_f16 v[12:15], v[76:79], v[36:39], v[12:15]
    ds_read_b64_tr_b16 v[80:81], v124 offset:768
    ds_read_b64_tr_b16 v[82:83], v124 offset:800
    s_waitcnt lgkmcnt(10)
    s_waitcnt lgkmcnt(8)
    v_mfma_f32_16x16x32_f16 v[8:11], v[40:43], v[88:91], v[8:11]
    ds_read2_b32 v[104:105], v125 offset0:1 offset1:65
    ds_read2_b32 v[106:107], v125 offset0:0 offset1:64
    s_waitcnt lgkmcnt(8)
    v_mfma_f32_16x16x32_f16 v[12:15], v[40:43], v[92:95], v[12:15]
    ds_read_b64_tr_b16 v[84:85], v124 offset:1024
    ds_read_b64_tr_b16 v[86:87], v124 offset:1056
    s_waitcnt lgkmcnt(8)
    s_waitcnt lgkmcnt(6)
    v_mfma_f32_16x16x32_f16 v[8:11], v[100:103], v[96:99], v[8:11]
    ds_read_b64_tr_b16 v[48:49], v124 offset:1280
    v_mfma_f32_16x16x32_f16 v[12:15], v[100:103], v[68:71], v[12:15]
    ds_read_b64_tr_b16 v[50:51], v124 offset:1312
    v_mfma_f32_16x16x32_f16 v[16:19], v[100:103], v[36:39], v[16:19]
    ds_read_b64_tr_b16 v[108:109], v124 offset:1536
    s_waitcnt lgkmcnt(7)
    s_waitcnt lgkmcnt(5)
    v_mfma_f32_16x16x32_f16 v[8:11], v[80:83], v[104:107], v[8:11]
    ds_read_b64_tr_b16 v[110:111], v124 offset:1568
    v_mfma_f32_16x16x32_f16 v[12:15], v[80:83], v[88:91], v[12:15]
    ds_read_b64_tr_b16 v[112:113], v124 offset:1792
    v_mfma_f32_16x16x32_f16 v[16:19], v[80:83], v[92:95], v[16:19]
    ds_read_b64_tr_b16 v[114:115], v124 offset:1824
    s_waitcnt lgkmcnt(6)
    v_mfma_f32_16x16x32_f16 v[12:15], v[84:87], v[96:99], v[12:15]
    v_mfma_f32_16x16x32_f16 v[16:19], v[84:87], v[68:71], v[16:19]
    v_pk_mul_f32 v[8:9], v[8:9], s[58:59] op_sel_hi:[1,0]
    v_pk_mul_f32 v[10:11], v[10:11], s[58:59] op_sel_hi:[1,0]
    v_mfma_f32_16x16x32_f16 v[20:23], v[84:87], v[36:39], v[20:23]
    v_cvt_pk_bf16_f32 v8, v8, v9
    v_cvt_pk_bf16_f32 v9, v10, v11
    s_waitcnt lgkmcnt(4)
    v_mfma_f32_16x16x32_f16 v[12:15], v[48:51], v[104:107], v[12:15]
    ds_write_b64 v123, v[8:9] offset:5104
    v_mfma_f32_16x16x32_f16 v[16:19], v[48:51], v[88:91], v[16:19]
    ds_read_b64_tr_b16 v[52:53], v124 offset:2048
    v_mfma_f32_16x16x32_f16 v[20:23], v[48:51], v[92:95], v[20:23]
    ds_read_b64_tr_b16 v[54:55], v124 offset:2080
    s_waitcnt lgkmcnt(5)
    v_mfma_f32_16x16x32_f16 v[16:19], v[108:111], v[96:99], v[16:19]
    ds_read_b64_tr_b16 v[56:57], v124 offset:2304
    v_mfma_f32_16x16x32_f16 v[20:23], v[108:111], v[68:71], v[20:23]
    ds_read_b64_tr_b16 v[58:59], v124 offset:2336
    v_mfma_f32_16x16x32_f16 v[24:27], v[108:111], v[36:39], v[24:27]
    ds_read_b64_tr_b16 v[60:61], v124 offset:2560
    s_waitcnt lgkmcnt(6)
    v_mfma_f32_16x16x32_f16 v[16:19], v[112:115], v[104:107], v[16:19]
    ds_read_b64_tr_b16 v[62:63], v124 offset:2592
    v_mfma_f32_16x16x32_f16 v[20:23], v[112:115], v[88:91], v[20:23]
    ds_read_b64_tr_b16 v[32:33], v124 offset:2816
    ds_read_b64_tr_b16 v[34:35], v124 offset:2848
    v_mfma_f32_16x16x32_f16 v[24:27], v[112:115], v[92:95], v[24:27]
    v_pk_mul_f32 v[12:13], v[12:13], s[58:59] op_sel_hi:[1,0]
    v_pk_mul_f32 v[14:15], v[14:15], s[58:59] op_sel_hi:[1,0]
    s_waitcnt lgkmcnt(6)
    v_mfma_f32_16x16x32_f16 v[20:23], v[52:55], v[96:99], v[20:23]
    v_cvt_pk_bf16_f32 v12, v12, v13
    v_cvt_pk_bf16_f32 v13, v14, v15
    v_mfma_f32_16x16x32_f16 v[24:27], v[52:55], v[68:71], v[24:27]
    ds_write_b64 v123, v[12:13] offset:5696
    s_waitcnt lgkmcnt(5)
    v_mfma_f32_16x16x32_f16 v[20:23], v[56:59], v[104:107], v[20:23]
    v_pk_mul_f32 v[16:17], v[16:17], s[58:59] op_sel_hi:[1,0]
    v_pk_mul_f32 v[18:19], v[18:19], s[58:59] op_sel_hi:[1,0]
    v_mfma_f32_16x16x32_f16 v[24:27], v[56:59], v[88:91], v[24:27]
    v_cvt_pk_bf16_f32 v16, v16, v17
    v_cvt_pk_bf16_f32 v17, v18, v19
    s_waitcnt lgkmcnt(3)
    v_mfma_f32_16x16x32_f16 v[24:27], v[60:63], v[96:99], v[24:27]
    ds_write_b64 v123, v[16:17] offset:6288
    s_waitcnt lgkmcnt(2)
    v_mfma_f32_16x16x32_f16 v[24:27], v[32:35], v[104:107], v[24:27]
    v_pk_mul_f32 v[20:21], v[20:21], s[58:59] op_sel_hi:[1,0]
    v_pk_mul_f32 v[22:23], v[22:23], s[58:59] op_sel_hi:[1,0]
    v_cvt_pk_bf16_f32 v20, v20, v21
    v_cvt_pk_bf16_f32 v21, v22, v23
    ds_write_b64 v123, v[20:21] offset:6880
    s_nop 2
    v_pk_mul_f32 v[24:25], v[24:25], s[58:59] op_sel_hi:[1,0]
    v_pk_mul_f32 v[26:27], v[26:27], s[58:59] op_sel_hi:[1,0]
    v_cvt_pk_bf16_f32 v24, v24, v25
    v_cvt_pk_bf16_f32 v25, v26, v27
    ds_write_b64 v123, v[24:25] offset:7472
    s_branch CV_END
CV_LIGHT:
    ds_read_b32 v4, v4 offset:560
    ds_read_b64 v[20:21], v127 offset:960
    ds_read_b64 v[22:23], v127 offset:968
    ds_read_b64 v[24:25], v127 offset:448
    ds_read_b64 v[26:27], v127 offset:456
    ds_read_b64 v[28:29], v127 offset:896
    ds_read_b64 v[30:31], v127 offset:904
    ds_read_b64 v[32:33], v127 offset:384
    ds_read_b64 v[34:35], v127 offset:392
    ds_read_b64 v[36:37], v127 offset:832
    ds_read_b64 v[38:39], v127 offset:840
    ds_read_b64 v[40:41], v127 offset:320
    ds_read_b64 v[42:43], v127 offset:328
    s_waitcnt lgkmcnt(12)
    v_readfirstlane_b32 s58, v4
    s_waitcnt lgkmcnt(0)
    s_barrier
    ds_read_b128 v[44:47], v126 offset:384
    ds_read_b128 v[48:51], v126 offset:896
    ds_read_b128 v[52:55], v126 offset:1408
    ds_read_b128 v[56:59], v126 offset:320
    s_waitcnt lgkmcnt(3)
    v_mfma_f32_16x16x32_f16 v[8:11], v[20:23], v[44:47], 0
    ds_read_b128 v[60:63], v126 offset:832
    v_mfma_f32_16x16x32_f16 v[12:15], v[24:27], v[44:47], 0
    s_waitcnt lgkmcnt(3)
    v_mfma_f32_16x16x32_f16 v[12:15], v[20:23], v[48:51], v[12:15]
    ds_read_b128 v[64:67], v126 offset:1344
    v_mfma_f32_16x16x32_f16 v[16:19], v[24:27], v[48:51], 0
    ds_read_b128 v[68:71], v126 offset:256
    s_waitcnt lgkmcnt(4)
    v_mfma_f32_16x16x32_f16 v[16:19], v[20:23], v[52:55], v[16:19]
    s_waitcnt lgkmcnt(3)
    v_mfma_f32_16x16x32_f16 v[8:11], v[28:31], v[56:59], v[8:11]
    ds_read_b128 v[72:75], v126 offset:768
    v_mfma_f32_16x16x32_f16 v[12:15], v[32:35], v[56:59], v[12:15]
    s_waitcnt lgkmcnt(3)
    v_mfma_f32_16x16x32_f16 v[12:15], v[28:31], v[60:63], v[12:15]
    ds_read_b128 v[76:79], v126 offset:1280
    v_mfma_f32_16x16x32_f16 v[16:19], v[32:35], v[60:63], v[16:19]
    ds_read_b128 v[80:83], v126 offset:192
    s_waitcnt lgkmcnt(4)
    v_mfma_f32_16x16x32_f16 v[16:19], v[28:31], v[64:67], v[16:19]
    ds_read_b64 v[84:85], v127 offset:768
    s_waitcnt lgkmcnt(4)
    v_mfma_f32_16x16x32_f16 v[8:11], v[36:39], v[68:71], v[8:11]
    ds_read_b64 v[86:87], v127 offset:776
    v_mfma_f32_16x16x32_f16 v[12:15], v[40:43], v[68:71], v[12:15]
    ds_read_b64 v[88:89], v127 offset:256
    ds_read_b64 v[90:91], v127 offset:264
    s_waitcnt lgkmcnt(6)
    v_mfma_f32_16x16x32_f16 v[12:15], v[36:39], v[72:75], v[12:15]
    ds_read_b128 v[92:95], v126 offset:704
    v_mfma_f32_16x16x32_f16 v[16:19], v[40:43], v[72:75], v[16:19]
    ds_read_b128 v[96:99], v126 offset:1216
    s_waitcnt lgkmcnt(7)
    v_mfma_f32_16x16x32_f16 v[16:19], v[36:39], v[76:79], v[16:19]
    ds_read_b128 v[100:103], v126 offset:128
    s_waitcnt lgkmcnt(5)
    v_mfma_f32_16x16x32_f16 v[8:11], v[84:87], v[80:83], v[8:11]
    ds_read_b64 v[104:105], v127 offset:704
    ds_read_b64 v[106:107], v127 offset:712
    s_waitcnt lgkmcnt(5)
    v_mfma_f32_16x16x32_f16 v[12:15], v[88:91], v[80:83], v[12:15]
    ds_read_b64 v[108:109], v127 offset:192
    ds_read_b64 v[110:111], v127 offset:200
    s_waitcnt lgkmcnt(6)
    v_mfma_f32_16x16x32_f16 v[12:15], v[84:87], v[92:95], v[12:15]
    ds_read_b128 v[112:115], v126 offset:640
    v_mfma_f32_16x16x32_f16 v[16:19], v[88:91], v[92:95], v[16:19]
    ds_read_b128 v[44:47], v126 offset:1152
    s_waitcnt lgkmcnt(7)
    v_mfma_f32_16x16x32_f16 v[16:19], v[84:87], v[96:99], v[16:19]
    ds_read_b128 v[24:27], v126 offset:64
    s_waitcnt lgkmcnt(5)
    v_mfma_f32_16x16x32_f16 v[8:11], v[104:107], v[100:103], v[8:11]
    ds_read_b64 v[48:49], v127 offset:640
    ds_read_b64 v[50:51], v127 offset:648
    s_waitcnt lgkmcnt(5)
    v_mfma_f32_16x16x32_f16 v[12:15], v[108:111], v[100:103], v[12:15]
    ds_read_b64 v[20:21], v127 offset:128
    ds_read_b64 v[22:23], v127 offset:136
    s_waitcnt lgkmcnt(6)
    v_mfma_f32_16x16x32_f16 v[12:15], v[104:107], v[112:115], v[12:15]
    ds_read_b128 v[52:55], v126 offset:576
    v_mfma_f32_16x16x32_f16 v[16:19], v[108:111], v[112:115], v[16:19]
    ds_read_b128 v[56:59], v126 offset:1088
    s_waitcnt lgkmcnt(7)
    v_mfma_f32_16x16x32_f16 v[16:19], v[104:107], v[44:47], v[16:19]
    ds_read_b128 v[32:35], v126 offset:0
    s_waitcnt lgkmcnt(5)
    v_mfma_f32_16x16x32_f16 v[8:11], v[48:51], v[24:27], v[8:11]
    ds_read_b64 v[60:61], v127 offset:576
    ds_read_b64 v[62:63], v127 offset:584
    s_waitcnt lgkmcnt(5)
    v_mfma_f32_16x16x32_f16 v[12:15], v[20:23], v[24:27], v[12:15]
    ds_read_b64 v[28:29], v127 offset:64
    ds_read_b64 v[30:31], v127 offset:72
    s_waitcnt lgkmcnt(6)
    v_mfma_f32_16x16x32_f16 v[12:15], v[48:51], v[52:55], v[12:15]
    ds_read_b128 v[64:67], v126 offset:512
    v_mfma_f32_16x16x32_f16 v[16:19], v[20:23], v[52:55], v[16:19]
    ds_read_b128 v[68:71], v126 offset:1024
    s_waitcnt lgkmcnt(7)
    v_mfma_f32_16x16x32_f16 v[16:19], v[48:51], v[56:59], v[16:19]
    ds_read_b32 v7, v6 offset:556
    ds_read_b128 v[40:43], v126 offset:448
    s_waitcnt lgkmcnt(6)
    v_mfma_f32_16x16x32_f16 v[8:11], v[60:63], v[32:35], v[8:11]
    ds_read_b64 v[72:73], v127 offset:1024
    ds_read_b64 v[74:75], v127 offset:1032
    s_waitcnt lgkmcnt(6)
    v_mfma_f32_16x16x32_f16 v[12:15], v[28:31], v[32:35], v[12:15]
    ds_read_b64 v[36:37], v127 offset:512
    ds_read_b64 v[38:39], v127 offset:520
    s_waitcnt lgkmcnt(7)
    v_mfma_f32_16x16x32_f16 v[12:15], v[60:63], v[64:67], v[12:15]
    ds_read_b64 v[76:77], v127 offset:0
    ds_read_b64 v[78:79], v127 offset:8
    v_mfma_f32_16x16x32_f16 v[16:19], v[28:31], v[64:67], v[16:19]
    ds_read_b128 v[80:83], v126 offset:960
    s_waitcnt lgkmcnt(9)
    v_mfma_f32_16x16x32_f16 v[16:19], v[60:63], v[68:71], v[16:19]
    s_waitcnt lgkmcnt(8)
    v_readfirstlane_b32 s56, v7
    s_nop 0
    s_cmp_ge_u32 s56, 10
    s_cbranch_scc1 CL_WOK
    s_mov_b32 s49, 0
CL_WSP:
    s_sleep 1
    ds_read_b32 v7, v6 offset:556
    s_add_u32 s49, s49, 1
    s_waitcnt lgkmcnt(0)
    v_readfirstlane_b32 s56, v7
    s_nop 0
    s_cmp_ge_u32 s56, 10
    s_cbranch_scc1 CL_WOK
    s_cmp_lt_u32 s49, 60000
    s_cbranch_scc1 CL_WSP
CL_WOK:
    s_waitcnt lgkmcnt(5)
    v_mfma_f32_16x16x32_f16 v[8:11], v[72:75], v[40:43], v[8:11]
    ds_read_b128 v[88:91], v126 offset:1472
    s_waitcnt lgkmcnt(4)
    v_mfma_f32_16x16x32_f16 v[12:15], v[36:39], v[40:43], v[12:15]
    ds_read_b64_tr_b16 v[92:93], v124 offset:0
    ds_read_b64_tr_b16 v[94:95], v124 offset:32
    s_waitcnt lgkmcnt(4)
    v_mfma_f32_16x16x32_f16 v[16:19], v[76:79], v[40:43], v[16:19]
    ds_read2_b32 v[84:85], v125 offset0:9 offset1:73
    ds_read2_b32 v[86:87], v125 offset0:8 offset1:72
    s_waitcnt lgkmcnt(5)
    v_mfma_f32_16x16x32_f16 v[12:15], v[72:75], v[80:83], v[12:15]
    ds_read_b64_tr_b16 v[96:97], v124 offset:256
    ds_read_b64_tr_b16 v[98:99], v124 offset:288
    v_mfma_f32_16x16x32_f16 v[16:19], v[36:39], v[80:83], v[16:19]
    ds_read2_b32 v[100:101], v125 offset0:1 offset1:65
    ds_read2_b32 v[102:103], v125 offset0:0 offset1:64
    s_waitcnt lgkmcnt(8)
    v_mfma_f32_16x16x32_f16 v[16:19], v[72:75], v[88:91], v[16:19]
    v_pk_mul_f32 v[8:9], v[8:9], s[58:59] op_sel_hi:[1,0]
    v_pk_mul_f32 v[10:11], v[10:11], s[58:59] op_sel_hi:[1,0]
    s_waitcnt lgkmcnt(6)
    s_waitcnt lgkmcnt(4)
    v_mfma_f32_16x16x32_f16 v[16:19], v[92:95], v[84:87], v[16:19]
    v_cvt_pk_bf16_f32 v8, v8, v9
    v_cvt_pk_bf16_f32 v9, v10, v11
    s_waitcnt lgkmcnt(2)
    s_waitcnt lgkmcnt(0)
    v_mfma_f32_16x16x32_f16 v[16:19], v[96:99], v[100:103], v[16:19]
    ds_write_b64 v123, v[8:9] offset:3328
    v_pk_mul_f32 v[12:13], v[12:13], s[58:59] op_sel_hi:[1,0]
    v_pk_mul_f32 v[14:15], v[14:15], s[58:59] op_sel_hi:[1,0]
    v_cvt_pk_bf16_f32 v12, v12, v13
    v_cvt_pk_bf16_f32 v13, v14, v15
    ds_write_b64 v123, v[12:13] offset:3920
    s_nop 1
    v_pk_mul_f32 v[16:17], v[16:17], s[58:59] op_sel_hi:[1,0]
    v_pk_mul_f32 v[18:19], v[18:19], s[58:59] op_sel_hi:[1,0]
    v_cvt_pk_bf16_f32 v16, v16, v17
    v_cvt_pk_bf16_f32 v17, v18, v19
    ds_write_b64 v123, v[16:17] offset:4512
CV_END:
    s_waitcnt lgkmcnt(0)
    s_barrier
    s_branch Y_DONE
CV_B4:
    s_waitcnt lgkmcnt(0)
    s_barrier
    s_setprio 3
    s_cmp_eq_u32 s46, 9
    s_cbranch_scc1 CV_WZ
    ds_read_b128 v[12:15], v48
    ds_read_b128 v[16:19], v48 offset:16
    s_waitcnt lgkmcnt(0)
    v_alignbit_b32 v25, v14, v13, 16
    v_alignbit_b32 v26, v15, v14, 16
    v_alignbit_b32 v27, v16, v15, 16
    v_alignbit_b32 v28, v17, v16, 16
    v_alignbit_b32 v29, v18, v17, 16
    v_pk_add_f16 v32, v25, v26
    v_pk_add_f16 v33, v26, v27
    v_pk_add_f16 v34, v27, v28
    v_pk_add_f16 v35, v28, v29
    v_pk_add_f16 v32, v32, v14
    v_pk_add_f16 v33, v33, v15
    v_pk_add_f16 v34, v34, v16
    v_pk_add_f16 v35, v35, v17
    ds_write_b128 v49, v[32:35] offset:0
    v_pk_add_f16 v36, v13, v15
    v_pk_add_f16 v37, v14, v16
    v_pk_add_f16 v38, v15, v17
    v_pk_add_f16 v39, v16, v18
    v_pk_add_f16 v36, v36, v32
    v_pk_add_f16 v37, v37, v33
    v_pk_add_f16 v38, v38, v34
    v_pk_add_f16 v39, v39, v35
    ds_write_b128 v49, v[36:39] offset:3200
    s_cmp_ge_u32 s46, 6
    s_cbranch_scc1 CV_WE
    v_alignbit_b32 v24, v13, v12, 16
    v_alignbit_b32 v30, v19, v18, 16
    v_pk_add_f16 v40, v24, v27
    v_pk_add_f16 v41, v25, v28
    v_pk_add_f16 v42, v26, v29
    v_pk_add_f16 v43, v27, v30
    v_pk_add_f16 v40, v40, v36
    v_pk_add_f16 v41, v41, v37
    v_pk_add_f16 v42, v42, v38
    v_pk_add_f16 v43, v43, v39
    ds_write_b128 v49, v[40:43] offset:6400
    v_pk_add_f16 v44, v12, v16
    v_pk_add_f16 v45, v13, v17
    v_pk_add_f16 v46, v14, v18
    v_pk_add_f16 v47, v15, v19
    v_pk_add_f16 v44, v44, v40
    v_pk_add_f16 v45, v45, v41
    v_pk_add_f16 v46, v46, v42
    v_pk_add_f16 v47, v47, v43
    ds_write_b128 v49, v[44:47] offset:8528
    s_branch CV_WE
CV_WZ:
    v_mov_b32 v12, 0
    v_mov_b32 v13, 0
    v_mov_b32 v14, 0
    v_mov_b32 v15, 0
    v_lshrrev_b32 v8, 1, v1
    v_mul_u32_u24 v8, 10608, v8
    v_and_b32 v9, 1, v1
    v_lshl_add_u32 v8, v9, 4, v8
    s_mov_b64 exec, 63
    ds_write_b128 v8, v[12:15] offset:17536
    ds_write_b128 v8, v[12:15] offset:20736
    ds_write_b128 v8, v[12:15] offset:23936
    ds_write_b128 v8, v[12:15] offset:26064
    s_mov_b64 exec, -1
CV_WE:
    s_waitcnt lgkmcnt(0)
    s_mov_b64 exec, 1
    ds_add_u32 v52, v53 offset:556
    s_mov_b64 exec, -1
    s_cmp_lt_u32 s2, 184
    s_cbranch_scc1 CV_NL
    s_cmp_lt_u32 s3, 8
    s_cbranch_scc1 CV_DONE
    s_sub_u32 s44, s2, 120
    s_lshr_b32 s45, s3, 2
    s_sub_u32 s45, s3, s45
    s_sub_u32 s45, s45, 6
    s_mul_i32 s56, s44, 73728
    s_mul_i32 s57, s45, 192
    s_add_u32 s56, s56, s57
    v_mul_u32_u24 v7, 9216, v5
    v_mul_u32_u24 v8, 12, v3
    v_add3_u32 v7, v7, v8, s56
    global_load_dwordx3 v[64:66], v7, s[26:27] offset:0 nt
    global_load_dwordx3 v[68:70], v7, s[26:27] offset:1152 nt
    global_load_dwordx3 v[72:74], v7, s[26:27] offset:2304 nt
    global_load_dwordx3 v[76:78], v7, s[26:27] offset:3456 nt
    v_add_u32 v7, 4608, v7
    global_load_dwordx3 v[80:82], v7, s[26:27] offset:0 nt
    global_load_dwordx3 v[84:86], v7, s[26:27] offset:1152 nt
    global_load_dwordx3 v[88:90], v7, s[26:27] offset:2304 nt
    global_load_dwordx3 v[92:94], v7, s[26:27] offset:3456 nt
    v_add_u32 v7, 32256, v7
    global_load_dwordx3 v[96:98], v7, s[26:27] offset:0 nt
    global_load_dwordx3 v[100:102], v7, s[26:27] offset:1152 nt
    global_load_dwordx3 v[104:106], v7, s[26:27] offset:2304 nt
    global_load_dwordx3 v[108:110], v7, s[26:27] offset:3456 nt
    v_add_u32 v7, 4608, v7
    global_load_dwordx3 v[112:114], v7, s[26:27] offset:0 nt
    global_load_dwordx3 v[116:118], v7, s[26:27] offset:1152 nt
    global_load_dwordx3 v[120:122], v7, s[26:27] offset:2304 nt
    global_load_dwordx3 v[124:126], v7, s[26:27] offset:3456 nt
CV_NL:
    s_cmp_ge_u32 s46, 8
    s_cbranch_scc1 CV_W2
    s_cmp_ge_u32 s2, 128
    s_cbranch_scc1 CV_DONE
    s_and_b32 s34, s46, 3
    s_mul_i32 s34, s34, 2304
    s_lshr_b32 s35, s46, 2
    s_lshl_b32 s35, s35, 7
    s_add_u32 s35, s35, s2
    s_mul_i32 s35, s35, 9216
    s_add_u32 s34, s34, s35
    s_add_u32 s34, s4, s34
    s_addc_u32 s35, s5, 0
    s_mul_i32 s36, s46, 2320
    s_add_u32 m0, s36, 122368
    s_nop 0
    global_load_lds_dwordx4 v50, s[34:35] nt
    global_load_lds_dwordx4 v50, s[34:35] offset:1024 nt
    s_mov_b64 exec, 0xffff
    global_load_lds_dwordx4 v50, s[34:35] offset:2048 nt
    s_mov_b64 exec, -1
    s_branch CV_DONE
CV_W2:
    s_cmp_lg_u32 s3, 13
    s_cbranch_scc1 CV_NX
    s_cmp_ge_u32 s2, 128
    s_cbranch_scc1 CV_DONE
    s_mov_b32 m0, 141824
    s_nop 0
    global_load_lds_dwordx4 v50, s[16:17]
    s_mov_b64 exec, 0xff
    global_load_lds_dwordx4 v50, s[16:17] offset:1024
    s_mov_b64 exec, -1
    s_mov_b32 m0, 143872
    s_nop 0
    global_load_lds_dwordx4 v50, s[20:21]
    s_mov_b64 exec, 0xff
    global_load_lds_dwordx4 v50, s[20:21] offset:1024
    s_mov_b64 exec, -1
    s_branch CV_DONE
CV_NX:
    s_cmp_lg_u32 s3, 14
    s_cbranch_scc1 CV_DONE
    s_and_b32 s56, s2, 7
    v_min_u32 v9, 35, v1
    v_mul_u32_u24 v8, 9216, v9
    s_cmp_ge_u32 s2, 128
    s_cbranch_scc1 CV_PB
    s_lshr_b32 s57, s2, 3
    s_mul_i32 s58, s57, 331776
    s_lshl_b32 s59, s56, 10
    s_add_u32 s58, s58, s59
    v_add_u32 v8, s58, v8
    global_load_dword v2, v8, s[24:25] offset:384
    s_branch CV_DONE
CV_PB:
    s_add_u32 s56, s56, 64
    s_bfe_u32 s57, s2, 0x30003
    s_mul_i32 s58, s57, 663552
    s_lshl_b32 s59, s56, 7
    s_add_u32 s58, s58, s59
    v_add_u32 v8, s58, v8
    v_add_u32 v10, 331776, v8
    global_load_dword v2, v8, s[22:23]
    global_load_dword v2, v10, s[22:23]
    global_load_dword v2, v8, s[24:25]
    global_load_dword v2, v10, s[24:25]
CV_DONE:
    s_setprio 3
    v_not_b32 v43, s48
    v_not_b32 v47, s48
    s_lshl_b32 s38, s2, 14
    s_lshl_b32 s57, s46, 11
    s_add_u32 s38, s38, s57
    s_add_u32 s38, s38, 3149824
    s_waitcnt lgkmcnt(0)
    s_barrier
    s_cmp_ge_u32 s46, 8
    s_cbranch_scc1 Y_DONE
    ds_read_b32 v40, v51 offset:3328
    ds_read_b32 v41, v51 offset:8064
    ds_read_b32 v42, v51 offset:12800
    ds_read_b32 v44, v51 offset:3360
    ds_read_b32 v45, v51 offset:8096
    ds_read_b32 v46, v51 offset:12832
    s_waitcnt lgkmcnt(3)
    buffer_store_dwordx4 v[40:43], v50, s[40:43], s38 offen offset:0 sc1
    s_waitcnt lgkmcnt(0)
    buffer_store_dwordx4 v[44:47], v50, s[40:43], s38 offen offset:1024 sc1
Y_DONE:
    s_cmp_ge_u32 s2, 184
    s_cbranch_scc1 FFN_B
    s_cmp_ge_u32 s2, 128
    s_cbranch_scc1 FIN
    s_lshr_b32 s38, s3, 1
    s_and_b32 s38, s38, 4
    s_and_b32 s34, s3, 3
    s_or_b32 s38, s38, s34
    s_bitcmp1_b32 s3, 2
    s_cbranch_scc1 LN2_H
    s_setprio 3
    v_and_b32 v6, 7, v1
    v_lshlrev_b32 v7, 4, v6
    s_lshl_b32 s35, s2, 7
    s_add_u32 s37, s35, 6475776
    buffer_load_dwordx4 v[48:51], v7, s[40:43], s37 offen sc1
    s_mul_i32 s34, s38, 24
    v_lshrrev_b32 v4, 3, v1
    v_add_u32 v4, s34, v4
    v_lshlrev_b32 v28, 14, v4
    v_add_u32 v28, v28, v7
    s_add_u32 s44, s35, 3149824
    s_add_u32 s45, s44, 131072
    s_add_u32 s46, s44, 262144
    v_mul_u32_u24 v22, 6, v4
    v_and_b32 v22, -4, v22
    v_mul_u32_u24 v23, 2320, v6
    v_add_u32 v23, v23, v22
    v_add_u32 v23, 122368, v23
    v_add_u32 v27, 1152, v23
    v_add_u32 v22, 141824, v22
    v_add_u32 v29, 2048, v22
    v_and_b32 v24, 1, v4
    s_mov_b32 s39, 0x02020000
    v_mul_lo_u32 v24, v24, s39
    v_add_u32 v24, 0x01000c0c, v24
    v_add_u32 v25, s39, v24
    v_add_u32 v26, s39, v25
    s_waitcnt vmcnt(0)
    v_cmp_ne_u32 vcc, s48, v51
    s_nop 0
    s_cbranch_vccz LN2_S
    s_mov_b32 s49, 0
P_1:
    buffer_load_dwordx4 v[48:51], v7, s[40:43], s37 offen sc1
PC_3:
    s_add_u32 s49, s49, 1
    s_waitcnt vmcnt(0)
    v_cmp_ne_u32 vcc, s48, v51
    s_nop 0
    s_cbranch_vccz PD_2
    s_cmp_lt_u32 s49, 60000
    s_cbranch_scc1 P_1
PD_2:
LN2_S:
    s_barrier
    s_sleep 2
    buffer_load_dwordx4 v[8:11], v28, s[40:43], s44 offen sc1
    buffer_load_dwordx4 v[12:15], v28, s[40:43], s45 offen sc1
    buffer_load_dwordx4 v[16:19], v28, s[40:43], s46 offen sc1
    ds_read2_b32 v[100:101], v23 offset0:0 offset1:1
    ds_read2_b32 v[102:103], v27 offset0:0 offset1:1
    ds_read2_b32 v[104:105], v23 offset0:12 offset1:13
    ds_read2_b32 v[106:107], v27 offset0:12 offset1:13
    ds_read2_b32 v[108:109], v23 offset0:24 offset1:25
    ds_read2_b32 v[110:111], v27 offset0:24 offset1:25
    ds_read2_b32 v[112:113], v22 offset0:0 offset1:1
    ds_read2_b32 v[114:115], v29 offset0:0 offset1:1
    ds_read2_b32 v[116:117], v22 offset0:12 offset1:13
    ds_read2_b32 v[118:119], v29 offset0:12 offset1:13
    ds_read2_b32 v[120:121], v22 offset0:24 offset1:25
    ds_read2_b32 v[122:123], v29 offset0:24 offset1:25
    v_lshlrev_b32 v52, 16, v50
    v_and_b32 v53, 0xffff0000, v50
    s_lshl_b32 s34, s38, 5
    v_mul_u32_u24 v21, 272, v6
    v_add_u32 v21, s34, v21
    v_lshrrev_b32 v30, 1, v5
    v_lshl_add_u32 v20, v30, 2, v21
    v_and_b32 v30, 1, v5
    v_lshl_add_u32 v21, v30, 3, v20
    s_waitcnt lgkmcnt(10)
    v_perm_b32 v64, v101, v100, v24
    v_perm_b32 v65, v103, v102, v24
    v_perm_b32 v66, v101, v100, v25
    v_perm_b32 v67, v103, v102, v25
    v_perm_b32 v68, v101, v100, v26
    v_perm_b32 v69, v103, v102, v26
    s_waitcnt lgkmcnt(8)
    v_perm_b32 v70, v105, v104, v24
    v_perm_b32 v71, v107, v106, v24
    v_perm_b32 v72, v105, v104, v25
    v_perm_b32 v73, v107, v106, v25
    v_perm_b32 v74, v105, v104, v26
    v_perm_b32 v75, v107, v106, v26
    s_waitcnt lgkmcnt(6)
    v_perm_b32 v76, v109, v108, v24
    v_perm_b32 v77, v111, v110, v24
    v_perm_b32 v78, v109, v108, v25
    v_perm_b32 v79, v111, v110, v25
    v_perm_b32 v80, v109, v108, v26
    v_perm_b32 v81, v111, v110, v26
    v_pk_add_f32 v[82:83], v[64:65], v[52:53] neg_lo:[0,1] neg_hi:[0,1]
    v_pk_add_f32 v[84:85], v[66:67], v[52:53] neg_lo:[0,1] neg_hi:[0,1]
    v_pk_add_f32 v[86:87], v[68:69], v[52:53] neg_lo:[0,1] neg_hi:[0,1]
    v_pk_add_f32 v[88:89], v[70:71], v[52:53] neg_lo:[0,1] neg_hi:[0,1]
    v_pk_add_f32 v[90:91], v[72:73], v[52:53] neg_lo:[0,1] neg_hi:[0,1]
    v_pk_add_f32 v[92:93], v[74:75], v[52:53] neg_lo:[0,1] neg_hi:[0,1]
    v_pk_add_f32 v[94:95], v[76:77], v[52:53] neg_lo:[0,1] neg_hi:[0,1]
    v_pk_add_f32 v[96:97], v[78:79], v[52:53] neg_lo:[0,1] neg_hi:[0,1]
    v_pk_add_f32 v[98:99], v[80:81], v[52:53] neg_lo:[0,1] neg_hi:[0,1]
    v_pk_mul_f32 v[82:83], v[82:83], v[48:49]
    v_pk_mul_f32 v[84:85], v[84:85], v[48:49]
    v_pk_mul_f32 v[86:87], v[86:87], v[48:49]
    v_pk_mul_f32 v[88:89], v[88:89], v[48:49]
    v_pk_mul_f32 v[90:91], v[90:91], v[48:49]
    v_pk_mul_f32 v[92:93], v[92:93], v[48:49]
    v_pk_mul_f32 v[94:95], v[94:95], v[48:49]
    v_pk_mul_f32 v[96:97], v[96:97], v[48:49]
    v_pk_mul_f32 v[98:99], v[98:99], v[48:49]
    s_waitcnt lgkmcnt(0)
    v_perm_b32 v32, v113, v112, v24
    v_perm_b32 v34, v113, v112, v25
    v_perm_b32 v36, v113, v112, v26
    v_perm_b32 v54, v115, v114, v24
    v_perm_b32 v55, v115, v114, v25
    v_perm_b32 v56, v115, v114, v26
    v_pk_fma_f32 v[64:65], v[82:83], v[32:33], v[64:65] op_sel_hi:[1,0,1]
    v_pk_fma_f32 v[66:67], v[84:85], v[34:35], v[66:67] op_sel_hi:[1,0,1]
    v_pk_fma_f32 v[68:69], v[86:87], v[36:37], v[68:69] op_sel_hi:[1,0,1]
    v_perm_b32 v32, v117, v116, v24
    v_perm_b32 v34, v117, v116, v25
    v_perm_b32 v36, v117, v116, v26
    v_perm_b32 v57, v119, v118, v24
    v_perm_b32 v58, v119, v118, v25
    v_perm_b32 v59, v119, v118, v26
    v_pk_fma_f32 v[70:71], v[88:89], v[32:33], v[70:71] op_sel_hi:[1,0,1]
    v_pk_fma_f32 v[72:73], v[90:91], v[34:35], v[72:73] op_sel_hi:[1,0,1]
    v_pk_fma_f32 v[74:75], v[92:93], v[36:37], v[74:75] op_sel_hi:[1,0,1]
    v_perm_b32 v32, v121, v120, v24
    v_perm_b32 v34, v121, v120, v25
    v_perm_b32 v36, v121, v120, v26
    v_perm_b32 v60, v123, v122, v24
    v_perm_b32 v61, v123, v122, v25
    v_perm_b32 v62, v123, v122, v26
    v_pk_fma_f32 v[76:77], v[94:95], v[32:33], v[76:77] op_sel_hi:[1,0,1]
    v_pk_fma_f32 v[78:79], v[96:97], v[34:35], v[78:79] op_sel_hi:[1,0,1]
    v_pk_fma_f32 v[80:81], v[98:99], v[36:37], v[80:81] op_sel_hi:[1,0,1]
    s_not_b32 s53, s48
    s_mov_b32 s49, 0
P_4:
    s_add_u32 s49, s49, 1
    s_waitcnt vmcnt(0)
    v_cmp_ne_u32 s[6:7], s53, v11
    v_cmp_ne_u32 s[8:9], s53, v15
    v_cmp_ne_u32 s[10:11], s53, v19
    s_or_b64 s[50:51], s[6:7], s[8:9]
    s_or_b64 s[50:51], s[50:51], s[10:11]
    s_cbranch_scc0 PD_5
    s_wqm_b64 exec, s[6:7]
    s_cbranch_execz PS_6
    buffer_load_dwordx4 v[8:11], v28, s[40:43], s44 offen sc1
PS_6:
    s_wqm_b64 exec, s[8:9]
    s_cbranch_execz PS_7
    buffer_load_dwordx4 v[12:15], v28, s[40:43], s45 offen sc1
PS_7:
    s_wqm_b64 exec, s[10:11]
    s_cbranch_execz PS_8
    buffer_load_dwordx4 v[16:19], v28, s[40:43], s46 offen sc1
PS_8:
    s_mov_b64 exec, -1
    s_cmp_lt_u32 s49, 60000
    s_cbranch_scc1 P_4
    s_waitcnt vmcnt(0)
PD_5:
    v_lshlrev_b32 v100, 16, v8
    v_and_b32 v101, 0xffff0000, v8
    v_lshlrev_b32 v102, 16, v9
    v_and_b32 v103, 0xffff0000, v9
    v_lshlrev_b32 v104, 16, v10
    v_and_b32 v105, 0xffff0000, v10
    v_lshlrev_b32 v106, 16, v12
    v_and_b32 v107, 0xffff0000, v12
    v_lshlrev_b32 v108, 16, v13
    v_and_b32 v109, 0xffff0000, v13
    v_lshlrev_b32 v110, 16, v14
    v_and_b32 v111, 0xffff0000, v14
    v_lshlrev_b32 v112, 16, v16
    v_and_b32 v113, 0xffff0000, v16
    v_lshlrev_b32 v114, 16, v17
    v_and_b32 v115, 0xffff0000, v17
    v_lshlrev_b32 v116, 16, v18
    v_and_b32 v117, 0xffff0000, v18
    v_pk_add_f32 v[64:65], v[64:65], v[100:101]
    v_pk_add_f32 v[66:67], v[66:67], v[102:103]
    v_pk_add_f32 v[68:69], v[68:69], v[104:105]
    v_pk_add_f32 v[70:71], v[70:71], v[106:107]
    v_pk_add_f32 v[72:73], v[72:73], v[108:109]
    v_pk_add_f32 v[74:75], v[74:75], v[110:111]
    v_pk_add_f32 v[76:77], v[76:77], v[112:113]
    v_pk_add_f32 v[78:79], v[78:79], v[114:115]
    v_pk_add_f32 v[80:81], v[80:81], v[116:117]
    v_pk_mul_f32 v[34:35], v[64:65], v[64:65]
    v_pk_mul_f32 v[36:37], v[64:65], v[54:55] op_sel:[0,0] op_sel_hi:[1,0]
    v_pk_add_f32 v[32:33], v[66:67], v[64:65]
    v_pk_fma_f32 v[34:35], v[66:67], v[66:67], v[34:35]
    v_pk_fma_f32 v[36:37], v[66:67], v[54:55], v[36:37] op_sel:[0,1,0] op_sel_hi:[1,1,1]
    v_pk_add_f32 v[32:33], v[68:69], v[32:33]
    v_pk_fma_f32 v[34:35], v[68:69], v[68:69], v[34:35]
    v_pk_fma_f32 v[36:37], v[68:69], v[56:57], v[36:37] op_sel:[0,0,0] op_sel_hi:[1,0,1]
    v_pk_add_f32 v[32:33], v[70:71], v[32:33]
    v_pk_fma_f32 v[34:35], v[70:71], v[70:71], v[34:35]
    v_pk_fma_f32 v[36:37], v[70:71], v[56:57], v[36:37] op_sel:[0,1,0] op_sel_hi:[1,1,1]
    v_pk_add_f32 v[32:33], v[72:73], v[32:33]
    v_pk_fma_f32 v[34:35], v[72:73], v[72:73], v[34:35]
    v_pk_fma_f32 v[36:37], v[72:73], v[58:59], v[36:37] op_sel:[0,0,0] op_sel_hi:[1,0,1]
    v_pk_add_f32 v[32:33], v[74:75], v[32:33]
    v_pk_fma_f32 v[34:35], v[74:75], v[74:75], v[34:35]
    v_pk_fma_f32 v[36:37], v[74:75], v[58:59], v[36:37] op_sel:[0,1,0] op_sel_hi:[1,1,1]
    v_pk_add_f32 v[32:33], v[76:77], v[32:33]
    v_pk_fma_f32 v[34:35], v[76:77], v[76:77], v[34:35]
    v_pk_fma_f32 v[36:37], v[76:77], v[60:61], v[36:37] op_sel:[0,0,0] op_sel_hi:[1,0,1]
    v_pk_add_f32 v[32:33], v[78:79], v[32:33]
    v_pk_fma_f32 v[34:35], v[78:79], v[78:79], v[34:35]
    v_pk_fma_f32 v[36:37], v[78:79], v[60:61], v[36:37] op_sel:[0,1,0] op_sel_hi:[1,1,1]
    v_pk_add_f32 v[32:33], v[80:81], v[32:33]
    v_pk_fma_f32 v[34:35], v[80:81], v[80:81], v[34:35]
    v_pk_fma_f32 v[36:37], v[80:81], v[62:63], v[36:37] op_sel:[0,0,0] op_sel_hi:[1,0,1]
    v_permlane32_swap_b32 v32, v33
    v_permlane32_swap_b32 v34, v35
    v_permlane32_swap_b32 v36, v37
    v_add_f32 v32, v32, v33
    v_add_f32 v34, v34, v35
    v_add_f32 v33, v36, v37
    v_add_f32 v35, v36, v37
    v_permlane16_swap_b32 v32, v34
    s_nop 0
    v_permlane16_swap_b32 v33, v35
    v_pk_add_f32 v[32:33], v[32:33], v[34:35]
    s_nop 1
    v_add_f32_dpp v32, v32, v32 row_ror:8 row_mask:0xf bank_mask:0xf
    v_add_f32_dpp v33, v33, v33 row_ror:8 row_mask:0xf bank_mask:0xf
    ds_write_b32 v21, v32 offset:1024
    ds_write_b32 v20, v33 offset:1040
    s_setprio 1
    s_waitcnt lgkmcnt(0)
    s_barrier
    v_mul_u32_u24 v30, 12, v4
    v_mul_u32_u24 v31, 2320, v6
    v_add_u32 v30, v30, v31
    v_add_u32 v29, 36096, v30
    v_add_u32 v31, 54656, v30
    v_add_u32 v30, 17536, v30
    v_cvt_pk_bf16_f32 v100, v64, v65
    v_cvt_pk_bf16_f32 v101, v66, v67
    v_cvt_pk_bf16_f32 v102, v68, v69
    v_cvt_pk_bf16_f32 v103, v70, v71
    v_cvt_pk_bf16_f32 v104, v72, v73
    v_cvt_pk_bf16_f32 v105, v74, v75
    v_cvt_pk_bf16_f32 v106, v76, v77
    v_cvt_pk_bf16_f32 v107, v78, v79
    v_cvt_pk_bf16_f32 v108, v80, v81
    ds_write2_b32 v29, v100, v101 offset0:0 offset1:1
    ds_write_b32 v29, v102 offset:8
    ds_write2_b32 v29, v103, v104 offset0:24 offset1:25
    ds_write_b32 v29, v105 offset:104
    ds_write2_b32 v29, v106, v107 offset0:48 offset1:49
    ds_write_b32 v29, v108 offset:200
    v_lshlrev_b32 v64, 16, v100
    v_and_b32 v65, 0xffff0000, v100
    v_lshlrev_b32 v66, 16, v101
    v_and_b32 v67, 0xffff0000, v101
    v_lshlrev_b32 v68, 16, v102
    v_and_b32 v69, 0xffff0000, v102
    v_lshlrev_b32 v70, 16, v103
    v_and_b32 v71, 0xffff0000, v103
    v_lshlrev_b32 v72, 16, v104
    v_and_b32 v73, 0xffff0000, v104
    v_lshlrev_b32 v74, 16, v105
    v_and_b32 v75, 0xffff0000, v105
    v_lshlrev_b32 v76, 16, v106
    v_and_b32 v77, 0xffff0000, v106
    v_lshlrev_b32 v78, 16, v107
    v_and_b32 v79, 0xffff0000, v107
    v_lshlrev_b32 v80, 16, v108
    v_and_b32 v81, 0xffff0000, v108
    s_barrier
    ds_read_b128 v[32:35], v7 offset:704
    s_waitcnt lgkmcnt(0)
    v_pk_add_f32 v[82:83], v[64:65], v[32:33] neg_lo:[0,1] neg_hi:[0,1]
    v_pk_add_f32 v[84:85], v[66:67], v[32:33] neg_lo:[0,1] neg_hi:[0,1]
    v_pk_add_f32 v[86:87], v[68:69], v[32:33] neg_lo:[0,1] neg_hi:[0,1]
    v_pk_add_f32 v[88:89], v[70:71], v[32:33] neg_lo:[0,1] neg_hi:[0,1]
    v_pk_add_f32 v[90:91], v[72:73], v[32:33] neg_lo:[0,1] neg_hi:[0,1]
    v_pk_add_f32 v[92:93], v[74:75], v[32:33] neg_lo:[0,1] neg_hi:[0,1]
    v_pk_add_f32 v[94:95], v[76:77], v[32:33] neg_lo:[0,1] neg_hi:[0,1]
    v_pk_add_f32 v[96:97], v[78:79], v[32:33] neg_lo:[0,1] neg_hi:[0,1]
    v_pk_add_f32 v[98:99], v[80:81], v[32:33] neg_lo:[0,1] neg_hi:[0,1]
    v_pk_mul_f32 v[82:83], v[82:83], v[34:35]
    v_pk_mul_f32 v[84:85], v[84:85], v[34:35]
    v_pk_mul_f32 v[86:87], v[86:87], v[34:35]
    v_pk_mul_f32 v[88:89], v[88:89], v[34:35]
    v_pk_mul_f32 v[90:91], v[90:91], v[34:35]
    v_pk_mul_f32 v[92:93], v[92:93], v[34:35]
    v_pk_mul_f32 v[94:95], v[94:95], v[34:35]
    v_pk_mul_f32 v[96:97], v[96:97], v[34:35]
    v_pk_mul_f32 v[98:99], v[98:99], v[34:35]
    v_cvt_pk_bf16_f32 v109, v82, v83
    v_cvt_pk_bf16_f32 v110, v84, v85
    v_cvt_pk_bf16_f32 v111, v86, v87
    v_cvt_pk_bf16_f32 v112, v88, v89
    v_cvt_pk_bf16_f32 v113, v90, v91
    v_cvt_pk_bf16_f32 v114, v92, v93
    v_cvt_pk_bf16_f32 v115, v94, v95
    v_cvt_pk_bf16_f32 v116, v96, v97
    v_cvt_pk_bf16_f32 v117, v98, v99
    ds_write2_b32 v30, v109, v110 offset0:0 offset1:1
    ds_write_b32 v30, v111 offset:8
    ds_write2_b32 v30, v112, v113 offset0:24 offset1:25
    ds_write_b32 v30, v114 offset:104
    ds_write2_b32 v30, v115, v116 offset0:48 offset1:49
    ds_write_b32 v30, v117 offset:200
    v_pk_add_f32 v[82:83], v[82:83], v[64:65]
    v_pk_add_f32 v[84:85], v[84:85], v[66:67]
    v_pk_add_f32 v[86:87], v[86:87], v[68:69]
    v_pk_add_f32 v[88:89], v[88:89], v[70:71]
    v_pk_add_f32 v[90:91], v[90:91], v[72:73]
    v_pk_add_f32 v[92:93], v[92:93], v[74:75]
    v_pk_add_f32 v[94:95], v[94:95], v[76:77]
    v_pk_add_f32 v[96:97], v[96:97], v[78:79]
    v_pk_add_f32 v[98:99], v[98:99], v[80:81]
    v_cvt_pk_bf16_f32 v118, v82, v83
    v_cvt_pk_bf16_f32 v119, v84, v85
    v_cvt_pk_bf16_f32 v120, v86, v87
    v_cvt_pk_bf16_f32 v121, v88, v89
    v_cvt_pk_bf16_f32 v122, v90, v91
    v_cvt_pk_bf16_f32 v123, v92, v93
    v_cvt_pk_bf16_f32 v124, v94, v95
    v_cvt_pk_bf16_f32 v125, v96, v97
    v_cvt_pk_bf16_f32 v126, v98, v99
    ds_write2_b32 v31, v118, v119 offset0:0 offset1:1
    ds_write_b32 v31, v120 offset:8
    ds_write2_b32 v31, v121, v122 offset0:24 offset1:25
    ds_write_b32 v31, v123 offset:104
    ds_write2_b32 v31, v124, v125 offset0:48 offset1:49
    ds_write_b32 v31, v126 offset:200
    s_waitcnt lgkmcnt(0)
    s_barrier
    s_branch FIN
LN2_H:
    s_setprio 2
    s_lshl_b32 s34, s38, 6
    v_add_u32 v11, s34, v1
    v_lshlrev_b32 v10, 4, v11
    s_and_b32 s39, s2, 7
    s_lshl_b32 s39, s39, 13
    s_add_u32 s39, s39, 6295552
    v_lshlrev_b32 v16, 2, v11
    v_sub_u32 v16, 0xffff, v16
    v_add_u32 v17, -1, v16
    v_add_u32 v18, -2, v16
    v_add_u32 v19, -3, v16
    v_lshlrev_b32 v8, 2, v3
    v_and_b32 v32, 127, v0
    v_mul_u32_u24 v33, 24, v32
    s_bitcmp1_b32 s3, 1
    s_cselect_b32 s37, 18560, 0
    s_cselect_b32 s36, 1, 0
    v_add_u32 v33, s37, v33
    s_add_u32 s36, s36, 96
    v_cmp_gt_u32 s[44:45], s36, v32
    s_movk_i32 s36, 96
    v_cmp_eq_u32 s[46:47], s36, v32
    v_lshlrev_b32 v32, 4, v32
    v_mov_b32 v27, s48
    s_mov_b32 s17, 0
    s_mov_b32 s18, 0
    s_mov_b32 s12, 0xffff0000
    s_mov_b32 s32, s28
    s_and_b32 s33, s29, 0xffff
    s_mov_b32 s34, 0x00240000
    s_mov_b32 s35, 0x00020000
    s_waitcnt vmcnt(0)
    s_barrier
    s_cmp_eq_u32 s3, 4
    s_cbranch_scc1 ST2
    s_barrier
    s_branch ST2_E
ST2:
    s_setprio 3
    v_lshlrev_b32 v40, 4, v1
    v_add_u32 v40, 143872, v40
    v_lshlrev_b32 v41, 1, v1
    v_add_u32 v41, 144896, v41
    ds_read_b128 v[44:47], v40
    ds_read_u16 v48, v41
    v_lshrrev_b32 v42, 3, v1
    v_and_b32 v43, 7, v1
    v_lshlrev_b32 v60, 5, v1
    v_lshl_add_u32 v60, v42, 4, v60
    v_lshlrev_b32 v61, 3, v42
    v_lshl_add_u32 v62, v43, 13, v61
    v_lshlrev_b32 v63, 4, v42
    s_lshl_b32 s13, s2, 4
    s_sub_u32 s13, 0xffff, s13
    v_lshlrev_b32 v64, 1, v42
    v_sub_u32 v64, s13, v64
    v_add_u32 v65, -1, v64
    s_lshl_b32 s4, s2, 6
    s_add_u32 s4, s4, 6295552
    v_mov_b32 v67, s48
    s_mov_b32 s52, 0x3ae38e39
    s_mov_b32 s54, 0x01010101
    s_mov_b32 s55, 0x01010101
    s_waitcnt lgkmcnt(0)
    v_lshlrev_b32 v48, 16, v48
    v_lshlrev_b32 v50, 16, v44
    v_and_b32 v51, 0xffff0000, v44
    v_add_f32 v48, v48, v50
    v_add_f32 v48, v48, v51
    v_lshlrev_b32 v50, 16, v45
    v_and_b32 v51, 0xffff0000, v45
    v_add_f32 v48, v48, v50
    v_add_f32 v48, v48, v51
    v_lshlrev_b32 v50, 16, v46
    v_and_b32 v51, 0xffff0000, v46
    v_add_f32 v48, v48, v50
    v_add_f32 v48, v48, v51
    v_lshlrev_b32 v50, 16, v47
    v_and_b32 v51, 0xffff0000, v47
    v_add_f32 v48, v48, v50
    v_add_f32 v48, v48, v51
    s_nop 1
    v_add_f32_dpp v48, v48, v48 row_ror:8 row_mask:0xf bank_mask:0xf
    s_nop 1
    v_add_f32_dpp v48, v48, v48 row_ror:4 row_mask:0xf bank_mask:0xf
    s_nop 1
    v_add_f32_dpp v48, v48, v48 row_ror:2 row_mask:0xf bank_mask:0xf
    s_nop 1
    v_add_f32_dpp v48, v48, v48 row_ror:1 row_mask:0xf bank_mask:0xf
    s_nop 1
    v_add_f32_dpp v48, v48, v48 row_bcast:15 row_mask:0xa bank_mask:0xf
    s_nop 1
    v_add_f32_dpp v48, v48, v48 row_bcast:31 row_mask:0xc bank_mask:0xf
    s_nop 0
    v_readlane_b32 s6, v48, 63
    s_barrier
    ds_read_b128 v[52:55], v60 offset:1024
    ds_read_b64 v[56:57], v60 offset:1040
    s_waitcnt lgkmcnt(0)
    v_add_f32_dpp v52, v52, v52 quad_perm:[1,0,3,2] row_mask:0xf bank_mask:0xf
    v_add_f32_dpp v53, v53, v53 quad_perm:[1,0,3,2] row_mask:0xf bank_mask:0xf
    v_add_f32_dpp v54, v54, v54 quad_perm:[1,0,3,2] row_mask:0xf bank_mask:0xf
    v_add_f32_dpp v55, v55, v55 quad_perm:[1,0,3,2] row_mask:0xf bank_mask:0xf
    v_add_f32_dpp v56, v56, v56 quad_perm:[1,0,3,2] row_mask:0xf bank_mask:0xf
    v_add_f32_dpp v57, v57, v57 quad_perm:[1,0,3,2] row_mask:0xf bank_mask:0xf
    v_add_f32_dpp v52, v52, v52 quad_perm:[2,3,0,1] row_mask:0xf bank_mask:0xf
    v_add_f32_dpp v53, v53, v53 quad_perm:[2,3,0,1] row_mask:0xf bank_mask:0xf
    v_add_f32_dpp v54, v54, v54 quad_perm:[2,3,0,1] row_mask:0xf bank_mask:0xf
    v_add_f32_dpp v55, v55, v55 quad_perm:[2,3,0,1] row_mask:0xf bank_mask:0xf
    v_add_f32_dpp v56, v56, v56 quad_perm:[2,3,0,1] row_mask:0xf bank_mask:0xf
    v_add_f32_dpp v57, v57, v57 quad_perm:[2,3,0,1] row_mask:0xf bank_mask:0xf
    v_add_f32_dpp v52, v52, v52 row_half_mirror row_mask:0xf bank_mask:0xf
    v_add_f32_dpp v53, v53, v53 row_half_mirror row_mask:0xf bank_mask:0xf
    v_add_f32_dpp v54, v54, v54 row_half_mirror row_mask:0xf bank_mask:0xf
    v_add_f32_dpp v55, v55, v55 row_half_mirror row_mask:0xf bank_mask:0xf
    v_add_f32_dpp v56, v56, v56 row_half_mirror row_mask:0xf bank_mask:0xf
    v_add_f32_dpp v57, v57, v57 row_half_mirror row_mask:0xf bank_mask:0xf
    v_pk_mul_f32 v[52:53], v[52:53], s[52:53] op_sel_hi:[1,0]
    v_pk_mul_f32 v[54:55], v[54:55], s[52:53] op_sel_hi:[1,0]
    v_pk_fma_f32 v[54:55], v[52:53], v[52:53], v[54:55] neg_lo:[1,0,0] neg_hi:[1,0,0]
    v_max_f32 v54, 0, v54
    v_max_f32 v55, 0, v55
    v_cvt_pk_bf16_f32 v58, v54, v55
    v_lshlrev_b32 v54, 16, v58
    v_and_b32 v55, 0xffff0000, v58
    v_add_f32 v54, 0x3727c5ac, v54
    v_add_f32 v55, 0x3727c5ac, v55
    v_cvt_pk_bf16_f32 v58, v54, v55
    v_lshlrev_b32 v54, 16, v58
    v_and_b32 v55, 0xffff0000, v58
    v_sqrt_f32 v54, v54
    v_sqrt_f32 v55, v55
    v_cvt_pk_bf16_f32 v59, v52, v53
    v_lshlrev_b32 v52, 16, v59
    v_and_b32 v53, 0xffff0000, v59
    v_cvt_pk_bf16_f32 v58, v54, v55
    v_lshlrev_b32 v54, 16, v58
    v_and_b32 v55, 0xffff0000, v58
    v_rcp_f32 v54, v54
    v_rcp_f32 v55, v55
    v_pk_fma_f32 v[56:57], v[52:53], s[6:7], v[56:57] op_sel_hi:[1,0,1] neg_lo:[1,0,0] neg_hi:[1,0,0]
    v_pk_mul_f32 v[56:57], v[56:57], v[54:55]
    v_cvt_pk_bf16_f32 v58, v56, v57
    v_pk_ashrrev_i16 v59, 15, v58 op_sel_hi:[0,1]
    v_or_b32 v59, 0x80008000, v59
    v_xor_b32 v66, v58, v59
    buffer_store_dwordx2 v[66:67], v62, s[40:43], s4 offen sc1
    v_lshl_or_b32 v58, v66, 16, v64
    v_and_or_b32 v59, v66, s12, v65
    s_mov_b64 exec, s[54:55]
    ds_write_b128 v63, v[52:55] offset:704
    ds_write_b64 v61, v[58:59] offset:576
    s_mov_b64 exec, -1
    s_waitcnt lgkmcnt(0)
ST2_E:
    s_barrier
    ds_read_b32 v8, v8 offset:576
    s_sleep 8
    buffer_load_dwordx4 v[12:15], v10, s[40:43], s39 offen sc1
    s_waitcnt lgkmcnt(0)
RANK:
    v_mov_b32 v9, v8
    s_nop 1
    v_max_u32_dpp v9, v9, v9 row_ror:8 row_mask:0xf bank_mask:0xf
    s_nop 1
    v_max_u32_dpp v9, v9, v9 row_ror:4 row_mask:0xf bank_mask:0xf
    s_nop 1
    v_max_u32_dpp v9, v9, v9 row_ror:2 row_mask:0xf bank_mask:0xf
    s_nop 1
    v_max_u32_dpp v9, v9, v9 row_ror:1 row_mask:0xf bank_mask:0xf
    v_cmp_ne_u32 vcc, v8, v9
    v_readfirstlane_b32 s15, v9
    s_nop 0
    v_cndmask_b32 v8, 0, v8, vcc
    v_mov_b32 v9, v8
    s_nop 1
    v_max_u32_dpp v9, v9, v9 row_ror:8 row_mask:0xf bank_mask:0xf
    s_nop 1
    v_max_u32_dpp v9, v9, v9 row_ror:4 row_mask:0xf bank_mask:0xf
    s_nop 1
    v_max_u32_dpp v9, v9, v9 row_ror:2 row_mask:0xf bank_mask:0xf
    s_nop 1
    v_max_u32_dpp v9, v9, v9 row_ror:1 row_mask:0xf bank_mask:0xf
    v_cmp_ne_u32 vcc, v8, v9
    v_readfirstlane_b32 s16, v9
    s_nop 0
    v_cndmask_b32 v8, 0, v8, vcc
    s_bitcmp1_b32 s3, 3
    s_cselect_b32 s19, s16, s15
    s_andn2_b32 s4, 15, s19
    s_lshr_b32 s5, s4, 1
    s_mul_i32 s5, s5, 2320
    v_add_u32 v34, s5, v33
    s_bitcmp1_b32 s4, 0
    s_mov_b32 s5, 0x05040100
    s_cselect_b32 s5, 0x07060302, s5
    v_mov_b32 v28, s19
    v_mov_b32 v29, s18
    s_cmp_lg_u32 s18, 0
    s_cbranch_scc1 RK_C2
    s_mov_b32 s49, 0
    s_branch PC_11
P_9:
    buffer_load_dwordx4 v[12:15], v10, s[40:43], s39 offen sc1
PC_11:
    s_add_u32 s49, s49, 1
    s_waitcnt vmcnt(0)
    v_cmp_ne_u32 vcc, s48, v13
    v_cmp_ne_u32 s[50:51], s48, v15
    s_nop 0
    s_or_b64 vcc, vcc, s[50:51]
    s_cbranch_vccz PD_10
    s_cmp_lt_u32 s49, 60000
    s_cbranch_scc1 P_9
PD_10:
    v_lshl_or_b32 v16, v12, 16, v16
    v_and_or_b32 v17, v12, s12, v17
    v_lshl_or_b32 v18, v14, 16, v18
    v_and_or_b32 v19, v14, s12, v19
RK_C2:
    v_cmp_lt_u32 s[20:21], s15, v16
    v_cmp_lt_u32 s[22:23], s15, v17
    v_cmp_lt_u32 s[24:25], s15, v18
    v_cmp_lt_u32 s[26:27], s15, v19
    s_bcnt1_i32_b64 s56, s[20:21]
    s_bcnt1_i32_b64 s57, s[22:23]
    s_bcnt1_i32_b64 s58, s[24:25]
    s_bcnt1_i32_b64 s59, s[26:27]
    v_cmp_lt_u32 s[20:21], s16, v16
    v_cmp_lt_u32 s[22:23], s16, v17
    v_cmp_lt_u32 s[24:25], s16, v18
    v_cmp_lt_u32 s[26:27], s16, v19
    s_add_u32 s56, s56, s57
    s_add_u32 s58, s58, s59
    s_add_u32 s13, s56, s58
    s_bcnt1_i32_b64 s56, s[20:21]
    s_bcnt1_i32_b64 s57, s[22:23]
    s_bcnt1_i32_b64 s58, s[24:25]
    s_bcnt1_i32_b64 s59, s[26:27]
    s_add_u32 s56, s56, s57
    s_add_u32 s58, s58, s59
    s_add_u32 s56, s56, s58
    s_pack_ll_b32_b16 s13, s13, s56
    v_mov_b32 v20, s13
    s_mov_b64 exec, 1
    ds_add_u32 v29, v20 offset:512
    s_mov_b64 exec, -1
    s_waitcnt lgkmcnt(0)
    s_barrier
    ds_read_b32 v29, v29 offset:512
    ds_read_b64 v[36:37], v34 offset:17536
    ds_read_b64 v[38:39], v34 offset:17544
    ds_read_b64 v[40:41], v34 offset:17552
    s_waitcnt lgkmcnt(3)
    v_readfirstlane_b32 s56, v29
    s_nop 0
    s_lshr_b32 s57, s56, 16
    s_and_b32 s56, s56, 0xffff
    s_cmp_ge_u32 s56, 8
    s_cbranch_scc1 RK_DONE
    s_bitcmp1_b32 s3, 3
    s_cselect_b32 s58, s57, s56
    s_cmp_ge_u32 s58, 8
    s_cbranch_scc1 RK_NP
    s_mul_i32 s59, s58, 1536
    s_add_u32 s59, s59, 6361088
    s_lshl_b32 s58, s58, 11
    s_add_u32 s58, s58, 6459392
    s_bitcmp1_b32 s3, 1
    s_cselect_b32 s58, s58, s59
    s_waitcnt lgkmcnt(0)
    v_perm_b32 v24, v37, v36, s5
    v_perm_b32 v25, v39, v38, s5
    v_perm_b32 v26, v41, v40, s5
    v_cndmask_b32 v24, v24, v28, s[46:47]
    s_mov_b64 exec, s[44:45]
    buffer_store_dwordx4 v[24:27], v32, s[40:43], s58 offen sc1
    s_cbranch_scc1 RK_N2
    s_add_u32 s58, s58, 12288
    buffer_store_dwordx4 v[24:27], v32, s[40:43], s58 offen sc1
    s_add_u32 s58, s58, 12288
    buffer_store_dwordx4 v[24:27], v32, s[40:43], s58 offen sc1
    s_add_u32 s58, s58, 12288
    buffer_store_dwordx4 v[24:27], v32, s[40:43], s58 offen sc1
    s_add_u32 s58, s58, 12288
    buffer_store_dwordx4 v[24:27], v32, s[40:43], s58 offen sc1
    s_add_u32 s58, s58, 12288
    buffer_store_dwordx4 v[24:27], v32, s[40:43], s58 offen sc1
    s_add_u32 s58, s58, 12288
    buffer_store_dwordx4 v[24:27], v32, s[40:43], s58 offen sc1
    s_add_u32 s58, s58, 12288
    buffer_store_dwordx4 v[24:27], v32, s[40:43], s58 offen sc1
RK_N2:
    s_mov_b64 exec, -1
RK_NP:
    s_andn2_b32 s4, 15, s15
    s_bitset1_b32 s17, s4
    s_cmp_ge_u32 s57, 8
    s_cbranch_scc1 RK_DONE
    s_andn2_b32 s4, 15, s16
    s_bitset1_b32 s17, s4
    s_add_u32 s18, s18, 4
    s_waitcnt lgkmcnt(0)
    s_cmp_lt_u32 s18, 32
    s_cbranch_scc1 RANK
RK_DONE:
    s_mov_b32 s4, s38
    s_mul_i32 s5, s4, 2320
    v_lshl_add_u32 v8, v1, 5, s5
    s_waitcnt lgkmcnt(0)
    ds_read_b128 v[40:43], v8 offset:54656
    ds_read_b128 v[44:47], v8 offset:54672
    ds_read_b128 v[48:51], v8 offset:56704
    ds_read_b128 v[52:55], v8 offset:56720
    s_lshr_b32 s6, s4, 2
    s_lshl_b32 s6, s6, 7
    s_add_u32 s6, s6, s2
    s_mul_i32 s6, s6, 9216
    s_and_b32 s7, s4, 3
    s_mul_i32 s7, s7, 2304
    s_add_u32 s6, s6, s7
    s_lshl_b32 s4, s4, 1
    s_lshr_b32 s17, s17, s4
    v_lshlrev_b32 v8, 4, v1
    s_mov_b32 s36, 0x05040100
    s_mov_b32 s37, 0x07060302
    s_sleep 8
    s_waitcnt lgkmcnt(0)
    s_bitcmp1_b32 s17, 0
    s_cbranch_scc1 OS_12
    v_perm_b32 v56, v41, v40, s36
    v_perm_b32 v57, v43, v42, s36
    v_perm_b32 v58, v45, v44, s36
    v_perm_b32 v59, v47, v46, s36
    v_perm_b32 v60, v49, v48, s36
    v_perm_b32 v61, v51, v50, s36
    v_perm_b32 v62, v53, v52, s36
    v_perm_b32 v63, v55, v54, s36
    buffer_store_dwordx4 v[56:59], v8, s[32:35], s6 offen offset:0 nt
    s_mov_b64 exec, 0xff
    buffer_store_dwordx4 v[60:63], v8, s[32:35], s6 offen offset:1024 nt
    s_mov_b64 exec, -1
OS_12:
    s_bitcmp1_b32 s17, 1
    s_cbranch_scc1 OS_13
    v_perm_b32 v64, v41, v40, s37
    v_perm_b32 v65, v43, v42, s37
    v_perm_b32 v66, v45, v44, s37
    v_perm_b32 v67, v47, v46, s37
    v_perm_b32 v68, v49, v48, s37
    v_perm_b32 v69, v51, v50, s37
    v_perm_b32 v70, v53, v52, s37
    v_perm_b32 v71, v55, v54, s37
    buffer_store_dwordx4 v[64:67], v8, s[32:35], s6 offen offset:1152 nt
    s_mov_b64 exec, 0xff
    buffer_store_dwordx4 v[68:71], v8, s[32:35], s6 offen offset:2176 nt
    s_mov_b64 exec, -1
OS_13:
    s_branch FIN
LNMAIN:
    s_mov_b32 s40, s30
    s_and_b32 s41, s31, 0xffff
    s_mov_b32 s42, 0x10000000
    s_mov_b32 s43, 0x00020000
    v_lshlrev_b32 v22, 6, v5
    v_lshl_add_u32 v21, v2, 4, v22
    s_mov_b32 s47, 0
    s_mov_b32 s46, s3
    s_mul_i32 s58, s46, 86
    s_lshr_b32 s58, s58, 8
    s_mul_i32 s56, s58, 3
    s_sub_u32 s56, s46, s56
    s_lshl_b32 s58, s58, 10
    s_mul_i32 s59, s56, 4608
    s_add_u32 s59, s59, s58
    s_add_u32 s59, s59, 109008
    v_lshlrev_b32 v50, 4, v1
    v_add_u32 v48, s59, v50
    s_mul_i32 s59, s56, 10608
    s_add_u32 s59, s59, s58
    s_add_u32 s59, s59, 17568
    v_add_u32 v49, s59, v50
    s_lshr_b32 s56, s46, 1
    s_mul_i32 s56, s56, 592
    s_and_b32 s58, s46, 1
    s_lshl_b32 s58, s58, 6
    s_add_u32 s56, s56, s58
    v_bfe_u32 v52, v1, 2, 1
    v_mul_u32_u24 v52, 2368, v52
    v_bfe_u32 v51, v1, 3, 1
    v_bfe_u32 v53, v1, 1, 1
    v_lshl_add_u32 v51, v51, 1, v53
    v_mul_u32_u24 v51, 144, v51
    v_lshl_add_u32 v51, v5, 3, v51
    v_and_b32 v53, 1, v1
    v_lshl_add_u32 v51, v53, 2, v51
    v_add3_u32 v51, v52, v51, s56
    v_mov_b32 v52, 0
    v_mov_b32 v53, 1
    v_and_b32 v24, 1, v0
    s_mov_b32 s39, 0x02020000
    v_mul_lo_u32 v24, v24, s39
    v_add_u32 v24, 0x01000c0c, v24
    v_add_u32 v25, s39, v24
    v_add_u32 v26, s39, v25
    s_mov_b32 s52, 0x3ae38e39
    s_mov_b32 s54, 0x00010001
    s_mov_b32 s55, 0x00010001
    v_and_b32 v23, 7, v3
    v_lshlrev_b32 v23, 7, v23
    v_lshrrev_b32 v20, 3, v3
    v_lshl_add_u32 v23, v20, 6, v23
    v_lshl_add_u32 v23, v5, 4, v23
    s_mul_i32 s36, s2, 12288
    s_mul_i32 s37, s3, 3072
    s_add_u32 s36, s36, s37
    s_add_u32 s36, s36, 4096
    s_add_u32 s37, s36, 1024
    s_add_u32 s38, s36, 2048
    s_waitcnt vmcnt(5)
    v_perm_b32 v64, v9, v8, v24
    v_perm_b32 v65, v11, v10, v24
    v_perm_b32 v66, v9, v8, v25
    v_perm_b32 v67, v11, v10, v25
    v_perm_b32 v68, v9, v8, v26
    v_perm_b32 v69, v11, v10, v26
    v_pk_mul_f32 v[42:43], v[64:65], v[64:65]
    v_pk_add_f32 v[40:41], v[66:67], v[64:65]
    v_pk_fma_f32 v[42:43], v[66:67], v[66:67], v[42:43]
    v_pk_add_f32 v[40:41], v[68:69], v[40:41]
    v_pk_fma_f32 v[42:43], v[68:69], v[68:69], v[42:43]
    s_waitcnt vmcnt(3)
    v_perm_b32 v70, v13, v12, v24
    v_perm_b32 v71, v15, v14, v24
    v_perm_b32 v72, v13, v12, v25
    v_perm_b32 v73, v15, v14, v25
    v_perm_b32 v74, v13, v12, v26
    v_perm_b32 v75, v15, v14, v26
    v_pk_add_f32 v[40:41], v[70:71], v[40:41]
    v_pk_fma_f32 v[42:43], v[70:71], v[70:71], v[42:43]
    v_pk_add_f32 v[40:41], v[72:73], v[40:41]
    v_pk_fma_f32 v[42:43], v[72:73], v[72:73], v[42:43]
    v_pk_add_f32 v[40:41], v[74:75], v[40:41]
    v_pk_fma_f32 v[42:43], v[74:75], v[74:75], v[42:43]
    s_waitcnt vmcnt(1)
    v_perm_b32 v76, v17, v16, v24
    v_perm_b32 v77, v19, v18, v24
    v_perm_b32 v78, v17, v16, v25
    v_perm_b32 v79, v19, v18, v25
    v_perm_b32 v80, v17, v16, v26
    v_perm_b32 v81, v19, v18, v26
    v_pk_add_f32 v[40:41], v[76:77], v[40:41]
    v_pk_fma_f32 v[42:43], v[76:77], v[76:77], v[42:43]
    v_pk_add_f32 v[40:41], v[78:79], v[40:41]
    v_pk_fma_f32 v[42:43], v[78:79], v[78:79], v[42:43]
    v_pk_add_f32 v[40:41], v[80:81], v[40:41]
    v_pk_fma_f32 v[42:43], v[80:81], v[80:81], v[42:43]
    s_nop 0
    v_add_f32_dpp v40, v40, v40 row_ror:8 row_mask:0xf bank_mask:0xf
    v_add_f32_dpp v41, v41, v41 row_ror:8 row_mask:0xf bank_mask:0xf
    v_add_f32_dpp v42, v42, v42 row_ror:8 row_mask:0xf bank_mask:0xf
    v_add_f32_dpp v43, v43, v43 row_ror:8 row_mask:0xf bank_mask:0xf
    v_add_f32_dpp v40, v40, v40 row_ror:4 row_mask:0xf bank_mask:0xf
    v_add_f32_dpp v41, v41, v41 row_ror:4 row_mask:0xf bank_mask:0xf
    v_add_f32_dpp v42, v42, v42 row_ror:4 row_mask:0xf bank_mask:0xf
    v_add_f32_dpp v43, v43, v43 row_ror:4 row_mask:0xf bank_mask:0xf
    v_add_f32_dpp v40, v40, v40 row_ror:2 row_mask:0xf bank_mask:0xf
    v_add_f32_dpp v41, v41, v41 row_ror:2 row_mask:0xf bank_mask:0xf
    v_add_f32_dpp v42, v42, v42 row_ror:2 row_mask:0xf bank_mask:0xf
    v_add_f32_dpp v43, v43, v43 row_ror:2 row_mask:0xf bank_mask:0xf
    v_add_f32_dpp v40, v40, v40 row_ror:1 row_mask:0xf bank_mask:0xf
    v_add_f32_dpp v41, v41, v41 row_ror:1 row_mask:0xf bank_mask:0xf
    v_add_f32_dpp v42, v42, v42 row_ror:1 row_mask:0xf bank_mask:0xf
    v_add_f32_dpp v43, v43, v43 row_ror:1 row_mask:0xf bank_mask:0xf
    v_max_f32 v43, 0, v43
    s_mov_b64 exec, s[54:55]
    ds_write_b128 v21, v[40:43] offset:0
    s_mov_b64 exec, -1
    s_waitcnt vmcnt(0)
    v_readfirstlane_b32 s48, v63
    s_nop 0
    s_mul_i32 s48, s48, 1664525
    s_add_u32 s48, s48, 1013904223
    v_mov_b32 v11, s48
    v_mov_b32 v15, s48
    v_mov_b32 v19, s48
    s_mov_b32 s49, 0
LA_SPIN:
    ds_read_b128 v[32:35], v22 offset:0
    ds_read_b128 v[36:39], v22 offset:16
    ds_read_b128 v[40:43], v22 offset:32
    ds_read_b128 v[44:47], v22 offset:48
    s_add_u32 s49, s49, 1
    s_waitcnt lgkmcnt(0)
    v_max3_u32 v30, v35, v39, v43
    v_max_u32 v30, v30, v47
    v_cmp_eq_u32 vcc, -1, v30
    s_nop 0
    s_cbranch_vccz LA_GO
    s_cmp_lt_u32 s49, 60000
    s_cbranch_scc1 LA_SPIN
LA_GO:
    v_pk_add_f32 v[32:33], v[32:33], v[36:37]
    v_pk_add_f32 v[34:35], v[34:35], v[38:39]
    v_pk_add_f32 v[40:41], v[40:41], v[44:45]
    v_pk_add_f32 v[42:43], v[42:43], v[46:47]
    v_pk_add_f32 v[32:33], v[32:33], v[40:41]
    v_pk_add_f32 v[60:61], v[34:35], v[42:43]
    v_pk_mul_f32 v[32:33], v[32:33], s[52:53] op_sel_hi:[1,0]
    v_pk_mul_f32 v[60:61], v[60:61], s[52:53] op_sel_hi:[1,0]
    v_pk_fma_f32 v[60:61], v[32:33], v[32:33], v[60:61] neg_lo:[1,0,0] neg_hi:[1,0,0]
    v_max_f32 v60, 0, v60
    v_max_f32 v61, 0, v61
    v_cvt_pk_bf16_f32 v30, v60, v61
    v_lshlrev_b32 v60, 16, v30
    v_and_b32 v61, 0xffff0000, v30
    v_add_f32 v60, 0x3727c5ac, v60
    v_add_f32 v61, 0x3727c5ac, v61
    v_cvt_pk_bf16_f32 v30, v60, v61
    v_lshlrev_b32 v60, 16, v30
    v_and_b32 v61, 0xffff0000, v30
    v_sqrt_f32 v60, v60
    v_sqrt_f32 v61, v61
    v_cvt_pk_bf16_f32 v31, v32, v33
    v_lshlrev_b32 v32, 16, v31
    v_and_b32 v33, 0xffff0000, v31
    v_cvt_pk_bf16_f32 v30, v60, v61
    v_lshlrev_b32 v60, 16, v30
    v_and_b32 v61, 0xffff0000, v30
    v_rcp_f32 v60, v60
    v_rcp_f32 v61, v61
    v_pk_add_f32 v[82:83], v[64:65], v[32:33] neg_lo:[0,1] neg_hi:[0,1]
    v_pk_add_f32 v[84:85], v[66:67], v[32:33] neg_lo:[0,1] neg_hi:[0,1]
    v_pk_add_f32 v[86:87], v[68:69], v[32:33] neg_lo:[0,1] neg_hi:[0,1]
    v_pk_mul_f32 v[82:83], v[82:83], v[60:61]
    v_pk_mul_f32 v[84:85], v[84:85], v[60:61]
    v_pk_mul_f32 v[86:87], v[86:87], v[60:61]
    v_cvt_pk_f16_f32 v8, v82, v83
    v_cvt_pk_f16_f32 v9, v84, v85
    v_cvt_pk_f16_f32 v10, v86, v87
    buffer_store_dwordx4 v[8:11], v23, s[40:43], s36 offen sc1
    v_pk_add_f32 v[88:89], v[70:71], v[32:33] neg_lo:[0,1] neg_hi:[0,1]
    v_pk_add_f32 v[90:91], v[72:73], v[32:33] neg_lo:[0,1] neg_hi:[0,1]
    v_pk_add_f32 v[92:93], v[74:75], v[32:33] neg_lo:[0,1] neg_hi:[0,1]
    v_pk_mul_f32 v[88:89], v[88:89], v[60:61]
    v_pk_mul_f32 v[90:91], v[90:91], v[60:61]
    v_pk_mul_f32 v[92:93], v[92:93], v[60:61]
    v_cvt_pk_f16_f32 v12, v88, v89
    v_cvt_pk_f16_f32 v13, v90, v91
    v_cvt_pk_f16_f32 v14, v92, v93
    buffer_store_dwordx4 v[12:15], v23, s[40:43], s37 offen sc1
    v_pk_add_f32 v[94:95], v[76:77], v[32:33] neg_lo:[0,1] neg_hi:[0,1]
    v_pk_add_f32 v[96:97], v[78:79], v[32:33] neg_lo:[0,1] neg_hi:[0,1]
    v_pk_add_f32 v[98:99], v[80:81], v[32:33] neg_lo:[0,1] neg_hi:[0,1]
    v_pk_mul_f32 v[94:95], v[94:95], v[60:61]
    v_pk_mul_f32 v[96:97], v[96:97], v[60:61]
    v_pk_mul_f32 v[98:99], v[98:99], v[60:61]
    v_cvt_pk_f16_f32 v16, v94, v95
    v_cvt_pk_f16_f32 v17, v96, v97
    v_cvt_pk_f16_f32 v18, v98, v99
    buffer_store_dwordx4 v[16:19], v23, s[40:43], s38 offen sc1
    s_cmp_lg_u32 s3, 0
    s_cbranch_scc1 LN_S
    v_mov_b32 v62, v31
    v_mov_b32 v63, s48
    v_lshlrev_b32 v20, 4, v5
    s_and_b32 s36, s2, 127
    s_lshl_b32 s36, s36, 7
    s_lshr_b32 s37, s2, 7
    s_lshl_b32 s37, s37, 6
    s_add_u32 s36, s36, s37
    s_add_u32 s36, s36, 6475776
    s_mov_b64 exec, s[54:55]
    buffer_store_dwordx4 v[60:63], v20, s[40:43], s36 offen sc1
    s_mov_b64 exec, -1
LN_S:
    s_cmp_ge_u32 s2, 192
    s_cbranch_scc1 FFN_C
    s_waitcnt vmcnt(0)
    v_lshlrev_b32 v31, 2, v0
    v_add_u32 v31, 109024, v31
    v_lshrrev_b32 v30, 2, v0
    v_mul_u32_u24 v30, 12288, v30
    v_and_b32 v29, 3, v0
    v_lshl_add_u32 v30, v29, 4, v30
    s_and_b32 s36, s2, 0xf0
    s_lshl_b32 s36, s36, 6
    s_and_b32 s37, s2, 7
    s_lshl_b32 s37, s37, 7
    s_add_u32 s36, s36, s37
    s_and_b32 s37, s2, 8
    s_lshl_b32 s37, s37, 3
    s_add_u32 s36, s36, s37
    s_add_u32 s36, s36, 4096
    s_add_u32 s37, s36, 786432
    s_add_u32 s38, s36, 1572864
    s_add_u32 s39, s36, 2359296
    s_sleep 4
    buffer_load_dwordx4 v[32:35], v30, s[40:43], s36 offen sc1
    buffer_load_dwordx4 v[36:39], v30, s[40:43], s37 offen sc1
    buffer_load_dwordx4 v[40:43], v30, s[40:43], s38 offen sc1
    buffer_load_dwordx4 v[44:47], v30, s[40:43], s39 offen sc1
    s_mov_b32 s49, 0
P_14:
    s_add_u32 s49, s49, 1
    s_waitcnt vmcnt(0)
    v_cmp_ne_u32 s[6:7], s48, v35
    v_cmp_ne_u32 s[8:9], s48, v39
    v_cmp_ne_u32 s[10:11], s48, v43
    v_cmp_ne_u32 s[12:13], s48, v47
    s_or_b64 s[50:51], s[6:7], s[8:9]
    s_or_b64 s[50:51], s[50:51], s[10:11]
    s_or_b64 s[50:51], s[50:51], s[12:13]
    s_cbranch_scc0 PD_15
    s_sleep 1
    s_wqm_b64 exec, s[6:7]
    s_cbranch_execz PS_16
    buffer_load_dwordx4 v[32:35], v30, s[40:43], s36 offen sc1
PS_16:
    s_wqm_b64 exec, s[8:9]
    s_cbranch_execz PS_17
    buffer_load_dwordx4 v[36:39], v30, s[40:43], s37 offen sc1
PS_17:
    s_wqm_b64 exec, s[10:11]
    s_cbranch_execz PS_18
    buffer_load_dwordx4 v[40:43], v30, s[40:43], s38 offen sc1
PS_18:
    s_wqm_b64 exec, s[12:13]
    s_cbranch_execz PS_19
    buffer_load_dwordx4 v[44:47], v30, s[40:43], s39 offen sc1
PS_19:
    s_mov_b64 exec, -1
    s_cmp_lt_u32 s49, 60000
    s_cbranch_scc1 P_14
    s_waitcnt vmcnt(0)
PD_15:
    ds_write_b32 v31, v32 offset:0
    ds_write_b32 v31, v33 offset:4608
    ds_write_b32 v31, v34 offset:9216
    ds_write_b32 v31, v36 offset:1024
    ds_write_b32 v31, v37 offset:5632
    ds_write_b32 v31, v38 offset:10240
    ds_write_b32 v31, v40 offset:2048
    ds_write_b32 v31, v41 offset:6656
    ds_write_b32 v31, v42 offset:11264
    ds_write_b32 v31, v44 offset:3072
    ds_write_b32 v31, v45 offset:7680
    ds_write_b32 v31, v46 offset:12288
    s_branch CV_B4
FFN_CK:
    s_waitcnt lgkmcnt(0)
    s_load_dword s48, s[30:31], 0
    s_mov_b32 s40, s30
    s_and_b32 s41, s31, 0xffff
    s_mov_b32 s42, 0x10000000
    s_mov_b32 s43, 0x00020000
FFN_C:
    s_and_b32 s56, s2, 7
    s_bfe_u32 s57, s2, 0x30003
    s_lshl_b32 s44, s56, 3
    s_or_b32 s44, s44, s57
    s_branch FFN_L
FFN_B:
    s_barrier
    s_sub_u32 s44, s2, 120
FFN_L:
    s_setprio 0
    s_cmp_ge_u32 s3, 8
    s_cbranch_scc1 F_L2
    s_barrier
    s_cmp_lg_u32 s3, 4
    s_cbranch_scc1 F_NP
    s_cmp_lt_u32 s2, 192
    s_cbranch_scc1 F_NP
    s_add_u32 s56, s56, 64
    s_mul_i32 s58, s56, 73728
    s_mul_i32 s59, s57, 9216
    s_add_u32 s58, s58, s59
    v_min_u32 v9, 35, v1
    v_lshl_add_u32 v9, v9, 8, s58
    global_load_dword v2, v9, s[26:27]
    global_load_dword v2, v9, s[26:27] offset:128
F_NP:
    v_bfe_u32 v7, v1, 2, 2
    v_bfe_u32 v8, v1, 1, 1
    v_lshl_add_u32 v9, v5, 3, v7
    v_lshlrev_b32 v9, 7, v9
    v_mul_u32_u24 v10, 73728, v8
    v_add_u32 v9, v9, v10
    v_lshrrev_b32 v7, 1, v7
    v_and_b32 v10, 1, v5
    v_lshl_add_u32 v7, v10, 1, v7
    v_lshl_add_u32 v7, v8, 2, v7
    v_xor_b32 v7, s3, v7
    v_lshl_add_u32 v9, v7, 4, v9
    v_and_b32 v7, 1, v1
    v_lshl_add_u32 v9, v7, 3, v9
    v_add_u32 v9, 3328, v9
    v_add_u32 v10, 36864, v9
    s_cmp_lt_u32 s2, 192
    s_cbranch_scc1 CT_20
    s_cmp_lt_u32 s3, 4
    s_cbranch_scc1 CT_20
    s_waitcnt lgkmcnt(0)
    s_mul_i32 s48, s48, 1664525
    s_add_u32 s48, s48, 1013904223
CT_20:
    s_barrier
    ds_read_b64_tr_b16 v[56:57], v9 offset:0
    ds_read_b64_tr_b16 v[58:59], v9 offset:512
    ds_read_b64_tr_b16 v[60:61], v9 offset:4096
    ds_read_b64_tr_b16 v[62:63], v9 offset:4608
    ds_read_b64_tr_b16 v[64:65], v9 offset:8192
    ds_read_b64_tr_b16 v[66:67], v9 offset:8704
    ds_read_b64_tr_b16 v[68:69], v9 offset:12288
    ds_read_b64_tr_b16 v[70:71], v9 offset:12800
    ds_read_b64_tr_b16 v[72:73], v9 offset:16384
    ds_read_b64_tr_b16 v[74:75], v9 offset:16896
    ds_read_b64_tr_b16 v[76:77], v9 offset:20480
    ds_read_b64_tr_b16 v[78:79], v9 offset:20992
    ds_read_b64_tr_b16 v[80:81], v9 offset:24576
    ds_read_b64_tr_b16 v[82:83], v9 offset:25088
    s_waitcnt lgkmcnt(12)
    ds_read_b64_tr_b16 v[84:85], v9 offset:28672
    ds_read_b64_tr_b16 v[86:87], v9 offset:29184
    s_waitcnt lgkmcnt(12)
    ds_read_b64_tr_b16 v[88:89], v9 offset:32768
    ds_read_b64_tr_b16 v[90:91], v9 offset:33280
    s_waitcnt lgkmcnt(12)
    ds_read_b64_tr_b16 v[92:93], v10 offset:0
    ds_read_b64_tr_b16 v[94:95], v10 offset:512
    s_waitcnt lgkmcnt(12)
    ds_read_b64_tr_b16 v[96:97], v10 offset:4096
    ds_read_b64_tr_b16 v[98:99], v10 offset:4608
    s_waitcnt lgkmcnt(12)
    ds_read_b64_tr_b16 v[100:101], v10 offset:8192
    ds_read_b64_tr_b16 v[102:103], v10 offset:8704
    s_waitcnt lgkmcnt(12)
    ds_read_b64_tr_b16 v[104:105], v10 offset:12288
    ds_read_b64_tr_b16 v[106:107], v10 offset:12800
    s_waitcnt lgkmcnt(12)
    ds_read_b64_tr_b16 v[108:109], v10 offset:16384
    ds_read_b64_tr_b16 v[110:111], v10 offset:16896
    s_waitcnt lgkmcnt(12)
    ds_read_b64_tr_b16 v[112:113], v10 offset:20480
    ds_read_b64_tr_b16 v[114:115], v10 offset:20992
    s_waitcnt lgkmcnt(12)
    ds_read_b64_tr_b16 v[116:117], v10 offset:24576
    ds_read_b64_tr_b16 v[118:119], v10 offset:25088
    s_waitcnt lgkmcnt(12)
    ds_read_b64_tr_b16 v[120:121], v10 offset:28672
    ds_read_b64_tr_b16 v[122:123], v10 offset:29184
    s_waitcnt lgkmcnt(12)
    ds_read_b64_tr_b16 v[124:125], v10 offset:32768
    ds_read_b64_tr_b16 v[126:127], v10 offset:33280
    v_lshlrev_b32 v7, 4, v1
    v_and_b32 v20, 31, v1
    v_lshlrev_b32 v21, 4, v20
    s_mul_i32 s38, s3, 1536
    s_and_b32 s39, s2, 7
    s_mul_i32 s39, s39, 12288
    s_add_u32 s38, s38, s39
    s_add_u32 s38, s38, 6361088
    s_mul_i32 s39, s3, 1184
    v_mul_u32_u24 v22, 12, v1
    v_add_u32 v22, s39, v22
    v_mul_u32_u24 v23, 12, v20
    v_add_u32 v23, s39, v23
    v_and_b32 v6, 7, v1
    v_mul_u32_u24 v4, 1184, v6
    v_lshl_add_u32 v4, v5, 4, v4
    v_mul_u32_u24 v6, 160, v6
    v_and_b32 v20, 1, v5
    v_lshl_add_u32 v6, v20, 3, v6
    v_lshrrev_b32 v20, 1, v5
    v_lshl_add_u32 v6, v20, 2, v6
    s_lshl_b32 s39, s3, 4
    v_add_u32 v6, s39, v6
    s_mov_b32 s56, 0x00ff00ff
    s_mov_b32 s57, 0x00ff00ff
    s_waitcnt lgkmcnt(0)
    s_setprio 3
    s_barrier
    s_mov_b32 s49, 0
P_21:
    buffer_load_dwordx4 v[12:15], v7, s[40:43], s38 offen sc1
    buffer_load_dwordx4 v[16:19], v21, s[40:43], s38 offen offset:1024 sc1
PC_23:
    s_add_u32 s49, s49, 1
    s_waitcnt vmcnt(0)
    v_cmp_ne_u32 vcc, s48, v15
    v_cmp_ne_u32 s[50:51], s48, v19
    s_nop 0
    s_or_b64 vcc, vcc, s[50:51]
    s_cbranch_vccz PD_22
    s_cmp_lt_u32 s49, 60000
    s_cbranch_scc1 P_21
PD_22:
    ds_write_b32 v22, v12 offset:3328
    ds_write_b32 v22, v13 offset:3332
    ds_write_b32 v22, v14 offset:3336
    ds_write_b32 v23, v16 offset:4096
    ds_write_b32 v23, v17 offset:4100
    ds_write_b32 v23, v18 offset:4104
    s_waitcnt lgkmcnt(0)
    s_barrier
    ds_read_b128 v[12:15], v4 offset:3328
    ds_read_b128 v[16:19], v4 offset:3392
    ds_read_b128 v[20:23], v4 offset:3456
    ds_read_b128 v[24:27], v4 offset:3520
    ds_read_b128 v[28:31], v4 offset:3584
    ds_read_b128 v[32:35], v4 offset:3648
    ds_read_b128 v[36:39], v4 offset:3712
    ds_read_b128 v[40:43], v4 offset:3776
    ds_read_b128 v[44:47], v4 offset:3840
    ds_read_b128 v[48:51], v4 offset:3904
    ds_read_b128 v[52:55], v4 offset:3968
    s_waitcnt lgkmcnt(10)
    v_mfma_f32_16x16x32_bf16 v[8:11], v[56:59], v[12:15], 0
    ds_read_b128 v[12:15], v4 offset:4032
    s_waitcnt lgkmcnt(10)
    v_mfma_f32_16x16x32_bf16 v[8:11], v[60:63], v[16:19], v[8:11]
    ds_read_b128 v[16:19], v4 offset:4096
    s_waitcnt lgkmcnt(10)
    v_mfma_f32_16x16x32_bf16 v[8:11], v[64:67], v[20:23], v[8:11]
    ds_read_b128 v[20:23], v4 offset:4160
    s_waitcnt lgkmcnt(10)
    v_mfma_f32_16x16x32_bf16 v[8:11], v[68:71], v[24:27], v[8:11]
    ds_read_b128 v[24:27], v4 offset:4224
    s_waitcnt lgkmcnt(10)
    v_mfma_f32_16x16x32_bf16 v[8:11], v[72:75], v[28:31], v[8:11]
    ds_read_b128 v[28:31], v4 offset:4288
    s_waitcnt lgkmcnt(10)
    v_mfma_f32_16x16x32_bf16 v[8:11], v[76:79], v[32:35], v[8:11]
    ds_read_b128 v[32:35], v4 offset:4352
    s_waitcnt lgkmcnt(10)
    v_mfma_f32_16x16x32_bf16 v[8:11], v[80:83], v[36:39], v[8:11]
    ds_read_b128 v[36:39], v4 offset:4416
    s_waitcnt lgkmcnt(10)
    v_mfma_f32_16x16x32_bf16 v[8:11], v[84:87], v[40:43], v[8:11]
    s_waitcnt lgkmcnt(9)
    v_mfma_f32_16x16x32_bf16 v[8:11], v[88:91], v[44:47], v[8:11]
    s_waitcnt lgkmcnt(8)
    v_mfma_f32_16x16x32_bf16 v[8:11], v[92:95], v[48:51], v[8:11]
    s_waitcnt lgkmcnt(7)
    v_mfma_f32_16x16x32_bf16 v[8:11], v[96:99], v[52:55], v[8:11]
    s_waitcnt lgkmcnt(6)
    v_mfma_f32_16x16x32_bf16 v[8:11], v[100:103], v[12:15], v[8:11]
    s_waitcnt lgkmcnt(5)
    v_mfma_f32_16x16x32_bf16 v[8:11], v[104:107], v[16:19], v[8:11]
    s_waitcnt lgkmcnt(4)
    v_mfma_f32_16x16x32_bf16 v[8:11], v[108:111], v[20:23], v[8:11]
    s_waitcnt lgkmcnt(3)
    v_mfma_f32_16x16x32_bf16 v[8:11], v[112:115], v[24:27], v[8:11]
    s_waitcnt lgkmcnt(2)
    v_mfma_f32_16x16x32_bf16 v[8:11], v[116:119], v[28:31], v[8:11]
    s_waitcnt lgkmcnt(1)
    v_mfma_f32_16x16x32_bf16 v[8:11], v[120:123], v[32:35], v[8:11]
    s_waitcnt lgkmcnt(0)
    v_mfma_f32_16x16x32_bf16 v[8:11], v[124:127], v[36:39], v[8:11]
    s_nop 7
    v_permlane32_swap_b32 v8, v10
    v_permlane32_swap_b32 v9, v11
    v_cvt_pk_bf16_f32 v12, v8, v9
    v_lshlrev_b32 v8, 16, v12
    v_and_b32 v9, 0xffff0000, v12
    v_cvt_pk_bf16_f32 v13, v10, v11
    v_lshlrev_b32 v10, 16, v13
    v_and_b32 v11, 0xffff0000, v13
    v_mul_f32 v12, 0xbfb8aa3b, v8
    v_mul_f32 v13, 0xbfb8aa3b, v9
    v_exp_f32 v12, v12
    v_exp_f32 v13, v13
    v_add_f32 v12, 1.0, v12
    v_add_f32 v13, 1.0, v13
    v_rcp_f32 v12, v12
    v_rcp_f32 v13, v13
    s_nop 0
    v_pk_mul_f32 v[8:9], v[8:9], v[12:13]
    v_cvt_pk_bf16_f32 v12, v8, v9
    v_lshlrev_b32 v8, 16, v12
    v_and_b32 v9, 0xffff0000, v12
    v_pk_mul_f32 v[8:9], v[8:9], v[10:11]
    v_cvt_pk_bf16_f32 v8, v8, v9
    s_mov_b64 exec, s[56:57]
    ds_write_b32 v6, v8 offset:12800
    s_mov_b64 exec, -1
    s_waitcnt lgkmcnt(0)
    s_barrier
    s_branch F_R
F_L2:
    s_and_b32 s56, s3, 3
    s_cmp_eq_u32 s56, 3
    s_cbranch_scc1 F_E
    s_lshr_b32 s45, s3, 2
    s_sub_u32 s45, s3, s45
    s_sub_u32 s45, s45, 6
    s_mul_i32 s56, s44, 73728
    s_mul_i32 s57, s45, 192
    s_add_u32 s56, s56, s57
    v_mul_u32_u24 v7, 9216, v5
    v_mul_u32_u24 v8, 12, v3
    v_add3_u32 v7, v7, v8, s56
    s_cmp_ge_u32 s45, 3
    s_cselect_b64 s[36:37], s[24:25], s[22:23]
    s_cselect_b32 s57, 4, 0
    s_cselect_b32 s56, 3, 0
    s_mov_b32 s32, s36
    s_and_b32 s33, s37, 0xffff
    s_mov_b32 s34, 0x00510000
    s_mov_b32 s35, 0x00020000
    v_lshrrev_b32 v27, 3, v1
    v_mul_u32_u24 v27, 9216, v27
    v_and_b32 v28, 7, v1
    v_bfe_u32 v29, v1, 4, 1
    v_xor_b32 v28, v28, v29
    v_xor_b32 v28, s57, v28
    v_xor_b32 v29, 2, v28
    v_lshl_add_u32 v28, v28, 4, v27
    v_lshl_add_u32 v29, v29, 4, v27
    s_sub_u32 s57, s45, s56
    s_mul_i32 s58, s57, 1769472
    s_lshl_b32 s59, s44, 7
    s_add_u32 s58, s58, s59
    s_mul_i32 s57, s45, 24576
    s_add_u32 s57, s57, 3328
    s_mov_b32 m0, s57
    s_nop 0
    buffer_load_dwordx4 v28, s[32:35], s58 offen nt lds
    s_add_u32 m0, m0, 1024
    s_add_u32 s58, s58, 73728
    buffer_load_dwordx4 v29, s[32:35], s58 offen nt lds
    s_add_u32 m0, m0, 1024
    s_add_u32 s58, s58, 73728
    buffer_load_dwordx4 v28, s[32:35], s58 offen nt lds
    s_add_u32 m0, m0, 1024
    s_add_u32 s58, s58, 73728
    s_barrier
    buffer_load_dwordx4 v29, s[32:35], s58 offen nt lds
    s_add_u32 m0, m0, 1024
    s_add_u32 s58, s58, 73728
    buffer_load_dwordx4 v28, s[32:35], s58 offen nt lds
    s_add_u32 m0, m0, 1024
    s_add_u32 s58, s58, 73728
    buffer_load_dwordx4 v29, s[32:35], s58 offen nt lds
    s_add_u32 m0, m0, 1024
    s_add_u32 s58, s58, 73728
    buffer_load_dwordx4 v28, s[32:35], s58 offen nt lds
    s_add_u32 m0, m0, 1024
    s_add_u32 s58, s58, 73728
    buffer_load_dwordx4 v29, s[32:35], s58 offen nt lds
    s_add_u32 m0, m0, 1024
    s_add_u32 s58, s58, 73728
    buffer_load_dwordx4 v28, s[32:35], s58 offen nt lds
    s_add_u32 m0, m0, 1024
    s_add_u32 s58, s58, 73728
    buffer_load_dwordx4 v29, s[32:35], s58 offen nt lds
    s_add_u32 m0, m0, 1024
    s_add_u32 s58, s58, 73728
    buffer_load_dwordx4 v28, s[32:35], s58 offen nt lds
    s_add_u32 m0, m0, 1024
    s_add_u32 s58, s58, 73728
    buffer_load_dwordx4 v29, s[32:35], s58 offen nt lds
    s_add_u32 m0, m0, 1024
    s_add_u32 s58, s58, 73728
    buffer_load_dwordx4 v28, s[32:35], s58 offen nt lds
    s_add_u32 m0, m0, 1024
    s_add_u32 s58, s58, 73728
    buffer_load_dwordx4 v29, s[32:35], s58 offen nt lds
    s_add_u32 m0, m0, 1024
    s_add_u32 s58, s58, 73728
    buffer_load_dwordx4 v28, s[32:35], s58 offen nt lds
    s_add_u32 m0, m0, 1024
    s_add_u32 s58, s58, 73728
    buffer_load_dwordx4 v29, s[32:35], s58 offen nt lds
    s_add_u32 m0, m0, 1024
    s_add_u32 s58, s58, 73728
    buffer_load_dwordx4 v28, s[32:35], s58 offen nt lds
    s_add_u32 m0, m0, 1024
    s_add_u32 s58, s58, 73728
    buffer_load_dwordx4 v29, s[32:35], s58 offen nt lds
    s_add_u32 m0, m0, 1024
    s_add_u32 s58, s58, 73728
    buffer_load_dwordx4 v28, s[32:35], s58 offen nt lds
    s_add_u32 m0, m0, 1024
    s_add_u32 s58, s58, 73728
    buffer_load_dwordx4 v29, s[32:35], s58 offen nt lds
    s_add_u32 m0, m0, 1024
    s_add_u32 s58, s58, 73728
    buffer_load_dwordx4 v28, s[32:35], s58 offen nt lds
    s_add_u32 m0, m0, 1024
    s_add_u32 s58, s58, 73728
    buffer_load_dwordx4 v29, s[32:35], s58 offen nt lds
    s_add_u32 m0, m0, 1024
    s_add_u32 s58, s58, 73728
    buffer_load_dwordx4 v28, s[32:35], s58 offen nt lds
    s_add_u32 m0, m0, 1024
    s_add_u32 s58, s58, 73728
    buffer_load_dwordx4 v29, s[32:35], s58 offen nt lds
    s_cmp_lt_u32 s2, 192
    s_cbranch_scc1 F_L4
    global_load_dwordx3 v[64:66], v7, s[26:27] offset:0 nt
    global_load_dwordx3 v[68:70], v7, s[26:27] offset:1152 nt
    global_load_dwordx3 v[72:74], v7, s[26:27] offset:2304 nt
    global_load_dwordx3 v[76:78], v7, s[26:27] offset:3456 nt
    v_add_u32 v7, 4608, v7
    global_load_dwordx3 v[80:82], v7, s[26:27] offset:0 nt
    global_load_dwordx3 v[84:86], v7, s[26:27] offset:1152 nt
    global_load_dwordx3 v[88:90], v7, s[26:27] offset:2304 nt
    global_load_dwordx3 v[92:94], v7, s[26:27] offset:3456 nt
    v_add_u32 v7, 32256, v7
    global_load_dwordx3 v[96:98], v7, s[26:27] offset:0 nt
    global_load_dwordx3 v[100:102], v7, s[26:27] offset:1152 nt
    global_load_dwordx3 v[104:106], v7, s[26:27] offset:2304 nt
    global_load_dwordx3 v[108:110], v7, s[26:27] offset:3456 nt
    v_add_u32 v7, 4608, v7
    global_load_dwordx3 v[112:114], v7, s[26:27] offset:0 nt
    global_load_dwordx3 v[116:118], v7, s[26:27] offset:1152 nt
    global_load_dwordx3 v[120:122], v7, s[26:27] offset:2304 nt
    global_load_dwordx3 v[124:126], v7, s[26:27] offset:3456 nt
    s_waitcnt vmcnt(16) lgkmcnt(0)
    s_mul_i32 s48, s48, 1664525
    s_add_u32 s48, s48, 1013904223
    s_branch F_L5
F_L4:
    s_waitcnt vmcnt(0)
F_L5:
    v_and_b32 v6, 7, v1
    v_mul_u32_u24 v4, 160, v6
    v_lshl_add_u32 v4, v5, 4, v4
    v_and_b32 v6, 1, v5
    v_lshlrev_b32 v6, 2, v6
    v_lshrrev_b32 v8, 1, v5
    v_add_u32 v6, v6, v8
    v_mul_u32_u24 v6, 1536, v6
    v_lshl_add_u32 v6, v3, 4, v6
    s_mul_i32 s36, s44, 12288
    s_lshl_b32 s37, s45, 8
    s_add_u32 s36, s36, s37
    s_add_u32 s36, s36, 6492160
    s_mov_b32 s56, 0x05040100
    s_mov_b32 s57, 0x07060302
    s_barrier
    s_waitcnt vmcnt(0)
    v_perm_b32 v16, v68, v64, s56
    v_perm_b32 v17, v76, v72, s56
    v_perm_b32 v18, v84, v80, s56
    v_perm_b32 v19, v92, v88, s56
    v_perm_b32 v20, v68, v64, s57
    v_perm_b32 v21, v76, v72, s57
    v_perm_b32 v22, v84, v80, s57
    v_perm_b32 v23, v92, v88, s57
    v_perm_b32 v24, v69, v65, s56
    v_perm_b32 v25, v77, v73, s56
    v_perm_b32 v26, v85, v81, s56
    v_perm_b32 v27, v93, v89, s56
    v_perm_b32 v28, v69, v65, s57
    v_perm_b32 v29, v77, v73, s57
    v_perm_b32 v30, v85, v81, s57
    v_perm_b32 v31, v93, v89, s57
    v_perm_b32 v32, v70, v66, s56
    v_perm_b32 v33, v78, v74, s56
    v_perm_b32 v34, v86, v82, s56
    v_perm_b32 v35, v94, v90, s56
    v_perm_b32 v36, v70, v66, s57
    v_perm_b32 v37, v78, v74, s57
    v_perm_b32 v38, v86, v82, s57
    v_perm_b32 v39, v94, v90, s57
    v_perm_b32 v40, v100, v96, s56
    v_perm_b32 v41, v108, v104, s56
    v_perm_b32 v42, v116, v112, s56
    v_perm_b32 v43, v124, v120, s56
    v_perm_b32 v44, v100, v96, s57
    v_perm_b32 v45, v108, v104, s57
    v_perm_b32 v46, v116, v112, s57
    v_perm_b32 v47, v124, v120, s57
    v_perm_b32 v48, v101, v97, s56
    v_perm_b32 v49, v109, v105, s56
    v_perm_b32 v50, v117, v113, s56
    v_perm_b32 v51, v125, v121, s56
    v_perm_b32 v52, v101, v97, s57
    v_perm_b32 v53, v109, v105, s57
    v_perm_b32 v54, v117, v113, s57
    v_perm_b32 v55, v125, v121, s57
    v_perm_b32 v56, v102, v98, s56
    v_perm_b32 v57, v110, v106, s56
    v_perm_b32 v58, v118, v114, s56
    v_perm_b32 v59, v126, v122, s56
    v_perm_b32 v60, v102, v98, s57
    v_perm_b32 v61, v110, v106, s57
    v_perm_b32 v62, v118, v114, s57
    v_perm_b32 v63, v126, v122, s57
    v_mov_b32 v91, s48
    v_mov_b32 v95, s48
    s_mov_b32 s56, 0
    s_mov_b32 s57, -1
    s_setprio 3
    s_barrier
    s_barrier
    s_barrier
    ds_read_b128 v[8:11], v4 offset:12800
    ds_read_b128 v[12:15], v4 offset:12864
    s_waitcnt lgkmcnt(1)
    v_mfma_f32_16x16x32_bf16 v[64:67], v[8:11], v[16:19], 0
    v_mfma_f32_16x16x32_bf16 v[68:71], v[8:11], v[20:23], 0
    v_mfma_f32_16x16x32_bf16 v[72:75], v[8:11], v[24:27], 0
    v_mfma_f32_16x16x32_bf16 v[76:79], v[8:11], v[28:31], 0
    v_mfma_f32_16x16x32_bf16 v[80:83], v[8:11], v[32:35], 0
    v_mfma_f32_16x16x32_bf16 v[84:87], v[8:11], v[36:39], 0
    s_waitcnt lgkmcnt(0)
    v_mfma_f32_16x16x32_bf16 v[64:67], v[12:15], v[40:43], v[64:67]
    v_mfma_f32_16x16x32_bf16 v[68:71], v[12:15], v[44:47], v[68:71]
    v_mfma_f32_16x16x32_bf16 v[72:75], v[12:15], v[48:51], v[72:75]
    v_mfma_f32_16x16x32_bf16 v[76:79], v[12:15], v[52:55], v[76:79]
    v_mfma_f32_16x16x32_bf16 v[80:83], v[12:15], v[56:59], v[80:83]
    v_mfma_f32_16x16x32_bf16 v[84:87], v[12:15], v[60:63], v[84:87]
    s_nop 3
    v_cvt_pk_bf16_f32 v88, v64, v68
    s_nop 0
    v_cvt_pk_bf16_f32 v89, v72, v76
    s_nop 0
    v_cvt_pk_bf16_f32 v90, v80, v84
    v_cvt_pk_bf16_f32 v92, v66, v70
    v_cvt_pk_bf16_f32 v93, v74, v78
    v_cvt_pk_bf16_f32 v94, v82, v86
    s_mov_b64 exec, s[56:57]
    v_cvt_pk_bf16_f32 v88, v65, v69
    v_cvt_pk_bf16_f32 v89, v73, v77
    v_cvt_pk_bf16_f32 v90, v81, v85
    v_cvt_pk_bf16_f32 v92, v67, v71
    v_cvt_pk_bf16_f32 v93, v75, v79
    v_cvt_pk_bf16_f32 v94, v83, v87
    s_mov_b64 exec, -1
    buffer_store_dwordx4 v[88:91], v6, s[40:43], s36 offen offset:0 sc1
    buffer_store_dwordx4 v[92:95], v6, s[40:43], s36 offen offset:3072 sc1
    s_branch F_R
F_E:
    s_barrier
    s_cmp_lt_u32 s2, 192
    s_cbranch_scc1 CT_24
    s_cmp_lt_u32 s3, 4
    s_cbranch_scc1 CT_24
    s_waitcnt lgkmcnt(0)
    s_mul_i32 s48, s48, 1664525
    s_add_u32 s48, s48, 1013904223
CT_24:
    s_cmp_eq_u32 s3, 15
    s_cbranch_scc1 F_E15
    s_barrier
    v_lshlrev_b32 v7, 4, v1
    s_and_b32 s37, s2, 7
    s_lshl_b32 s37, s37, 13
    s_add_u32 s37, s37, 6295552
    s_lshl_b32 s38, s44, 6
    s_add_u32 s38, s38, s37
    s_mov_b32 s36, s37
    s_add_u32 s37, s37, 4096
    s_mov_b64 exec, 1
    s_mov_b32 s49, 0
P_25:
    buffer_load_dwordx4 v[8:11], v7, s[40:43], s38 offen sc1
PC_27:
    s_add_u32 s49, s49, 1
    s_waitcnt vmcnt(0)
    v_cmp_ne_u32 vcc, s48, v11
    s_nop 0
    s_cbranch_vccz PD_26
    s_sleep 4
    s_cmp_lt_u32 s49, 60000
    s_cbranch_scc1 P_25
PD_26:
    s_mov_b64 exec, -1
    s_mov_b32 s49, 0
    buffer_load_dwordx4 v[8:11], v7, s[40:43], s36 offen offset:0 sc1
    buffer_load_dwordx4 v[12:15], v7, s[40:43], s36 offen offset:1024 sc1
    buffer_load_dwordx4 v[16:19], v7, s[40:43], s36 offen offset:2048 sc1
    buffer_load_dwordx4 v[20:23], v7, s[40:43], s36 offen offset:3072 sc1
    buffer_load_dwordx4 v[24:27], v7, s[40:43], s37 offen offset:0 sc1
    buffer_load_dwordx4 v[28:31], v7, s[40:43], s37 offen offset:1024 sc1
    buffer_load_dwordx4 v[32:35], v7, s[40:43], s37 offen offset:2048 sc1
    buffer_load_dwordx4 v[36:39], v7, s[40:43], s37 offen offset:3072 sc1
P_28:
    s_add_u32 s49, s49, 1
    s_waitcnt vmcnt(0)
    v_cmp_ne_u32 s[4:5], s48, v11
    v_cmp_ne_u32 s[6:7], s48, v15
    v_cmp_ne_u32 s[8:9], s48, v19
    v_cmp_ne_u32 s[10:11], s48, v23
    v_cmp_ne_u32 s[12:13], s48, v27
    v_cmp_ne_u32 s[14:15], s48, v31
    v_cmp_ne_u32 s[16:17], s48, v35
    v_cmp_ne_u32 s[18:19], s48, v39
    s_or_b64 s[50:51], s[4:5], s[6:7]
    s_or_b64 s[50:51], s[50:51], s[8:9]
    s_or_b64 s[50:51], s[50:51], s[10:11]
    s_or_b64 s[50:51], s[50:51], s[12:13]
    s_or_b64 s[50:51], s[50:51], s[14:15]
    s_or_b64 s[50:51], s[50:51], s[16:17]
    s_or_b64 s[50:51], s[50:51], s[18:19]
    s_cbranch_scc0 PD_29
    s_sleep 1
    s_wqm_b64 exec, s[4:5]
    s_cbranch_execz PS_30
    buffer_load_dwordx4 v[8:11], v7, s[40:43], s36 offen offset:0 sc1
PS_30:
    s_wqm_b64 exec, s[6:7]
    s_cbranch_execz PS_31
    buffer_load_dwordx4 v[12:15], v7, s[40:43], s36 offen offset:1024 sc1
PS_31:
    s_wqm_b64 exec, s[8:9]
    s_cbranch_execz PS_32
    buffer_load_dwordx4 v[16:19], v7, s[40:43], s36 offen offset:2048 sc1
PS_32:
    s_wqm_b64 exec, s[10:11]
    s_cbranch_execz PS_33
    buffer_load_dwordx4 v[20:23], v7, s[40:43], s36 offen offset:3072 sc1
PS_33:
    s_wqm_b64 exec, s[12:13]
    s_cbranch_execz PS_34
    buffer_load_dwordx4 v[24:27], v7, s[40:43], s37 offen offset:0 sc1
PS_34:
    s_wqm_b64 exec, s[14:15]
    s_cbranch_execz PS_35
    buffer_load_dwordx4 v[28:31], v7, s[40:43], s37 offen offset:1024 sc1
PS_35:
    s_wqm_b64 exec, s[16:17]
    s_cbranch_execz PS_36
    buffer_load_dwordx4 v[32:35], v7, s[40:43], s37 offen offset:2048 sc1
PS_36:
    s_wqm_b64 exec, s[18:19]
    s_cbranch_execz PS_37
    buffer_load_dwordx4 v[36:39], v7, s[40:43], s37 offen offset:3072 sc1
PS_37:
    s_mov_b64 exec, -1
    s_cmp_lt_u32 s49, 60000
    s_cbranch_scc1 P_28
    s_waitcnt vmcnt(0)
PD_29:
    s_cmp_le_u32 s49, 1
    s_cbranch_scc1 F_NS
    s_sleep 14
F_NS:
    s_barrier
    s_barrier
    s_barrier
    s_branch F_R
F_E15:
    s_mov_b32 s32, s28
    s_and_b32 s33, s29, 0xffff
    s_mov_b32 s34, 0x00240000
    s_mov_b32 s35, 0x00020000
    s_mul_i32 s56, s44, 43
    s_lshr_b32 s56, s56, 8
    s_min_u32 s56, s56, 7
    s_mul_i32 s57, s56, 6
    s_sub_u32 s57, s44, s57
    s_min_u32 s57, s57, 5
    s_lshl_b32 s57, s57, 4
    v_add_u32 v13, s57, v3
    v_mul_u32_u24 v12, 12, v13
    v_lshrrev_b32 v14, 1, v5
    v_lshl_add_u32 v12, v14, 1, v12
    v_add_u32 v25, 8, v12
    v_and_b32 v15, 1, v5
    v_lshl_add_u32 v12, v15, 2, v12
    v_lshlrev_b32 v13, 4, v13
    v_cmp_eq_u32 s[46:47], 1, v15
    v_mov_b32 v15, 1536
    v_lshlrev_b32 v14, 4, v14
    s_lshl_b32 s38, s56, 11
    s_add_u32 s38, s38, 6459392
    s_mul_i32 s57, s56, 1184
    v_add_u32 v26, s57, v12
    v_add_u32 v27, s57, v25
    v_lshlrev_b32 v11, 3, v1
    s_barrier
    s_barrier
    s_barrier
    s_cmp_ge_u32 s44, 48
    s_cbranch_scc1 END
    buffer_load_dwordx4 v[16:19], v13, s[40:43], s38 offen sc1
    buffer_load_dwordx4 v[20:23], v15, s[40:43], s38 offen sc1
    ds_read_u16 v26, v26 offset:3328
    ds_read_u16 v27, v27 offset:3328
    s_barrier
    s_mov_b32 s49, 0
    s_branch PC_40
P_38:
    buffer_load_dwordx4 v[16:19], v13, s[40:43], s38 offen sc1
    buffer_load_dwordx4 v[20:23], v15, s[40:43], s38 offen sc1
PC_40:
    s_add_u32 s49, s49, 1
    s_waitcnt vmcnt(0)
    v_cmp_ne_u32 vcc, s48, v19
    v_cmp_ne_u32 s[50:51], s48, v23
    s_nop 0
    s_or_b64 vcc, vcc, s[50:51]
    s_cbranch_vccz PD_39
    s_cmp_lt_u32 s49, 60000
    s_cbranch_scc1 P_38
PD_39:
    v_cndmask_b32 v16, v16, v17, s[46:47]
    v_lshrrev_b32 v16, v14, v16
    v_lshrrev_b32 v17, v14, v18
    v_lshlrev_b32 v16, 16, v16
    v_lshlrev_b32 v17, 16, v17
    v_readfirstlane_b32 s45, v20
    s_nop 0
    s_lshr_b32 s56, s45, 16
    s_xor_b32 s57, s56, 0x8000
    s_xor_b32 s58, s56, 0xffff
    s_bitcmp1_b32 s56, 15
    s_cselect_b32 s56, s57, s58
    s_lshl_b32 s56, s56, 16
    v_mov_b32 v18, 0xbfb8aa3b
    v_mul_f32 v18, s56, v18
    v_exp_f32 v18, v18
    s_andn2_b32 s45, 0x7ff, s45
    s_lshr_b32 s56, s45, 4
    s_lshl_b32 s56, s56, 3
    s_and_b32 s57, s45, 7
    s_or_b32 s56, s56, s57
    s_and_b32 s45, s45, 8
    s_lshl_b32 s45, s45, 7
    s_or_b32 s45, s45, s56
    s_mul_i32 s45, s45, 1152
    v_add_f32 v18, 1.0, v18
    v_rcp_f32 v18, v18
    s_waitcnt lgkmcnt(0)
    v_lshlrev_b32 v26, 16, v26
    v_lshlrev_b32 v27, 16, v27
    v_cvt_pk_bf16_f32 v18, v18, v18
    v_lshlrev_b32 v18, 16, v18
    s_setprio 3
    s_barrier
    s_barrier
    ds_read_b64 v[32:33], v11 offset:14080
    ds_read_b64 v[34:35], v11 offset:14592
    ds_read_b64 v[36:37], v11 offset:15104
    ds_read_b64 v[38:39], v11 offset:15616
    ds_read_b64 v[40:41], v11 offset:16128
    ds_read_b64 v[42:43], v11 offset:16640
    ds_read_b64 v[44:45], v11 offset:17152
    ds_read_b64 v[46:47], v11 offset:17664
    ds_read_b64 v[48:49], v11 offset:18176
    s_waitcnt lgkmcnt(7)
    v_pk_add_f32 v[32:33], v[32:33], v[34:35]
    s_waitcnt lgkmcnt(5)
    v_pk_add_f32 v[36:37], v[36:37], v[38:39]
    s_waitcnt lgkmcnt(3)
    v_pk_add_f32 v[40:41], v[40:41], v[42:43]
    s_waitcnt lgkmcnt(1)
    v_pk_add_f32 v[44:45], v[44:45], v[46:47]
    v_pk_add_f32 v[32:33], v[32:33], v[36:37]
    v_pk_add_f32 v[40:41], v[40:41], v[44:45]
    s_waitcnt lgkmcnt(0)
    v_pk_add_f32 v[32:33], v[32:33], v[48:49]
    v_pk_add_f32 v[32:33], v[32:33], v[40:41]
    v_cvt_pk_bf16_f32 v34, v32, v33
    v_lshlrev_b32 v32, 16, v34
    v_and_b32 v33, 0xffff0000, v34
    v_pk_mul_f32 v[32:33], v[32:33], v[18:19] op_sel_hi:[1,0]
    v_cvt_pk_bf16_f32 v34, v32, v33
    v_lshlrev_b32 v32, 16, v34
    v_and_b32 v33, 0xffff0000, v34
    v_pk_add_f32 v[32:33], v[32:33], v[26:27]
    v_cvt_pk_bf16_f32 v34, v32, v33
    v_lshlrev_b32 v32, 16, v34
    v_and_b32 v33, 0xffff0000, v34
    v_pk_add_f32 v[32:33], v[32:33], v[16:17]
    v_cvt_pk_bf16_f32 v32, v32, v33
    buffer_store_short v32, v12, s[32:35], s45 offen
    s_mov_b32 exec_lo, 0xffff
    s_mov_b32 exec_hi, 0xffff
    buffer_store_short_d16_hi v32, v25, s[32:35], s45 offen
    s_cmp_lg_u32 s44, 0
    s_cbranch_scc1 F_NE
    s_mov_b64 exec, 1
    v_mov_b32 v6, 0
    v_mov_b32 v7, s48
    buffer_store_dword v7, v6, s[40:43], 0 offen sc1
F_NE:
    s_mov_b64 exec, -1
    s_branch FIN
F_R:
    s_cmp_ge_u32 s44, 48
    s_cbranch_scc1 FIN
    s_min_u32 s45, s3, 8
    s_mul_i32 s39, s45, 98304
    s_lshl_b32 s38, s44, 8
    s_add_u32 s38, s38, s39
    s_add_u32 s38, s38, 6492160
    s_add_u32 s37, s38, 49152
    v_mul_u32_u24 v10, 12288, v5
    v_lshl_add_u32 v10, v3, 4, v10
    s_lshl_b32 s39, s45, 9
    v_lshl_add_u32 v11, v1, 3, s39
    s_barrier
    s_lshl_b32 s39, 1, s3
    s_and_b32 s39, s39, 0x7700
    s_cbranch_scc1 END
    s_sleep 7
    s_mov_b32 s49, 0
    buffer_load_dwordx4 v[32:35], v10, s[40:43], s38 offen sc1
    buffer_load_dwordx4 v[36:39], v10, s[40:43], s37 offen sc1
P_41:
    s_add_u32 s49, s49, 1
    s_waitcnt vmcnt(0)
    v_cmp_ne_u32 s[4:5], s48, v35
    v_cmp_ne_u32 s[6:7], s48, v39
    s_nop 0
    s_or_b64 s[50:51], s[4:5], s[6:7]
    s_cbranch_scc0 PD_42
    s_wqm_b64 exec, s[4:5]
    s_cbranch_execz PS_43
    buffer_load_dwordx4 v[32:35], v10, s[40:43], s38 offen sc1
PS_43:
    s_wqm_b64 exec, s[6:7]
    s_cbranch_execz PS_44
    buffer_load_dwordx4 v[36:39], v10, s[40:43], s37 offen sc1
PS_44:
    s_mov_b64 exec, -1
    s_cmp_lt_u32 s49, 60000
    s_cbranch_scc1 P_41
    s_waitcnt vmcnt(0)
PD_42:
    v_lshlrev_b32 v12, 16, v32
    v_and_b32 v13, 0xffff0000, v32
    v_lshlrev_b32 v14, 16, v33
    v_and_b32 v15, 0xffff0000, v33
    v_lshlrev_b32 v16, 16, v34
    v_and_b32 v17, 0xffff0000, v34
    v_lshlrev_b32 v18, 16, v36
    v_and_b32 v19, 0xffff0000, v36
    v_lshlrev_b32 v20, 16, v37
    v_and_b32 v21, 0xffff0000, v37
    v_lshlrev_b32 v22, 16, v38
    v_and_b32 v23, 0xffff0000, v38
    v_pk_add_f32 v[12:13], v[12:13], v[18:19]
    v_pk_add_f32 v[14:15], v[14:15], v[20:21]
    v_pk_add_f32 v[16:17], v[16:17], v[22:23]
    v_permlane32_swap_b32 v12, v13
    v_permlane32_swap_b32 v14, v15
    v_permlane32_swap_b32 v16, v17
    v_add_f32 v12, v12, v13
    v_add_f32 v14, v14, v15
    v_add_f32 v13, v16, v17
    v_add_f32 v15, v16, v17
    v_permlane16_swap_b32 v12, v14
    s_nop 0
    v_permlane16_swap_b32 v13, v15
    v_pk_add_f32 v[12:13], v[12:13], v[14:15]
    ds_write_b64 v11, v[12:13] offset:14080
    s_waitcnt lgkmcnt(0)
F_X:
    s_barrier
FIN:
END:
    s_endpgm
.section .rodata,"a"
.p2align 6
.amdhsa_kernel sequential_preLN__ssm_conv_s4d__moe_arch_mod__prompt_kernel
  .amdhsa_next_free_vgpr 128
  .amdhsa_next_free_sgpr 102
  .amdhsa_accum_offset 128
  .amdhsa_group_segment_fixed_size 0
  .amdhsa_kernarg_size 120
  .amdhsa_user_sgpr_count 2
  .amdhsa_user_sgpr_kernarg_segment_ptr 1
  .amdhsa_system_sgpr_workgroup_id_x 1
.end_amdhsa_kernel
.text
```
